```python
import torch

def _softmax(x, axis=-1):
    return torch.softmax(x, dim=axis)
def _gelu(x):
    return torch.nn.functional.gelu(x, approximate="tanh")
def _silu(x):
    return torch.nn.functional.silu(x)
def _sigmoid(x):
    return torch.sigmoid(x)
def _layernorm(x, axis=-1, eps=1e-5):
    m = x.mean(dim=axis, keepdim=True)
    v = x.var(dim=axis, keepdim=True, unbiased=False)
    return (x - m) / torch.sqrt(v + eps)
def _scatter_add(tgt, idx, src, axis=0):
    return tgt.clone().index_add_(axis, idx, src)
def _segment_sum(src, seg, n):
    out = torch.zeros((n,) + src.shape[1:], dtype=src.dtype)
    return out.index_add_(0, seg, src)
def _pad(x, pw):
    flat = tuple(v for pair in reversed(pw) for v in pair)
    return torch.nn.functional.pad(x, flat)

kernel_name = 'concat_heads__spectral_gfnet__compressed_kv_cla__prompt'

def setup_inputs():

    _w = (lambda a: (lambda t: t.to(torch.bfloat16) if t.is_floating_point() else t)(torch.as_tensor(a)))
    def _A_setup():
        B, S, D = 1, 2048, 448
        Df = D // 2 + 1
        return {
            "x": _w((lambda *s: torch.randn(*s, dtype=torch.bfloat16) * 0.05)(B, S, D)),
            "w_r": _w((lambda *s: torch.randn(*s, dtype=torch.bfloat16) * 0.05)(S, Df) * 0.02),
            "w_i": _w((lambda *s: torch.randn(*s, dtype=torch.bfloat16) * 0.05)(S, Df) * 0.02),
        }
    _A_in = _A_setup()

    def _B_setup():
        B, H, Sq, Sk, D, M = 1, 16, 2048, 2048, 256, 448
        Dc = 4 * D
        return {
            "x": _w((lambda *s: torch.randn(*s, dtype=torch.bfloat16) * 3.2)(B, Sq, M)),
            "c_kv": _w((lambda *s: torch.randn(*s, dtype=torch.bfloat16) * 0.05)(B, Sk, Dc)),
            "w_q": _w((lambda *s: torch.randn(*s, dtype=torch.bfloat16) * 3.2)(M, H, D) * (M ** -0.5)),
            "w_uk": _w((lambda *s: torch.randn(*s, dtype=torch.bfloat16) * 3.2)(Dc, H, D) * (Dc ** -0.5)),
            "w_uv": _w((lambda *s: torch.randn(*s, dtype=torch.bfloat16) * 0.05)(Dc, H, D) * (Dc ** -0.5)),
            "w_o": _w((lambda *s: torch.randn(*s, dtype=torch.bfloat16) * 0.05)(H, D, M) * ((H * D) ** -0.5)),
        }
    _B_in = _B_setup()

    return {
        "A_x": _A_in["x"],
        "A_w_r": _A_in["w_r"],
        "A_w_i": _A_in["w_i"],
        "B_x": _B_in["x"],
        "B_c_kv": _B_in["c_kv"],
        "B_w_q": _B_in["w_q"],
        "B_w_uk": _B_in["w_uk"],
        "B_w_uv": _B_in["w_uv"],
        "B_w_o": _B_in["w_o"],
    }

def reference(A_x, A_w_r, A_w_i, B_x, B_c_kv, B_w_q, B_w_uk, B_w_uv, B_w_o):
    def _A_ref(x, w_r, w_i):
        B, S, D = x.shape
        X = (lambda x, axes=(-2,-1): torch.fft.rfft2(x.float(), dim=axes))(x, axes=(-2, -1))
        W = w_r + 1j * w_i
        X = X * W
        y = (lambda x, s, axes=(-2,-1): torch.fft.irfft2(x, s=s, dim=axes).to(torch.bfloat16))(X, (S, D), axes=(-2, -1))
        return y

    def _B_ref(x, c_kv, w_q, w_uk, w_uv, w_o):
        B, Sq, M = x.shape[0], x.shape[1], x.shape[2]
        Sk = c_kv.shape[1]
        H, D = w_q.shape[1], w_q.shape[2]
        q = torch.einsum("bqm,mhd->bhqd", x, w_q)
        k = torch.einsum("bkc,chd->bhkd", c_kv, w_uk)
        v = torch.einsum("bkc,chd->bhkd", c_kv, w_uv)
        scores = torch.einsum("bhqd,bhkd->bhqk", q, k) * (D ** -0.5)
        off = Sk - Sq
        qi = torch.arange(Sq)[:, None]
        kj = torch.arange(Sk)[None, :]
        cmask = kj <= (qi + off)
        scores = torch.where(cmask[None, None], scores, -1e9)
        p = _softmax(scores, axis=-1)
        ctx = torch.einsum("bhqk,bhkd->bhqd", p, v)
        return torch.einsum("bhqd,hdm->bqm", ctx, w_o)

    a = _A_ref(A_x, A_w_r, A_w_i)
    b = _B_ref(B_x, B_c_kv, B_w_q, B_w_uk, B_w_uv, B_w_o)
    return torch.concatenate([a, b], axis=-1)
```

```asm
; @launch grid=(256,1,1) block=(256,1,1) lds=163840
.amdgcn_target "amdgcn-amd-amdhsa--gfx950"
.text
.macro M d, a, b, c
v_mfma_f32_16x16x32_bf16 \d, \a, \b, \c
.endm
.macro CV d, a, b
v_cvt_pk_bf16_f32 \d, \a, \b
.endm
.macro DR d, a, o
ds_read_b128 \d, \a offset:\o
.endm
.macro DT d, a, o
ds_read_b64_tr_b16 \d, \a offset:\o
.endm
.globl concat_heads__spectral_gfnet__compressed_kv_cla__prompt_kernel
.p2align 8
.type concat_heads__spectral_gfnet__compressed_kv_cla__prompt_kernel,@function
concat_heads__spectral_gfnet__compressed_kv_cla__prompt_kernel:
L_code_begin:
s_cmp_ge_u32 s2,256
s_cbranch_scc1 L_f_end
s_load_dwordx4 s[72:75],s[0:1],24
s_load_dwordx4 s[76:79],s[0:1],40
s_load_dwordx2 s[70:71],s[0:1],56
s_load_dwordx2 s[20:21],s[0:1],0
s_load_dwordx4 s[80:83],s[0:1],80
s_load_dwordx2 s[12:13],s[0:1],8
s_load_dwordx2 s[16:17],s[0:1],16
s_bitcmp1_b32 s2,4
s_cselect_b32 s3,64,40
s_load_dwordx2 s[96:97],s[0:1],s3
v_lshrrev_b32 v12,6,v0
v_and_b32 v10,63,v0
v_readfirstlane_b32 s42,v12
s_getpc_b64 s[94:95]
L_here:
s_sub_u32 s94,s94,L_here-L_code_begin
s_subb_u32 s95,s95,0
s_lshr_b32 s46,s2,3
s_lshl_b32 s46,s46,2
s_add_u32 s46,s46,s42
s_mul_i32 s47,s46,8
v_min_u32 v13,7,v10
v_add_u32 v13,s47,v13
v_lshlrev_b32 v13,7,v13
v_min_u32 v13,L_code_end-L_code_begin,v13
global_load_dword a238,v13,s[94:95]
s_lshl_b32 s51,s46,15
s_lshr_b32 s44,s2,4
s_lshr_b32 s45,s44,1
s_bfe_u32 s47,s2,0x10003
s_and_b32 s43,s2,7
s_lshl_b32 s43,s43,1
s_add_u32 s43,s43,s47
s_lshl_b32 s46,s45,1
s_add_u32 s46,s46,s47
s_lshl_b32 s46,s46,2
s_add_u32 s46,s46,s42
s_lshl_b32 s52,s46,14
v_mov_b32 v14,0x7ff00000
v_lshlrev_b32 v4,4,v10
v_lshrrev_b32 v13,3,v10
v_and_b32 v12,7,v10
v_lshlrev_b32 v12,7,v12
v_cmp_gt_u32 vcc,16,v10
v_lshl_add_u32 v15,v13,13,v12
v_lshrrev_b32 v13,1,v10
v_cndmask_b32 v15,v14,v15,vcc
v_and_b32 v12,1,v10
v_cmp_gt_u32 vcc,32,v10
v_lshlrev_b32 v12,7,v12
v_lshl_add_u32 v13,v13,11,v12
v_cndmask_b32 v0,v14,v13,vcc
s_and_b32 s3,s2,7
s_lshl_b32 s46,s45,3
s_or_b32 s3,s3,s46
s_bfe_u32 s46,s2,0x20003
s_lshl_b32 s46,s46,2
s_add_u32 s46,s46,s42
s_lshl_b32 s46,s46,7
s_add_u32 s46,s46,s3
s_mul_i32 s54,s46,896
v_cmp_lt_u32 vcc,6,v10
v_lshlrev_b32 v12,7,v10
v_add_u32 v13,56448,v12
v_cndmask_b32 v12,v12,v13,vcc
v_cmp_gt_u32 vcc,14,v10
s_and_b32 s46,s2,7
s_lshl_b32 s46,s46,10
v_cndmask_b32 v12,v14,v12,vcc
s_waitcnt lgkmcnt(0)
s_bitcmp1_b32 s44,0
s_cselect_b32 s78,s70,s78
s_cselect_b32 s79,s71,s79
s_add_u32 s88,s78,s46
s_addc_u32 s89,s79,0
s_sub_u32 s90,8388608,s46
s_mov_b32 s91,0x20000
s_mov_b32 s84,s74
s_mov_b32 s85,s75
s_mov_b32 s86,4194304
s_mov_b32 s87,0x20000
s_mov_b32 s22,1835008
s_mov_b32 s23,0x20000
buffer_load_dword a238,v12,s[20:23],s54 offen
buffer_load_dword a238,v15,s[88:91],s52 offen
s_add_u32 s52,s52,1048576
buffer_load_dword a238,v0,s[84:87],s51 offen
s_add_u32 s51,s51,256
s_lshr_b32 s46,s42,1
s_lshl_b32 s46,s46,2
s_and_b32 s47,s42,1
s_add_u32 s46,s46,s47
s_lshl_b32 s46,s46,1
v_and_b32 v13,48,v10
v_bfe_u32 v12,v10,3,1
v_add3_u32 v13,v13,v12,s46
v_and_b32 v12,7,v10
v_lshlrev_b32 v12,4,v12
v_lshl_add_u32 v3,v13,11,v12
s_lshr_b32 s46,s42,1
s_lshl_b32 s46,s46,3
s_lshl_b32 s47,s47,1
s_add_u32 s46,s46,s47
v_lshrrev_b32 v13,5,v10
v_lshlrev_b32 v13,2,v13
v_add_u32 v13,s46,v13
v_and_b32 v12,31,v10
v_lshlrev_b32 v12,4,v12
v_lshl_add_u32 v5,v13,13,v12
s_mov_b32 s28,0
s_mov_b32 s56,0
s_mov_b32 s29,130048
s_mov_b32 s57,130048
s_mov_b32 s30,260096
s_mov_b32 s58,260096
s_mov_b32 s31,390144
s_mov_b32 s59,390144
s_mov_b32 s32,8192
s_mov_b32 s60,8192
s_mov_b32 s33,138240
s_mov_b32 s61,138240
s_mov_b32 s34,268288
s_mov_b32 s62,268288
s_mov_b32 s35,398336
s_mov_b32 s63,398336
s_mul_i32 s46,s42,8224
s_add_u32 s36,s46,0
s_add_u32 s37,s46,4096
s_add_u32 s38,s46,33152
s_add_u32 s39,s46,37248
s_mul_i32 s46,s42,8256
s_add_u32 s68,s46,66304
s_add_u32 s69,s46,70432
s_add_u32 s70,s46,99456
s_add_u32 s71,s46,103584
s_add_u32 s41,s46,33152
s_mul_i32 s40,s42,4128
s_lshl_b32 s46,s45,19
s_add_u32 s4,s74,s46
s_addc_u32 s5,s75,0
s_sub_u32 s6,4194304,s46
s_mov_b32 s7,0x20000
s_lshl_b32 s46,s43,9
s_add_u32 s8,s78,s46
s_addc_u32 s9,s79,0
s_sub_u32 s10,8388608,s46
s_mov_b32 s11,0x20000
v_bfe_u32 v13,v10,3,1
v_lshlrev_b32 v13,2,v13
v_bfe_u32 v12,v10,1,1
v_lshl_or_b32 v13,v12,1,v13
v_bfe_u32 v12,v10,2,1
v_or_b32 v13,v13,v12
v_lshrrev_b32 v12,1,v13
v_lshlrev_b32 v12,5,v12
v_and_b32 v7,1,v10
v_lshl_add_u32 v12,v7,7,v12
v_lshrrev_b32 v7,4,v10
v_lshl_add_u32 v12,v7,4,v12
v_add_u32 v12,132608,v12
v_lshl_add_u32 v6,v13,10,v12
v_lshl_add_u32 v7,v13,9,v12
v_lshl_add_u32 v1,v13,12,v12
s_bfe_u32 s46,s2,0x20003
s_lshl_b32 s47,s46,3
s_lshl_b32 s54,s42,1
s_add_u32 s47,s47,s54
s_add_u32 s54,s42,24
s_cmp_eq_u32 s46,3
s_cselect_b32 s47,s54,s47
s_add_u32 s54,s47,1
s_cmp_eq_u32 s46,3
s_cselect_b32 s54,31,s54
s_lshl_b32 s47,s47,4
s_lshl_b32 s54,s54,4
s_lshl_b32 s46,s3,7
v_and_b32 v12,15,v10
v_add_u32 v12,s47,v12
v_lshrrev_b32 v13,4,v10
v_lshlrev_b32 v13,4,v13
v_and_b32 v8,1,v12
v_lshl_add_u32 v8,v8,6,v13
v_lshrrev_b32 v128,1,v12
v_lshl_add_u32 v8,v128,13,v8
v_add_u32 v8,s46,v8
v_subrev_u32 v128,224,v12
v_cmp_lt_u32 vcc,224,v12
v_mov_b32 v130,0
v_mov_b32 v131,0x3e800000
v_cndmask_b32 v128,v12,v128,vcc
v_cndmask_b32 v130,v130,v131,vcc
v_cvt_f32_u32 v128,v128
v_mul_f32 v128,0x3b124925,v128
v_lshrrev_b32 v13,1,v13
v_cvt_f32_u32 v13,v13
v_fma_f32 v129,v13,v128,v130
v_mul_f32 v132,0x42000000,v128
v_cos_f32 v132,v132
s_nop 0
v_add_f32 v132,v132,v132
v_mov_b32 v133,v132
v_fmamk_f32 v136,v128,0x00000000,v129
v_fmamk_f32 v137,v128,0x3f800000,v129
v_fmamk_f32 v138,v128,0x40000000,v129
v_fmamk_f32 v139,v128,0x40400000,v129
v_fmamk_f32 v140,v128,0x40800000,v129
v_fmamk_f32 v141,v128,0x40a00000,v129
v_fmamk_f32 v142,v128,0x40c00000,v129
v_fmamk_f32 v143,v128,0x40e00000,v129
v_cos_f32 v136,v136
v_cos_f32 v137,v137
v_cos_f32 v138,v138
v_cos_f32 v139,v139
v_cos_f32 v140,v140
v_cos_f32 v141,v141
v_cos_f32 v142,v142
v_cos_f32 v143,v143
v_fmamk_f32 v144,v128,0x42000000,v129
v_fmamk_f32 v145,v128,0x42040000,v129
v_fmamk_f32 v146,v128,0x42080000,v129
v_fmamk_f32 v147,v128,0x420c0000,v129
v_fmamk_f32 v148,v128,0x42100000,v129
v_fmamk_f32 v149,v128,0x42140000,v129
v_fmamk_f32 v150,v128,0x42180000,v129
v_fmamk_f32 v151,v128,0x421c0000,v129
v_cos_f32 v144,v144
v_cos_f32 v145,v145
v_cos_f32 v146,v146
v_cos_f32 v147,v147
v_cos_f32 v148,v148
v_cos_f32 v149,v149
v_cos_f32 v150,v150
v_cos_f32 v151,v151
CV v16,v136,v137
CV v17,v138,v139
CV v18,v140,v141
CV v19,v142,v143
CV v20,v144,v145
CV v21,v146,v147
CV v22,v148,v149
CV v23,v150,v151
v_pk_fma_f32 v[136:137],v[132:133],v[144:145],v[136:137] neg_lo:[0,0,1] neg_hi:[0,0,1]
v_pk_fma_f32 v[138:139],v[132:133],v[146:147],v[138:139] neg_lo:[0,0,1] neg_hi:[0,0,1]
v_pk_fma_f32 v[140:141],v[132:133],v[148:149],v[140:141] neg_lo:[0,0,1] neg_hi:[0,0,1]
v_pk_fma_f32 v[142:143],v[132:133],v[150:151],v[142:143] neg_lo:[0,0,1] neg_hi:[0,0,1]
CV v24,v136,v137
CV v25,v138,v139
CV v26,v140,v141
CV v27,v142,v143
v_pk_fma_f32 v[144:145],v[132:133],v[136:137],v[144:145] neg_lo:[0,0,1] neg_hi:[0,0,1]
v_pk_fma_f32 v[146:147],v[132:133],v[138:139],v[146:147] neg_lo:[0,0,1] neg_hi:[0,0,1]
v_pk_fma_f32 v[148:149],v[132:133],v[140:141],v[148:149] neg_lo:[0,0,1] neg_hi:[0,0,1]
v_pk_fma_f32 v[150:151],v[132:133],v[142:143],v[150:151] neg_lo:[0,0,1] neg_hi:[0,0,1]
CV v28,v144,v145
CV v29,v146,v147
CV v30,v148,v149
CV v31,v150,v151
v_pk_fma_f32 v[136:137],v[132:133],v[144:145],v[136:137] neg_lo:[0,0,1] neg_hi:[0,0,1]
v_pk_fma_f32 v[138:139],v[132:133],v[146:147],v[138:139] neg_lo:[0,0,1] neg_hi:[0,0,1]
v_pk_fma_f32 v[140:141],v[132:133],v[148:149],v[140:141] neg_lo:[0,0,1] neg_hi:[0,0,1]
v_pk_fma_f32 v[142:143],v[132:133],v[150:151],v[142:143] neg_lo:[0,0,1] neg_hi:[0,0,1]
CV v32,v136,v137
CV v33,v138,v139
CV v34,v140,v141
CV v35,v142,v143
v_pk_fma_f32 v[144:145],v[132:133],v[136:137],v[144:145] neg_lo:[0,0,1] neg_hi:[0,0,1]
v_pk_fma_f32 v[146:147],v[132:133],v[138:139],v[146:147] neg_lo:[0,0,1] neg_hi:[0,0,1]
v_pk_fma_f32 v[148:149],v[132:133],v[140:141],v[148:149] neg_lo:[0,0,1] neg_hi:[0,0,1]
v_pk_fma_f32 v[150:151],v[132:133],v[142:143],v[150:151] neg_lo:[0,0,1] neg_hi:[0,0,1]
CV v36,v144,v145
CV v37,v146,v147
CV v38,v148,v149
CV v39,v150,v151
v_pk_fma_f32 v[136:137],v[132:133],v[144:145],v[136:137] neg_lo:[0,0,1] neg_hi:[0,0,1]
v_pk_fma_f32 v[138:139],v[132:133],v[146:147],v[138:139] neg_lo:[0,0,1] neg_hi:[0,0,1]
v_pk_fma_f32 v[140:141],v[132:133],v[148:149],v[140:141] neg_lo:[0,0,1] neg_hi:[0,0,1]
v_pk_fma_f32 v[142:143],v[132:133],v[150:151],v[142:143] neg_lo:[0,0,1] neg_hi:[0,0,1]
CV v40,v136,v137
CV v41,v138,v139
CV v42,v140,v141
CV v43,v142,v143
v_pk_fma_f32 v[144:145],v[132:133],v[136:137],v[144:145] neg_lo:[0,0,1] neg_hi:[0,0,1]
v_pk_fma_f32 v[146:147],v[132:133],v[138:139],v[146:147] neg_lo:[0,0,1] neg_hi:[0,0,1]
v_pk_fma_f32 v[148:149],v[132:133],v[140:141],v[148:149] neg_lo:[0,0,1] neg_hi:[0,0,1]
v_pk_fma_f32 v[150:151],v[132:133],v[142:143],v[150:151] neg_lo:[0,0,1] neg_hi:[0,0,1]
CV v44,v144,v145
CV v45,v146,v147
CV v46,v148,v149
CV v47,v150,v151
v_pk_fma_f32 v[136:137],v[132:133],v[144:145],v[136:137] neg_lo:[0,0,1] neg_hi:[0,0,1]
v_pk_fma_f32 v[138:139],v[132:133],v[146:147],v[138:139] neg_lo:[0,0,1] neg_hi:[0,0,1]
v_pk_fma_f32 v[140:141],v[132:133],v[148:149],v[140:141] neg_lo:[0,0,1] neg_hi:[0,0,1]
v_pk_fma_f32 v[142:143],v[132:133],v[150:151],v[142:143] neg_lo:[0,0,1] neg_hi:[0,0,1]
CV v48,v136,v137
CV v49,v138,v139
CV v50,v140,v141
CV v51,v142,v143
v_pk_fma_f32 v[144:145],v[132:133],v[136:137],v[144:145] neg_lo:[0,0,1] neg_hi:[0,0,1]
v_pk_fma_f32 v[146:147],v[132:133],v[138:139],v[146:147] neg_lo:[0,0,1] neg_hi:[0,0,1]
v_pk_fma_f32 v[148:149],v[132:133],v[140:141],v[148:149] neg_lo:[0,0,1] neg_hi:[0,0,1]
v_pk_fma_f32 v[150:151],v[132:133],v[142:143],v[150:151] neg_lo:[0,0,1] neg_hi:[0,0,1]
CV v52,v144,v145
CV v53,v146,v147
CV v54,v148,v149
CV v55,v150,v151
v_pk_fma_f32 v[136:137],v[132:133],v[144:145],v[136:137] neg_lo:[0,0,1] neg_hi:[0,0,1]
v_pk_fma_f32 v[138:139],v[132:133],v[146:147],v[138:139] neg_lo:[0,0,1] neg_hi:[0,0,1]
v_pk_fma_f32 v[140:141],v[132:133],v[148:149],v[140:141] neg_lo:[0,0,1] neg_hi:[0,0,1]
v_pk_fma_f32 v[142:143],v[132:133],v[150:151],v[142:143] neg_lo:[0,0,1] neg_hi:[0,0,1]
CV v56,v136,v137
CV v57,v138,v139
CV v58,v140,v141
CV v59,v142,v143
v_pk_fma_f32 v[144:145],v[132:133],v[136:137],v[144:145] neg_lo:[0,0,1] neg_hi:[0,0,1]
v_pk_fma_f32 v[146:147],v[132:133],v[138:139],v[146:147] neg_lo:[0,0,1] neg_hi:[0,0,1]
v_pk_fma_f32 v[148:149],v[132:133],v[140:141],v[148:149] neg_lo:[0,0,1] neg_hi:[0,0,1]
v_pk_fma_f32 v[150:151],v[132:133],v[142:143],v[150:151] neg_lo:[0,0,1] neg_hi:[0,0,1]
CV v60,v144,v145
CV v61,v146,v147
CV v62,v148,v149
CV v63,v150,v151
v_pk_fma_f32 v[136:137],v[132:133],v[144:145],v[136:137] neg_lo:[0,0,1] neg_hi:[0,0,1]
v_pk_fma_f32 v[138:139],v[132:133],v[146:147],v[138:139] neg_lo:[0,0,1] neg_hi:[0,0,1]
v_pk_fma_f32 v[140:141],v[132:133],v[148:149],v[140:141] neg_lo:[0,0,1] neg_hi:[0,0,1]
v_pk_fma_f32 v[142:143],v[132:133],v[150:151],v[142:143] neg_lo:[0,0,1] neg_hi:[0,0,1]
CV v64,v136,v137
CV v65,v138,v139
CV v66,v140,v141
CV v67,v142,v143
v_pk_fma_f32 v[144:145],v[132:133],v[136:137],v[144:145] neg_lo:[0,0,1] neg_hi:[0,0,1]
v_pk_fma_f32 v[146:147],v[132:133],v[138:139],v[146:147] neg_lo:[0,0,1] neg_hi:[0,0,1]
v_pk_fma_f32 v[148:149],v[132:133],v[140:141],v[148:149] neg_lo:[0,0,1] neg_hi:[0,0,1]
v_pk_fma_f32 v[150:151],v[132:133],v[142:143],v[150:151] neg_lo:[0,0,1] neg_hi:[0,0,1]
CV v68,v144,v145
CV v69,v146,v147
CV v70,v148,v149
CV v71,v150,v151
v_and_b32 v12,15,v10
v_add_u32 v12,s54,v12
v_lshrrev_b32 v13,4,v10
v_lshlrev_b32 v13,4,v13
v_and_b32 v9,1,v12
v_lshl_add_u32 v9,v9,6,v13
v_lshrrev_b32 v128,1,v12
v_lshl_add_u32 v9,v128,13,v9
v_add_u32 v9,s46,v9
v_subrev_u32 v128,224,v12
v_cmp_lt_u32 vcc,224,v12
v_mov_b32 v130,0
v_mov_b32 v131,0x3e800000
v_cndmask_b32 v128,v12,v128,vcc
v_cndmask_b32 v130,v130,v131,vcc
v_cvt_f32_u32 v128,v128
v_mul_f32 v128,0x3b124925,v128
v_lshrrev_b32 v13,1,v13
v_cvt_f32_u32 v13,v13
v_fma_f32 v129,v13,v128,v130
v_mul_f32 v132,0x42000000,v128
v_cos_f32 v132,v132
s_nop 0
v_add_f32 v132,v132,v132
v_mov_b32 v133,v132
v_fmamk_f32 v136,v128,0x00000000,v129
v_fmamk_f32 v137,v128,0x3f800000,v129
v_fmamk_f32 v138,v128,0x40000000,v129
v_fmamk_f32 v139,v128,0x40400000,v129
v_fmamk_f32 v140,v128,0x40800000,v129
v_fmamk_f32 v141,v128,0x40a00000,v129
v_fmamk_f32 v142,v128,0x40c00000,v129
v_fmamk_f32 v143,v128,0x40e00000,v129
v_cos_f32 v136,v136
v_cos_f32 v137,v137
v_cos_f32 v138,v138
v_cos_f32 v139,v139
v_cos_f32 v140,v140
v_cos_f32 v141,v141
v_cos_f32 v142,v142
v_cos_f32 v143,v143
v_fmamk_f32 v144,v128,0x42000000,v129
v_fmamk_f32 v145,v128,0x42040000,v129
v_fmamk_f32 v146,v128,0x42080000,v129
v_fmamk_f32 v147,v128,0x420c0000,v129
v_fmamk_f32 v148,v128,0x42100000,v129
v_fmamk_f32 v149,v128,0x42140000,v129
v_fmamk_f32 v150,v128,0x42180000,v129
v_fmamk_f32 v151,v128,0x421c0000,v129
v_cos_f32 v144,v144
v_cos_f32 v145,v145
v_cos_f32 v146,v146
v_cos_f32 v147,v147
v_cos_f32 v148,v148
v_cos_f32 v149,v149
v_cos_f32 v150,v150
v_cos_f32 v151,v151
CV v72,v136,v137
CV v73,v138,v139
CV v74,v140,v141
CV v75,v142,v143
CV v76,v144,v145
CV v77,v146,v147
CV v78,v148,v149
CV v79,v150,v151
v_pk_fma_f32 v[136:137],v[132:133],v[144:145],v[136:137] neg_lo:[0,0,1] neg_hi:[0,0,1]
v_pk_fma_f32 v[138:139],v[132:133],v[146:147],v[138:139] neg_lo:[0,0,1] neg_hi:[0,0,1]
v_pk_fma_f32 v[140:141],v[132:133],v[148:149],v[140:141] neg_lo:[0,0,1] neg_hi:[0,0,1]
v_pk_fma_f32 v[142:143],v[132:133],v[150:151],v[142:143] neg_lo:[0,0,1] neg_hi:[0,0,1]
CV v80,v136,v137
CV v81,v138,v139
CV v82,v140,v141
CV v83,v142,v143
v_pk_fma_f32 v[144:145],v[132:133],v[136:137],v[144:145] neg_lo:[0,0,1] neg_hi:[0,0,1]
v_pk_fma_f32 v[146:147],v[132:133],v[138:139],v[146:147] neg_lo:[0,0,1] neg_hi:[0,0,1]
v_pk_fma_f32 v[148:149],v[132:133],v[140:141],v[148:149] neg_lo:[0,0,1] neg_hi:[0,0,1]
v_pk_fma_f32 v[150:151],v[132:133],v[142:143],v[150:151] neg_lo:[0,0,1] neg_hi:[0,0,1]
CV v84,v144,v145
CV v85,v146,v147
CV v86,v148,v149
CV v87,v150,v151
v_pk_fma_f32 v[136:137],v[132:133],v[144:145],v[136:137] neg_lo:[0,0,1] neg_hi:[0,0,1]
v_pk_fma_f32 v[138:139],v[132:133],v[146:147],v[138:139] neg_lo:[0,0,1] neg_hi:[0,0,1]
v_pk_fma_f32 v[140:141],v[132:133],v[148:149],v[140:141] neg_lo:[0,0,1] neg_hi:[0,0,1]
v_pk_fma_f32 v[142:143],v[132:133],v[150:151],v[142:143] neg_lo:[0,0,1] neg_hi:[0,0,1]
CV v88,v136,v137
CV v89,v138,v139
CV v90,v140,v141
CV v91,v142,v143
v_pk_fma_f32 v[144:145],v[132:133],v[136:137],v[144:145] neg_lo:[0,0,1] neg_hi:[0,0,1]
v_pk_fma_f32 v[146:147],v[132:133],v[138:139],v[146:147] neg_lo:[0,0,1] neg_hi:[0,0,1]
v_pk_fma_f32 v[148:149],v[132:133],v[140:141],v[148:149] neg_lo:[0,0,1] neg_hi:[0,0,1]
v_pk_fma_f32 v[150:151],v[132:133],v[142:143],v[150:151] neg_lo:[0,0,1] neg_hi:[0,0,1]
CV v92,v144,v145
CV v93,v146,v147
CV v94,v148,v149
CV v95,v150,v151
v_pk_fma_f32 v[136:137],v[132:133],v[144:145],v[136:137] neg_lo:[0,0,1] neg_hi:[0,0,1]
v_pk_fma_f32 v[138:139],v[132:133],v[146:147],v[138:139] neg_lo:[0,0,1] neg_hi:[0,0,1]
v_pk_fma_f32 v[140:141],v[132:133],v[148:149],v[140:141] neg_lo:[0,0,1] neg_hi:[0,0,1]
v_pk_fma_f32 v[142:143],v[132:133],v[150:151],v[142:143] neg_lo:[0,0,1] neg_hi:[0,0,1]
CV v96,v136,v137
CV v97,v138,v139
CV v98,v140,v141
CV v99,v142,v143
v_pk_fma_f32 v[144:145],v[132:133],v[136:137],v[144:145] neg_lo:[0,0,1] neg_hi:[0,0,1]
v_pk_fma_f32 v[146:147],v[132:133],v[138:139],v[146:147] neg_lo:[0,0,1] neg_hi:[0,0,1]
v_pk_fma_f32 v[148:149],v[132:133],v[140:141],v[148:149] neg_lo:[0,0,1] neg_hi:[0,0,1]
v_pk_fma_f32 v[150:151],v[132:133],v[142:143],v[150:151] neg_lo:[0,0,1] neg_hi:[0,0,1]
CV v100,v144,v145
CV v101,v146,v147
CV v102,v148,v149
CV v103,v150,v151
v_pk_fma_f32 v[136:137],v[132:133],v[144:145],v[136:137] neg_lo:[0,0,1] neg_hi:[0,0,1]
v_pk_fma_f32 v[138:139],v[132:133],v[146:147],v[138:139] neg_lo:[0,0,1] neg_hi:[0,0,1]
v_pk_fma_f32 v[140:141],v[132:133],v[148:149],v[140:141] neg_lo:[0,0,1] neg_hi:[0,0,1]
v_pk_fma_f32 v[142:143],v[132:133],v[150:151],v[142:143] neg_lo:[0,0,1] neg_hi:[0,0,1]
CV v104,v136,v137
CV v105,v138,v139
CV v106,v140,v141
CV v107,v142,v143
v_pk_fma_f32 v[144:145],v[132:133],v[136:137],v[144:145] neg_lo:[0,0,1] neg_hi:[0,0,1]
v_pk_fma_f32 v[146:147],v[132:133],v[138:139],v[146:147] neg_lo:[0,0,1] neg_hi:[0,0,1]
v_pk_fma_f32 v[148:149],v[132:133],v[140:141],v[148:149] neg_lo:[0,0,1] neg_hi:[0,0,1]
v_pk_fma_f32 v[150:151],v[132:133],v[142:143],v[150:151] neg_lo:[0,0,1] neg_hi:[0,0,1]
CV v108,v144,v145
CV v109,v146,v147
CV v110,v148,v149
CV v111,v150,v151
v_pk_fma_f32 v[136:137],v[132:133],v[144:145],v[136:137] neg_lo:[0,0,1] neg_hi:[0,0,1]
v_pk_fma_f32 v[138:139],v[132:133],v[146:147],v[138:139] neg_lo:[0,0,1] neg_hi:[0,0,1]
v_pk_fma_f32 v[140:141],v[132:133],v[148:149],v[140:141] neg_lo:[0,0,1] neg_hi:[0,0,1]
v_pk_fma_f32 v[142:143],v[132:133],v[150:151],v[142:143] neg_lo:[0,0,1] neg_hi:[0,0,1]
CV v112,v136,v137
CV v113,v138,v139
CV v114,v140,v141
CV v115,v142,v143
v_pk_fma_f32 v[144:145],v[132:133],v[136:137],v[144:145] neg_lo:[0,0,1] neg_hi:[0,0,1]
v_pk_fma_f32 v[146:147],v[132:133],v[138:139],v[146:147] neg_lo:[0,0,1] neg_hi:[0,0,1]
v_pk_fma_f32 v[148:149],v[132:133],v[140:141],v[148:149] neg_lo:[0,0,1] neg_hi:[0,0,1]
v_pk_fma_f32 v[150:151],v[132:133],v[142:143],v[150:151] neg_lo:[0,0,1] neg_hi:[0,0,1]
CV v116,v144,v145
CV v117,v146,v147
CV v118,v148,v149
CV v119,v150,v151
v_pk_fma_f32 v[136:137],v[132:133],v[144:145],v[136:137] neg_lo:[0,0,1] neg_hi:[0,0,1]
v_pk_fma_f32 v[138:139],v[132:133],v[146:147],v[138:139] neg_lo:[0,0,1] neg_hi:[0,0,1]
v_pk_fma_f32 v[140:141],v[132:133],v[148:149],v[140:141] neg_lo:[0,0,1] neg_hi:[0,0,1]
v_pk_fma_f32 v[142:143],v[132:133],v[150:151],v[142:143] neg_lo:[0,0,1] neg_hi:[0,0,1]
CV v120,v136,v137
CV v121,v138,v139
CV v122,v140,v141
CV v123,v142,v143
v_pk_fma_f32 v[144:145],v[132:133],v[136:137],v[144:145] neg_lo:[0,0,1] neg_hi:[0,0,1]
v_pk_fma_f32 v[146:147],v[132:133],v[138:139],v[146:147] neg_lo:[0,0,1] neg_hi:[0,0,1]
v_pk_fma_f32 v[148:149],v[132:133],v[140:141],v[148:149] neg_lo:[0,0,1] neg_hi:[0,0,1]
v_pk_fma_f32 v[150:151],v[132:133],v[142:143],v[150:151] neg_lo:[0,0,1] neg_hi:[0,0,1]
CV v124,v144,v145
CV v125,v146,v147
CV v126,v148,v149
CV v127,v150,v151
v_bfe_u32 v13,v10,2,3
v_mul_u32_u24 v13,4128,v13
v_lshrrev_b32 v12,5,v10
v_lshl_add_u32 v13,v12,10,v13
s_and_b32 s46,s42,1
s_lshl_b32 s46,s46,8
s_add_u32 s46,s46,66304
v_and_b32 v12,3,v10
v_lshl_add_u32 v13,v12,3,v13
v_add_u32 v2,s46,v13
s_lshr_b32 s46,s42,1
s_lshl_b32 s46,s46,11
s_sub_u32 s46,s46,132608
v_add_u32 v1,s46,v1
s_lshr_b32 s46,s42,1
s_lshl_b32 s46,s46,2
s_and_b32 s47,s42,1
s_add_u32 s46,s46,s47
s_lshl_b32 s46,s46,1
v_and_b32 v12,16,v10
v_bfe_u32 v13,v10,3,1
v_add3_u32 v12,v12,v13,s46
v_lshlrev_b32 v12,6,v12
v_add_u32 v12,s3,v12
v_mul_u32_u24 v12,896,v12
v_lshrrev_b32 v13,5,v10
v_lshl_add_u32 v12,v13,7,v12
v_and_b32 v13,7,v10
v_lshl_add_u32 v152,v13,4,v12
s_mul_i32 s46,s42,2080
s_add_u32 m0,s46,132608
s_mov_b32 s47,0
s_mov_b32 s54,228352
buffer_load_dwordx4 v152,s[20:23],s47 offen lds
buffer_load_dwordx4 v152,s[20:23],s54 offen offset:1024 lds
s_add_u32 m0,s46,140896
s_mov_b32 s47,256
s_mov_b32 s54,228608
buffer_load_dwordx4 v152,s[20:23],s47 offen lds
buffer_load_dwordx4 v152,s[20:23],s54 offen offset:1024 lds
s_add_u32 m0,s46,149184
s_mov_b32 s47,512
s_mov_b32 s54,228864
buffer_load_dwordx4 v152,s[20:23],s47 offen lds
buffer_load_dwordx4 v152,s[20:23],s54 offen offset:1024 lds
s_mul_i32 s46,s42,1056
s_mov_b32 exec_hi,0
s_add_u32 m0,s46,157472
s_mov_b32 s47,768
s_mov_b32 s54,229632
buffer_load_dwordx4 v152,s[20:23],s47 offen lds
buffer_load_dwordx4 v152,s[20:23],s54 offen offset:512 lds
s_mov_b64 exec,-1
s_mov_b32 m0,s36
s_nop 0
buffer_load_dwordx4 v3,s[4:7],s28 offen offset:0 lds
buffer_load_dwordx4 v3,s[4:7],s29 offen offset:1024 lds
buffer_load_dwordx4 v3,s[4:7],s30 offen offset:2048 lds
buffer_load_dwordx4 v3,s[4:7],s31 offen offset:3072 lds
s_mov_b32 m0,s37
s_nop 0
buffer_load_dwordx4 v3,s[4:7],s32 offen offset:0 lds
buffer_load_dwordx4 v3,s[4:7],s33 offen offset:1024 lds
buffer_load_dwordx4 v3,s[4:7],s34 offen offset:2048 lds
buffer_load_dwordx4 v3,s[4:7],s35 offen offset:3072 lds
s_add_u32 s4,s4,128
s_addc_u32 s5,s5,0
s_sub_u32 s6,s6,128
s_add_u32 s20,s82,100663296
s_addc_u32 s21,s83,0
s_mov_b32 s22,1835008
s_mov_b32 s23,0x20000
s_add_u32 s24,s82,117440512
s_addc_u32 s25,s83,0
s_mov_b32 s26,8192
s_mov_b32 s27,0x20000
s_lshl_b32 s55,s43,7
s_lshl_b32 s46,s45,2
s_add_u32 s55,s55,s46
s_mov_b32 s49,0x3db8aa3b
s_or_b32 s46,s2,s42
s_cbranch_scc1 L_noinit
v_mov_b32 v160,0
v_mov_b32 v161,0
v_mov_b32 v162,0
v_mov_b32 v163,0
s_mov_b32 s46,4096
buffer_store_dwordx4 v[160:163],v4,s[24:27],0 offen offset:0 sc1
buffer_store_dwordx4 v[160:163],v4,s[24:27],0 offen offset:1024 sc1
buffer_store_dwordx4 v[160:163],v4,s[24:27],0 offen offset:2048 sc1
buffer_store_dwordx4 v[160:163],v4,s[24:27],0 offen offset:3072 sc1
buffer_store_dwordx4 v[160:163],v4,s[24:27],s46 offen offset:0 sc1
buffer_store_dwordx4 v[160:163],v4,s[24:27],s46 offen offset:1024 sc1
buffer_store_dwordx4 v[160:163],v4,s[24:27],s46 offen offset:2048 sc1
buffer_store_dwordx4 v[160:163],v4,s[24:27],s46 offen offset:3072 sc1
L_noinit:
s_waitcnt vmcnt(8)
s_barrier
DR a[160:163],v6,0
DR a[164:167],v6,256
DR a[168:171],v6,64
DR a[172:175],v6,320
DR a[176:179],v6,512
DR a[180:183],v6,768
DR a[184:187],v6,576
DR a[188:191],v6,832
s_waitcnt lgkmcnt(7)
M v[128:131],a[160:163],v[16:19],0
s_mov_b32 m0,s68
DR a[192:195],v6,8288
M v[136:139],a[160:163],v[72:75],0
DR a[196:199],v6,8544
s_waitcnt lgkmcnt(8)
M v[132:135],a[164:167],v[16:19],0
DR a[200:203],v6,8352
M v[140:143],a[164:167],v[72:75],0
DR a[204:207],v6,8608
s_waitcnt lgkmcnt(9)
M v[128:131],a[168:171],v[20:23],v[128:131]
DR a[208:211],v6,8800
M v[136:139],a[168:171],v[76:79],v[136:139]
DR a[212:215],v6,9056
s_waitcnt lgkmcnt(10)
M v[132:135],a[172:175],v[20:23],v[132:135]
DR a[216:219],v6,8864
M v[140:143],a[172:175],v[76:79],v[140:143]
s_waitcnt lgkmcnt(7)
DR a[220:223],v6,9120
M v[128:131],a[176:179],v[24:27],v[128:131]
DR a[160:163],v6,16576
M v[136:139],a[176:179],v[80:83],v[136:139]
DR a[164:167],v6,16832
M v[132:135],a[180:183],v[24:27],v[132:135]
DR a[168:171],v6,16640
M v[140:143],a[180:183],v[80:83],v[140:143]
DR a[172:175],v6,16896
M v[128:131],a[184:187],v[28:31],v[128:131]
DR a[176:179],v6,17088
M v[136:139],a[184:187],v[84:87],v[136:139]
DR a[180:183],v6,17344
M v[132:135],a[188:191],v[28:31],v[132:135]
buffer_load_dwordx4 v5,s[8:11],s56 offen offset:0 lds
M v[140:143],a[188:191],v[84:87],v[140:143]
s_waitcnt lgkmcnt(10)
DR a[184:187],v6,17152
M v[128:131],a[192:195],v[32:35],v[128:131]
buffer_load_dwordx4 v5,s[8:11],s57 offen offset:1024 lds
M v[136:139],a[192:195],v[88:91],v[136:139]
DR a[188:191],v6,17408
M v[132:135],a[196:199],v[32:35],v[132:135]
buffer_load_dwordx4 v5,s[8:11],s58 offen offset:2048 lds
M v[140:143],a[196:199],v[88:91],v[140:143]
DR a[192:195],v7,24864
M v[128:131],a[200:203],v[36:39],v[128:131]
buffer_load_dwordx4 v5,s[8:11],s59 offen offset:3072 lds
M v[136:139],a[200:203],v[92:95],v[136:139]
s_mov_b32 m0,s69
DR a[196:199],v7,25120
M v[132:135],a[204:207],v[36:39],v[132:135]
buffer_load_dwordx4 v5,s[8:11],s60 offen offset:0 lds
M v[140:143],a[204:207],v[92:95],v[140:143]
s_waitcnt lgkmcnt(10)
buffer_load_dwordx4 v5,s[8:11],s61 offen offset:1024 lds
M v[128:131],a[208:211],v[40:43],v[128:131]
DR a[200:203],v7,24928
M v[136:139],a[208:211],v[96:99],v[136:139]
buffer_load_dwordx4 v5,s[8:11],s62 offen offset:2048 lds
M v[132:135],a[212:215],v[40:43],v[132:135]
DR a[204:207],v7,25184
M v[140:143],a[212:215],v[96:99],v[140:143]
buffer_load_dwordx4 v5,s[8:11],s63 offen offset:3072 lds
M v[128:131],a[216:219],v[44:47],v[128:131]
s_add_u32 s8,s8,524288
s_addc_u32 s9,s9,0
s_sub_u32 s10,s10,524288
s_mov_b32 m0,s70
M v[136:139],a[216:219],v[100:103],v[136:139]
buffer_load_dwordx4 v5,s[8:11],s56 offen offset:0 lds
M v[132:135],a[220:223],v[44:47],v[132:135]
buffer_load_dwordx4 v5,s[8:11],s57 offen offset:1024 lds
M v[140:143],a[220:223],v[100:103],v[140:143]
s_waitcnt lgkmcnt(8)
M v[128:131],a[160:163],v[48:51],v[128:131]
buffer_load_dwordx4 v5,s[8:11],s58 offen offset:2048 lds
M v[136:139],a[160:163],v[104:107],v[136:139]
buffer_load_dwordx4 v5,s[8:11],s59 offen offset:3072 lds
M v[132:135],a[164:167],v[48:51],v[132:135]
s_mov_b32 m0,s71
M v[140:143],a[164:167],v[104:107],v[140:143]
buffer_load_dwordx4 v5,s[8:11],s60 offen offset:0 lds
M v[128:131],a[168:171],v[52:55],v[128:131]
buffer_load_dwordx4 v5,s[8:11],s61 offen offset:1024 lds
M v[136:139],a[168:171],v[108:111],v[136:139]
buffer_load_dwordx4 v5,s[8:11],s62 offen offset:2048 lds
M v[132:135],a[172:175],v[52:55],v[132:135]
buffer_load_dwordx4 v5,s[8:11],s63 offen offset:3072 lds
M v[140:143],a[172:175],v[108:111],v[140:143]
s_waitcnt lgkmcnt(4)
s_add_u32 s8,s8,524288
s_addc_u32 s9,s9,0
M v[128:131],a[176:179],v[56:59],v[128:131]
s_sub_u32 s10,s10,524288
s_mov_b32 m0,s38
M v[136:139],a[176:179],v[112:115],v[136:139]
buffer_load_dwordx4 v3,s[4:7],s28 offen offset:0 lds
M v[132:135],a[180:183],v[56:59],v[132:135]
buffer_load_dwordx4 v3,s[4:7],s29 offen offset:1024 lds
M v[140:143],a[180:183],v[112:115],v[140:143]
buffer_load_dwordx4 v3,s[4:7],s30 offen offset:2048 lds
M v[128:131],a[184:187],v[60:63],v[128:131]
s_waitcnt vmcnt(11)
s_barrier
M v[136:139],a[184:187],v[116:119],v[136:139]
DR a[128:131],v1,0
M v[132:135],a[188:191],v[60:63],v[132:135]
DR a[132:135],v1,64
M v[140:143],a[188:191],v[116:119],v[140:143]
s_waitcnt lgkmcnt(2)
DT a[0:1],v2,0
M v[128:131],a[192:195],v[64:67],v[128:131]
DT a[2:3],v2,512
M v[136:139],a[192:195],v[120:123],v[136:139]
DT a[4:5],v2,2048
M v[132:135],a[196:199],v[64:67],v[132:135]
DT a[6:7],v2,2560
M v[140:143],a[196:199],v[120:123],v[140:143]
DT a[8:9],v2,32
M v[128:131],a[200:203],v[68:71],v[128:131]
DT a[10:11],v2,544
M v[136:139],a[200:203],v[124:127],v[136:139]
DT a[12:13],v2,2080
M v[132:135],a[204:207],v[68:71],v[132:135]
buffer_load_dwordx4 v3,s[4:7],s31 offen offset:3072 lds
M v[140:143],a[204:207],v[124:127],v[140:143]
s_mov_b32 m0,s39
DT a[14:15],v2,2592
DT a[16:17],v2,64
DT a[18:19],v2,576
DT a[20:21],v2,2112
DT a[22:23],v2,2624
DT a[24:25],v2,96
DT a[26:27],v2,608
DT a[28:29],v2,2144
DT a[30:31],v2,2656
DT a[32:33],v2,128
DT a[34:35],v2,640
DT a[36:37],v2,2176
DT a[38:39],v2,2688
DT a[40:41],v2,160
DT a[42:43],v2,672
DT a[44:45],v2,2208
DT a[46:47],v2,2720
DT a[48:49],v2,192
DT a[50:51],v2,704
DT a[52:53],v2,2240
DT a[54:55],v2,2752
DT a[56:57],v2,224
DT a[58:59],v2,736
DT a[60:61],v2,2272
DT a[62:63],v2,2784
DR a[136:139],v1,256
DR a[140:143],v1,320
buffer_load_dwordx4 v3,s[4:7],s32 offen offset:0 lds
buffer_load_dwordx4 v3,s[4:7],s33 offen offset:1024 lds
buffer_load_dwordx4 v3,s[4:7],s34 offen offset:2048 lds
buffer_load_dwordx4 v3,s[4:7],s35 offen offset:3072 lds
s_add_u32 s4,s4,128
s_addc_u32 s5,s5,0
s_sub_u32 s6,s6,128
buffer_load_dword a238,v15,s[88:91],s52 offen
s_add_u32 s52,s52,1048576
buffer_load_dword a238,v0,s[84:87],s51 offen
s_add_u32 s51,s51,256
CV v128,v128,v129
CV v129,v130,v131
CV v130,v132,v133
CV v131,v134,v135
CV v136,v136,v137
CV v137,v138,v139
CV v138,v140,v141
CV v139,v142,v143
s_bitcmp1_b32 s44,0
s_cbranch_scc1 L_role_a
s_waitcnt lgkmcnt(15)
M v[16:19],a[0:3],a[128:131],0
DR a[144:147],v1,512
M v[16:19],a[4:7],a[132:135],v[16:19]
DR a[148:151],v1,576
M v[20:23],a[12:15],a[132:135],0
DR a[152:155],v1,768
M v[20:23],a[8:11],a[128:131],v[20:23]
DR a[156:159],v1,832
M v[24:27],a[16:19],a[128:131],0
M v[24:27],a[20:23],a[132:135],v[24:27]
M v[28:31],a[28:31],a[132:135],0
M v[28:31],a[24:27],a[128:131],v[28:31]
M v[32:35],a[32:35],a[128:131],0
s_waitcnt lgkmcnt(15)
M v[32:35],a[36:39],a[132:135],v[32:35]
s_waitcnt lgkmcnt(14)
M v[36:39],a[44:47],a[132:135],0
M v[36:39],a[40:43],a[128:131],v[36:39]
s_waitcnt lgkmcnt(12)
M v[40:43],a[48:51],a[128:131],0
s_waitcnt lgkmcnt(10)
M v[40:43],a[52:55],a[132:135],v[40:43]
s_waitcnt lgkmcnt(6)
M v[44:47],a[60:63],a[132:135],0
s_mov_b32 m0,s68
M v[44:47],a[56:59],a[128:131],v[44:47]
s_waitcnt lgkmcnt(5)
M v[48:51],a[0:3],a[136:139],0
DR a[128:131],v1,1024
s_waitcnt lgkmcnt(5)
M v[48:51],a[4:7],a[140:143],v[48:51]
DR a[132:135],v1,1088
M v[52:55],a[12:15],a[140:143],0
s_waitcnt lgkmcnt(0)
s_barrier
M v[52:55],a[8:11],a[136:139],v[52:55]
M v[56:59],a[16:19],a[136:139],0
buffer_load_dwordx4 v5,s[8:11],s56 offen offset:0 lds
M v[56:59],a[20:23],a[140:143],v[56:59]
M v[60:63],a[28:31],a[140:143],0
M v[60:63],a[24:27],a[136:139],v[60:63]
buffer_load_dwordx4 v5,s[8:11],s57 offen offset:1024 lds
M v[64:67],a[32:35],a[136:139],0
M v[64:67],a[36:39],a[140:143],v[64:67]
buffer_load_dwordx4 v5,s[8:11],s58 offen offset:2048 lds
M v[68:71],a[44:47],a[140:143],0
M v[68:71],a[40:43],a[136:139],v[68:71]
M v[72:75],a[48:51],a[136:139],0
buffer_load_dwordx4 v5,s[8:11],s59 offen offset:3072 lds
M v[72:75],a[52:55],a[140:143],v[72:75]
s_mov_b32 m0,s69
M v[76:79],a[60:63],a[140:143],0
buffer_load_dwordx4 v5,s[8:11],s60 offen offset:0 lds
M v[76:79],a[56:59],a[136:139],v[76:79]
M v[80:83],a[0:3],a[144:147],0
DR a[136:139],v1,1280
M v[80:83],a[4:7],a[148:151],v[80:83]
DR a[140:143],v1,1344
M v[84:87],a[12:15],a[148:151],0
buffer_load_dwordx4 v5,s[8:11],s61 offen offset:1024 lds
M v[84:87],a[8:11],a[144:147],v[84:87]
buffer_load_dwordx4 v5,s[8:11],s62 offen offset:2048 lds
M v[88:91],a[16:19],a[144:147],0
M v[88:91],a[20:23],a[148:151],v[88:91]
M v[92:95],a[28:31],a[148:151],0
buffer_load_dwordx4 v5,s[8:11],s63 offen offset:3072 lds
M v[92:95],a[24:27],a[144:147],v[92:95]
s_add_u32 s8,s8,524288
s_addc_u32 s9,s9,0
s_sub_u32 s10,s10,524288
M v[96:99],a[32:35],a[144:147],0
M v[96:99],a[36:39],a[148:151],v[96:99]
M v[100:103],a[44:47],a[148:151],0
M v[100:103],a[40:43],a[144:147],v[100:103]
M v[104:107],a[48:51],a[144:147],0
s_waitcnt vmcnt(18)
s_barrier
M v[104:107],a[52:55],a[148:151],v[104:107]
DT a[64:65],v2,33152
M v[108:111],a[60:63],a[148:151],0
v_accvgpr_write_b32 a176,v128
v_accvgpr_write_b32 a177,v129
M v[108:111],a[56:59],a[144:147],v[108:111]
DT a[66:67],v2,33664
v_accvgpr_write_b32 a178,v130
M v[112:115],a[0:3],a[152:155],0
DR a[144:147],v1,1536
v_accvgpr_write_b32 a179,v131
M v[112:115],a[4:7],a[156:159],v[112:115]
DR a[148:151],v1,1600
v_accvgpr_write_b32 a180,v136
M v[116:119],a[12:15],a[156:159],0
DT a[68:69],v2,35200
v_accvgpr_write_b32 a181,v137
M v[116:119],a[8:11],a[152:155],v[116:119]
DT a[70:71],v2,35712
v_accvgpr_write_b32 a182,v138
M v[120:123],a[16:19],a[152:155],0
DT a[72:73],v2,33184
v_accvgpr_write_b32 a183,v139
M v[120:123],a[20:23],a[156:159],v[120:123]
DT a[74:75],v2,33696
M v[124:127],a[28:31],a[156:159],0
DT a[76:77],v2,35232
M v[124:127],a[24:27],a[152:155],v[124:127]
DT a[78:79],v2,35744
M v[128:131],a[32:35],a[152:155],0
DT a[80:81],v2,33216
M v[128:131],a[36:39],a[156:159],v[128:131]
DT a[82:83],v2,33728
M v[132:135],a[44:47],a[156:159],0
DT a[84:85],v2,35264
M v[132:135],a[40:43],a[152:155],v[132:135]
DT a[86:87],v2,35776
M v[136:139],a[48:51],a[152:155],0
DT a[88:89],v2,33248
M v[136:139],a[52:55],a[156:159],v[136:139]
buffer_load_dword a238,v15,s[88:91],s52 offen
M v[140:143],a[60:63],a[156:159],0
s_add_u32 s52,s52,1048576
DT a[90:91],v2,33760
M v[140:143],a[56:59],a[152:155],v[140:143]
DT a[92:93],v2,35296
M v[144:147],a[0:3],a[128:131],0
DR a[152:155],v1,1792
M v[144:147],a[4:7],a[132:135],v[144:147]
DR a[156:159],v1,1856
M v[148:151],a[12:15],a[132:135],0
DT a[94:95],v2,35808
M v[148:151],a[8:11],a[128:131],v[148:151]
DT a[96:97],v2,33280
M v[152:155],a[16:19],a[128:131],0
DT a[98:99],v2,33792
M v[152:155],a[20:23],a[132:135],v[152:155]
DT a[100:101],v2,35328
M v[156:159],a[28:31],a[132:135],0
DT a[102:103],v2,35840
M v[156:159],a[24:27],a[128:131],v[156:159]
DT a[104:105],v2,33312
M v[160:163],a[32:35],a[128:131],0
DT a[106:107],v2,33824
M v[160:163],a[36:39],a[132:135],v[160:163]
DT a[108:109],v2,35360
M v[164:167],a[44:47],a[132:135],0
DT a[110:111],v2,35872
M v[164:167],a[40:43],a[128:131],v[164:167]
DT a[112:113],v2,33344
M v[168:171],a[48:51],a[128:131],0
buffer_load_dword a238,v0,s[84:87],s51 offen
M v[168:171],a[52:55],a[132:135],v[168:171]
s_add_u32 s51,s51,256
DT a[114:115],v2,33856
M v[172:175],a[60:63],a[132:135],0
DT a[116:117],v2,35392
M v[172:175],a[56:59],a[128:131],v[172:175]
s_waitcnt lgkmcnt(15)
DT a[118:119],v2,35904
M v[176:179],a[0:3],a[136:139],0
DT a[120:121],v2,33376
M v[176:179],a[4:7],a[140:143],v[176:179]
M v[180:183],a[12:15],a[140:143],0
DT a[122:123],v2,33888
M v[180:183],a[8:11],a[136:139],v[180:183]
DT a[124:125],v2,35424
M v[184:187],a[16:19],a[136:139],0
DT a[126:127],v2,35936
M v[184:187],a[20:23],a[140:143],v[184:187]
M v[188:191],a[28:31],a[140:143],0
M v[188:191],a[24:27],a[136:139],v[188:191]
M v[192:195],a[32:35],a[136:139],0
M v[192:195],a[36:39],a[140:143],v[192:195]
M v[196:199],a[44:47],a[140:143],0
M v[196:199],a[40:43],a[136:139],v[196:199]
M v[200:203],a[48:51],a[136:139],0
M v[200:203],a[52:55],a[140:143],v[200:203]
M v[204:207],a[60:63],a[140:143],0
M v[204:207],a[56:59],a[136:139],v[204:207]
s_waitcnt vmcnt(12) lgkmcnt(0)
s_barrier
s_or_b32 s46,s2,s42
s_cbranch_scc1 L_noinit2
s_mov_b32 s92,s80
s_mov_b32 s93,s81
s_mov_b32 s94,256
s_mov_b32 s95,0x20000
v_mov_b32 v12,1
buffer_store_dword v12,off,s[92:95],0 sc1
L_noinit2:
M v[208:211],a[0:3],a[144:147],0
s_mov_b32 m0,s36
DR a[128:131],v1,33152
M v[208:211],a[4:7],a[148:151],v[208:211]
DR a[132:135],v1,33216
M v[212:215],a[12:15],a[148:151],0
DR a[136:139],v1,33408
M v[212:215],a[8:11],a[144:147],v[212:215]
DR a[140:143],v1,33472
M v[216:219],a[16:19],a[144:147],0
buffer_load_dwordx4 v3,s[4:7],s28 offen offset:0 lds
M v[216:219],a[20:23],a[148:151],v[216:219]
M v[220:223],a[28:31],a[148:151],0
M v[220:223],a[24:27],a[144:147],v[220:223]
M v[224:227],a[32:35],a[144:147],0
buffer_load_dwordx4 v3,s[4:7],s29 offen offset:1024 lds
M v[224:227],a[36:39],a[148:151],v[224:227]
M v[228:231],a[44:47],a[148:151],0
M v[228:231],a[40:43],a[144:147],v[228:231]
M v[232:235],a[48:51],a[144:147],0
M v[232:235],a[52:55],a[148:151],v[232:235]
M v[236:239],a[60:63],a[148:151],0
buffer_load_dwordx4 v3,s[4:7],s30 offen offset:2048 lds
M v[236:239],a[56:59],a[144:147],v[236:239]
M v[240:243],a[0:3],a[152:155],0
DR a[144:147],v1,33664
M v[240:243],a[4:7],a[156:159],v[240:243]
DR a[148:151],v1,33728
M a[240:243],a[12:15],a[156:159],0
M a[240:243],a[8:11],a[152:155],a[240:243]
M v[244:247],a[16:19],a[152:155],0
buffer_load_dwordx4 v3,s[4:7],s31 offen offset:3072 lds
M v[244:247],a[20:23],a[156:159],v[244:247]
s_mov_b32 m0,s37
M a[244:247],a[28:31],a[156:159],0
M a[244:247],a[24:27],a[152:155],a[244:247]
M v[248:251],a[32:35],a[152:155],0
M v[248:251],a[36:39],a[156:159],v[248:251]
buffer_load_dwordx4 v3,s[4:7],s32 offen offset:0 lds
M a[248:251],a[44:47],a[156:159],0
M a[248:251],a[40:43],a[152:155],a[248:251]
M v[252:255],a[48:51],a[152:155],0
M v[252:255],a[52:55],a[156:159],v[252:255]
M a[252:255],a[60:63],a[156:159],0
M a[252:255],a[56:59],a[152:155],a[252:255]
s_waitcnt lgkmcnt(4)
M v[16:19],a[64:67],a[128:131],v[16:19]
DR a[152:155],v1,33920
M v[16:19],a[68:71],a[132:135],v[16:19]
DR a[156:159],v1,33984
M v[20:23],a[76:79],a[132:135],v[20:23]
buffer_load_dwordx4 v3,s[4:7],s33 offen offset:1024 lds
M v[20:23],a[72:75],a[128:131],v[20:23]
M v[24:27],a[80:83],a[128:131],v[24:27]
M v[24:27],a[84:87],a[132:135],v[24:27]
buffer_load_dwordx4 v3,s[4:7],s34 offen offset:2048 lds
M v[28:31],a[92:95],a[132:135],v[28:31]
M v[28:31],a[88:91],a[128:131],v[28:31]
M v[32:35],a[96:99],a[128:131],v[32:35]
M v[32:35],a[100:103],a[132:135],v[32:35]
M v[36:39],a[108:111],a[132:135],v[36:39]
M v[36:39],a[104:107],a[128:131],v[36:39]
buffer_load_dwordx4 v3,s[4:7],s35 offen offset:3072 lds
M v[40:43],a[112:115],a[128:131],v[40:43]
s_add_u32 s4,s4,128
s_addc_u32 s5,s5,0
s_sub_u32 s6,s6,128
M v[40:43],a[116:119],a[132:135],v[40:43]
M v[44:47],a[124:127],a[132:135],v[44:47]
s_mov_b32 m0,s70
M v[44:47],a[120:123],a[128:131],v[44:47]
s_waitcnt vmcnt(10) lgkmcnt(4)
s_barrier
M v[48:51],a[64:67],a[136:139],v[48:51]
DR a[128:131],v1,34176
M v[48:51],a[68:71],a[140:143],v[48:51]
DR a[132:135],v1,34240
M v[52:55],a[76:79],a[140:143],v[52:55]
DT a[0:1],v2,0
M v[52:55],a[72:75],a[136:139],v[52:55]
DT a[2:3],v2,512
M v[56:59],a[80:83],a[136:139],v[56:59]
buffer_load_dwordx4 v5,s[8:11],s56 offen offset:0 lds
M v[56:59],a[84:87],a[140:143],v[56:59]
DT a[4:5],v2,2048
M v[60:63],a[92:95],a[140:143],v[60:63]
M v[60:63],a[88:91],a[136:139],v[60:63]
DT a[6:7],v2,2560
M v[64:67],a[96:99],a[136:139],v[64:67]
M v[64:67],a[100:103],a[140:143],v[64:67]
DT a[8:9],v2,32
M v[68:71],a[108:111],a[140:143],v[68:71]
buffer_load_dwordx4 v5,s[8:11],s57 offen offset:1024 lds
M v[68:71],a[104:107],a[136:139],v[68:71]
DT a[10:11],v2,544
M v[72:75],a[112:115],a[136:139],v[72:75]
M v[72:75],a[116:119],a[140:143],v[72:75]
M v[76:79],a[124:127],a[140:143],v[76:79]
DT a[12:13],v2,2080
M v[76:79],a[120:123],a[136:139],v[76:79]
s_waitcnt lgkmcnt(11)
M v[80:83],a[64:67],a[144:147],v[80:83]
DR a[136:139],v1,34432
M v[80:83],a[68:71],a[148:151],v[80:83]
DR a[140:143],v1,34496
M v[84:87],a[76:79],a[148:151],v[84:87]
DT a[14:15],v2,2592
M v[84:87],a[72:75],a[144:147],v[84:87]
DT a[16:17],v2,64
M v[88:91],a[80:83],a[144:147],v[88:91]
DT a[18:19],v2,576
M v[88:91],a[84:87],a[148:151],v[88:91]
buffer_load_dwordx4 v5,s[8:11],s58 offen offset:2048 lds
M v[92:95],a[92:95],a[148:151],v[92:95]
DT a[20:21],v2,2112
M v[92:95],a[88:91],a[144:147],v[92:95]
buffer_load_dwordx4 v5,s[8:11],s59 offen offset:3072 lds
M v[96:99],a[96:99],a[144:147],v[96:99]
s_mov_b32 m0,s71
M v[96:99],a[100:103],a[148:151],v[96:99]
DT a[22:23],v2,2624
M v[100:103],a[108:111],a[148:151],v[100:103]
M v[100:103],a[104:107],a[144:147],v[100:103]
DT a[24:25],v2,96
M v[104:107],a[112:115],a[144:147],v[104:107]
buffer_load_dwordx4 v5,s[8:11],s60 offen offset:0 lds
M v[104:107],a[116:119],a[148:151],v[104:107]
DT a[26:27],v2,608
M v[108:111],a[124:127],a[148:151],v[108:111]
M v[108:111],a[120:123],a[144:147],v[108:111]
s_waitcnt lgkmcnt(15)
DT a[28:29],v2,2144
M v[112:115],a[64:67],a[152:155],v[112:115]
DR a[144:147],v1,34688
M v[112:115],a[68:71],a[156:159],v[112:115]
DR a[148:151],v1,34752
M v[116:119],a[76:79],a[156:159],v[116:119]
DT a[30:31],v2,2656
M v[116:119],a[72:75],a[152:155],v[116:119]
DT a[32:33],v2,128
M v[120:123],a[80:83],a[152:155],v[120:123]
buffer_load_dwordx4 v5,s[8:11],s61 offen offset:1024 lds
M v[120:123],a[84:87],a[156:159],v[120:123]
M v[124:127],a[92:95],a[156:159],v[124:127]
DT a[34:35],v2,640
M v[124:127],a[88:91],a[152:155],v[124:127]
buffer_load_dwordx4 v5,s[8:11],s62 offen offset:2048 lds
M v[128:131],a[96:99],a[152:155],v[128:131]
DT a[36:37],v2,2176
M v[128:131],a[100:103],a[156:159],v[128:131]
M v[132:135],a[108:111],a[156:159],v[132:135]
DT a[38:39],v2,2688
M v[132:135],a[104:107],a[152:155],v[132:135]
M v[136:139],a[112:115],a[152:155],v[136:139]
DT a[40:41],v2,160
M v[136:139],a[116:119],a[156:159],v[136:139]
buffer_load_dwordx4 v5,s[8:11],s63 offen offset:3072 lds
M v[140:143],a[124:127],a[156:159],v[140:143]
s_add_u32 s8,s8,524288
s_addc_u32 s9,s9,0
DT a[42:43],v2,672
M v[140:143],a[120:123],a[152:155],v[140:143]
s_sub_u32 s10,s10,524288
M v[144:147],a[64:67],a[128:131],v[144:147]
DR a[152:155],v1,34944
M v[144:147],a[68:71],a[132:135],v[144:147]
DR a[156:159],v1,35008
M v[148:151],a[76:79],a[132:135],v[148:151]
DT a[44:45],v2,2208
M v[148:151],a[72:75],a[128:131],v[148:151]
DT a[46:47],v2,2720
M v[152:155],a[80:83],a[128:131],v[152:155]
buffer_load_dword a238,v0,s[84:87],s51 offen
M v[152:155],a[84:87],a[132:135],v[152:155]
s_add_u32 s51,s51,256
s_mov_b32 s14,921600
s_mov_b32 s15,0x20000
M v[156:159],a[92:95],a[132:135],v[156:159]
s_mov_b32 s18,921600
s_mov_b32 s19,0x20000
s_lshr_b32 s46,s2,4
M v[156:159],a[88:91],a[128:131],v[156:159]
s_lshl_b32 s46,s46,6
s_lshl_b32 s47,s42,4
s_add_u32 s46,s46,s47
M v[160:163],a[96:99],a[128:131],v[160:163]
s_and_b32 s47,s2,15
s_add_u32 s46,s46,s47
DT a[48:49],v2,192
M v[160:163],a[100:103],a[132:135],v[160:163]
s_mul_i32 s46,s46,900
DT a[50:51],v2,704
v_lshrrev_b32 v6,2,v4
M v[164:167],a[108:111],a[132:135],v[164:167]
s_lshl_b32 s47,s42,11
s_add_u32 m0,s47,132608
DT a[52:53],v2,2240
M v[164:167],a[104:107],a[128:131],v[164:167]
buffer_load_dword v6,s[12:15],s46 offen offset:0 lds
M v[168:171],a[112:115],a[128:131],v[168:171]
buffer_load_dword v6,s[12:15],s46 offen offset:256 lds
M v[168:171],a[116:119],a[132:135],v[168:171]
buffer_load_dword v6,s[12:15],s46 offen offset:512 lds
M v[172:175],a[124:127],a[132:135],v[172:175]
buffer_load_dword v6,s[12:15],s46 offen offset:768 lds
M v[172:175],a[120:123],a[128:131],v[172:175]
s_waitcnt lgkmcnt(15)
s_add_u32 m0,s47,133632
DT a[54:55],v2,2752
M v[176:179],a[64:67],a[136:139],v[176:179]
buffer_load_dword v6,s[16:19],s46 offen offset:0 lds
M v[176:179],a[68:71],a[140:143],v[176:179]
DT a[56:57],v2,224
M v[180:183],a[76:79],a[140:143],v[180:183]
buffer_load_dword v6,s[16:19],s46 offen offset:256 lds
M v[180:183],a[72:75],a[136:139],v[180:183]
DT a[58:59],v2,736
M v[184:187],a[80:83],a[136:139],v[184:187]
buffer_load_dword v6,s[16:19],s46 offen offset:512 lds
M v[184:187],a[84:87],a[140:143],v[184:187]
DT a[60:61],v2,2272
M v[188:191],a[92:95],a[140:143],v[188:191]
buffer_load_dword v6,s[16:19],s46 offen offset:768 lds
M v[188:191],a[88:91],a[136:139],v[188:191]
DT a[62:63],v2,2784
M v[192:195],a[96:99],a[136:139],v[192:195]
M v[192:195],a[100:103],a[140:143],v[192:195]
M v[196:199],a[108:111],a[140:143],v[196:199]
M v[196:199],a[104:107],a[136:139],v[196:199]
M v[200:203],a[112:115],a[136:139],v[200:203]
M v[200:203],a[116:119],a[140:143],v[200:203]
M v[204:207],a[124:127],a[140:143],v[204:207]
M v[204:207],a[120:123],a[136:139],v[204:207]
s_waitcnt vmcnt(17) lgkmcnt(0)
s_barrier
M v[208:211],a[64:67],a[144:147],v[208:211]
s_mov_b32 m0,s38
DR a[128:131],v1,0
M v[208:211],a[68:71],a[148:151],v[208:211]
DR a[132:135],v1,64
M v[212:215],a[76:79],a[148:151],v[212:215]
DR a[136:139],v1,256
M v[212:215],a[72:75],a[144:147],v[212:215]
DR a[140:143],v1,320
M v[216:219],a[80:83],a[144:147],v[216:219]
buffer_load_dwordx4 v3,s[4:7],s28 offen offset:0 lds
M v[216:219],a[84:87],a[148:151],v[216:219]
M v[220:223],a[92:95],a[148:151],v[220:223]
M v[220:223],a[88:91],a[144:147],v[220:223]
M v[224:227],a[96:99],a[144:147],v[224:227]
buffer_load_dwordx4 v3,s[4:7],s29 offen offset:1024 lds
M v[224:227],a[100:103],a[148:151],v[224:227]
M v[228:231],a[108:111],a[148:151],v[228:231]
M v[228:231],a[104:107],a[144:147],v[228:231]
M v[232:235],a[112:115],a[144:147],v[232:235]
M v[232:235],a[116:119],a[148:151],v[232:235]
M v[236:239],a[124:127],a[148:151],v[236:239]
buffer_load_dwordx4 v3,s[4:7],s30 offen offset:2048 lds
M v[236:239],a[120:123],a[144:147],v[236:239]
M v[240:243],a[64:67],a[152:155],v[240:243]
DR a[144:147],v1,512
M v[240:243],a[68:71],a[156:159],v[240:243]
DR a[148:151],v1,576
M a[240:243],a[76:79],a[156:159],a[240:243]
M a[240:243],a[72:75],a[152:155],a[240:243]
M v[244:247],a[80:83],a[152:155],v[244:247]
buffer_load_dwordx4 v3,s[4:7],s31 offen offset:3072 lds
M v[244:247],a[84:87],a[156:159],v[244:247]
s_mov_b32 m0,s39
M a[244:247],a[92:95],a[156:159],a[244:247]
M a[244:247],a[88:91],a[152:155],a[244:247]
M v[248:251],a[96:99],a[152:155],v[248:251]
M v[248:251],a[100:103],a[156:159],v[248:251]
buffer_load_dwordx4 v3,s[4:7],s32 offen offset:0 lds
M a[248:251],a[108:111],a[156:159],a[248:251]
M a[248:251],a[104:107],a[152:155],a[248:251]
M v[252:255],a[112:115],a[152:155],v[252:255]
M v[252:255],a[116:119],a[156:159],v[252:255]
M a[252:255],a[124:127],a[156:159],a[252:255]
M a[252:255],a[120:123],a[152:155],a[252:255]
s_waitcnt lgkmcnt(4)
M v[16:19],a[0:3],a[128:131],v[16:19]
DR a[152:155],v1,768
M v[16:19],a[4:7],a[132:135],v[16:19]
DR a[156:159],v1,832
M v[20:23],a[12:15],a[132:135],v[20:23]
buffer_load_dwordx4 v3,s[4:7],s33 offen offset:1024 lds
M v[20:23],a[8:11],a[128:131],v[20:23]
M v[24:27],a[16:19],a[128:131],v[24:27]
M v[24:27],a[20:23],a[132:135],v[24:27]
buffer_load_dwordx4 v3,s[4:7],s34 offen offset:2048 lds
M v[28:31],a[28:31],a[132:135],v[28:31]
M v[28:31],a[24:27],a[128:131],v[28:31]
M v[32:35],a[32:35],a[128:131],v[32:35]
M v[32:35],a[36:39],a[132:135],v[32:35]
M v[36:39],a[44:47],a[132:135],v[36:39]
M v[36:39],a[40:43],a[128:131],v[36:39]
buffer_load_dwordx4 v3,s[4:7],s35 offen offset:3072 lds
M v[40:43],a[48:51],a[128:131],v[40:43]
s_add_u32 s4,s4,128
s_addc_u32 s5,s5,0
s_sub_u32 s6,s6,128
M v[40:43],a[52:55],a[132:135],v[40:43]
M v[44:47],a[60:63],a[132:135],v[44:47]
s_mov_b32 m0,s68
M v[44:47],a[56:59],a[128:131],v[44:47]
s_waitcnt vmcnt(17) lgkmcnt(4)
s_barrier
M v[48:51],a[0:3],a[136:139],v[48:51]
DR a[128:131],v1,1024
M v[48:51],a[4:7],a[140:143],v[48:51]
DR a[132:135],v1,1088
M v[52:55],a[12:15],a[140:143],v[52:55]
DT a[64:65],v2,33152
M v[52:55],a[8:11],a[136:139],v[52:55]
DT a[66:67],v2,33664
M v[56:59],a[16:19],a[136:139],v[56:59]
buffer_load_dwordx4 v5,s[8:11],s56 offen offset:0 lds
M v[56:59],a[20:23],a[140:143],v[56:59]
DT a[68:69],v2,35200
M v[60:63],a[28:31],a[140:143],v[60:63]
M v[60:63],a[24:27],a[136:139],v[60:63]
DT a[70:71],v2,35712
M v[64:67],a[32:35],a[136:139],v[64:67]
M v[64:67],a[36:39],a[140:143],v[64:67]
DT a[72:73],v2,33184
M v[68:71],a[44:47],a[140:143],v[68:71]
buffer_load_dwordx4 v5,s[8:11],s57 offen offset:1024 lds
M v[68:71],a[40:43],a[136:139],v[68:71]
DT a[74:75],v2,33696
M v[72:75],a[48:51],a[136:139],v[72:75]
M v[72:75],a[52:55],a[140:143],v[72:75]
M v[76:79],a[60:63],a[140:143],v[76:79]
DT a[76:77],v2,35232
M v[76:79],a[56:59],a[136:139],v[76:79]
s_waitcnt lgkmcnt(11)
M v[80:83],a[0:3],a[144:147],v[80:83]
DR a[136:139],v1,1280
M v[80:83],a[4:7],a[148:151],v[80:83]
DR a[140:143],v1,1344
M v[84:87],a[12:15],a[148:151],v[84:87]
DT a[78:79],v2,35744
M v[84:87],a[8:11],a[144:147],v[84:87]
DT a[80:81],v2,33216
M v[88:91],a[16:19],a[144:147],v[88:91]
DT a[82:83],v2,33728
M v[88:91],a[20:23],a[148:151],v[88:91]
buffer_load_dwordx4 v5,s[8:11],s58 offen offset:2048 lds
M v[92:95],a[28:31],a[148:151],v[92:95]
DT a[84:85],v2,35264
M v[92:95],a[24:27],a[144:147],v[92:95]
buffer_load_dwordx4 v5,s[8:11],s59 offen offset:3072 lds
M v[96:99],a[32:35],a[144:147],v[96:99]
s_mov_b32 m0,s69
M v[96:99],a[36:39],a[148:151],v[96:99]
DT a[86:87],v2,35776
M v[100:103],a[44:47],a[148:151],v[100:103]
M v[100:103],a[40:43],a[144:147],v[100:103]
DT a[88:89],v2,33248
M v[104:107],a[48:51],a[144:147],v[104:107]
buffer_load_dwordx4 v5,s[8:11],s60 offen offset:0 lds
M v[104:107],a[52:55],a[148:151],v[104:107]
DT a[90:91],v2,33760
M v[108:111],a[60:63],a[148:151],v[108:111]
M v[108:111],a[56:59],a[144:147],v[108:111]
s_waitcnt lgkmcnt(15)
DT a[92:93],v2,35296
M v[112:115],a[0:3],a[152:155],v[112:115]
DR a[144:147],v1,1536
M v[112:115],a[4:7],a[156:159],v[112:115]
DR a[148:151],v1,1600
M v[116:119],a[12:15],a[156:159],v[116:119]
DT a[94:95],v2,35808
M v[116:119],a[8:11],a[152:155],v[116:119]
DT a[96:97],v2,33280
M v[120:123],a[16:19],a[152:155],v[120:123]
buffer_load_dwordx4 v5,s[8:11],s61 offen offset:1024 lds
M v[120:123],a[20:23],a[156:159],v[120:123]
M v[124:127],a[28:31],a[156:159],v[124:127]
DT a[98:99],v2,33792
M v[124:127],a[24:27],a[152:155],v[124:127]
buffer_load_dwordx4 v5,s[8:11],s62 offen offset:2048 lds
M v[128:131],a[32:35],a[152:155],v[128:131]
DT a[100:101],v2,35328
M v[128:131],a[36:39],a[156:159],v[128:131]
M v[132:135],a[44:47],a[156:159],v[132:135]
DT a[102:103],v2,35840
M v[132:135],a[40:43],a[152:155],v[132:135]
M v[136:139],a[48:51],a[152:155],v[136:139]
DT a[104:105],v2,33312
M v[136:139],a[52:55],a[156:159],v[136:139]
buffer_load_dwordx4 v5,s[8:11],s63 offen offset:3072 lds
M v[140:143],a[60:63],a[156:159],v[140:143]
s_add_u32 s8,s8,524288
s_addc_u32 s9,s9,0
DT a[106:107],v2,33824
M v[140:143],a[56:59],a[152:155],v[140:143]
s_sub_u32 s10,s10,524288
M v[144:147],a[0:3],a[128:131],v[144:147]
buffer_store_dwordx4 a[176:179],v8,s[20:23],0 offen sc1
DR a[152:155],v1,1792
M v[144:147],a[4:7],a[132:135],v[144:147]
buffer_store_dwordx4 a[180:183],v9,s[20:23],0 offen sc1
DR a[156:159],v1,1856
M v[148:151],a[12:15],a[132:135],v[148:151]
DT a[108:109],v2,35360
M v[148:151],a[8:11],a[128:131],v[148:151]
DT a[110:111],v2,35872
M v[152:155],a[16:19],a[128:131],v[152:155]
buffer_load_dword a238,v15,s[88:91],s52 offen
M v[152:155],a[20:23],a[132:135],v[152:155]
s_add_u32 s52,s52,1048576
s_mov_b32 s92,s80
s_mov_b32 s93,s81
M v[156:159],a[28:31],a[132:135],v[156:159]
s_mov_b32 s94,256
s_mov_b32 s95,0x20000
DT a[112:113],v2,33344
M v[156:159],a[24:27],a[128:131],v[156:159]
buffer_load_dword v13,off,s[92:95],0 sc1
M v[160:163],a[32:35],a[128:131],v[160:163]
DT a[114:115],v2,33856
M v[160:163],a[36:39],a[132:135],v[160:163]
DT a[116:117],v2,35392
M v[164:167],a[44:47],a[132:135],v[164:167]
M v[164:167],a[40:43],a[128:131],v[164:167]
M v[168:171],a[48:51],a[128:131],v[168:171]
DT a[118:119],v2,35904
M v[168:171],a[52:55],a[132:135],v[168:171]
M v[172:175],a[60:63],a[132:135],v[172:175]
DT a[120:121],v2,33376
M v[172:175],a[56:59],a[128:131],v[172:175]
s_waitcnt lgkmcnt(15)
M v[176:179],a[0:3],a[136:139],v[176:179]
DT a[122:123],v2,33888
M v[176:179],a[4:7],a[140:143],v[176:179]
M v[180:183],a[12:15],a[140:143],v[180:183]
DT a[124:125],v2,35424
M v[180:183],a[8:11],a[136:139],v[180:183]
M v[184:187],a[16:19],a[136:139],v[184:187]
DT a[126:127],v2,35936
M v[184:187],a[20:23],a[140:143],v[184:187]
M v[188:191],a[28:31],a[140:143],v[188:191]
M v[188:191],a[24:27],a[136:139],v[188:191]
M v[192:195],a[32:35],a[136:139],v[192:195]
M v[192:195],a[36:39],a[140:143],v[192:195]
M v[196:199],a[44:47],a[140:143],v[196:199]
M v[196:199],a[40:43],a[136:139],v[196:199]
M v[200:203],a[48:51],a[136:139],v[200:203]
M v[200:203],a[52:55],a[140:143],v[200:203]
M v[204:207],a[60:63],a[140:143],v[204:207]
M v[204:207],a[56:59],a[136:139],v[204:207]
s_waitcnt vmcnt(12) lgkmcnt(0)
s_barrier
M v[208:211],a[0:3],a[144:147],v[208:211]
s_mov_b32 m0,s36
s_mul_i32 s46,s2,7296
DR a[128:131],v1,33152
M v[208:211],a[4:7],a[148:151],v[208:211]
s_add_u32 s20,s82,s46
s_addc_u32 s21,s83,0
DR a[132:135],v1,33216
M v[212:215],a[12:15],a[148:151],v[212:215]
s_add_u32 s20,s20,109051904
s_addc_u32 s21,s21,0
DR a[136:139],v1,33408
M v[212:215],a[8:11],a[144:147],v[212:215]
s_mov_b32 s22,7200
s_mov_b32 s23,0x20000
DR a[140:143],v1,33472
M v[216:219],a[16:19],a[144:147],v[216:219]
buffer_load_dwordx4 v3,s[4:7],s28 offen offset:0 lds
M v[216:219],a[20:23],a[148:151],v[216:219]
s_lshl_b32 s47,s42,10
v_add_u32 v12,s47,v4
v_bfe_u32 v10,v12,4,1
M v[220:223],a[28:31],a[148:151],v[220:223]
v_mul_u32_u24 v10,450,v10
v_lshrrev_b32 v6,5,v12
M v[220:223],a[24:27],a[144:147],v[220:223]
v_lshl_add_u32 v10,v6,1,v10
v_add_u32 v10,132608,v10
M v[224:227],a[32:35],a[144:147],v[224:227]
s_mov_b32 s46,4096
M v[224:227],a[36:39],a[148:151],v[224:227]
buffer_load_dwordx4 v3,s[4:7],s29 offen offset:1024 lds
M v[228:231],a[44:47],a[148:151],v[228:231]
M v[228:231],a[40:43],a[144:147],v[228:231]
M v[232:235],a[48:51],a[144:147],v[232:235]
M v[232:235],a[52:55],a[148:151],v[232:235]
M v[236:239],a[60:63],a[148:151],v[236:239]
buffer_load_dwordx4 v3,s[4:7],s30 offen offset:2048 lds
M v[236:239],a[56:59],a[144:147],v[236:239]
ds_read_u16 a160,v10 offset:0
M v[240:243],a[0:3],a[152:155],v[240:243]
DR a[144:147],v1,33664
M v[240:243],a[4:7],a[156:159],v[240:243]
DR a[148:151],v1,33728
M a[240:243],a[12:15],a[156:159],a[240:243]
ds_read_u16 a161,v10 offset:2048
M a[240:243],a[8:11],a[152:155],a[240:243]
ds_read_u16 a162,v10 offset:4096
M v[244:247],a[16:19],a[152:155],v[244:247]
buffer_load_dwordx4 v3,s[4:7],s31 offen offset:3072 lds
M v[244:247],a[20:23],a[156:159],v[244:247]
s_mov_b32 m0,s37
ds_read_u16 a163,v10 offset:6144
M a[244:247],a[28:31],a[156:159],a[244:247]
ds_read_u16 a164,v10 offset:1024
M a[244:247],a[24:27],a[152:155],a[244:247]
ds_read_u16 a165,v10 offset:3072
M v[248:251],a[32:35],a[152:155],v[248:251]
ds_read_u16 a166,v10 offset:5120
M v[248:251],a[36:39],a[156:159],v[248:251]
buffer_load_dwordx4 v3,s[4:7],s32 offen offset:0 lds
M a[248:251],a[44:47],a[156:159],a[248:251]
ds_read_u16 a167,v10 offset:7168
M a[248:251],a[40:43],a[152:155],a[248:251]
ds_read_u16 a168,v10 offset:256
M v[252:255],a[48:51],a[152:155],v[252:255]
ds_read_u16 a169,v10 offset:2304
M v[252:255],a[52:55],a[156:159],v[252:255]
ds_read_u16 a170,v10 offset:4352
M a[252:255],a[60:63],a[156:159],a[252:255]
ds_read_u16 a171,v10 offset:6400
M a[252:255],a[56:59],a[152:155],a[252:255]
s_waitcnt lgkmcnt(15)
ds_read_u16 a172,v10 offset:1280
M v[16:19],a[64:67],a[128:131],v[16:19]
DR a[152:155],v1,33920
M v[16:19],a[68:71],a[132:135],v[16:19]
DR a[156:159],v1,33984
M v[20:23],a[76:79],a[132:135],v[20:23]
buffer_load_dwordx4 v3,s[4:7],s33 offen offset:1024 lds
M v[20:23],a[72:75],a[128:131],v[20:23]
ds_read_u16 a173,v10 offset:3328
M v[24:27],a[80:83],a[128:131],v[24:27]
ds_read_u16 a174,v10 offset:5376
M v[24:27],a[84:87],a[132:135],v[24:27]
buffer_load_dwordx4 v3,s[4:7],s34 offen offset:2048 lds
M v[28:31],a[92:95],a[132:135],v[28:31]
ds_read_u16 a175,v10 offset:7424
M v[28:31],a[88:91],a[128:131],v[28:31]
M v[32:35],a[96:99],a[128:131],v[32:35]
M v[32:35],a[100:103],a[132:135],v[32:35]
M v[36:39],a[108:111],a[132:135],v[36:39]
M v[36:39],a[104:107],a[128:131],v[36:39]
buffer_load_dwordx4 v3,s[4:7],s35 offen offset:3072 lds
M v[40:43],a[112:115],a[128:131],v[40:43]
s_add_u32 s4,s4,128
s_addc_u32 s5,s5,0
s_sub_u32 s6,s6,128
M v[40:43],a[116:119],a[132:135],v[40:43]
M v[44:47],a[124:127],a[132:135],v[44:47]
s_waitcnt lgkmcnt(0)
s_mov_b32 m0,s70
v_accvgpr_read_b32 v6,a161
M v[44:47],a[120:123],a[128:131],v[44:47]
s_waitcnt vmcnt(12)
s_barrier
M v[48:51],a[64:67],a[136:139],v[48:51]
DR a[128:131],v1,34176
v_accvgpr_read_b32 v14,a160
M v[48:51],a[68:71],a[140:143],v[48:51]
DR a[132:135],v1,34240
v_lshl_or_b32 v6,v6,16,v14
M v[52:55],a[76:79],a[140:143],v[52:55]
DT a[0:1],v2,0
v_accvgpr_read_b32 v7,a163
M v[52:55],a[72:75],a[136:139],v[52:55]
DT a[2:3],v2,512
v_accvgpr_read_b32 v14,a162
M v[56:59],a[80:83],a[136:139],v[56:59]
buffer_load_dwordx4 v5,s[8:11],s56 offen offset:0 lds
M v[56:59],a[84:87],a[140:143],v[56:59]
DT a[4:5],v2,2048
v_lshl_or_b32 v7,v7,16,v14
M v[60:63],a[92:95],a[140:143],v[60:63]
v_accvgpr_read_b32 v8,a165
v_accvgpr_read_b32 v14,a164
M v[60:63],a[88:91],a[136:139],v[60:63]
DT a[6:7],v2,2560
v_lshl_or_b32 v8,v8,16,v14
M v[64:67],a[96:99],a[136:139],v[64:67]
v_accvgpr_read_b32 v9,a167
v_accvgpr_read_b32 v14,a166
M v[64:67],a[100:103],a[140:143],v[64:67]
DT a[8:9],v2,32
v_lshl_or_b32 v9,v9,16,v14
M v[68:71],a[108:111],a[140:143],v[68:71]
buffer_load_dwordx4 v5,s[8:11],s57 offen offset:1024 lds
M v[68:71],a[104:107],a[136:139],v[68:71]
buffer_store_dwordx4 v[6:9],v12,s[20:23],0 offen sc1
DT a[10:11],v2,544
M v[72:75],a[112:115],a[136:139],v[72:75]
s_nop 0
v_accvgpr_read_b32 v6,a169
v_accvgpr_read_b32 v14,a168
M v[72:75],a[116:119],a[140:143],v[72:75]
v_lshl_or_b32 v6,v6,16,v14
v_accvgpr_read_b32 v7,a171
M v[76:79],a[124:127],a[140:143],v[76:79]
DT a[12:13],v2,2080
v_accvgpr_read_b32 v14,a170
M v[76:79],a[120:123],a[136:139],v[76:79]
v_lshl_or_b32 v7,v7,16,v14
v_accvgpr_read_b32 v8,a173
M v[80:83],a[64:67],a[144:147],v[80:83]
DR a[136:139],v1,34432
v_accvgpr_read_b32 v14,a172
M v[80:83],a[68:71],a[148:151],v[80:83]
DR a[140:143],v1,34496
v_lshl_or_b32 v8,v8,16,v14
M v[84:87],a[76:79],a[148:151],v[84:87]
DT a[14:15],v2,2592
v_accvgpr_read_b32 v9,a175
M v[84:87],a[72:75],a[144:147],v[84:87]
DT a[16:17],v2,64
v_accvgpr_read_b32 v14,a174
M v[88:91],a[80:83],a[144:147],v[88:91]
DT a[18:19],v2,576
v_lshl_or_b32 v9,v9,16,v14
M v[88:91],a[84:87],a[148:151],v[88:91]
buffer_load_dwordx4 v5,s[8:11],s58 offen offset:2048 lds
M v[92:95],a[92:95],a[148:151],v[92:95]
buffer_store_dwordx4 v[6:9],v12,s[20:23],s46 offen sc1
DT a[20:21],v2,2112
M v[92:95],a[88:91],a[144:147],v[92:95]
buffer_load_dwordx4 v5,s[8:11],s59 offen offset:3072 lds
M v[96:99],a[96:99],a[144:147],v[96:99]
s_mov_b32 m0,s71
s_nop 0
M v[96:99],a[100:103],a[148:151],v[96:99]
DT a[22:23],v2,2624
M v[100:103],a[108:111],a[148:151],v[100:103]
M v[100:103],a[104:107],a[144:147],v[100:103]
DT a[24:25],v2,96
M v[104:107],a[112:115],a[144:147],v[104:107]
buffer_load_dwordx4 v5,s[8:11],s60 offen offset:0 lds
M v[104:107],a[116:119],a[148:151],v[104:107]
DT a[26:27],v2,608
M v[108:111],a[124:127],a[148:151],v[108:111]
M v[108:111],a[120:123],a[144:147],v[108:111]
DT a[28:29],v2,2144
M v[112:115],a[64:67],a[152:155],v[112:115]
DR a[144:147],v1,34688
M v[112:115],a[68:71],a[156:159],v[112:115]
DR a[148:151],v1,34752
M v[116:119],a[76:79],a[156:159],v[116:119]
DT a[30:31],v2,2656
M v[116:119],a[72:75],a[152:155],v[116:119]
DT a[32:33],v2,128
M v[120:123],a[80:83],a[152:155],v[120:123]
buffer_load_dwordx4 v5,s[8:11],s61 offen offset:1024 lds
M v[120:123],a[84:87],a[156:159],v[120:123]
M v[124:127],a[92:95],a[156:159],v[124:127]
DT a[34:35],v2,640
M v[124:127],a[88:91],a[152:155],v[124:127]
buffer_load_dwordx4 v5,s[8:11],s62 offen offset:2048 lds
M v[128:131],a[96:99],a[152:155],v[128:131]
DT a[36:37],v2,2176
M v[128:131],a[100:103],a[156:159],v[128:131]
M v[132:135],a[108:111],a[156:159],v[132:135]
DT a[38:39],v2,2688
M v[132:135],a[104:107],a[152:155],v[132:135]
M v[136:139],a[112:115],a[152:155],v[136:139]
DT a[40:41],v2,160
M v[136:139],a[116:119],a[156:159],v[136:139]
buffer_load_dwordx4 v5,s[8:11],s63 offen offset:3072 lds
M v[140:143],a[124:127],a[156:159],v[140:143]
s_add_u32 s8,s8,524288
s_addc_u32 s9,s9,0
DT a[42:43],v2,672
M v[140:143],a[120:123],a[152:155],v[140:143]
s_waitcnt lgkmcnt(15)
s_sub_u32 s10,s10,524288
M v[144:147],a[64:67],a[128:131],v[144:147]
DR a[152:155],v1,34944
M v[144:147],a[68:71],a[132:135],v[144:147]
DR a[156:159],v1,35008
M v[148:151],a[76:79],a[132:135],v[148:151]
DT a[44:45],v2,2208
M v[148:151],a[72:75],a[128:131],v[148:151]
DT a[46:47],v2,2720
M v[152:155],a[80:83],a[128:131],v[152:155]
buffer_load_dword a238,v0,s[84:87],s51 offen
M v[152:155],a[84:87],a[132:135],v[152:155]
s_add_u32 s51,s51,256
DT a[48:49],v2,192
M v[156:159],a[92:95],a[132:135],v[156:159]
M v[156:159],a[88:91],a[128:131],v[156:159]
DT a[50:51],v2,704
M v[160:163],a[96:99],a[128:131],v[160:163]
M v[160:163],a[100:103],a[132:135],v[160:163]
DT a[52:53],v2,2240
M v[164:167],a[108:111],a[132:135],v[164:167]
M v[164:167],a[104:107],a[128:131],v[164:167]
M v[168:171],a[112:115],a[128:131],v[168:171]
DT a[54:55],v2,2752
M v[168:171],a[116:119],a[132:135],v[168:171]
M v[172:175],a[124:127],a[132:135],v[172:175]
DT a[56:57],v2,224
M v[172:175],a[120:123],a[128:131],v[172:175]
M v[176:179],a[64:67],a[136:139],v[176:179]
DT a[58:59],v2,736
M v[176:179],a[68:71],a[140:143],v[176:179]
M v[180:183],a[76:79],a[140:143],v[180:183]
DT a[60:61],v2,2272
M v[180:183],a[72:75],a[136:139],v[180:183]
M v[184:187],a[80:83],a[136:139],v[184:187]
DT a[62:63],v2,2784
M v[184:187],a[84:87],a[140:143],v[184:187]
M v[188:191],a[92:95],a[140:143],v[188:191]
M v[188:191],a[88:91],a[136:139],v[188:191]
M v[192:195],a[96:99],a[136:139],v[192:195]
M v[192:195],a[100:103],a[140:143],v[192:195]
M v[196:199],a[108:111],a[140:143],v[196:199]
M v[196:199],a[104:107],a[136:139],v[196:199]
M v[200:203],a[112:115],a[136:139],v[200:203]
M v[200:203],a[116:119],a[140:143],v[200:203]
M v[204:207],a[124:127],a[140:143],v[204:207]
M v[204:207],a[120:123],a[136:139],v[204:207]
s_waitcnt vmcnt(11) lgkmcnt(0)
s_barrier
v_mov_b32 v14,0x7ff00000
v_cmp_eq_u32 vcc,1,v13
s_nop 0
s_cmp_eq_u64 vcc,-1
s_cbranch_scc0 L_spin0
L_spun0:
s_getreg_b32 s54,hwreg(HW_REG_XCC_ID)
s_and_b32 s54,s54,15
s_or_b32 s54,s54,0x80
s_lshl_b32 s46,s43,4
s_add_u32 s46,s46,s44
s_lshr_b32 s47,s46,3
s_mul_i32 s47,s47,120
s_add_u32 s46,s46,s47
s_add_u32 s46,s46,4096
s_cmp_eq_u32 s42,0
s_cbranch_scc0 L_nopub0
s_mov_b64 exec,1
v_mov_b32 v12,s54
buffer_store_byte v12,off,s[24:27],s46 offset:16 sc1
s_mov_b64 exec,-1
L_nopub0:
s_lshl_b32 s54,s54,16
s_or_b32 s44,s44,s54
s_lshl_b32 s46,s45,4
s_and_b32 s47,s2,15
s_add_u32 s46,s46,s47
s_lshl_b32 s46,s46,2
s_add_u32 s46,s46,s42
s_add_u32 s46,s46,0
s_mov_b32 s92,s72
s_mov_b32 s93,s73
s_mov_b32 s94,1835008
s_mov_b32 s95,0x20000
s_mul_i32 s47,s46,1792
v_lshlrev_b32 v13,3,v4
v_cmp_gt_u32 vcc,224,v4
s_nop 1
v_cndmask_b32 v13,v14,v13,vcc
buffer_load_dword a238,v13,s[92:95],s47 offen
s_lshl_b32 s46,s45,4
s_and_b32 s47,s2,15
s_add_u32 s46,s46,s47
s_lshl_b32 s46,s46,2
s_add_u32 s46,s46,s42
s_mov_b32 s98,3670016
s_mov_b32 s99,0x20000
v_lshlrev_b32 v13,3,v4
v_cmp_gt_u32 vcc,192,v4
s_nop 1
v_cndmask_b32 v13,v14,v13,vcc
s_mul_i32 s3,s46,7168
s_add_u32 s46,s46,s47
s_lshl_b32 s46,s46,2
s_add_u32 s46,s46,s42
s_mov_b32 s48,5
.p2align 4
L_kv_loop_b:
M v[208:211],a[64:67],a[144:147],v[208:211]
s_mov_b32 m0,s38
DR a[128:131],v1,0
M v[208:211],a[68:71],a[148:151],v[208:211]
DR a[132:135],v1,64
M v[212:215],a[76:79],a[148:151],v[212:215]
DR a[136:139],v1,256
M v[212:215],a[72:75],a[144:147],v[212:215]
DR a[140:143],v1,320
M v[216:219],a[80:83],a[144:147],v[216:219]
buffer_load_dwordx4 v3,s[4:7],s28 offen offset:0 lds
M v[216:219],a[84:87],a[148:151],v[216:219]
M v[220:223],a[92:95],a[148:151],v[220:223]
M v[220:223],a[88:91],a[144:147],v[220:223]
M v[224:227],a[96:99],a[144:147],v[224:227]
buffer_load_dwordx4 v3,s[4:7],s29 offen offset:1024 lds
M v[224:227],a[100:103],a[148:151],v[224:227]
M v[228:231],a[108:111],a[148:151],v[228:231]
M v[228:231],a[104:107],a[144:147],v[228:231]
M v[232:235],a[112:115],a[144:147],v[232:235]
M v[232:235],a[116:119],a[148:151],v[232:235]
M v[236:239],a[124:127],a[148:151],v[236:239]
buffer_load_dwordx4 v3,s[4:7],s30 offen offset:2048 lds
M v[236:239],a[120:123],a[144:147],v[236:239]
M v[240:243],a[64:67],a[152:155],v[240:243]
DR a[144:147],v1,512
M v[240:243],a[68:71],a[156:159],v[240:243]
DR a[148:151],v1,576
M a[240:243],a[76:79],a[156:159],a[240:243]
M a[240:243],a[72:75],a[152:155],a[240:243]
M v[244:247],a[80:83],a[152:155],v[244:247]
buffer_load_dwordx4 v3,s[4:7],s31 offen offset:3072 lds
M v[244:247],a[84:87],a[156:159],v[244:247]
s_mov_b32 m0,s39
M a[244:247],a[92:95],a[156:159],a[244:247]
M a[244:247],a[88:91],a[152:155],a[244:247]
M v[248:251],a[96:99],a[152:155],v[248:251]
M v[248:251],a[100:103],a[156:159],v[248:251]
buffer_load_dwordx4 v3,s[4:7],s32 offen offset:0 lds
M a[248:251],a[108:111],a[156:159],a[248:251]
M a[248:251],a[104:107],a[152:155],a[248:251]
M v[252:255],a[112:115],a[152:155],v[252:255]
M v[252:255],a[116:119],a[156:159],v[252:255]
M a[252:255],a[124:127],a[156:159],a[252:255]
M a[252:255],a[120:123],a[152:155],a[252:255]
s_waitcnt lgkmcnt(4)
M v[16:19],a[0:3],a[128:131],v[16:19]
DR a[152:155],v1,768
M v[16:19],a[4:7],a[132:135],v[16:19]
DR a[156:159],v1,832
M v[20:23],a[12:15],a[132:135],v[20:23]
buffer_load_dwordx4 v3,s[4:7],s33 offen offset:1024 lds
M v[20:23],a[8:11],a[128:131],v[20:23]
M v[24:27],a[16:19],a[128:131],v[24:27]
M v[24:27],a[20:23],a[132:135],v[24:27]
buffer_load_dwordx4 v3,s[4:7],s34 offen offset:2048 lds
M v[28:31],a[28:31],a[132:135],v[28:31]
M v[28:31],a[24:27],a[128:131],v[28:31]
M v[32:35],a[32:35],a[128:131],v[32:35]
M v[32:35],a[36:39],a[132:135],v[32:35]
M v[36:39],a[44:47],a[132:135],v[36:39]
M v[36:39],a[40:43],a[128:131],v[36:39]
buffer_load_dwordx4 v3,s[4:7],s35 offen offset:3072 lds
M v[40:43],a[48:51],a[128:131],v[40:43]
s_add_u32 s4,s4,128
s_addc_u32 s5,s5,0
s_sub_u32 s6,s6,128
M v[40:43],a[52:55],a[132:135],v[40:43]
M v[44:47],a[60:63],a[132:135],v[44:47]
s_mov_b32 m0,s68
M v[44:47],a[56:59],a[128:131],v[44:47]
s_waitcnt vmcnt(9) lgkmcnt(4)
s_barrier
M v[48:51],a[0:3],a[136:139],v[48:51]
DR a[128:131],v1,1024
M v[48:51],a[4:7],a[140:143],v[48:51]
DR a[132:135],v1,1088
M v[52:55],a[12:15],a[140:143],v[52:55]
DT a[64:65],v2,33152
M v[52:55],a[8:11],a[136:139],v[52:55]
DT a[66:67],v2,33664
M v[56:59],a[16:19],a[136:139],v[56:59]
buffer_load_dwordx4 v5,s[8:11],s56 offen offset:0 lds
M v[56:59],a[20:23],a[140:143],v[56:59]
DT a[68:69],v2,35200
M v[60:63],a[28:31],a[140:143],v[60:63]
M v[60:63],a[24:27],a[136:139],v[60:63]
DT a[70:71],v2,35712
M v[64:67],a[32:35],a[136:139],v[64:67]
M v[64:67],a[36:39],a[140:143],v[64:67]
DT a[72:73],v2,33184
M v[68:71],a[44:47],a[140:143],v[68:71]
buffer_load_dwordx4 v5,s[8:11],s57 offen offset:1024 lds
M v[68:71],a[40:43],a[136:139],v[68:71]
DT a[74:75],v2,33696
M v[72:75],a[48:51],a[136:139],v[72:75]
M v[72:75],a[52:55],a[140:143],v[72:75]
M v[76:79],a[60:63],a[140:143],v[76:79]
DT a[76:77],v2,35232
M v[76:79],a[56:59],a[136:139],v[76:79]
s_waitcnt lgkmcnt(11)
M v[80:83],a[0:3],a[144:147],v[80:83]
DR a[136:139],v1,1280
M v[80:83],a[4:7],a[148:151],v[80:83]
DR a[140:143],v1,1344
M v[84:87],a[12:15],a[148:151],v[84:87]
DT a[78:79],v2,35744
M v[84:87],a[8:11],a[144:147],v[84:87]
DT a[80:81],v2,33216
M v[88:91],a[16:19],a[144:147],v[88:91]
DT a[82:83],v2,33728
M v[88:91],a[20:23],a[148:151],v[88:91]
buffer_load_dwordx4 v5,s[8:11],s58 offen offset:2048 lds
M v[92:95],a[28:31],a[148:151],v[92:95]
DT a[84:85],v2,35264
M v[92:95],a[24:27],a[144:147],v[92:95]
buffer_load_dwordx4 v5,s[8:11],s59 offen offset:3072 lds
M v[96:99],a[32:35],a[144:147],v[96:99]
s_mov_b32 m0,s69
M v[96:99],a[36:39],a[148:151],v[96:99]
DT a[86:87],v2,35776
M v[100:103],a[44:47],a[148:151],v[100:103]
M v[100:103],a[40:43],a[144:147],v[100:103]
DT a[88:89],v2,33248
M v[104:107],a[48:51],a[144:147],v[104:107]
buffer_load_dwordx4 v5,s[8:11],s60 offen offset:0 lds
M v[104:107],a[52:55],a[148:151],v[104:107]
DT a[90:91],v2,33760
M v[108:111],a[60:63],a[148:151],v[108:111]
M v[108:111],a[56:59],a[144:147],v[108:111]
s_waitcnt lgkmcnt(15)
DT a[92:93],v2,35296
M v[112:115],a[0:3],a[152:155],v[112:115]
DR a[144:147],v1,1536
M v[112:115],a[4:7],a[156:159],v[112:115]
DR a[148:151],v1,1600
M v[116:119],a[12:15],a[156:159],v[116:119]
DT a[94:95],v2,35808
M v[116:119],a[8:11],a[152:155],v[116:119]
DT a[96:97],v2,33280
M v[120:123],a[16:19],a[152:155],v[120:123]
buffer_load_dwordx4 v5,s[8:11],s61 offen offset:1024 lds
M v[120:123],a[20:23],a[156:159],v[120:123]
M v[124:127],a[28:31],a[156:159],v[124:127]
DT a[98:99],v2,33792
M v[124:127],a[24:27],a[152:155],v[124:127]
buffer_load_dwordx4 v5,s[8:11],s62 offen offset:2048 lds
M v[128:131],a[32:35],a[152:155],v[128:131]
DT a[100:101],v2,35328
M v[128:131],a[36:39],a[156:159],v[128:131]
M v[132:135],a[44:47],a[156:159],v[132:135]
DT a[102:103],v2,35840
M v[132:135],a[40:43],a[152:155],v[132:135]
M v[136:139],a[48:51],a[152:155],v[136:139]
DT a[104:105],v2,33312
M v[136:139],a[52:55],a[156:159],v[136:139]
buffer_load_dwordx4 v5,s[8:11],s63 offen offset:3072 lds
M v[140:143],a[60:63],a[156:159],v[140:143]
s_add_u32 s8,s8,524288
s_addc_u32 s9,s9,0
DT a[106:107],v2,33824
M v[140:143],a[56:59],a[152:155],v[140:143]
s_sub_u32 s10,s10,524288
M v[144:147],a[0:3],a[128:131],v[144:147]
DR a[152:155],v1,1792
M v[144:147],a[4:7],a[132:135],v[144:147]
DR a[156:159],v1,1856
M v[148:151],a[12:15],a[132:135],v[148:151]
DT a[108:109],v2,35360
M v[148:151],a[8:11],a[128:131],v[148:151]
DT a[110:111],v2,35872
M v[152:155],a[16:19],a[128:131],v[152:155]
buffer_load_dword a238,v15,s[88:91],s52 offen
M v[152:155],a[20:23],a[132:135],v[152:155]
s_add_u32 s52,s52,1048576
DT a[112:113],v2,33344
M v[156:159],a[28:31],a[132:135],v[156:159]
buffer_load_dword a238,v13,s[96:99],s3 offen
M v[156:159],a[24:27],a[128:131],v[156:159]
s_add_u32 s3,s3,1536
DT a[114:115],v2,33856
M v[160:163],a[32:35],a[128:131],v[160:163]
M v[160:163],a[36:39],a[132:135],v[160:163]
DT a[116:117],v2,35392
M v[164:167],a[44:47],a[132:135],v[164:167]
M v[164:167],a[40:43],a[128:131],v[164:167]
M v[168:171],a[48:51],a[128:131],v[168:171]
DT a[118:119],v2,35904
M v[168:171],a[52:55],a[132:135],v[168:171]
M v[172:175],a[60:63],a[132:135],v[172:175]
DT a[120:121],v2,33376
M v[172:175],a[56:59],a[128:131],v[172:175]
s_waitcnt lgkmcnt(15)
M v[176:179],a[0:3],a[136:139],v[176:179]
DT a[122:123],v2,33888
M v[176:179],a[4:7],a[140:143],v[176:179]
M v[180:183],a[12:15],a[140:143],v[180:183]
DT a[124:125],v2,35424
M v[180:183],a[8:11],a[136:139],v[180:183]
M v[184:187],a[16:19],a[136:139],v[184:187]
DT a[126:127],v2,35936
M v[184:187],a[20:23],a[140:143],v[184:187]
M v[188:191],a[28:31],a[140:143],v[188:191]
M v[188:191],a[24:27],a[136:139],v[188:191]
M v[192:195],a[32:35],a[136:139],v[192:195]
M v[192:195],a[36:39],a[140:143],v[192:195]
M v[196:199],a[44:47],a[140:143],v[196:199]
M v[196:199],a[40:43],a[136:139],v[196:199]
M v[200:203],a[48:51],a[136:139],v[200:203]
M v[200:203],a[52:55],a[140:143],v[200:203]
M v[204:207],a[60:63],a[140:143],v[204:207]
M v[204:207],a[56:59],a[136:139],v[204:207]
s_waitcnt vmcnt(10) lgkmcnt(0)
s_barrier
M v[208:211],a[0:3],a[144:147],v[208:211]
s_mov_b32 m0,s36
DR a[128:131],v1,33152
M v[208:211],a[4:7],a[148:151],v[208:211]
DR a[132:135],v1,33216
M v[212:215],a[12:15],a[148:151],v[212:215]
DR a[136:139],v1,33408
M v[212:215],a[8:11],a[144:147],v[212:215]
DR a[140:143],v1,33472
M v[216:219],a[16:19],a[144:147],v[216:219]
buffer_load_dwordx4 v3,s[4:7],s28 offen offset:0 lds
M v[216:219],a[20:23],a[148:151],v[216:219]
M v[220:223],a[28:31],a[148:151],v[220:223]
M v[220:223],a[24:27],a[144:147],v[220:223]
M v[224:227],a[32:35],a[144:147],v[224:227]
buffer_load_dwordx4 v3,s[4:7],s29 offen offset:1024 lds
M v[224:227],a[36:39],a[148:151],v[224:227]
M v[228:231],a[44:47],a[148:151],v[228:231]
M v[228:231],a[40:43],a[144:147],v[228:231]
M v[232:235],a[48:51],a[144:147],v[232:235]
M v[232:235],a[52:55],a[148:151],v[232:235]
M v[236:239],a[60:63],a[148:151],v[236:239]
buffer_load_dwordx4 v3,s[4:7],s30 offen offset:2048 lds
M v[236:239],a[56:59],a[144:147],v[236:239]
M v[240:243],a[0:3],a[152:155],v[240:243]
DR a[144:147],v1,33664
M v[240:243],a[4:7],a[156:159],v[240:243]
DR a[148:151],v1,33728
M a[240:243],a[12:15],a[156:159],a[240:243]
M a[240:243],a[8:11],a[152:155],a[240:243]
M v[244:247],a[16:19],a[152:155],v[244:247]
buffer_load_dwordx4 v3,s[4:7],s31 offen offset:3072 lds
M v[244:247],a[20:23],a[156:159],v[244:247]
s_mov_b32 m0,s37
M a[244:247],a[28:31],a[156:159],a[244:247]
M a[244:247],a[24:27],a[152:155],a[244:247]
M v[248:251],a[32:35],a[152:155],v[248:251]
M v[248:251],a[36:39],a[156:159],v[248:251]
buffer_load_dwordx4 v3,s[4:7],s32 offen offset:0 lds
M a[248:251],a[44:47],a[156:159],a[248:251]
M a[248:251],a[40:43],a[152:155],a[248:251]
M v[252:255],a[48:51],a[152:155],v[252:255]
M v[252:255],a[52:55],a[156:159],v[252:255]
M a[252:255],a[60:63],a[156:159],a[252:255]
M a[252:255],a[56:59],a[152:155],a[252:255]
s_waitcnt lgkmcnt(4)
M v[16:19],a[64:67],a[128:131],v[16:19]
DR a[152:155],v1,33920
M v[16:19],a[68:71],a[132:135],v[16:19]
DR a[156:159],v1,33984
M v[20:23],a[76:79],a[132:135],v[20:23]
buffer_load_dwordx4 v3,s[4:7],s33 offen offset:1024 lds
M v[20:23],a[72:75],a[128:131],v[20:23]
M v[24:27],a[80:83],a[128:131],v[24:27]
M v[24:27],a[84:87],a[132:135],v[24:27]
buffer_load_dwordx4 v3,s[4:7],s34 offen offset:2048 lds
M v[28:31],a[92:95],a[132:135],v[28:31]
M v[28:31],a[88:91],a[128:131],v[28:31]
M v[32:35],a[96:99],a[128:131],v[32:35]
M v[32:35],a[100:103],a[132:135],v[32:35]
M v[36:39],a[108:111],a[132:135],v[36:39]
M v[36:39],a[104:107],a[128:131],v[36:39]
buffer_load_dwordx4 v3,s[4:7],s35 offen offset:3072 lds
M v[40:43],a[112:115],a[128:131],v[40:43]
s_add_u32 s4,s4,128
s_addc_u32 s5,s5,0
s_sub_u32 s6,s6,128
M v[40:43],a[116:119],a[132:135],v[40:43]
M v[44:47],a[124:127],a[132:135],v[44:47]
s_mov_b32 m0,s70
M v[44:47],a[120:123],a[128:131],v[44:47]
s_waitcnt vmcnt(10) lgkmcnt(4)
s_barrier
M v[48:51],a[64:67],a[136:139],v[48:51]
DR a[128:131],v1,34176
M v[48:51],a[68:71],a[140:143],v[48:51]
DR a[132:135],v1,34240
M v[52:55],a[76:79],a[140:143],v[52:55]
DT a[0:1],v2,0
M v[52:55],a[72:75],a[136:139],v[52:55]
DT a[2:3],v2,512
M v[56:59],a[80:83],a[136:139],v[56:59]
buffer_load_dwordx4 v5,s[8:11],s56 offen offset:0 lds
M v[56:59],a[84:87],a[140:143],v[56:59]
DT a[4:5],v2,2048
M v[60:63],a[92:95],a[140:143],v[60:63]
M v[60:63],a[88:91],a[136:139],v[60:63]
DT a[6:7],v2,2560
M v[64:67],a[96:99],a[136:139],v[64:67]
M v[64:67],a[100:103],a[140:143],v[64:67]
DT a[8:9],v2,32
M v[68:71],a[108:111],a[140:143],v[68:71]
buffer_load_dwordx4 v5,s[8:11],s57 offen offset:1024 lds
M v[68:71],a[104:107],a[136:139],v[68:71]
DT a[10:11],v2,544
M v[72:75],a[112:115],a[136:139],v[72:75]
M v[72:75],a[116:119],a[140:143],v[72:75]
M v[76:79],a[124:127],a[140:143],v[76:79]
DT a[12:13],v2,2080
M v[76:79],a[120:123],a[136:139],v[76:79]
s_waitcnt lgkmcnt(11)
M v[80:83],a[64:67],a[144:147],v[80:83]
DR a[136:139],v1,34432
M v[80:83],a[68:71],a[148:151],v[80:83]
DR a[140:143],v1,34496
M v[84:87],a[76:79],a[148:151],v[84:87]
DT a[14:15],v2,2592
M v[84:87],a[72:75],a[144:147],v[84:87]
DT a[16:17],v2,64
M v[88:91],a[80:83],a[144:147],v[88:91]
DT a[18:19],v2,576
M v[88:91],a[84:87],a[148:151],v[88:91]
buffer_load_dwordx4 v5,s[8:11],s58 offen offset:2048 lds
M v[92:95],a[92:95],a[148:151],v[92:95]
DT a[20:21],v2,2112
M v[92:95],a[88:91],a[144:147],v[92:95]
buffer_load_dwordx4 v5,s[8:11],s59 offen offset:3072 lds
M v[96:99],a[96:99],a[144:147],v[96:99]
s_mov_b32 m0,s71
M v[96:99],a[100:103],a[148:151],v[96:99]
DT a[22:23],v2,2624
M v[100:103],a[108:111],a[148:151],v[100:103]
M v[100:103],a[104:107],a[144:147],v[100:103]
DT a[24:25],v2,96
M v[104:107],a[112:115],a[144:147],v[104:107]
buffer_load_dwordx4 v5,s[8:11],s60 offen offset:0 lds
M v[104:107],a[116:119],a[148:151],v[104:107]
DT a[26:27],v2,608
M v[108:111],a[124:127],a[148:151],v[108:111]
M v[108:111],a[120:123],a[144:147],v[108:111]
s_waitcnt lgkmcnt(15)
DT a[28:29],v2,2144
M v[112:115],a[64:67],a[152:155],v[112:115]
DR a[144:147],v1,34688
M v[112:115],a[68:71],a[156:159],v[112:115]
DR a[148:151],v1,34752
M v[116:119],a[76:79],a[156:159],v[116:119]
DT a[30:31],v2,2656
M v[116:119],a[72:75],a[152:155],v[116:119]
DT a[32:33],v2,128
M v[120:123],a[80:83],a[152:155],v[120:123]
buffer_load_dwordx4 v5,s[8:11],s61 offen offset:1024 lds
M v[120:123],a[84:87],a[156:159],v[120:123]
M v[124:127],a[92:95],a[156:159],v[124:127]
DT a[34:35],v2,640
M v[124:127],a[88:91],a[152:155],v[124:127]
buffer_load_dwordx4 v5,s[8:11],s62 offen offset:2048 lds
M v[128:131],a[96:99],a[152:155],v[128:131]
DT a[36:37],v2,2176
M v[128:131],a[100:103],a[156:159],v[128:131]
M v[132:135],a[108:111],a[156:159],v[132:135]
DT a[38:39],v2,2688
M v[132:135],a[104:107],a[152:155],v[132:135]
M v[136:139],a[112:115],a[152:155],v[136:139]
DT a[40:41],v2,160
M v[136:139],a[116:119],a[156:159],v[136:139]
buffer_load_dwordx4 v5,s[8:11],s63 offen offset:3072 lds
M v[140:143],a[124:127],a[156:159],v[140:143]
s_add_u32 s8,s8,524288
s_addc_u32 s9,s9,0
DT a[42:43],v2,672
M v[140:143],a[120:123],a[152:155],v[140:143]
s_sub_u32 s10,s10,524288
M v[144:147],a[64:67],a[128:131],v[144:147]
DR a[152:155],v1,34944
M v[144:147],a[68:71],a[132:135],v[144:147]
DR a[156:159],v1,35008
M v[148:151],a[76:79],a[132:135],v[148:151]
DT a[44:45],v2,2208
M v[148:151],a[72:75],a[128:131],v[148:151]
DT a[46:47],v2,2720
M v[152:155],a[80:83],a[128:131],v[152:155]
buffer_load_dword a238,v0,s[84:87],s51 offen
M v[152:155],a[84:87],a[132:135],v[152:155]
s_add_u32 s51,s51,256
DT a[48:49],v2,192
M v[156:159],a[92:95],a[132:135],v[156:159]
M v[156:159],a[88:91],a[128:131],v[156:159]
DT a[50:51],v2,704
M v[160:163],a[96:99],a[128:131],v[160:163]
M v[160:163],a[100:103],a[132:135],v[160:163]
DT a[52:53],v2,2240
M v[164:167],a[108:111],a[132:135],v[164:167]
M v[164:167],a[104:107],a[128:131],v[164:167]
M v[168:171],a[112:115],a[128:131],v[168:171]
DT a[54:55],v2,2752
M v[168:171],a[116:119],a[132:135],v[168:171]
M v[172:175],a[124:127],a[132:135],v[172:175]
DT a[56:57],v2,224
M v[172:175],a[120:123],a[128:131],v[172:175]
s_waitcnt lgkmcnt(15)
M v[176:179],a[64:67],a[136:139],v[176:179]
DT a[58:59],v2,736
M v[176:179],a[68:71],a[140:143],v[176:179]
M v[180:183],a[76:79],a[140:143],v[180:183]
DT a[60:61],v2,2272
M v[180:183],a[72:75],a[136:139],v[180:183]
M v[184:187],a[80:83],a[136:139],v[184:187]
DT a[62:63],v2,2784
M v[184:187],a[84:87],a[140:143],v[184:187]
M v[188:191],a[92:95],a[140:143],v[188:191]
M v[188:191],a[88:91],a[136:139],v[188:191]
M v[192:195],a[96:99],a[136:139],v[192:195]
M v[192:195],a[100:103],a[140:143],v[192:195]
M v[196:199],a[108:111],a[140:143],v[196:199]
M v[196:199],a[104:107],a[136:139],v[196:199]
M v[200:203],a[112:115],a[136:139],v[200:203]
M v[200:203],a[116:119],a[140:143],v[200:203]
M v[204:207],a[124:127],a[140:143],v[204:207]
M v[204:207],a[120:123],a[136:139],v[204:207]
s_waitcnt vmcnt(9) lgkmcnt(0)
s_barrier
s_sub_u32 s48,s48,1
s_cmp_lg_u32 s48,0
s_cbranch_scc1 L_kv_loop_b
L_postloop_b:
s_lshl_b32 s3,s43,8
s_add_u32 s3,s3,4096
v_lshrrev_b32 v13,2,v4
v_and_b32 v13,4,v13
v_lshl_or_b32 v13,v4,2,v13
v_and_b32 v13,0x84,v13
buffer_load_dword a239,v13,s[24:27],s3 offen offset:16 sc1
M v[208:211],a[64:67],a[144:147],v[208:211]
s_mov_b32 m0,s38
DR a[128:131],v1,0
v_mov_b32 v14,0x7ff00000
M v[208:211],a[68:71],a[148:151],v[208:211]
s_mov_b32 s64,4096
s_mov_b32 s65,3072
DR a[132:135],v1,64
M v[212:215],a[76:79],a[148:151],v[212:215]
s_mov_b32 s66,5632
s_mov_b32 s67,4608
DR a[136:139],v1,256
M v[212:215],a[72:75],a[144:147],v[212:215]
s_lshl_b32 s46,s43,9
DR a[140:143],v1,320
M v[216:219],a[80:83],a[144:147],v[216:219]
buffer_load_dwordx4 v3,s[4:7],s28 offen offset:0 lds
M v[216:219],a[84:87],a[148:151],v[216:219]
s_add_u32 s16,s76,s46
s_addc_u32 s17,s77,0
s_sub_u32 s18,3670016,s46
M v[220:223],a[92:95],a[148:151],v[220:223]
s_mov_b32 s19,0x20000
s_sub_u32 s46,15,s45
M v[220:223],a[88:91],a[144:147],v[220:223]
s_bitcmp1_b32 s44,0
s_cselect_b32 s47,s46,s45
s_mul_i32 s46,s47,114688
M v[224:227],a[96:99],a[144:147],v[224:227]
buffer_load_dwordx4 v3,s[4:7],s29 offen offset:1024 lds
M v[224:227],a[100:103],a[148:151],v[224:227]
s_sub_u32 s12,s72,4096
s_subb_u32 s13,s73,0
M v[228:231],a[108:111],a[148:151],v[228:231]
s_add_u32 s12,s12,s46
s_addc_u32 s13,s13,0
s_sub_u32 s14,1839104,s46
M v[228:231],a[104:107],a[144:147],v[228:231]
s_mov_b32 s15,0x20000
s_lshl_b32 s46,s43,20
s_lshl_b32 s47,s45,17
M v[232:235],a[112:115],a[144:147],v[232:235]
s_add_u32 s46,s46,s47
s_lshr_b32 s47,s42,1
s_lshl_b32 s47,s47,16
M v[232:235],a[116:119],a[148:151],v[232:235]
s_add_u32 s46,s46,s47
s_and_b32 s47,s42,1
s_lshl_b32 s47,s47,12
M v[236:239],a[124:127],a[148:151],v[236:239]
buffer_load_dwordx4 v3,s[4:7],s30 offen offset:2048 lds
M v[236:239],a[120:123],a[144:147],v[236:239]
s_add_u32 s46,s46,s47
s_add_u32 s96,s82,s46
s_addc_u32 s97,s83,0
M v[240:243],a[64:67],a[152:155],v[240:243]
s_mov_b32 s98,131072
s_mov_b32 s99,0x20000
DR a[144:147],v1,512
M v[240:243],a[68:71],a[156:159],v[240:243]
s_lshl_b32 s46,s43,9
DR a[148:151],v1,576
M a[240:243],a[76:79],a[156:159],a[240:243]
s_add_u32 s84,s76,s46
s_addc_u32 s85,s77,0
s_sub_u32 s86,3670016,s46
M a[240:243],a[72:75],a[152:155],a[240:243]
s_mov_b32 s87,0x20000
s_mov_b32 s46,s45
s_mul_i32 s46,s46,114688
M v[244:247],a[80:83],a[152:155],v[244:247]
s_add_u32 s88,s72,s46
s_addc_u32 s89,s73,0
s_sub_u32 s90,1835008,s46
M v[244:247],a[84:87],a[156:159],v[244:247]
s_mov_b32 s91,0x20000
s_lshl_b32 s46,s45,3
s_lshl_b32 s47,s42,1
M a[244:247],a[92:95],a[156:159],a[244:247]
s_add_u32 s46,s46,s47
v_lshrrev_b32 v13,6,v4
v_add_u32 v13,s46,v13
M a[244:247],a[88:91],a[152:155],a[244:247]
buffer_load_dwordx4 v3,s[4:7],s31 offen offset:3072 lds
M v[248:251],a[96:99],a[152:155],v[248:251]
s_mov_b32 m0,s39
v_and_b32 v0,48,v4
v_lshlrev_b32 v0,3,v0
M v[248:251],a[100:103],a[156:159],v[248:251]
buffer_load_dwordx4 v3,s[4:7],s32 offen offset:0 lds
M a[248:251],a[108:111],a[156:159],a[248:251]
v_lshl_add_u32 v13,v13,13,v0
v_cmp_gt_u32 vcc,128,v4
M a[248:251],a[104:107],a[152:155],a[248:251]
s_nop 0
v_cndmask_b32 v0,v14,v13,vcc
M v[252:255],a[112:115],a[152:155],v[252:255]
s_and_b32 s46,s43,1
s_lshl_b32 s46,s46,6
s_lshl_b32 s47,s42,4
M v[252:255],a[116:119],a[156:159],v[252:255]
s_add_u32 s46,s46,s47
v_lshrrev_b32 v13,4,v4
v_add_u32 v13,s46,v13
M a[252:255],a[124:127],a[156:159],a[252:255]
v_mul_u32_u24 v13,896,v13
v_cmp_gt_u32 vcc,256,v4
M a[252:255],a[120:123],a[152:155],a[252:255]
s_waitcnt lgkmcnt(4)
s_nop 0
v_cndmask_b32 v15,v14,v13,vcc
v_lshrrev_b32 v12,4,v4
M v[16:19],a[0:3],a[128:131],v[16:19]
s_lshr_b32 s46,s42,1
s_lshl_b32 s46,s46,2
DR a[152:155],v1,768
M v[16:19],a[4:7],a[132:135],v[16:19]
s_and_b32 s47,s42,1
s_add_u32 s46,s46,s47
DR a[156:159],v1,832
M v[20:23],a[12:15],a[132:135],v[20:23]
s_lshl_b32 s46,s46,1
v_lshrrev_b32 v6,5,v12
v_sub_u32 v7,7,v6
M v[20:23],a[8:11],a[128:131],v[20:23]
buffer_load_dwordx4 v3,s[4:7],s33 offen offset:1024 lds
M v[24:27],a[16:19],a[128:131],v[24:27]
v_and_b32 v8,16,v12
v_cmp_eq_u32 vcc,0,v8
M v[24:27],a[20:23],a[132:135],v[24:27]
buffer_load_dwordx4 v3,s[4:7],s34 offen offset:2048 lds
M v[28:31],a[28:31],a[132:135],v[28:31]
v_cndmask_b32 v6,v7,v6,vcc
v_mov_b32 v7,-28672
M v[28:31],a[24:27],a[128:131],v[28:31]
v_mov_b32 v8,28672
v_cndmask_b32 v9,v7,v8,vcc
M v[32:35],a[32:35],a[128:131],v[32:35]
v_lshlrev_b32 v6,4,v6
v_bfe_u32 v7,v12,3,1
M v[32:35],a[36:39],a[132:135],v[32:35]
v_add3_u32 v6,v6,v7,s46
v_mul_u32_u24 v6,896,v6
M v[36:39],a[44:47],a[132:135],v[36:39]
v_and_b32 v7,7,v12
v_lshl_add_u32 v8,v7,4,v6
M v[36:39],a[40:43],a[128:131],v[36:39]
buffer_load_dwordx4 v3,s[4:7],s35 offen offset:3072 lds
M v[40:43],a[48:51],a[128:131],v[40:43]
v_add_u32 v9,v9,v8
v_bfe_u32 v6,v12,3,1
M v[40:43],a[52:55],a[132:135],v[40:43]
v_lshlrev_b32 v6,2,v6
v_bfe_u32 v7,v12,1,1
M v[44:47],a[60:63],a[132:135],v[44:47]
v_lshl_or_b32 v6,v7,1,v6
v_bfe_u32 v7,v12,2,1
M v[44:47],a[56:59],a[128:131],v[44:47]
s_waitcnt vmcnt(10) lgkmcnt(4)
s_barrier
M v[48:51],a[0:3],a[136:139],v[48:51]
DR a[128:131],v1,1024
v_or_b32 v6,v6,v7
M v[48:51],a[4:7],a[140:143],v[48:51]
DR a[132:135],v1,1088
v_lshrrev_b32 v7,1,v6
M v[52:55],a[12:15],a[140:143],v[52:55]
DT a[64:65],v2,33152
v_lshlrev_b32 v7,5,v7
M v[52:55],a[8:11],a[136:139],v[52:55]
DT a[66:67],v2,33664
v_and_b32 v10,1,v12
M v[56:59],a[16:19],a[136:139],v[56:59]
v_lshl_add_u32 v7,v10,7,v7
v_lshrrev_b32 v10,4,v12
M v[56:59],a[20:23],a[140:143],v[56:59]
DT a[68:69],v2,35200
v_lshl_add_u32 v7,v10,4,v7
M v[60:63],a[28:31],a[140:143],v[60:63]
s_lshl_b32 s46,s42,9
v_lshl_add_u32 v6,v6,11,v7
v_add_u32 v6,s46,v6
s_lshr_b32 s53,s2,3
s_mul_i32 s53,s53,120
s_add_u32 s50,s2,s53
s_add_u32 s50,s50,4096
s_cmp_eq_u32 s42,0
s_cbranch_scc0 L_nopub1
s_mov_b64 exec,1
v_mov_b32 v13,1
buffer_store_byte v13,off,s[24:27],s50 offset:0 sc1
s_mov_b64 exec,-1
L_nopub1:
M v[60:63],a[24:27],a[136:139],v[60:63]
DT a[70:71],v2,35712
v_add_u32 v7,132608,v6
M v[64:67],a[32:35],a[136:139],v[64:67]
s_and_b32 s46,s42,1
s_lshl_b32 s46,s46,8
v_subrev_u32 v12,s46,v2
M v[64:67],a[36:39],a[140:143],v[64:67]
DT a[72:73],v2,33184
v_subrev_u32 v10,33152,v12
M v[68:71],a[44:47],a[140:143],v[68:71]
s_add_u32 s4,s4,128
s_addc_u32 s5,s5,0
s_sub_u32 s6,s6,128
M v[68:71],a[40:43],a[136:139],v[68:71]
s_nop 0
s_mov_b32 s54,0
DT a[74:75],v2,33696
M v[72:75],a[48:51],a[136:139],v[72:75]
buffer_load_dword a238,v0,s[84:87],s54 offen
M v[72:75],a[52:55],a[140:143],v[72:75]
buffer_load_dword a238,v15,s[88:91],0 offen offset:0
M v[76:79],a[60:63],a[140:143],v[76:79]
s_mov_b32 s54,524288
DT a[76:77],v2,35232
M v[76:79],a[56:59],a[136:139],v[76:79]
s_waitcnt lgkmcnt(11)
M v[80:83],a[0:3],a[144:147],v[80:83]
DR a[136:139],v1,1280
M v[80:83],a[4:7],a[148:151],v[80:83]
DR a[140:143],v1,1344
M v[84:87],a[12:15],a[148:151],v[84:87]
DT a[78:79],v2,35744
M v[84:87],a[8:11],a[144:147],v[84:87]
DT a[80:81],v2,33216
M v[88:91],a[16:19],a[144:147],v[88:91]
DT a[82:83],v2,33728
M v[88:91],a[20:23],a[148:151],v[88:91]
buffer_load_dword a238,v0,s[84:87],s54 offen
M v[92:95],a[28:31],a[148:151],v[92:95]
DT a[84:85],v2,35264
M v[92:95],a[24:27],a[144:147],v[92:95]
buffer_load_dword a238,v15,s[88:91],0 offen offset:128
M v[96:99],a[32:35],a[144:147],v[96:99]
M v[96:99],a[36:39],a[148:151],v[96:99]
DT a[86:87],v2,35776
M v[100:103],a[44:47],a[148:151],v[100:103]
M v[100:103],a[40:43],a[144:147],v[100:103]
DT a[88:89],v2,33248
M v[104:107],a[48:51],a[144:147],v[104:107]
M v[104:107],a[52:55],a[148:151],v[104:107]
DT a[90:91],v2,33760
M v[108:111],a[60:63],a[148:151],v[108:111]
M v[108:111],a[56:59],a[144:147],v[108:111]
s_waitcnt lgkmcnt(15)
DT a[92:93],v2,35296
M v[112:115],a[0:3],a[152:155],v[112:115]
DR a[144:147],v1,1536
M v[112:115],a[4:7],a[156:159],v[112:115]
DR a[148:151],v1,1600
M v[116:119],a[12:15],a[156:159],v[116:119]
DT a[94:95],v2,35808
M v[116:119],a[8:11],a[152:155],v[116:119]
DT a[96:97],v2,33280
M v[120:123],a[16:19],a[152:155],v[120:123]
M v[120:123],a[20:23],a[156:159],v[120:123]
M v[124:127],a[28:31],a[156:159],v[124:127]
DT a[98:99],v2,33792
M v[124:127],a[24:27],a[152:155],v[124:127]
M v[128:131],a[32:35],a[152:155],v[128:131]
DT a[100:101],v2,35328
M v[128:131],a[36:39],a[156:159],v[128:131]
M v[132:135],a[44:47],a[156:159],v[132:135]
s_mov_b32 m0,s68
DT a[102:103],v2,35840
M v[132:135],a[40:43],a[152:155],v[132:135]
M v[136:139],a[48:51],a[152:155],v[136:139]
DT a[104:105],v2,33312
M v[136:139],a[52:55],a[156:159],v[136:139]
M v[140:143],a[60:63],a[156:159],v[140:143]
DT a[106:107],v2,33824
M v[140:143],a[56:59],a[152:155],v[140:143]
M v[144:147],a[0:3],a[128:131],v[144:147]
DR a[152:155],v1,1792
M v[144:147],a[4:7],a[132:135],v[144:147]
DR a[156:159],v1,1856
M v[148:151],a[12:15],a[132:135],v[148:151]
DT a[108:109],v2,35360
M v[148:151],a[8:11],a[128:131],v[148:151]
DT a[110:111],v2,35872
M v[152:155],a[16:19],a[128:131],v[152:155]
buffer_load_dwordx4 v5,s[16:19],s56 offen offset:0 lds
M v[152:155],a[20:23],a[132:135],v[152:155]
DT a[112:113],v2,33344
M v[156:159],a[28:31],a[132:135],v[156:159]
buffer_load_dwordx4 v5,s[16:19],s57 offen offset:1024 lds
M v[156:159],a[24:27],a[128:131],v[156:159]
DT a[114:115],v2,33856
M v[160:163],a[32:35],a[128:131],v[160:163]
buffer_load_dwordx4 v5,s[16:19],s58 offen offset:2048 lds
M v[160:163],a[36:39],a[132:135],v[160:163]
DT a[116:117],v2,35392
M v[164:167],a[44:47],a[132:135],v[164:167]
buffer_load_dwordx4 v5,s[16:19],s59 offen offset:3072 lds
M v[164:167],a[40:43],a[128:131],v[164:167]
s_mov_b32 m0,s69
M v[168:171],a[48:51],a[128:131],v[168:171]
DT a[118:119],v2,35904
M v[168:171],a[52:55],a[132:135],v[168:171]
buffer_load_dwordx4 v5,s[16:19],s60 offen offset:0 lds
M v[172:175],a[60:63],a[132:135],v[172:175]
DT a[120:121],v2,33376
M v[172:175],a[56:59],a[128:131],v[172:175]
s_waitcnt lgkmcnt(15)
M v[176:179],a[0:3],a[136:139],v[176:179]
DT a[122:123],v2,33888
M v[176:179],a[4:7],a[140:143],v[176:179]
buffer_load_dwordx4 v5,s[16:19],s61 offen offset:1024 lds
M v[180:183],a[12:15],a[140:143],v[180:183]
DT a[124:125],v2,35424
M v[180:183],a[8:11],a[136:139],v[180:183]
buffer_load_dwordx4 v5,s[16:19],s62 offen offset:2048 lds
M v[184:187],a[16:19],a[136:139],v[184:187]
DT a[126:127],v2,35936
M v[184:187],a[20:23],a[140:143],v[184:187]
buffer_load_dwordx4 v5,s[16:19],s63 offen offset:3072 lds
M v[188:191],a[28:31],a[140:143],v[188:191]
s_add_u32 s16,s16,524288
s_addc_u32 s17,s17,0
s_sub_u32 s18,s18,524288
M v[188:191],a[24:27],a[136:139],v[188:191]
s_add_u32 m0,s40,132608
M v[192:195],a[32:35],a[136:139],v[192:195]
buffer_load_dwordx4 v8,s[12:15],s64 offen offset:0 lds
M v[192:195],a[36:39],a[140:143],v[192:195]
buffer_load_dwordx4 v9,s[12:15],s65 offen offset:1024 lds
M v[196:199],a[44:47],a[140:143],v[196:199]
buffer_load_dwordx4 v8,s[12:15],s66 offen offset:2048 lds
M v[196:199],a[40:43],a[136:139],v[196:199]
buffer_load_dwordx4 v9,s[12:15],s67 offen offset:3072 lds
M v[200:203],a[48:51],a[136:139],v[200:203]
s_add_u32 s12,s12,128
s_addc_u32 s13,s13,0
s_sub_u32 s14,s14,128
M v[200:203],a[52:55],a[140:143],v[200:203]
s_mov_b32 s54,1048576
M v[204:207],a[60:63],a[140:143],v[204:207]
buffer_load_dword a238,v0,s[84:87],s54 offen
M v[204:207],a[56:59],a[136:139],v[204:207]
buffer_load_dword a238,v15,s[88:91],0 offen offset:256
s_waitcnt vmcnt(18) lgkmcnt(0)
s_barrier
v_accvgpr_read_b32 v13,a239
v_and_b32 v14,0x80808080,v13
v_cmp_eq_u32 vcc,0x80808080,v14
s_nop 0
s_cmp_eq_u64 vcc,-1
s_cbranch_scc0 L_spin1
L_spun1:
s_lshr_b32 s46,s44,16
s_mul_i32 s46,s46,0x01010101
v_cmp_eq_u32 vcc,s46,v13
s_nop 0
s_cmp_eq_u64 vcc,-1
s_cselect_b32 s46,0,0x100
s_or_b32 s44,s44,s46
M v[208:211],a[0:3],a[144:147],v[208:211]
s_mov_b32 m0,s70
DR a[128:131],v1,33152
M v[208:211],a[4:7],a[148:151],v[208:211]
DR a[132:135],v1,33216
M v[212:215],a[12:15],a[148:151],v[212:215]
DR a[136:139],v1,33408
M v[212:215],a[8:11],a[144:147],v[212:215]
DR a[140:143],v1,33472
M v[216:219],a[16:19],a[144:147],v[216:219]
buffer_load_dwordx4 v5,s[16:19],s56 offen offset:0 lds
M v[216:219],a[20:23],a[148:151],v[216:219]
M v[220:223],a[28:31],a[148:151],v[220:223]
M v[220:223],a[24:27],a[144:147],v[220:223]
buffer_load_dwordx4 v5,s[16:19],s57 offen offset:1024 lds
M v[224:227],a[32:35],a[144:147],v[224:227]
M v[224:227],a[36:39],a[148:151],v[224:227]
M v[228:231],a[44:47],a[148:151],v[228:231]
buffer_load_dwordx4 v5,s[16:19],s58 offen offset:2048 lds
M v[228:231],a[40:43],a[144:147],v[228:231]
M v[232:235],a[48:51],a[144:147],v[232:235]
M v[232:235],a[52:55],a[148:151],v[232:235]
M v[236:239],a[60:63],a[148:151],v[236:239]
buffer_load_dwordx4 v5,s[16:19],s59 offen offset:3072 lds
M v[236:239],a[56:59],a[144:147],v[236:239]
s_mov_b32 m0,s71
M v[240:243],a[0:3],a[152:155],v[240:243]
DR a[144:147],v1,33664
M v[240:243],a[4:7],a[156:159],v[240:243]
DR a[148:151],v1,33728
M a[240:243],a[12:15],a[156:159],a[240:243]
buffer_load_dwordx4 v5,s[16:19],s60 offen offset:0 lds
M a[240:243],a[8:11],a[152:155],a[240:243]
M v[244:247],a[16:19],a[152:155],v[244:247]
M v[244:247],a[20:23],a[156:159],v[244:247]
buffer_load_dwordx4 v5,s[16:19],s61 offen offset:1024 lds
M a[244:247],a[28:31],a[156:159],a[244:247]
M a[244:247],a[24:27],a[152:155],a[244:247]
M v[248:251],a[32:35],a[152:155],v[248:251]
buffer_load_dwordx4 v5,s[16:19],s62 offen offset:2048 lds
M v[248:251],a[36:39],a[156:159],v[248:251]
M a[248:251],a[44:47],a[156:159],a[248:251]
M a[248:251],a[40:43],a[152:155],a[248:251]
buffer_load_dwordx4 v5,s[16:19],s63 offen offset:3072 lds
M v[252:255],a[48:51],a[152:155],v[252:255]
s_add_u32 s16,s16,524288
s_addc_u32 s17,s17,0
s_sub_u32 s18,s18,524288
M v[252:255],a[52:55],a[156:159],v[252:255]
s_add_u32 m0,s40,0
M a[252:255],a[60:63],a[156:159],a[252:255]
M a[252:255],a[56:59],a[152:155],a[252:255]
s_waitcnt lgkmcnt(4)
M v[16:19],a[64:67],a[128:131],v[16:19]
DR a[152:155],v1,33920
M v[16:19],a[68:71],a[132:135],v[16:19]
DR a[156:159],v1,33984
M v[20:23],a[76:79],a[132:135],v[20:23]
buffer_load_dwordx4 v8,s[12:15],s64 offen offset:0 lds
M v[20:23],a[72:75],a[128:131],v[20:23]
buffer_load_dwordx4 v9,s[12:15],s65 offen offset:1024 lds
M v[24:27],a[80:83],a[128:131],v[24:27]
M v[24:27],a[84:87],a[132:135],v[24:27]
M v[28:31],a[92:95],a[132:135],v[28:31]
buffer_load_dwordx4 v8,s[12:15],s66 offen offset:2048 lds
M v[28:31],a[88:91],a[128:131],v[28:31]
M v[32:35],a[96:99],a[128:131],v[32:35]
M v[32:35],a[100:103],a[132:135],v[32:35]
buffer_load_dwordx4 v9,s[12:15],s67 offen offset:3072 lds
M v[36:39],a[108:111],a[132:135],v[36:39]
s_add_u32 s12,s12,128
s_addc_u32 s13,s13,0
s_sub_u32 s14,s14,128
M v[36:39],a[104:107],a[128:131],v[36:39]
M v[40:43],a[112:115],a[128:131],v[40:43]
s_mov_b32 s54,1572864
M v[40:43],a[116:119],a[132:135],v[40:43]
buffer_load_dword a238,v0,s[84:87],s54 offen
M v[44:47],a[124:127],a[132:135],v[44:47]
buffer_load_dword a238,v15,s[88:91],0 offen offset:384
M v[44:47],a[120:123],a[128:131],v[44:47]
s_waitcnt lgkmcnt(4)
M v[48:51],a[64:67],a[136:139],v[48:51]
DR a[128:131],v1,34176
M v[48:51],a[68:71],a[140:143],v[48:51]
DR a[132:135],v1,34240
M v[52:55],a[76:79],a[140:143],v[52:55]
M v[52:55],a[72:75],a[136:139],v[52:55]
M v[56:59],a[80:83],a[136:139],v[56:59]
M v[56:59],a[84:87],a[140:143],v[56:59]
CV v16,v16,v17
CV v17,v18,v19
M v[60:63],a[92:95],a[140:143],v[60:63]
CV v18,v20,v21
CV v19,v22,v23
M v[60:63],a[88:91],a[136:139],v[60:63]
CV v24,v24,v25
CV v25,v26,v27
M v[64:67],a[96:99],a[136:139],v[64:67]
CV v26,v28,v29
CV v27,v30,v31
M v[64:67],a[100:103],a[140:143],v[64:67]
CV v32,v32,v33
CV v33,v34,v35
M v[68:71],a[108:111],a[140:143],v[68:71]
CV v34,v36,v37
CV v35,v38,v39
M v[68:71],a[104:107],a[136:139],v[68:71]
s_mov_b32 s54,0
CV v40,v40,v41
CV v41,v42,v43
M v[72:75],a[112:115],a[136:139],v[72:75]
buffer_store_dwordx4 v[16:19],v4,s[96:99],s54 offen offset:0
CV v42,v44,v45
M v[72:75],a[116:119],a[140:143],v[72:75]
CV v43,v46,v47
M v[76:79],a[124:127],a[140:143],v[76:79]
M v[76:79],a[120:123],a[136:139],v[76:79]
s_waitcnt lgkmcnt(4)
M v[80:83],a[64:67],a[144:147],v[80:83]
s_mov_b32 s54,0
DR a[136:139],v1,34432
M v[80:83],a[68:71],a[148:151],v[80:83]
buffer_store_dwordx4 v[24:27],v4,s[96:99],s54 offen offset:1024
DR a[140:143],v1,34496
M v[84:87],a[76:79],a[148:151],v[84:87]
M v[84:87],a[72:75],a[144:147],v[84:87]
M v[88:91],a[80:83],a[144:147],v[88:91]
s_mov_b32 s54,0
M v[88:91],a[84:87],a[148:151],v[88:91]
buffer_store_dwordx4 v[32:35],v4,s[96:99],s54 offen offset:2048
CV v48,v48,v49
M v[92:95],a[92:95],a[148:151],v[92:95]
CV v49,v50,v51
CV v50,v52,v53
M v[92:95],a[88:91],a[144:147],v[92:95]
CV v51,v54,v55
CV v56,v56,v57
M v[96:99],a[96:99],a[144:147],v[96:99]
s_mov_b32 s54,0
CV v57,v58,v59
CV v58,v60,v61
M v[96:99],a[100:103],a[148:151],v[96:99]
buffer_store_dwordx4 v[40:43],v4,s[96:99],s54 offen offset:3072
CV v59,v62,v63
M v[100:103],a[108:111],a[148:151],v[100:103]
CV v64,v64,v65
CV v65,v66,v67
M v[100:103],a[104:107],a[144:147],v[100:103]
CV v66,v68,v69
CV v67,v70,v71
M v[104:107],a[112:115],a[144:147],v[104:107]
s_mov_b32 s54,8192
CV v72,v72,v73
CV v73,v74,v75
M v[104:107],a[116:119],a[148:151],v[104:107]
buffer_store_dwordx4 v[48:51],v4,s[96:99],s54 offen offset:0
CV v74,v76,v77
M v[108:111],a[124:127],a[148:151],v[108:111]
CV v75,v78,v79
M v[108:111],a[120:123],a[144:147],v[108:111]
s_waitcnt lgkmcnt(4)
M v[112:115],a[64:67],a[152:155],v[112:115]
s_mov_b32 s54,8192
DR a[144:147],v1,34688
M v[112:115],a[68:71],a[156:159],v[112:115]
buffer_store_dwordx4 v[56:59],v4,s[96:99],s54 offen offset:1024
DR a[148:151],v1,34752
M v[116:119],a[76:79],a[156:159],v[116:119]
M v[116:119],a[72:75],a[152:155],v[116:119]
M v[120:123],a[80:83],a[152:155],v[120:123]
s_mov_b32 s54,8192
M v[120:123],a[84:87],a[156:159],v[120:123]
buffer_store_dwordx4 v[64:67],v4,s[96:99],s54 offen offset:2048
CV v80,v80,v81
M v[124:127],a[92:95],a[156:159],v[124:127]
CV v81,v82,v83
CV v82,v84,v85
M v[124:127],a[88:91],a[152:155],v[124:127]
CV v83,v86,v87
CV v88,v88,v89
M v[128:131],a[96:99],a[152:155],v[128:131]
s_mov_b32 s54,8192
CV v89,v90,v91
CV v90,v92,v93
M v[128:131],a[100:103],a[156:159],v[128:131]
buffer_store_dwordx4 v[72:75],v4,s[96:99],s54 offen offset:3072
CV v91,v94,v95
M v[132:135],a[108:111],a[156:159],v[132:135]
CV v96,v96,v97
CV v97,v98,v99
M v[132:135],a[104:107],a[152:155],v[132:135]
CV v98,v100,v101
CV v99,v102,v103
M v[136:139],a[112:115],a[152:155],v[136:139]
s_mov_b32 s54,16384
CV v104,v104,v105
CV v105,v106,v107
M v[136:139],a[116:119],a[156:159],v[136:139]
buffer_store_dwordx4 v[80:83],v4,s[96:99],s54 offen offset:0
CV v106,v108,v109
M v[140:143],a[124:127],a[156:159],v[140:143]
CV v107,v110,v111
M v[140:143],a[120:123],a[152:155],v[140:143]
s_waitcnt lgkmcnt(4)
M v[144:147],a[64:67],a[128:131],v[144:147]
DR a[152:155],v1,34944
M v[144:147],a[68:71],a[132:135],v[144:147]
s_mov_b32 s54,16384
DR a[156:159],v1,35008
M v[148:151],a[76:79],a[132:135],v[148:151]
buffer_store_dwordx4 v[88:91],v4,s[96:99],s54 offen offset:1024
M v[148:151],a[72:75],a[128:131],v[148:151]
M v[152:155],a[80:83],a[128:131],v[152:155]
M v[152:155],a[84:87],a[132:135],v[152:155]
s_mov_b32 s54,16384
CV v112,v112,v113
CV v113,v114,v115
M v[156:159],a[92:95],a[132:135],v[156:159]
buffer_store_dwordx4 v[96:99],v4,s[96:99],s54 offen offset:2048
CV v114,v116,v117
M v[156:159],a[88:91],a[128:131],v[156:159]
CV v115,v118,v119
CV v120,v120,v121
M v[160:163],a[96:99],a[128:131],v[160:163]
CV v121,v122,v123
CV v122,v124,v125
M v[160:163],a[100:103],a[132:135],v[160:163]
s_mov_b32 s54,16384
CV v123,v126,v127
CV v128,v128,v129
M v[164:167],a[108:111],a[132:135],v[164:167]
buffer_store_dwordx4 v[104:107],v4,s[96:99],s54 offen offset:3072
CV v129,v130,v131
M v[164:167],a[104:107],a[128:131],v[164:167]
CV v130,v132,v133
CV v131,v134,v135
M v[168:171],a[112:115],a[128:131],v[168:171]
CV v136,v136,v137
CV v137,v138,v139
M v[168:171],a[116:119],a[132:135],v[168:171]
s_mov_b32 s54,24576
CV v138,v140,v141
CV v139,v142,v143
M v[172:175],a[124:127],a[132:135],v[172:175]
buffer_store_dwordx4 v[112:115],v4,s[96:99],s54 offen offset:0
M v[172:175],a[120:123],a[128:131],v[172:175]
s_waitcnt lgkmcnt(4)
M v[176:179],a[64:67],a[136:139],v[176:179]
M v[176:179],a[68:71],a[140:143],v[176:179]
s_mov_b32 s54,24576
M v[180:183],a[76:79],a[140:143],v[180:183]
buffer_store_dwordx4 v[120:123],v4,s[96:99],s54 offen offset:1024
M v[180:183],a[72:75],a[136:139],v[180:183]
M v[184:187],a[80:83],a[136:139],v[184:187]
M v[184:187],a[84:87],a[140:143],v[184:187]
s_mov_b32 s54,24576
CV v144,v144,v145
CV v145,v146,v147
M v[188:191],a[92:95],a[140:143],v[188:191]
buffer_store_dwordx4 v[128:131],v4,s[96:99],s54 offen offset:2048
CV v146,v148,v149
M v[188:191],a[88:91],a[136:139],v[188:191]
CV v147,v150,v151
CV v152,v152,v153
M v[192:195],a[96:99],a[136:139],v[192:195]
CV v153,v154,v155
CV v154,v156,v157
M v[192:195],a[100:103],a[140:143],v[192:195]
s_mov_b32 s54,24576
CV v155,v158,v159
CV v160,v160,v161
M v[196:199],a[108:111],a[140:143],v[196:199]
buffer_store_dwordx4 v[136:139],v4,s[96:99],s54 offen offset:3072
CV v161,v162,v163
M v[196:199],a[104:107],a[136:139],v[196:199]
CV v162,v164,v165
CV v163,v166,v167
M v[200:203],a[112:115],a[136:139],v[200:203]
CV v168,v168,v169
CV v169,v170,v171
M v[200:203],a[116:119],a[140:143],v[200:203]
CV v170,v172,v173
CV v171,v174,v175
M v[204:207],a[124:127],a[140:143],v[204:207]
M v[204:207],a[120:123],a[136:139],v[204:207]
s_waitcnt vmcnt(32) lgkmcnt(0)
s_barrier
M v[208:211],a[64:67],a[144:147],v[208:211]
DR a[192:195],v7,0
DR a[196:199],v7,64
DR a[200:203],v7,256
M v[208:211],a[68:71],a[148:151],v[208:211]
s_add_u32 m0,s41,0
DR a[204:207],v7,320
M v[212:215],a[76:79],a[148:151],v[212:215]
DT a[0:1],v12,0
M v[212:215],a[72:75],a[144:147],v[212:215]
DT a[2:3],v12,512
M v[216:219],a[80:83],a[144:147],v[216:219]
DT a[4:5],v12,2048
M v[216:219],a[84:87],a[148:151],v[216:219]
DT a[6:7],v12,2560
CV v176,v176,v177
M v[220:223],a[92:95],a[148:151],v[220:223]
DT a[8:9],v12,32
CV v177,v178,v179
M v[220:223],a[88:91],a[144:147],v[220:223]
DT a[10:11],v12,544
CV v178,v180,v181
M v[224:227],a[96:99],a[144:147],v[224:227]
DT a[12:13],v12,2080
CV v179,v182,v183
M v[224:227],a[100:103],a[148:151],v[224:227]
DT a[14:15],v12,2592
DT a[16:17],v12,64
DT a[18:19],v12,576
M v[228:231],a[108:111],a[148:151],v[228:231]
DT a[20:21],v12,2112
CV v184,v184,v185
M v[228:231],a[104:107],a[144:147],v[228:231]
DT a[22:23],v12,2624
CV v185,v186,v187
M v[232:235],a[112:115],a[144:147],v[232:235]
DT a[24:25],v12,96
CV v186,v188,v189
M v[232:235],a[116:119],a[148:151],v[232:235]
DT a[26:27],v12,608
CV v187,v190,v191
M v[236:239],a[124:127],a[148:151],v[236:239]
DT a[28:29],v12,2144
CV v192,v192,v193
M v[236:239],a[120:123],a[144:147],v[236:239]
DT a[30:31],v12,2656
CV v193,v194,v195
M v[240:243],a[64:67],a[152:155],v[240:243]
buffer_load_dwordx4 v5,s[16:19],s56 offen offset:0 lds
DT a[32:33],v12,128
M v[240:243],a[68:71],a[156:159],v[240:243]
DT a[34:35],v12,640
CV v194,v196,v197
M a[240:243],a[76:79],a[156:159],a[240:243]
buffer_load_dwordx4 v5,s[16:19],s57 offen offset:1024 lds
DT a[36:37],v12,2176
M a[240:243],a[72:75],a[152:155],a[240:243]
DT a[38:39],v12,2688
CV v195,v198,v199
M v[244:247],a[80:83],a[152:155],v[244:247]
buffer_load_dwordx4 v5,s[16:19],s58 offen offset:2048 lds
DT a[40:41],v12,160
M v[244:247],a[84:87],a[156:159],v[244:247]
buffer_load_dwordx4 v5,s[16:19],s59 offen offset:3072 lds
DT a[42:43],v12,672
DT a[44:45],v12,2208
M a[244:247],a[92:95],a[156:159],a[244:247]
s_add_u32 m0,s41,4128
DT a[46:47],v12,2720
CV v200,v200,v201
M a[244:247],a[88:91],a[152:155],a[244:247]
buffer_load_dwordx4 v5,s[16:19],s60 offen offset:0 lds
DT a[48:49],v12,192
M v[248:251],a[96:99],a[152:155],v[248:251]
DT a[50:51],v12,704
CV v201,v202,v203
M v[248:251],a[100:103],a[156:159],v[248:251]
buffer_load_dwordx4 v5,s[16:19],s61 offen offset:1024 lds
DT a[52:53],v12,2240
M a[248:251],a[108:111],a[156:159],a[248:251]
buffer_load_dwordx4 v5,s[16:19],s62 offen offset:2048 lds
DT a[54:55],v12,2752
M a[248:251],a[104:107],a[152:155],a[248:251]
DT a[56:57],v12,224
DT a[58:59],v12,736
DT a[60:61],v12,2272
M v[252:255],a[112:115],a[152:155],v[252:255]
buffer_load_dwordx4 v5,s[16:19],s63 offen offset:3072 lds
M v[252:255],a[116:119],a[156:159],v[252:255]
DT a[62:63],v12,2784
CV v202,v204,v205
M a[252:255],a[124:127],a[156:159],a[252:255]
CV v203,v206,v207
CV v208,v208,v209
M a[252:255],a[120:123],a[152:155],a[252:255]
s_waitcnt lgkmcnt(15)
s_add_u32 s16,s16,524288
s_addc_u32 s17,s17,0
M v[20:23],a[0:3],a[192:195],0
DT a[64:65],v12,256
DT a[66:67],v12,768
DT a[68:69],v12,2304
M v[20:23],a[4:7],a[196:199],v[20:23]
DT a[70:71],v12,2816
DT a[72:73],v12,288
DT a[74:75],v12,800
M v[28:31],a[4:7],a[204:207],0
s_sub_u32 s18,s18,524288
s_add_u32 m0,s40,16480
DT a[76:77],v12,2336
CV v209,v210,v211
M v[28:31],a[0:3],a[200:203],v[28:31]
buffer_load_dwordx4 v8,s[12:15],s64 offen offset:0 lds
M v[36:39],a[8:11],a[192:195],0
buffer_load_dwordx4 v9,s[12:15],s65 offen offset:1024 lds
DT a[78:79],v12,2848
M v[36:39],a[12:15],a[196:199],v[36:39]
buffer_load_dwordx4 v8,s[12:15],s66 offen offset:2048 lds
DT a[80:81],v12,320
M v[44:47],a[12:15],a[204:207],0
buffer_load_dwordx4 v9,s[12:15],s67 offen offset:3072 lds
DT a[82:83],v12,832
M v[44:47],a[8:11],a[200:203],v[44:47]
DT a[84:85],v12,2368
DT a[86:87],v12,2880
DT a[88:89],v12,352
M v[52:55],a[16:19],a[192:195],0
DT a[90:91],v12,864
CV v210,v212,v213
M v[52:55],a[20:23],a[196:199],v[52:55]
DT a[92:93],v12,2400
CV v211,v214,v215
M v[60:63],a[20:23],a[204:207],0
DT a[94:95],v12,2912
CV v216,v216,v217
M v[60:63],a[16:19],a[200:203],v[60:63]
DT a[96:97],v12,384
CV v217,v218,v219
M v[68:71],a[24:27],a[192:195],0
DT a[98:99],v12,896
CV v218,v220,v221
M v[68:71],a[28:31],a[196:199],v[68:71]
DT a[100:101],v12,2432
CV v219,v222,v223
M v[76:79],a[28:31],a[204:207],0
DT a[102:103],v12,2944
CV v224,v224,v225
M v[76:79],a[24:27],a[200:203],v[76:79]
s_waitcnt lgkmcnt(15)
DT a[104:105],v12,416
CV v225,v226,v227
M v[84:87],a[32:35],a[192:195],0
DT a[106:107],v12,928
CV v226,v228,v229
M v[84:87],a[36:39],a[196:199],v[84:87]
DT a[108:109],v12,2464
CV v227,v230,v231
M v[92:95],a[36:39],a[204:207],0
DT a[110:111],v12,2976
CV v232,v232,v233
M v[92:95],a[32:35],a[200:203],v[92:95]
DT a[112:113],v12,448
DT a[114:115],v12,960
DT a[116:117],v12,2496
M v[100:103],a[40:43],a[192:195],0
DT a[118:119],v12,3008
CV v233,v234,v235
M v[100:103],a[44:47],a[196:199],v[100:103]
DT a[120:121],v12,480
CV v234,v236,v237
M v[108:111],a[44:47],a[204:207],0
DT a[122:123],v12,992
CV v235,v238,v239
M v[108:111],a[40:43],a[200:203],v[108:111]
DT a[124:125],v12,2528
v_accvgpr_read_b32 v212,a240
M v[116:119],a[48:51],a[192:195],0
DT a[126:127],v12,3040
v_accvgpr_read_b32 v213,a241
M v[116:119],a[52:55],a[196:199],v[116:119]
s_add_u32 s12,s12,128
s_addc_u32 s13,s13,0
s_sub_u32 s14,s14,128
M v[124:127],a[52:55],a[204:207],0
s_mov_b32 s54,2097152
v_accvgpr_read_b32 v214,a242
v_accvgpr_read_b32 v215,a243
M v[124:127],a[48:51],a[200:203],v[124:127]
buffer_load_dword a238,v0,s[84:87],s54 offen
M v[132:135],a[56:59],a[192:195],0
buffer_load_dword a238,v15,s[88:91],0 offen offset:512
M v[132:135],a[60:63],a[196:199],v[132:135]
s_mov_b32 s54,32768
CV v240,v240,v241
CV v241,v242,v243
M v[140:143],a[60:63],a[204:207],0
buffer_store_dwordx4 v[144:147],v4,s[96:99],s54 offen offset:0
CV v242,v212,v213
M v[140:143],a[56:59],a[200:203],v[140:143]
CV v243,v214,v215
v_accvgpr_read_b32 v212,a244
v_accvgpr_read_b32 v213,a245
v_accvgpr_read_b32 v214,a246
v_accvgpr_read_b32 v215,a247
CV v244,v244,v245
CV v245,v246,v247
CV v246,v212,v213
CV v247,v214,v215
v_accvgpr_read_b32 v212,a248
v_accvgpr_read_b32 v213,a249
v_accvgpr_read_b32 v214,a250
v_accvgpr_read_b32 v215,a251
CV v248,v248,v249
CV v249,v250,v251
CV v250,v212,v213
CV v251,v214,v215
v_accvgpr_read_b32 v212,a252
v_accvgpr_read_b32 v213,a253
v_accvgpr_read_b32 v214,a254
v_accvgpr_read_b32 v215,a255
CV v252,v252,v253
CV v253,v254,v255
CV v254,v212,v213
CV v255,v214,v215
v_bfe_u32 v16,v4,4,4
v_cvt_f32_u32 v16,v16
v_lshrrev_b32 v17,8,v4
v_lshlrev_b32 v17,2,v17
v_cvt_f32_u32 v17,v17
v_cvt_f32_u32 v18,s42
v_fmamk_f32 v18,v18,0x41800000,v16
v_mul_f32 v18,0x3c800000,v18
v_mul_f32 v19,v17,v18
s_mov_b32 s54,32768
buffer_store_dwordx4 v[152:155],v4,s[96:99],s54 offen offset:1024
v_fmamk_f32 v24,v18,0x00000000,v19
v_fmamk_f32 v25,v18,0x3f800000,v19
v_fmamk_f32 v26,v18,0x40000000,v19
v_fmamk_f32 v27,v18,0x40400000,v19
v_fmamk_f32 v32,v18,0x41800000,v19
v_fmamk_f32 v33,v18,0x41880000,v19
v_fmamk_f32 v34,v18,0x41900000,v19
v_fmamk_f32 v35,v18,0x41980000,v19
v_cos_f32 v40,v24
s_mov_b32 s54,32768
buffer_store_dwordx4 v[160:163],v4,s[96:99],s54 offen offset:2048
v_cos_f32 v41,v25
v_cos_f32 v42,v26
v_cos_f32 v43,v27
v_cos_f32 v48,v32
v_cos_f32 v49,v33
v_cos_f32 v50,v34
v_cos_f32 v51,v35
v_sin_f32 v24,v24
v_sin_f32 v25,v25
s_mov_b32 s54,32768
buffer_store_dwordx4 v[168:171],v4,s[96:99],s54 offen offset:3072
v_sin_f32 v26,v26
v_sin_f32 v27,v27
v_sin_f32 v32,v32
v_sin_f32 v33,v33
v_sin_f32 v34,v34
v_sin_f32 v35,v35
CV v80,v40,v41
CV v81,v42,v43
CV v82,v48,v49
s_mov_b32 s54,40960
buffer_store_dwordx4 v[176:179],v4,s[96:99],s54 offen offset:0
CV v83,v50,v51
CV v88,v24,v25
CV v89,v26,v27
CV v90,v32,v33
CV v91,v34,v35
v_fmamk_f32 v24,v18,0x42000000,v19
v_fmamk_f32 v25,v18,0x42040000,v19
v_fmamk_f32 v26,v18,0x42080000,v19
v_fmamk_f32 v27,v18,0x420c0000,v19
s_mov_b32 s54,40960
buffer_store_dwordx4 v[184:187],v4,s[96:99],s54 offen offset:1024
v_fmamk_f32 v32,v18,0x42400000,v19
v_fmamk_f32 v33,v18,0x42440000,v19
v_fmamk_f32 v34,v18,0x42480000,v19
v_fmamk_f32 v35,v18,0x424c0000,v19
v_cos_f32 v40,v24
v_cos_f32 v41,v25
v_cos_f32 v42,v26
v_cos_f32 v43,v27
v_cos_f32 v48,v32
s_mov_b32 s54,40960
buffer_store_dwordx4 v[192:195],v4,s[96:99],s54 offen offset:2048
v_cos_f32 v49,v33
v_cos_f32 v50,v34
v_cos_f32 v51,v35
v_sin_f32 v24,v24
v_sin_f32 v25,v25
v_sin_f32 v26,v26
v_sin_f32 v27,v27
v_sin_f32 v32,v32
v_sin_f32 v33,v33
s_mov_b32 s54,40960
buffer_store_dwordx4 v[200:203],v4,s[96:99],s54 offen offset:3072
v_sin_f32 v34,v34
v_sin_f32 v35,v35
CV v96,v40,v41
CV v97,v42,v43
CV v98,v48,v49
CV v99,v50,v51
CV v104,v24,v25
CV v105,v26,v27
CV v106,v32,v33
s_mov_b32 s54,49152
buffer_store_dwordx4 v[208:211],v4,s[96:99],s54 offen offset:0
CV v107,v34,v35
v_add_f32 v18,0x00000000,v16
v_mul_f32 v18,0x3d000000,v18
v_mul_f32 v19,v17,v18
v_fmamk_f32 v24,v18,0x00000000,v19
v_fmamk_f32 v25,v18,0x3f800000,v19
v_fmamk_f32 v26,v18,0x40000000,v19
v_fmamk_f32 v27,v18,0x40400000,v19
v_fmamk_f32 v32,v18,0x41800000,v19
s_mov_b32 s54,49152
buffer_store_dwordx4 v[216:219],v4,s[96:99],s54 offen offset:1024
v_fmamk_f32 v33,v18,0x41880000,v19
v_fmamk_f32 v34,v18,0x41900000,v19
v_fmamk_f32 v35,v18,0x41980000,v19
v_cos_f32 v40,v24
v_cos_f32 v41,v25
v_cos_f32 v42,v26
v_cos_f32 v43,v27
v_cos_f32 v48,v32
v_cos_f32 v49,v33
s_mov_b32 s54,49152
buffer_store_dwordx4 v[224:227],v4,s[96:99],s54 offen offset:2048
v_cos_f32 v50,v34
v_cos_f32 v51,v35
v_sin_f32 v24,v24
v_sin_f32 v25,v25
v_sin_f32 v26,v26
v_sin_f32 v27,v27
v_sin_f32 v32,v32
v_sin_f32 v33,v33
v_sin_f32 v34,v34
s_mov_b32 s54,49152
buffer_store_dwordx4 v[232:235],v4,s[96:99],s54 offen offset:3072
v_sin_f32 v35,v35
CV v112,v40,v41
CV v113,v42,v43
CV v114,v48,v49
CV v115,v50,v51
CV v128,v24,v25
CV v129,v26,v27
CV v130,v32,v33
CV v131,v34,v35
s_mov_b32 s54,57344
buffer_store_dwordx4 v[240:243],v4,s[96:99],s54 offen offset:0
v_add_f32 v18,0x41800000,v16
v_mul_f32 v18,0x3d000000,v18
v_mul_f32 v19,v17,v18
v_fmamk_f32 v24,v18,0x00000000,v19
v_fmamk_f32 v25,v18,0x3f800000,v19
v_fmamk_f32 v26,v18,0x40000000,v19
v_fmamk_f32 v27,v18,0x40400000,v19
v_fmamk_f32 v32,v18,0x41800000,v19
v_fmamk_f32 v33,v18,0x41880000,v19
s_mov_b32 s54,57344
buffer_store_dwordx4 v[244:247],v4,s[96:99],s54 offen offset:1024
v_fmamk_f32 v34,v18,0x41900000,v19
v_fmamk_f32 v35,v18,0x41980000,v19
v_cos_f32 v40,v24
v_cos_f32 v41,v25
v_cos_f32 v42,v26
v_cos_f32 v43,v27
v_cos_f32 v48,v32
v_cos_f32 v49,v33
v_cos_f32 v50,v34
s_mov_b32 s54,57344
buffer_store_dwordx4 v[248:251],v4,s[96:99],s54 offen offset:2048
v_cos_f32 v51,v35
v_sin_f32 v24,v24
v_sin_f32 v25,v25
v_sin_f32 v26,v26
v_sin_f32 v27,v27
v_sin_f32 v32,v32
v_sin_f32 v33,v33
v_sin_f32 v34,v34
v_sin_f32 v35,v35
s_mov_b32 s54,57344
buffer_store_dwordx4 v[252:255],v4,s[96:99],s54 offen offset:3072
CV v120,v40,v41
CV v121,v42,v43
CV v122,v48,v49
CV v123,v50,v51
CV v136,v24,v25
CV v137,v26,v27
CV v138,v32,v33
CV v139,v34,v35
s_waitcnt vmcnt(48) lgkmcnt(0)
s_barrier
M v[148:151],a[64:67],a[192:195],0
DR a[208:211],v6,0
DR a[212:215],v6,64
DR a[216:219],v6,256
M v[148:151],a[68:71],a[196:199],v[148:151]
s_mov_b32 m0,s68
DR a[220:223],v6,320
v_lshrrev_b32 v13,2,v4
M v[156:159],a[68:71],a[204:207],0
buffer_load_dwordx4 v5,s[16:19],s56 offen offset:0 lds
M v[156:159],a[64:67],a[200:203],v[156:159]
DT a[64:65],v12,33152
DT a[66:67],v12,33664
DT a[68:69],v12,35200
M v[164:167],a[72:75],a[192:195],0
DT a[70:71],v12,35712
v_and_b32 v13,28,v13
M v[164:167],a[76:79],a[196:199],v[164:167]
M v[172:175],a[76:79],a[204:207],0
M v[172:175],a[72:75],a[200:203],v[172:175]
DT a[72:73],v12,33184
DT a[74:75],v12,33696
DT a[76:77],v12,35232
M v[180:183],a[80:83],a[192:195],0
DT a[78:79],v12,35744
M v[180:183],a[84:87],a[196:199],v[180:183]
buffer_load_dwordx4 v5,s[16:19],s57 offen offset:1024 lds
M v[188:191],a[84:87],a[204:207],0
M v[188:191],a[80:83],a[200:203],v[188:191]
DT a[80:81],v12,33216
DT a[82:83],v12,33728
DT a[84:85],v12,35264
M v[196:199],a[88:91],a[192:195],0
DT a[86:87],v12,35776
M v[196:199],a[92:95],a[196:199],v[196:199]
buffer_load_dwordx4 v5,s[16:19],s58 offen offset:2048 lds
M v[204:207],a[92:95],a[204:207],0
M v[204:207],a[88:91],a[200:203],v[204:207]
DT a[88:89],v12,33248
DT a[90:91],v12,33760
DT a[92:93],v12,35296
DT a[94:95],v12,35808
M v[212:215],a[96:99],a[192:195],0
buffer_load_dwordx4 v5,s[16:19],s59 offen offset:3072 lds
M v[212:215],a[100:103],a[196:199],v[212:215]
s_mov_b32 m0,s69
M v[220:223],a[100:103],a[204:207],0
M v[220:223],a[96:99],a[200:203],v[220:223]
DT a[96:97],v12,33280
DT a[98:99],v12,33792
DT a[100:101],v12,35328
DT a[102:103],v12,35840
M a[240:243],a[104:107],a[192:195],0
buffer_load_dwordx4 v5,s[16:19],s60 offen offset:0 lds
M a[240:243],a[108:111],a[196:199],a[240:243]
M a[244:247],a[108:111],a[204:207],0
M a[244:247],a[104:107],a[200:203],a[244:247]
DT a[104:105],v12,33312
DT a[106:107],v12,33824
DT a[108:109],v12,35360
DT a[110:111],v12,35872
M v[228:231],a[112:115],a[192:195],0
M v[228:231],a[116:119],a[196:199],v[228:231]
buffer_load_dwordx4 v5,s[16:19],s61 offen offset:1024 lds
M v[236:239],a[116:119],a[204:207],0
M v[236:239],a[112:115],a[200:203],v[236:239]
DT a[112:113],v12,33344
DT a[114:115],v12,33856
DT a[116:117],v12,35392
DT a[118:119],v12,35904
M a[248:251],a[120:123],a[192:195],0
M a[248:251],a[124:127],a[196:199],a[248:251]
buffer_load_dwordx4 v5,s[16:19],s62 offen offset:2048 lds
M a[252:255],a[124:127],a[204:207],0
M a[252:255],a[120:123],a[200:203],a[252:255]
s_waitcnt lgkmcnt(12)
DT a[120:121],v12,33376
DT a[122:123],v12,33888
DT a[124:125],v12,35424
DT a[126:127],v12,35936
DT a[128:129],v12,33408
DT a[130:131],v12,33920
M v[20:23],a[64:67],a[208:211],v[20:23]
DT a[132:133],v12,35456
M v[20:23],a[68:71],a[212:215],v[20:23]
DT a[134:135],v12,35968
DT a[136:137],v12,33440
DT a[138:139],v12,33952
M v[28:31],a[68:71],a[220:223],v[28:31]
DT a[140:141],v12,35488
M v[28:31],a[64:67],a[216:219],v[28:31]
DT a[142:143],v12,36000
M v[36:39],a[72:75],a[208:211],v[36:39]
DT a[144:145],v12,33472
M v[36:39],a[76:79],a[212:215],v[36:39]
DT a[146:147],v12,33984
M v[44:47],a[76:79],a[220:223],v[44:47]
DT a[148:149],v12,35520
M v[44:47],a[72:75],a[216:219],v[44:47]
DT a[150:151],v12,36032
M v[52:55],a[80:83],a[208:211],v[52:55]
DT a[152:153],v12,33504
M v[52:55],a[84:87],a[212:215],v[52:55]
DT a[154:155],v12,34016
M v[60:63],a[84:87],a[220:223],v[60:63]
DT a[156:157],v12,35552
M v[60:63],a[80:83],a[216:219],v[60:63]
DT a[158:159],v12,36064
M v[68:71],a[88:91],a[208:211],v[68:71]
DT a[160:161],v12,33536
M v[68:71],a[92:95],a[212:215],v[68:71]
DT a[162:163],v12,34048
DT a[164:165],v12,35584
DT a[166:167],v12,36096
M v[76:79],a[92:95],a[220:223],v[76:79]
DT a[168:169],v12,33568
M v[76:79],a[88:91],a[216:219],v[76:79]
s_waitcnt lgkmcnt(15)
DT a[170:171],v12,34080
M v[84:87],a[96:99],a[208:211],v[84:87]
buffer_load_dwordx4 v5,s[16:19],s63 offen offset:3072 lds
M v[84:87],a[100:103],a[212:215],v[84:87]
s_add_u32 s16,s16,524288
s_addc_u32 s17,s17,0
DT a[172:173],v12,35616
M v[92:95],a[100:103],a[220:223],v[92:95]
s_sub_u32 s18,s18,524288
s_add_u32 m0,s40,132608
DT a[174:175],v12,36128
M v[92:95],a[96:99],a[216:219],v[92:95]
DT a[176:177],v12,33600
DT a[178:179],v12,34112
DT a[180:181],v12,35648
M v[100:103],a[104:107],a[208:211],v[100:103]
buffer_load_dwordx4 v8,s[12:15],s64 offen offset:0 lds
M v[100:103],a[108:111],a[212:215],v[100:103]
DT a[182:183],v12,36160
M v[108:111],a[108:111],a[220:223],v[108:111]
DT a[184:185],v12,33632
M v[108:111],a[104:107],a[216:219],v[108:111]
DT a[186:187],v12,34144
M v[116:119],a[112:115],a[208:211],v[116:119]
DT a[188:189],v12,35680
M v[116:119],a[116:119],a[212:215],v[116:119]
buffer_load_dwordx4 v9,s[12:15],s65 offen offset:1024 lds
DT a[190:191],v12,36192
M v[124:127],a[116:119],a[220:223],v[124:127]
buffer_load_dwordx4 v8,s[12:15],s66 offen offset:2048 lds
M v[124:127],a[112:115],a[216:219],v[124:127]
buffer_load_dwordx4 v9,s[12:15],s67 offen offset:3072 lds
M v[132:135],a[120:123],a[208:211],v[132:135]
s_add_u32 s12,s12,128
s_addc_u32 s13,s13,0
s_sub_u32 s14,s14,128
M v[132:135],a[124:127],a[212:215],v[132:135]
s_mov_b32 s54,2621440
M v[140:143],a[124:127],a[220:223],v[140:143]
buffer_load_dword a238,v0,s[84:87],s54 offen
M v[140:143],a[120:123],a[216:219],v[140:143]
buffer_load_dword a238,v15,s[88:91],0 offen offset:640
s_waitcnt vmcnt(14) lgkmcnt(0)
s_barrier
s_cmp_eq_u32 s42,0
s_cbranch_scc0 L_nopub2
s_bitcmp1_b32 s44,8
s_cbranch_scc1 L_rel2
L_reld2:
s_mov_b64 exec,1
v_mov_b32 v15,1
buffer_store_dword v15,off,s[24:27],s55 offset:0 sc1
s_mov_b64 exec,-1
L_nopub2:
M v[148:151],a[128:131],a[208:211],v[148:151]
DR a[192:195],v6,16480
DR a[196:199],v6,16544
DR a[200:203],v6,16736
M v[148:151],a[132:135],a[212:215],v[148:151]
s_mov_b32 m0,s70
DR a[204:207],v6,16800
M v[156:159],a[132:135],a[220:223],v[156:159]
DT a[64:65],v10,0
M v[156:159],a[128:131],a[216:219],v[156:159]
DT a[66:67],v10,512
M v[164:167],a[136:139],a[208:211],v[164:167]
DT a[68:69],v10,2048
M v[164:167],a[140:143],a[212:215],v[164:167]
DT a[70:71],v10,2560
M v[172:175],a[140:143],a[220:223],v[172:175]
DT a[72:73],v10,32
M v[172:175],a[136:139],a[216:219],v[172:175]
DT a[74:75],v10,544
M v[180:183],a[144:147],a[208:211],v[180:183]
DT a[76:77],v10,2080
M v[180:183],a[148:151],a[212:215],v[180:183]
DT a[78:79],v10,2592
DT a[80:81],v10,64
DT a[82:83],v10,576
M v[188:191],a[148:151],a[220:223],v[188:191]
DT a[84:85],v10,2112
M v[188:191],a[144:147],a[216:219],v[188:191]
DT a[86:87],v10,2624
M v[196:199],a[152:155],a[208:211],v[196:199]
DT a[88:89],v10,96
M v[196:199],a[156:159],a[212:215],v[196:199]
DT a[90:91],v10,608
M v[204:207],a[156:159],a[220:223],v[204:207]
DT a[92:93],v10,2144
M v[204:207],a[152:155],a[216:219],v[204:207]
DT a[94:95],v10,2656
M v[212:215],a[160:163],a[208:211],v[212:215]
buffer_load_dwordx4 v5,s[16:19],s56 offen offset:0 lds
DT a[96:97],v10,128
M v[212:215],a[164:167],a[212:215],v[212:215]
DT a[98:99],v10,640
M v[220:223],a[164:167],a[220:223],v[220:223]
DT a[100:101],v10,2176
M v[220:223],a[160:163],a[216:219],v[220:223]
DT a[102:103],v10,2688
M a[240:243],a[168:171],a[208:211],a[240:243]
DT a[104:105],v10,160
M a[240:243],a[172:175],a[212:215],a[240:243]
buffer_load_dwordx4 v5,s[16:19],s57 offen offset:1024 lds
DT a[106:107],v10,672
DT a[108:109],v10,2208
M a[244:247],a[172:175],a[220:223],a[244:247]
DT a[110:111],v10,2720
M a[244:247],a[168:171],a[216:219],a[244:247]
DT a[112:113],v10,192
M v[228:231],a[176:179],a[208:211],v[228:231]
DT a[114:115],v10,704
M v[228:231],a[180:183],a[212:215],v[228:231]
buffer_load_dwordx4 v5,s[16:19],s58 offen offset:2048 lds
DT a[116:117],v10,2240
M v[236:239],a[180:183],a[220:223],v[236:239]
DT a[118:119],v10,2752
M v[236:239],a[176:179],a[216:219],v[236:239]
DT a[120:121],v10,224
DT a[122:123],v10,736
DT a[124:125],v10,2272
M a[248:251],a[184:187],a[208:211],a[248:251]
DT a[126:127],v10,2784
M a[248:251],a[188:191],a[212:215],a[248:251]
DT a[128:129],v10,256
M a[252:255],a[188:191],a[220:223],a[252:255]
buffer_load_dwordx4 v5,s[16:19],s59 offen offset:3072 lds
M a[252:255],a[184:187],a[216:219],a[252:255]
s_waitcnt lgkmcnt(15)
s_mov_b32 m0,s71
DT a[130:131],v10,768
M v[20:23],a[64:67],a[192:195],v[20:23]
DT a[132:133],v10,2304
M v[20:23],a[68:71],a[196:199],v[20:23]
DT a[134:135],v10,2816
DT a[136:137],v10,288
DT a[138:139],v10,800
M v[28:31],a[68:71],a[204:207],v[28:31]
buffer_load_dwordx4 v5,s[16:19],s60 offen offset:0 lds
M v[28:31],a[64:67],a[200:203],v[28:31]
DT a[140:141],v10,2336
M v[36:39],a[72:75],a[192:195],v[36:39]
DT a[142:143],v10,2848
M v[36:39],a[76:79],a[196:199],v[36:39]
DT a[144:145],v10,320
M v[44:47],a[76:79],a[204:207],v[44:47]
DT a[146:147],v10,832
M v[44:47],a[72:75],a[200:203],v[44:47]
buffer_load_dwordx4 v5,s[16:19],s61 offen offset:1024 lds
DT a[148:149],v10,2368
DT a[150:151],v10,2880
M v[52:55],a[80:83],a[192:195],v[52:55]
DT a[152:153],v10,352
M v[52:55],a[84:87],a[196:199],v[52:55]
DT a[154:155],v10,864
M v[60:63],a[84:87],a[204:207],v[60:63]
DT a[156:157],v10,2400
M v[60:63],a[80:83],a[200:203],v[60:63]
buffer_load_dwordx4 v5,s[16:19],s62 offen offset:2048 lds
DT a[158:159],v10,2912
M v[68:71],a[88:91],a[192:195],v[68:71]
DT a[160:161],v10,384
M v[68:71],a[92:95],a[196:199],v[68:71]
DT a[162:163],v10,896
DT a[164:165],v10,2432
DT a[166:167],v10,2944
M v[76:79],a[92:95],a[204:207],v[76:79]
DT a[168:169],v10,416
M v[76:79],a[88:91],a[200:203],v[76:79]
s_waitcnt lgkmcnt(15)
DT a[170:171],v10,928
M v[84:87],a[96:99],a[192:195],v[84:87]
buffer_load_dwordx4 v5,s[16:19],s63 offen offset:3072 lds
M v[84:87],a[100:103],a[196:199],v[84:87]
s_add_u32 s16,s16,524288
s_addc_u32 s17,s17,0
DT a[172:173],v10,2464
M v[92:95],a[100:103],a[204:207],v[92:95]
s_sub_u32 s18,s18,524288
s_add_u32 m0,s40,0
DT a[174:175],v10,2976
M v[92:95],a[96:99],a[200:203],v[92:95]
DT a[176:177],v10,448
DT a[178:179],v10,960
DT a[180:181],v10,2496
M v[100:103],a[104:107],a[192:195],v[100:103]
buffer_load_dwordx4 v8,s[12:15],s64 offen offset:0 lds
M v[100:103],a[108:111],a[196:199],v[100:103]
DT a[182:183],v10,3008
M v[108:111],a[108:111],a[204:207],v[108:111]
DT a[184:185],v10,480
M v[108:111],a[104:107],a[200:203],v[108:111]
DT a[186:187],v10,992
M v[116:119],a[112:115],a[192:195],v[116:119]
DT a[188:189],v10,2528
M v[116:119],a[116:119],a[196:199],v[116:119]
buffer_load_dwordx4 v9,s[12:15],s65 offen offset:1024 lds
DT a[190:191],v10,3040
M v[124:127],a[116:119],a[204:207],v[124:127]
buffer_load_dwordx4 v8,s[12:15],s66 offen offset:2048 lds
M v[124:127],a[112:115],a[200:203],v[124:127]
buffer_load_dwordx4 v9,s[12:15],s67 offen offset:3072 lds
M v[132:135],a[120:123],a[192:195],v[132:135]
s_add_u32 s12,s12,128
s_addc_u32 s13,s13,0
s_sub_u32 s14,s14,128
M v[132:135],a[124:127],a[196:199],v[132:135]
s_mov_b32 s54,3145728
M v[140:143],a[124:127],a[204:207],v[140:143]
buffer_load_dword a238,v0,s[84:87],s54 offen
M v[140:143],a[120:123],a[200:203],v[140:143]
buffer_load_dword a238,v15,s[88:91],0 offen offset:768
s_waitcnt vmcnt(16) lgkmcnt(0)
s_barrier
M v[148:151],a[128:131],a[192:195],v[148:151]
DR a[208:211],v7,0
DR a[212:215],v7,64
DR a[216:219],v7,256
M v[148:151],a[132:135],a[196:199],v[148:151]
s_add_u32 m0,s41,0
DR a[220:223],v7,320
M v[156:159],a[132:135],a[204:207],v[156:159]
DT a[64:65],v12,0
M v[156:159],a[128:131],a[200:203],v[156:159]
DT a[66:67],v12,512
M v[164:167],a[136:139],a[192:195],v[164:167]
DT a[68:69],v12,2048
M v[164:167],a[140:143],a[196:199],v[164:167]
DT a[70:71],v12,2560
M v[172:175],a[140:143],a[204:207],v[172:175]
DT a[72:73],v12,32
M v[172:175],a[136:139],a[200:203],v[172:175]
DT a[74:75],v12,544
M v[180:183],a[144:147],a[192:195],v[180:183]
DT a[76:77],v12,2080
M v[180:183],a[148:151],a[196:199],v[180:183]
DT a[78:79],v12,2592
DT a[80:81],v12,64
DT a[82:83],v12,576
M v[188:191],a[148:151],a[204:207],v[188:191]
DT a[84:85],v12,2112
M v[188:191],a[144:147],a[200:203],v[188:191]
DT a[86:87],v12,2624
M v[196:199],a[152:155],a[192:195],v[196:199]
DT a[88:89],v12,96
M v[196:199],a[156:159],a[196:199],v[196:199]
DT a[90:91],v12,608
M v[204:207],a[156:159],a[204:207],v[204:207]
DT a[92:93],v12,2144
M v[204:207],a[152:155],a[200:203],v[204:207]
DT a[94:95],v12,2656
M v[212:215],a[160:163],a[192:195],v[212:215]
buffer_load_dwordx4 v5,s[16:19],s56 offen offset:0 lds
DT a[96:97],v12,128
M v[212:215],a[164:167],a[196:199],v[212:215]
DT a[98:99],v12,640
M v[220:223],a[164:167],a[204:207],v[220:223]
DT a[100:101],v12,2176
M v[220:223],a[160:163],a[200:203],v[220:223]
DT a[102:103],v12,2688
M a[240:243],a[168:171],a[192:195],a[240:243]
DT a[104:105],v12,160
M a[240:243],a[172:175],a[196:199],a[240:243]
buffer_load_dwordx4 v5,s[16:19],s57 offen offset:1024 lds
DT a[106:107],v12,672
DT a[108:109],v12,2208
M a[244:247],a[172:175],a[204:207],a[244:247]
DT a[110:111],v12,2720
M a[244:247],a[168:171],a[200:203],a[244:247]
DT a[112:113],v12,192
M v[228:231],a[176:179],a[192:195],v[228:231]
DT a[114:115],v12,704
M v[228:231],a[180:183],a[196:199],v[228:231]
buffer_load_dwordx4 v5,s[16:19],s58 offen offset:2048 lds
DT a[116:117],v12,2240
M v[236:239],a[180:183],a[204:207],v[236:239]
DT a[118:119],v12,2752
M v[236:239],a[176:179],a[200:203],v[236:239]
DT a[120:121],v12,224
DT a[122:123],v12,736
DT a[124:125],v12,2272
M a[248:251],a[184:187],a[192:195],a[248:251]
DT a[126:127],v12,2784
M a[248:251],a[188:191],a[196:199],a[248:251]
DT a[128:129],v12,256
M a[252:255],a[188:191],a[204:207],a[252:255]
buffer_load_dwordx4 v5,s[16:19],s59 offen offset:3072 lds
M a[252:255],a[184:187],a[200:203],a[252:255]
s_waitcnt lgkmcnt(15)
s_add_u32 m0,s41,4128
DT a[130:131],v12,768
M v[20:23],a[64:67],a[208:211],v[20:23]
DT a[132:133],v12,2304
M v[20:23],a[68:71],a[212:215],v[20:23]
DT a[134:135],v12,2816
DT a[136:137],v12,288
DT a[138:139],v12,800
M v[28:31],a[68:71],a[220:223],v[28:31]
buffer_load_dwordx4 v5,s[16:19],s60 offen offset:0 lds
M v[28:31],a[64:67],a[216:219],v[28:31]
DT a[140:141],v12,2336
M v[36:39],a[72:75],a[208:211],v[36:39]
DT a[142:143],v12,2848
M v[36:39],a[76:79],a[212:215],v[36:39]
DT a[144:145],v12,320
M v[44:47],a[76:79],a[220:223],v[44:47]
DT a[146:147],v12,832
M v[44:47],a[72:75],a[216:219],v[44:47]
buffer_load_dwordx4 v5,s[16:19],s61 offen offset:1024 lds
DT a[148:149],v12,2368
DT a[150:151],v12,2880
M v[52:55],a[80:83],a[208:211],v[52:55]
DT a[152:153],v12,352
M v[52:55],a[84:87],a[212:215],v[52:55]
DT a[154:155],v12,864
M v[60:63],a[84:87],a[220:223],v[60:63]
DT a[156:157],v12,2400
M v[60:63],a[80:83],a[216:219],v[60:63]
buffer_load_dwordx4 v5,s[16:19],s62 offen offset:2048 lds
DT a[158:159],v12,2912
M v[68:71],a[88:91],a[208:211],v[68:71]
DT a[160:161],v12,384
M v[68:71],a[92:95],a[212:215],v[68:71]
DT a[162:163],v12,896
DT a[164:165],v12,2432
DT a[166:167],v12,2944
M v[76:79],a[92:95],a[220:223],v[76:79]
DT a[168:169],v12,416
M v[76:79],a[88:91],a[216:219],v[76:79]
s_waitcnt lgkmcnt(15)
DT a[170:171],v12,928
M v[84:87],a[96:99],a[208:211],v[84:87]
buffer_load_dwordx4 v5,s[16:19],s63 offen offset:3072 lds
M v[84:87],a[100:103],a[212:215],v[84:87]
s_add_u32 s16,s16,524288
s_addc_u32 s17,s17,0
DT a[172:173],v12,2464
M v[92:95],a[100:103],a[220:223],v[92:95]
s_sub_u32 s18,s18,524288
s_add_u32 m0,s40,16480
DT a[174:175],v12,2976
M v[92:95],a[96:99],a[216:219],v[92:95]
DT a[176:177],v12,448
DT a[178:179],v12,960
DT a[180:181],v12,2496
M v[100:103],a[104:107],a[208:211],v[100:103]
buffer_load_dwordx4 v8,s[12:15],s64 offen offset:0 lds
M v[100:103],a[108:111],a[212:215],v[100:103]
DT a[182:183],v12,3008
M v[108:111],a[108:111],a[220:223],v[108:111]
DT a[184:185],v12,480
M v[108:111],a[104:107],a[216:219],v[108:111]
DT a[186:187],v12,992
M v[116:119],a[112:115],a[208:211],v[116:119]
DT a[188:189],v12,2528
M v[116:119],a[116:119],a[212:215],v[116:119]
buffer_load_dwordx4 v9,s[12:15],s65 offen offset:1024 lds
DT a[190:191],v12,3040
M v[124:127],a[116:119],a[220:223],v[124:127]
buffer_load_dwordx4 v8,s[12:15],s66 offen offset:2048 lds
M v[124:127],a[112:115],a[216:219],v[124:127]
buffer_load_dwordx4 v9,s[12:15],s67 offen offset:3072 lds
M v[132:135],a[120:123],a[208:211],v[132:135]
s_add_u32 s12,s12,128
s_addc_u32 s13,s13,0
s_sub_u32 s14,s14,128
M v[132:135],a[124:127],a[212:215],v[132:135]
s_mov_b32 s3,4096
v_lshrrev_b32 v0,2,v4
v_and_b32 v0,4,v0
M v[140:143],a[124:127],a[220:223],v[140:143]
v_lshl_or_b32 v0,v4,2,v0
v_and_b32 v0,0xf84,v0
M v[140:143],a[120:123],a[216:219],v[140:143]
buffer_load_dword v15,v0,s[24:27],s3 offen offset:0 sc1
s_waitcnt vmcnt(15) lgkmcnt(0)
s_barrier
M v[148:151],a[128:131],a[208:211],v[148:151]
DR a[192:195],v6,0
DR a[196:199],v6,64
DR a[200:203],v6,256
M v[148:151],a[132:135],a[212:215],v[148:151]
s_mov_b32 m0,s68
DR a[204:207],v6,320
M v[156:159],a[132:135],a[220:223],v[156:159]
DT a[64:65],v12,33152
M v[156:159],a[128:131],a[216:219],v[156:159]
DT a[66:67],v12,33664
M v[164:167],a[136:139],a[208:211],v[164:167]
DT a[68:69],v12,35200
M v[164:167],a[140:143],a[212:215],v[164:167]
DT a[70:71],v12,35712
M v[172:175],a[140:143],a[220:223],v[172:175]
DT a[72:73],v12,33184
M v[172:175],a[136:139],a[216:219],v[172:175]
DT a[74:75],v12,33696
M v[180:183],a[144:147],a[208:211],v[180:183]
DT a[76:77],v12,35232
M v[180:183],a[148:151],a[212:215],v[180:183]
DT a[78:79],v12,35744
DT a[80:81],v12,33216
DT a[82:83],v12,33728
M v[188:191],a[148:151],a[220:223],v[188:191]
DT a[84:85],v12,35264
M v[188:191],a[144:147],a[216:219],v[188:191]
DT a[86:87],v12,35776
M v[196:199],a[152:155],a[208:211],v[196:199]
DT a[88:89],v12,33248
M v[196:199],a[156:159],a[212:215],v[196:199]
DT a[90:91],v12,33760
M v[204:207],a[156:159],a[220:223],v[204:207]
DT a[92:93],v12,35296
M v[204:207],a[152:155],a[216:219],v[204:207]
DT a[94:95],v12,35808
M v[212:215],a[160:163],a[208:211],v[212:215]
buffer_load_dwordx4 v5,s[16:19],s56 offen offset:0 lds
DT a[96:97],v12,33280
M v[212:215],a[164:167],a[212:215],v[212:215]
DT a[98:99],v12,33792
M v[220:223],a[164:167],a[220:223],v[220:223]
DT a[100:101],v12,35328
M v[220:223],a[160:163],a[216:219],v[220:223]
DT a[102:103],v12,35840
M a[240:243],a[168:171],a[208:211],a[240:243]
DT a[104:105],v12,33312
M a[240:243],a[172:175],a[212:215],a[240:243]
buffer_load_dwordx4 v5,s[16:19],s57 offen offset:1024 lds
DT a[106:107],v12,33824
DT a[108:109],v12,35360
M a[244:247],a[172:175],a[220:223],a[244:247]
DT a[110:111],v12,35872
M a[244:247],a[168:171],a[216:219],a[244:247]
DT a[112:113],v12,33344
M v[228:231],a[176:179],a[208:211],v[228:231]
DT a[114:115],v12,33856
M v[228:231],a[180:183],a[212:215],v[228:231]
buffer_load_dwordx4 v5,s[16:19],s58 offen offset:2048 lds
DT a[116:117],v12,35392
M v[236:239],a[180:183],a[220:223],v[236:239]
DT a[118:119],v12,35904
M v[236:239],a[176:179],a[216:219],v[236:239]
DT a[120:121],v12,33376
DT a[122:123],v12,33888
DT a[124:125],v12,35424
M a[248:251],a[184:187],a[208:211],a[248:251]
DT a[126:127],v12,35936
M a[248:251],a[188:191],a[212:215],a[248:251]
DT a[128:129],v12,33408
M a[252:255],a[188:191],a[220:223],a[252:255]
buffer_load_dwordx4 v5,s[16:19],s59 offen offset:3072 lds
M a[252:255],a[184:187],a[216:219],a[252:255]
s_waitcnt lgkmcnt(15)
s_mov_b32 m0,s69
DT a[130:131],v12,33920
M v[20:23],a[64:67],a[192:195],v[20:23]
DT a[132:133],v12,35456
M v[20:23],a[68:71],a[196:199],v[20:23]
DT a[134:135],v12,35968
DT a[136:137],v12,33440
DT a[138:139],v12,33952
M v[28:31],a[68:71],a[204:207],v[28:31]
buffer_load_dwordx4 v5,s[16:19],s60 offen offset:0 lds
M v[28:31],a[64:67],a[200:203],v[28:31]
DT a[140:141],v12,35488
M v[36:39],a[72:75],a[192:195],v[36:39]
DT a[142:143],v12,36000
M v[36:39],a[76:79],a[196:199],v[36:39]
DT a[144:145],v12,33472
M v[44:47],a[76:79],a[204:207],v[44:47]
DT a[146:147],v12,33984
M v[44:47],a[72:75],a[200:203],v[44:47]
buffer_load_dwordx4 v5,s[16:19],s61 offen offset:1024 lds
DT a[148:149],v12,35520
DT a[150:151],v12,36032
M v[52:55],a[80:83],a[192:195],v[52:55]
DT a[152:153],v12,33504
M v[52:55],a[84:87],a[196:199],v[52:55]
DT a[154:155],v12,34016
M v[60:63],a[84:87],a[204:207],v[60:63]
DT a[156:157],v12,35552
M v[60:63],a[80:83],a[200:203],v[60:63]
buffer_load_dwordx4 v5,s[16:19],s62 offen offset:2048 lds
DT a[158:159],v12,36064
M v[68:71],a[88:91],a[192:195],v[68:71]
DT a[160:161],v12,33536
M v[68:71],a[92:95],a[196:199],v[68:71]
DT a[162:163],v12,34048
DT a[164:165],v12,35584
DT a[166:167],v12,36096
M v[76:79],a[92:95],a[204:207],v[76:79]
DT a[168:169],v12,33568
M v[76:79],a[88:91],a[200:203],v[76:79]
s_waitcnt lgkmcnt(15)
DT a[170:171],v12,34080
M v[84:87],a[96:99],a[192:195],v[84:87]
buffer_load_dwordx4 v5,s[16:19],s63 offen offset:3072 lds
M v[84:87],a[100:103],a[196:199],v[84:87]
s_add_u32 s16,s16,524288
s_addc_u32 s17,s17,0
DT a[172:173],v12,35616
M v[92:95],a[100:103],a[204:207],v[92:95]
s_sub_u32 s18,s18,524288
s_add_u32 m0,s40,132608
DT a[174:175],v12,36128
M v[92:95],a[96:99],a[200:203],v[92:95]
DT a[176:177],v12,33600
DT a[178:179],v12,34112
DT a[180:181],v12,35648
M v[100:103],a[104:107],a[192:195],v[100:103]
buffer_load_dwordx4 v8,s[12:15],s64 offen offset:0 lds
M v[100:103],a[108:111],a[196:199],v[100:103]
DT a[182:183],v12,36160
M v[108:111],a[108:111],a[204:207],v[108:111]
DT a[184:185],v12,33632
M v[108:111],a[104:107],a[200:203],v[108:111]
DT a[186:187],v12,34144
M v[116:119],a[112:115],a[192:195],v[116:119]
DT a[188:189],v12,35680
M v[116:119],a[116:119],a[196:199],v[116:119]
buffer_load_dwordx4 v9,s[12:15],s65 offen offset:1024 lds
DT a[190:191],v12,36192
M v[124:127],a[116:119],a[204:207],v[124:127]
buffer_load_dwordx4 v8,s[12:15],s66 offen offset:2048 lds
M v[124:127],a[112:115],a[200:203],v[124:127]
buffer_load_dwordx4 v9,s[12:15],s67 offen offset:3072 lds
M v[132:135],a[120:123],a[192:195],v[132:135]
s_add_u32 s12,s12,128
s_addc_u32 s13,s13,0
s_sub_u32 s14,s14,128
M v[132:135],a[124:127],a[196:199],v[132:135]
s_lshl_b32 s51,s43,7
s_lshl_b32 s46,s43,20
M v[140:143],a[124:127],a[204:207],v[140:143]
s_add_u32 s4,s82,s46
s_addc_u32 s5,s83,0
s_mov_b32 s6,1048576
M v[140:143],a[120:123],a[200:203],v[140:143]
s_mov_b32 s7,0x20000
s_add_u32 s8,s82,s46
s_addc_u32 s9,s83,0
s_add_u32 s8,s8,16777216
s_addc_u32 s9,s9,0
s_mov_b32 s10,1048576
s_mov_b32 s11,0x20000
s_add_u32 s12,s82,s46
s_addc_u32 s13,s83,0
s_add_u32 s12,s12,33554432
s_addc_u32 s13,s13,0
s_mov_b32 s14,1048576
s_mov_b32 s15,0x20000
s_lshl_b32 s47,s45,1
s_sub_u32 s47,12,s47
s_max_i32 s47,s47,0
s_lshl_b32 s47,s47,15
s_sub_u32 s52,15,s45
s_lshl_b32 s52,s52,16
s_mov_b32 s28,0
s_add_u32 s32,s45,1
s_lshl_b32 s32,s32,16
s_cmp_eq_u32 s47,0
s_cselect_b32 s32,-1,s32
s_mov_b32 s33,s32
s_add_u32 s29,s28,4096
s_mov_b32 s30,s28
s_mov_b32 s31,s29
s_lshl_b32 s46,s42,13
s_add_u32 s34,s46,99456
s_add_u32 s35,s46,103552
s_add_u32 s36,s46,66304
s_add_u32 s37,s46,70400
s_add_u32 s38,s46,0
s_add_u32 s39,s46,4096
s_add_u32 s40,s46,33152
s_add_u32 s41,s46,37248
v_add_u32 v3,s46,v4
buffer_load_dword v14,v13,s[24:27],s51 offen offset:0 sc1
s_waitcnt vmcnt(14) lgkmcnt(0)
s_barrier
s_waitcnt vmcnt(0)
v_cmp_eq_u32 vcc,1,v14
s_nop 0
s_cmp_eq_u64 vcc,-1
s_cbranch_scc0 L_spin2
L_spun2:
s_bitcmp1_b32 s44,8
s_cbranch_scc1 L_acq2
L_acqd2:
v_cmp_eq_u32 vcc,0x01010101,v15
s_nop 0
s_cmp_eq_u64 vcc,-1
s_cbranch_scc0 L_spin3
L_spun3:
M v[148:151],a[128:131],a[192:195],v[148:151]
DR a[208:211],v6,16480
DR a[212:215],v6,16544
DR a[216:219],v6,16736
M v[148:151],a[132:135],a[196:199],v[148:151]
s_mov_b32 m0,s34
DR a[220:223],v6,16800
M v[156:159],a[132:135],a[204:207],v[156:159]
s_add_u32 s84,s82,100663296
s_addc_u32 s85,s83,0
DT a[64:65],v10,0
M v[156:159],a[128:131],a[200:203],v[156:159]
s_mov_b32 s86,1835008
s_mov_b32 s87,0x20000
DT a[66:67],v10,512
M v[164:167],a[136:139],a[192:195],v[164:167]
s_add_u32 s88,s82,109051904
s_addc_u32 s89,s83,0
DT a[68:69],v10,2048
M v[164:167],a[140:143],a[196:199],v[164:167]
s_mov_b32 s90,1867776
s_mov_b32 s91,0x20000
DT a[70:71],v10,2560
M v[172:175],a[140:143],a[204:207],v[172:175]
s_add_u32 s92,s82,104857600
s_addc_u32 s93,s83,0
DT a[72:73],v10,32
M v[172:175],a[136:139],a[200:203],v[172:175]
s_mov_b32 s94,1835008
s_mov_b32 s95,0x20000
DT a[74:75],v10,544
M v[180:183],a[144:147],a[192:195],v[180:183]
s_lshl_b32 s67,s45,4
s_and_b32 s46,s2,15
DT a[76:77],v10,2080
M v[180:183],a[148:151],a[196:199],v[180:183]
DT a[78:79],v10,2592
DT a[80:81],v10,64
DT a[82:83],v10,576
M v[188:191],a[148:151],a[204:207],v[188:191]
s_add_u32 s67,s67,s46
s_lshl_b32 s66,s67,1
DT a[84:85],v10,2112
M v[188:191],a[144:147],a[200:203],v[188:191]
s_lshr_b32 s46,s42,1
s_add_u32 s66,s66,s46
DT a[86:87],v10,2624
M v[196:199],a[152:155],a[192:195],v[196:199]
s_lshl_b32 s64,s66,12
s_add_u32 s65,s64,917504
DT a[88:89],v10,96
M v[196:199],a[156:159],a[196:199],v[196:199]
s_cmp_eq_u32 s66,0
s_cselect_b32 s65,0x7ff00000,s65
DT a[90:91],v10,608
M v[204:207],a[156:159],a[204:207],v[204:207]
s_cmp_ge_u32 s66,224
s_cselect_b32 s65,0x7ff00000,s65
DT a[92:93],v10,2144
M v[204:207],a[152:155],a[200:203],v[204:207]
buffer_load_dwordx4 v3,s[4:7],s28 offen offset:0 sc1 lds
DT a[94:95],v10,2656
M v[212:215],a[160:163],a[192:195],v[212:215]
s_cmp_ge_u32 s66,225
s_cselect_b32 s64,0x7ff00000,s64
DT a[96:97],v10,128
M v[212:215],a[164:167],a[196:199],v[212:215]
DT a[98:99],v10,640
M v[220:223],a[164:167],a[204:207],v[220:223]
buffer_load_dwordx4 v3,s[4:7],s28 offen offset:1024 sc1 lds
DT a[100:101],v10,2176
M v[220:223],a[160:163],a[200:203],v[220:223]
DT a[102:103],v10,2688
M a[240:243],a[168:171],a[192:195],a[240:243]
DT a[104:105],v10,160
M a[240:243],a[172:175],a[196:199],a[240:243]
buffer_load_dwordx4 v3,s[4:7],s28 offen offset:2048 sc1 lds
DT a[106:107],v10,672
DT a[108:109],v10,2208
M a[244:247],a[172:175],a[204:207],a[244:247]
DT a[110:111],v10,2720
M a[244:247],a[168:171],a[200:203],a[244:247]
DT a[112:113],v10,192
M v[228:231],a[176:179],a[192:195],v[228:231]
buffer_load_dwordx4 v3,s[4:7],s28 offen offset:3072 sc1 lds
DT a[114:115],v10,704
M v[228:231],a[180:183],a[196:199],v[228:231]
s_mov_b32 m0,s35
DT a[116:117],v10,2240
M v[236:239],a[180:183],a[204:207],v[236:239]
DT a[118:119],v10,2752
M v[236:239],a[176:179],a[200:203],v[236:239]
buffer_load_dwordx4 v3,s[4:7],s29 offen offset:0 sc1 lds
DT a[120:121],v10,224
DT a[122:123],v10,736
M a[248:251],a[184:187],a[192:195],a[248:251]
DT a[124:125],v10,2272
M a[248:251],a[188:191],a[196:199],a[248:251]
DT a[126:127],v10,2784
M a[252:255],a[188:191],a[204:207],a[252:255]
buffer_load_dwordx4 v3,s[4:7],s29 offen offset:1024 sc1 lds
DT a[128:129],v10,256
M a[252:255],a[184:187],a[200:203],a[252:255]
s_waitcnt lgkmcnt(15)
DT a[130:131],v10,768
M v[20:23],a[64:67],a[208:211],v[20:23]
DT a[132:133],v10,2304
M v[20:23],a[68:71],a[212:215],v[20:23]
buffer_load_dwordx4 v3,s[4:7],s29 offen offset:2048 sc1 lds
DT a[134:135],v10,2816
DT a[136:137],v10,288
M v[28:31],a[68:71],a[220:223],v[28:31]
DT a[138:139],v10,800
M v[28:31],a[64:67],a[216:219],v[28:31]
DT a[140:141],v10,2336
M v[36:39],a[72:75],a[208:211],v[36:39]
buffer_load_dwordx4 v3,s[4:7],s29 offen offset:3072 sc1 lds
DT a[142:143],v10,2848
M v[36:39],a[76:79],a[212:215],v[36:39]
s_add_u32 s28,s28,32768
DT a[144:145],v10,320
M v[44:47],a[76:79],a[220:223],v[44:47]
s_cmp_eq_u32 s28,s32
s_cselect_b32 s28,0,s28
DT a[146:147],v10,832
M v[44:47],a[72:75],a[216:219],v[44:47]
DT a[148:149],v10,2368
DT a[150:151],v10,2880
DT a[152:153],v10,352
M v[52:55],a[80:83],a[208:211],v[52:55]
s_add_u32 s29,s28,4096
s_nop 0
DT a[154:155],v10,864
M v[52:55],a[84:87],a[212:215],v[52:55]
s_lshl_b32 s47,s42,11
s_lshl_b32 s46,s67,13
DT a[156:157],v10,2400
M v[60:63],a[84:87],a[220:223],v[60:63]
s_add_u32 s46,s46,s47
s_add_u32 m0,s47,0
DT a[158:159],v10,2912
M v[60:63],a[80:83],a[216:219],v[60:63]
DT a[160:161],v10,384
M v[68:71],a[88:91],a[208:211],v[68:71]
DT a[162:163],v10,896
M v[68:71],a[92:95],a[212:215],v[68:71]
DT a[164:165],v10,2432
M v[76:79],a[92:95],a[220:223],v[76:79]
DT a[166:167],v10,2944
M v[76:79],a[88:91],a[216:219],v[76:79]
s_waitcnt lgkmcnt(15)
DT a[168:169],v10,416
M v[84:87],a[96:99],a[208:211],v[84:87]
DT a[170:171],v10,928
M v[84:87],a[100:103],a[212:215],v[84:87]
DT a[172:173],v10,2464
M v[92:95],a[100:103],a[220:223],v[92:95]
DT a[174:175],v10,2976
M v[92:95],a[96:99],a[216:219],v[92:95]
DT a[176:177],v10,448
DT a[178:179],v10,960
DT a[180:181],v10,2496
M v[100:103],a[104:107],a[208:211],v[100:103]
DT a[182:183],v10,3008
M v[100:103],a[108:111],a[212:215],v[100:103]
DT a[184:185],v10,480
M v[108:111],a[108:111],a[220:223],v[108:111]
buffer_load_dwordx4 v4,s[84:87],s46 offen offset:0 sc1 lds
M v[108:111],a[104:107],a[216:219],v[108:111]
DT a[186:187],v10,992
M v[116:119],a[112:115],a[208:211],v[116:119]
DT a[188:189],v10,2528
M v[116:119],a[116:119],a[212:215],v[116:119]
DT a[190:191],v10,3040
M v[124:127],a[116:119],a[220:223],v[124:127]
buffer_load_dwordx4 v4,s[84:87],s46 offen offset:1024 sc1 lds
M v[124:127],a[112:115],a[216:219],v[124:127]
s_add_u32 s46,s46,917504
s_add_u32 m0,s47,8192
M v[132:135],a[120:123],a[208:211],v[132:135]
buffer_load_dwordx4 v4,s[84:87],s46 offen offset:0 sc1 lds
M v[132:135],a[124:127],a[212:215],v[132:135]
buffer_load_dwordx4 v4,s[84:87],s46 offen offset:1024 sc1 lds
M v[140:143],a[124:127],a[220:223],v[140:143]
M v[140:143],a[120:123],a[216:219],v[140:143]
s_waitcnt lgkmcnt(0)
s_barrier
M v[148:151],a[128:131],a[208:211],v[148:151]
DR a[192:195],v7,0
DR a[196:199],v7,64
DR a[200:203],v7,256
M v[148:151],a[132:135],a[212:215],v[148:151]
s_lshl_b32 s47,s42,6
DR a[204:207],v7,320
v_lshrrev_b32 v15,6,v4
M v[156:159],a[132:135],a[220:223],v[156:159]
DT a[64:65],v12,0
v_add_u32 v15,s47,v15
M v[156:159],a[128:131],a[216:219],v[156:159]
DT a[66:67],v12,512
v_mul_u32_u24 v15,7296,v15
M v[164:167],a[136:139],a[208:211],v[164:167]
DT a[68:69],v12,2048
v_and_b32 v0,48,v4
M v[164:167],a[140:143],a[212:215],v[164:167]
DT a[70:71],v12,2560
v_add_u32 v15,v15,v0
M v[172:175],a[140:143],a[220:223],v[172:175]
s_lshl_b32 s47,s42,12
s_add_u32 m0,s47,16480
DT a[72:73],v12,32
M v[172:175],a[136:139],a[216:219],v[172:175]
s_lshl_b32 s46,s67,6
DT a[74:75],v12,544
M v[180:183],a[144:147],a[208:211],v[180:183]
DT a[76:77],v12,2080
M v[180:183],a[148:151],a[212:215],v[180:183]
DT a[78:79],v12,2592
DT a[80:81],v12,64
DT a[82:83],v12,576
M v[188:191],a[148:151],a[220:223],v[188:191]
DT a[84:85],v12,2112
M v[188:191],a[144:147],a[216:219],v[188:191]
DT a[86:87],v12,2624
M v[196:199],a[152:155],a[208:211],v[196:199]
DT a[88:89],v12,96
M v[196:199],a[156:159],a[212:215],v[196:199]
DT a[90:91],v12,608
M v[204:207],a[156:159],a[220:223],v[204:207]
DT a[92:93],v12,2144
M v[204:207],a[152:155],a[216:219],v[204:207]
DT a[94:95],v12,2656
M v[212:215],a[160:163],a[208:211],v[212:215]
DT a[96:97],v12,128
M v[212:215],a[164:167],a[212:215],v[212:215]
DT a[98:99],v12,640
M v[220:223],a[164:167],a[220:223],v[220:223]
DT a[100:101],v12,2176
M v[220:223],a[160:163],a[216:219],v[220:223]
DT a[102:103],v12,2688
M a[240:243],a[168:171],a[208:211],a[240:243]
DT a[104:105],v12,160
M a[240:243],a[172:175],a[212:215],a[240:243]
DT a[106:107],v12,672
DT a[108:109],v12,2208
DT a[110:111],v12,2720
M a[244:247],a[172:175],a[220:223],a[244:247]
DT a[112:113],v12,192
M a[244:247],a[168:171],a[216:219],a[244:247]
DT a[114:115],v12,704
M v[228:231],a[176:179],a[208:211],v[228:231]
DT a[116:117],v12,2240
M v[228:231],a[180:183],a[212:215],v[228:231]
DT a[118:119],v12,2752
M v[236:239],a[180:183],a[220:223],v[236:239]
buffer_load_dwordx4 v15,s[88:91],s46 offen offset:0 sc1 lds
M v[236:239],a[176:179],a[216:219],v[236:239]
DT a[120:121],v12,224
DT a[122:123],v12,736
DT a[124:125],v12,2272
M a[248:251],a[184:187],a[208:211],a[248:251]
s_add_u32 s46,s46,115712
DT a[126:127],v12,2784
M a[248:251],a[188:191],a[212:215],a[248:251]
DT a[128:129],v12,256
M a[252:255],a[188:191],a[220:223],a[252:255]
DT a[130:131],v12,768
M a[252:255],a[184:187],a[216:219],a[252:255]
s_waitcnt lgkmcnt(15)
DT a[132:133],v12,2304
M v[20:23],a[64:67],a[192:195],v[20:23]
DT a[134:135],v12,2816
M v[20:23],a[68:71],a[196:199],v[20:23]
DT a[136:137],v12,288
M v[28:31],a[68:71],a[204:207],v[28:31]
DT a[138:139],v12,800
M v[28:31],a[64:67],a[200:203],v[28:31]
DT a[140:141],v12,2336
M v[36:39],a[72:75],a[192:195],v[36:39]
buffer_load_dwordx4 v15,s[88:91],s46 offen offset:1024 sc1 lds
DT a[142:143],v12,2848
M v[36:39],a[76:79],a[196:199],v[36:39]
s_add_u32 s46,s46,115712
DT a[144:145],v12,320
M v[44:47],a[76:79],a[204:207],v[44:47]
DT a[146:147],v12,832
M v[44:47],a[72:75],a[200:203],v[44:47]
DT a[148:149],v12,2368
DT a[150:151],v12,2880
DT a[152:153],v12,352
M v[52:55],a[80:83],a[192:195],v[52:55]
DT a[154:155],v12,864
M v[52:55],a[84:87],a[196:199],v[52:55]
DT a[156:157],v12,2400
M v[60:63],a[84:87],a[204:207],v[60:63]
DT a[158:159],v12,2912
M v[60:63],a[80:83],a[200:203],v[60:63]
DT a[160:161],v12,384
M v[68:71],a[88:91],a[192:195],v[68:71]
DT a[162:163],v12,896
M v[68:71],a[92:95],a[196:199],v[68:71]
buffer_load_dwordx4 v15,s[88:91],s46 offen offset:2048 sc1 lds
DT a[164:165],v12,2432
M v[76:79],a[92:95],a[204:207],v[76:79]
s_add_u32 s46,s46,115712
DT a[166:167],v12,2944
v_mul_f32 v20,s49,v20
M v[76:79],a[88:91],a[200:203],v[76:79]
s_waitcnt lgkmcnt(15)
DT a[168:169],v12,416
v_mul_f32 v21,s49,v21
M v[84:87],a[96:99],a[192:195],v[84:87]
DT a[170:171],v12,928
v_mul_f32 v22,s49,v22
M v[84:87],a[100:103],a[196:199],v[84:87]
DT a[172:173],v12,2464
v_mul_f32 v23,s49,v23
M v[92:95],a[100:103],a[204:207],v[92:95]
DT a[174:175],v12,2976
v_mul_f32 v36,s49,v36
M v[92:95],a[96:99],a[200:203],v[92:95]
DT a[176:177],v12,448
DT a[178:179],v12,960
DT a[180:181],v12,2496
M v[100:103],a[104:107],a[192:195],v[100:103]
DT a[182:183],v12,3008
v_mul_f32 v37,s49,v37
M v[100:103],a[108:111],a[196:199],v[100:103]
DT a[184:185],v12,480
v_mul_f32 v38,s49,v38
M v[108:111],a[108:111],a[204:207],v[108:111]
DT a[186:187],v12,992
v_mul_f32 v39,s49,v39
M v[108:111],a[104:107],a[200:203],v[108:111]
buffer_load_dwordx4 v15,s[88:91],s46 offen offset:3072 sc1 lds
M v[116:119],a[112:115],a[192:195],v[116:119]
DT a[188:189],v12,2528
CV v20,v20,v21
M v[116:119],a[116:119],a[196:199],v[116:119]
DT a[190:191],v12,3040
CV v21,v22,v23
M v[124:127],a[116:119],a[204:207],v[124:127]
CV v22,v36,v37
CV v23,v38,v39
M v[124:127],a[112:115],a[200:203],v[124:127]
v_mul_f32 v28,s49,v28
v_mul_f32 v29,s49,v29
M v[132:135],a[120:123],a[192:195],v[132:135]
v_mul_f32 v30,s49,v30
v_mul_f32 v31,s49,v31
M v[132:135],a[124:127],a[196:199],v[132:135]
v_mul_f32 v44,s49,v44
v_mul_f32 v45,s49,v45
M v[140:143],a[124:127],a[204:207],v[140:143]
v_mul_f32 v46,s49,v46
v_mul_f32 v47,s49,v47
M v[140:143],a[120:123],a[200:203],v[140:143]
CV v28,v28,v29
CV v29,v30,v31
CV v30,v44,v45
CV v31,v46,v47
v_accvgpr_write_b32 a0,v20
v_accvgpr_write_b32 a1,v21
v_accvgpr_write_b32 a2,v22
v_accvgpr_write_b32 a3,v23
v_accvgpr_write_b32 a32,v28
v_accvgpr_write_b32 a33,v29
v_accvgpr_write_b32 a34,v30
v_accvgpr_write_b32 a35,v31
s_waitcnt lgkmcnt(0)
s_barrier
M v[148:151],a[128:131],a[192:195],v[148:151]
v_mul_f32 v52,s49,v52
v_mul_f32 v53,s49,v53
M v[148:151],a[132:135],a[196:199],v[148:151]
v_mul_f32 v54,s49,v54
v_mul_f32 v55,s49,v55
M v[156:159],a[132:135],a[204:207],v[156:159]
v_mul_f32 v68,s49,v68
v_mul_f32 v69,s49,v69
M v[156:159],a[128:131],a[200:203],v[156:159]
v_mul_f32 v70,s49,v70
v_mul_f32 v71,s49,v71
M v[164:167],a[136:139],a[192:195],v[164:167]
CV v52,v52,v53
CV v53,v54,v55
M v[164:167],a[140:143],a[196:199],v[164:167]
CV v54,v68,v69
CV v55,v70,v71
M v[172:175],a[140:143],a[204:207],v[172:175]
v_mul_f32 v60,s49,v60
v_mul_f32 v61,s49,v61
M v[172:175],a[136:139],a[200:203],v[172:175]
v_mul_f32 v62,s49,v62
v_mul_f32 v63,s49,v63
M v[180:183],a[144:147],a[192:195],v[180:183]
v_mul_f32 v76,s49,v76
v_mul_f32 v77,s49,v77
M v[180:183],a[148:151],a[196:199],v[180:183]
v_mul_f32 v78,s49,v78
v_mul_f32 v79,s49,v79
M v[188:191],a[148:151],a[204:207],v[188:191]
CV v60,v60,v61
CV v61,v62,v63
M v[188:191],a[144:147],a[200:203],v[188:191]
CV v62,v76,v77
CV v63,v78,v79
M v[196:199],a[152:155],a[192:195],v[196:199]
v_mul_f32 v84,s49,v84
v_mul_f32 v85,s49,v85
M v[196:199],a[156:159],a[196:199],v[196:199]
v_mul_f32 v86,s49,v86
v_mul_f32 v87,s49,v87
M v[204:207],a[156:159],a[204:207],v[204:207]
v_mul_f32 v100,s49,v100
v_mul_f32 v101,s49,v101
M v[204:207],a[152:155],a[200:203],v[204:207]
v_mul_f32 v102,s49,v102
v_mul_f32 v103,s49,v103
M v[212:215],a[160:163],a[192:195],v[212:215]
CV v84,v84,v85
CV v85,v86,v87
M v[212:215],a[164:167],a[196:199],v[212:215]
CV v86,v100,v101
CV v87,v102,v103
M v[220:223],a[164:167],a[204:207],v[220:223]
v_mul_f32 v92,s49,v92
v_mul_f32 v93,s49,v93
M v[220:223],a[160:163],a[200:203],v[220:223]
v_mul_f32 v94,s49,v94
v_mul_f32 v95,s49,v95
M a[240:243],a[168:171],a[192:195],a[240:243]
v_mul_f32 v108,s49,v108
v_mul_f32 v109,s49,v109
M a[240:243],a[172:175],a[196:199],a[240:243]
v_mul_f32 v110,s49,v110
v_mul_f32 v111,s49,v111
M a[244:247],a[172:175],a[204:207],a[244:247]
CV v92,v92,v93
CV v93,v94,v95
M a[244:247],a[168:171],a[200:203],a[244:247]
CV v94,v108,v109
CV v95,v110,v111
M v[228:231],a[176:179],a[192:195],v[228:231]
v_accvgpr_write_b32 a4,v52
v_accvgpr_write_b32 a5,v53
M v[228:231],a[180:183],a[196:199],v[228:231]
v_accvgpr_write_b32 a6,v54
v_accvgpr_write_b32 a7,v55
M v[236:239],a[180:183],a[204:207],v[236:239]
v_accvgpr_write_b32 a36,v60
v_accvgpr_write_b32 a37,v61
M v[236:239],a[176:179],a[200:203],v[236:239]
v_accvgpr_write_b32 a38,v62
v_accvgpr_write_b32 a39,v63
M a[248:251],a[184:187],a[192:195],a[248:251]
v_accvgpr_write_b32 a8,v84
v_accvgpr_write_b32 a9,v85
M a[248:251],a[188:191],a[196:199],a[248:251]
v_accvgpr_write_b32 a10,v86
v_accvgpr_write_b32 a11,v87
M a[252:255],a[188:191],a[204:207],a[252:255]
v_accvgpr_write_b32 a40,v92
v_accvgpr_write_b32 a41,v93
M a[252:255],a[184:187],a[200:203],a[252:255]
v_accvgpr_write_b32 a42,v94
v_accvgpr_write_b32 a43,v95
s_mov_b32 m0,s36
s_nop 0
buffer_load_dwordx4 v3,s[4:7],s28 offen offset:0 sc1 lds
buffer_load_dwordx4 v3,s[4:7],s28 offen offset:1024 sc1 lds
buffer_load_dwordx4 v3,s[4:7],s28 offen offset:2048 sc1 lds
buffer_load_dwordx4 v3,s[4:7],s28 offen offset:3072 sc1 lds
s_mov_b32 m0,s37
s_nop 0
buffer_load_dwordx4 v3,s[4:7],s29 offen offset:0 sc1 lds
buffer_load_dwordx4 v3,s[4:7],s29 offen offset:1024 sc1 lds
buffer_load_dwordx4 v3,s[4:7],s29 offen offset:2048 sc1 lds
buffer_load_dwordx4 v3,s[4:7],s29 offen offset:3072 sc1 lds
s_add_u32 s28,s28,32768
s_cmp_eq_u32 s28,s32
s_cselect_b32 s28,0,s28
s_add_u32 s29,s28,4096
v_mov_b32 v6,s49
v_mov_b32 v7,s49
s_lshl_b32 s76,s42,13
s_add_u32 s77,s52,57344
s_sub_u32 s77,s77,s76
s_add_u32 s76,s76,s52
v_pk_mul_f32 v[116:117],v[116:117],v[6:7]
v_pk_mul_f32 v[118:119],v[118:119],v[6:7]
v_pk_mul_f32 v[132:133],v[132:133],v[6:7]
v_pk_mul_f32 v[134:135],v[134:135],v[6:7]
CV v116,v116,v117
CV v117,v118,v119
CV v118,v132,v133
CV v119,v134,v135
v_accvgpr_write_b32 a12,v116
v_accvgpr_write_b32 a13,v117
v_accvgpr_write_b32 a14,v118
v_accvgpr_write_b32 a15,v119
v_pk_mul_f32 v[124:125],v[124:125],v[6:7]
v_pk_mul_f32 v[126:127],v[126:127],v[6:7]
v_pk_mul_f32 v[140:141],v[140:141],v[6:7]
v_pk_mul_f32 v[142:143],v[142:143],v[6:7]
CV v124,v124,v125
CV v125,v126,v127
CV v126,v140,v141
CV v127,v142,v143
v_accvgpr_write_b32 a44,v124
v_accvgpr_write_b32 a45,v125
v_accvgpr_write_b32 a46,v126
v_accvgpr_write_b32 a47,v127
v_pk_mul_f32 v[148:149],v[148:149],v[6:7]
v_pk_mul_f32 v[150:151],v[150:151],v[6:7]
v_pk_mul_f32 v[164:165],v[164:165],v[6:7]
v_pk_mul_f32 v[166:167],v[166:167],v[6:7]
CV v148,v148,v149
CV v149,v150,v151
CV v150,v164,v165
CV v151,v166,v167
v_accvgpr_write_b32 a16,v148
v_accvgpr_write_b32 a17,v149
v_accvgpr_write_b32 a18,v150
v_accvgpr_write_b32 a19,v151
v_pk_mul_f32 v[156:157],v[156:157],v[6:7]
v_pk_mul_f32 v[158:159],v[158:159],v[6:7]
v_pk_mul_f32 v[172:173],v[172:173],v[6:7]
v_pk_mul_f32 v[174:175],v[174:175],v[6:7]
CV v156,v156,v157
CV v157,v158,v159
CV v158,v172,v173
CV v159,v174,v175
v_accvgpr_write_b32 a48,v156
v_accvgpr_write_b32 a49,v157
v_accvgpr_write_b32 a50,v158
v_accvgpr_write_b32 a51,v159
v_pk_mul_f32 v[180:181],v[180:181],v[6:7]
v_pk_mul_f32 v[182:183],v[182:183],v[6:7]
v_pk_mul_f32 v[196:197],v[196:197],v[6:7]
v_pk_mul_f32 v[198:199],v[198:199],v[6:7]
CV v180,v180,v181
CV v181,v182,v183
CV v182,v196,v197
CV v183,v198,v199
v_accvgpr_write_b32 a20,v180
v_accvgpr_write_b32 a21,v181
v_accvgpr_write_b32 a22,v182
v_accvgpr_write_b32 a23,v183
v_pk_mul_f32 v[188:189],v[188:189],v[6:7]
v_pk_mul_f32 v[190:191],v[190:191],v[6:7]
v_pk_mul_f32 v[204:205],v[204:205],v[6:7]
v_pk_mul_f32 v[206:207],v[206:207],v[6:7]
CV v188,v188,v189
CV v189,v190,v191
CV v190,v204,v205
CV v191,v206,v207
v_accvgpr_write_b32 a52,v188
v_accvgpr_write_b32 a53,v189
v_accvgpr_write_b32 a54,v190
v_accvgpr_write_b32 a55,v191
v_accvgpr_read_b32 v36,a240
v_accvgpr_read_b32 v37,a241
v_accvgpr_read_b32 v38,a242
v_accvgpr_read_b32 v39,a243
v_pk_mul_f32 v[212:213],v[212:213],v[6:7]
v_pk_mul_f32 v[214:215],v[214:215],v[6:7]
v_pk_mul_f32 v[36:37],v[36:37],v[6:7]
v_pk_mul_f32 v[38:39],v[38:39],v[6:7]
CV v212,v212,v213
CV v213,v214,v215
CV v214,v36,v37
CV v215,v38,v39
v_accvgpr_write_b32 a24,v212
v_accvgpr_write_b32 a25,v213
v_accvgpr_write_b32 a26,v214
v_accvgpr_write_b32 a27,v215
v_accvgpr_read_b32 v44,a244
v_accvgpr_read_b32 v45,a245
v_accvgpr_read_b32 v46,a246
v_accvgpr_read_b32 v47,a247
v_pk_mul_f32 v[220:221],v[220:221],v[6:7]
v_pk_mul_f32 v[222:223],v[222:223],v[6:7]
v_pk_mul_f32 v[44:45],v[44:45],v[6:7]
v_pk_mul_f32 v[46:47],v[46:47],v[6:7]
CV v220,v220,v221
CV v221,v222,v223
CV v222,v44,v45
CV v223,v46,v47
v_accvgpr_write_b32 a56,v220
v_accvgpr_write_b32 a57,v221
v_accvgpr_write_b32 a58,v222
v_accvgpr_write_b32 a59,v223
v_accvgpr_read_b32 v36,a248
v_accvgpr_read_b32 v37,a249
v_accvgpr_read_b32 v38,a250
v_accvgpr_read_b32 v39,a251
v_pk_mul_f32 v[228:229],v[228:229],v[6:7]
v_pk_mul_f32 v[230:231],v[230:231],v[6:7]
v_pk_mul_f32 v[36:37],v[36:37],v[6:7]
v_pk_mul_f32 v[38:39],v[38:39],v[6:7]
CV v228,v228,v229
CV v229,v230,v231
CV v230,v36,v37
CV v231,v38,v39
v_accvgpr_write_b32 a28,v228
v_accvgpr_write_b32 a29,v229
v_accvgpr_write_b32 a30,v230
v_accvgpr_write_b32 a31,v231
v_accvgpr_read_b32 v44,a252
v_accvgpr_read_b32 v45,a253
v_accvgpr_read_b32 v46,a254
v_accvgpr_read_b32 v47,a255
v_pk_mul_f32 v[236:237],v[236:237],v[6:7]
v_pk_mul_f32 v[238:239],v[238:239],v[6:7]
v_pk_mul_f32 v[44:45],v[44:45],v[6:7]
v_pk_mul_f32 v[46:47],v[46:47],v[6:7]
CV v236,v236,v237
CV v237,v238,v239
CV v238,v44,v45
CV v239,v46,v47
v_accvgpr_write_b32 a60,v236
v_accvgpr_write_b32 a61,v237
v_accvgpr_write_b32 a62,v238
v_accvgpr_write_b32 a63,v239
v_bfe_u32 v24,v4,4,4
v_cvt_f32_u32 v24,v24
v_lshrrev_b32 v25,8,v4
v_lshlrev_b32 v25,2,v25
v_cvt_f32_u32 v25,v25
s_lshl_b32 s46,s42,11
s_add_u32 s46,s46,132608
v_add_u32 v30,s46,v4
ds_write_b128 v30,v[80:83] offset:0
ds_write_b128 v30,v[88:91] offset:8192
ds_write_b128 v30,v[96:99] offset:1024
ds_write_b128 v30,v[104:107] offset:9216
s_lshr_b32 s46,s42,1
s_lshl_b32 s47,s46,6
v_and_b32 v30,240,v4
v_lshlrev_b32 v30,3,v30
v_lshrrev_b32 v31,8,v4
v_lshl_add_u32 v30,v31,4,v30
v_add_u32 v30,s47,v30
s_lshl_b32 s46,s46,5
s_and_b32 s47,s42,1
s_lshl_b32 s47,s47,9
s_add_u32 s46,s46,s47
v_lshlrev_b32 v31,10,v31
v_bfe_u32 v29,v4,5,3
v_lshl_add_u32 v31,v29,6,v31
v_and_b32 v29,16,v4
v_add3_u32 v31,v31,v29,s46
v_add_u32 v23,132608,v4
s_waitcnt vmcnt(8) lgkmcnt(0)
s_barrier
s_bitcmp1_b32 s42,0
s_cselect_b64 s[58:59],-1,0
DR a[64:67],v30,0
s_cselect_b32 s46,0x41800000,0
DR a[80:83],v30,8192
s_cmp_eq_u32 s65,0x7ff00000
DR a[68:71],v30,2048
s_cselect_b32 s47,0,-1
DR a[84:87],v30,10240
v_cndmask_b32 v80,v112,v120,s[58:59]
DR a[72:75],v30,4096
v_cndmask_b32 v84,v128,v136,s[58:59]
DR a[88:91],v30,12288
v_xor_b32 v88,0x80008000,v84
DR a[76:79],v30,6144
v_cndmask_b32 v81,v113,v121,s[58:59]
DR a[92:95],v30,14336
v_cndmask_b32 v85,v129,v137,s[58:59]
DR a[128:131],v23,0
v_xor_b32 v89,0x80008000,v85
DR a[132:135],v23,1024
v_cndmask_b32 v82,v114,v122,s[58:59]
DR a[136:139],v23,2048
v_cndmask_b32 v86,v130,v138,s[58:59]
DR a[140:143],v23,3072
v_xor_b32 v90,0x80008000,v86
DR a[144:147],v23,4096
v_cndmask_b32 v83,v115,v123,s[58:59]
DR a[148:151],v23,5120
v_cndmask_b32 v87,v131,v139,s[58:59]
DR a[152:155],v23,6144
v_xor_b32 v91,0x80008000,v87
DR a[156:159],v23,7168
v_and_b32 v232,s47,v80
DR a[160:163],v23,8192
v_and_b32 v233,s47,v81
DR a[164:167],v23,9216
v_and_b32 v234,s47,v82
DR a[168:171],v23,10240
v_and_b32 v235,s47,v83
DR a[172:175],v23,11264
v_and_b32 v236,s47,v84
DR a[176:179],v23,12288
v_and_b32 v237,s47,v85
DR a[180:183],v23,13312
v_and_b32 v238,s47,v86
DR a[184:187],v23,14336
v_and_b32 v239,s47,v87
DR a[188:191],v23,15360
v_add_f32 v26,s46,v24
DR v[216:219],v31,16480
v_mul_f32 v26,0x3a000000,v26
DR v[220:223],v31,20576
v_mul_f32 v27,v25,v26
DR v[224:227],v31,24672
v_mul_f32 v28,0x41800000,v26
DR v[228:231],v31,28768
v_cos_f32 v28,v28
s_nop 0
v_add_f32 v28,v28,v28
v_mov_b32 v29,v28
v_fmamk_f32 v160,v26,0x00000000,v27
v_fmamk_f32 v161,v26,0x3f800000,v27
v_fmamk_f32 v162,v26,0x40000000,v27
v_fmamk_f32 v163,v26,0x40400000,v27
v_fmamk_f32 v164,v26,0x41800000,v27
v_fmamk_f32 v165,v26,0x41880000,v27
v_fmamk_f32 v166,v26,0x41900000,v27
v_fmamk_f32 v167,v26,0x41980000,v27
s_waitcnt lgkmcnt(15)
M v[32:35],a[64:67],v[80:83],0
v_cos_f32 v144,v160
M v[32:35],a[80:83],v[236:239],v[32:35]
v_cos_f32 v145,v161
M v[48:51],a[80:83],v[232:235],0
v_cos_f32 v146,v162
M v[48:51],a[64:67],v[88:91],v[48:51]
v_cos_f32 v147,v163
M v[36:39],a[68:71],v[80:83],0
v_cos_f32 v148,v164
M v[36:39],a[84:87],v[236:239],v[36:39]
v_cos_f32 v149,v165
M v[52:55],a[84:87],v[232:235],0
v_cos_f32 v150,v166
M v[52:55],a[68:71],v[88:91],v[52:55]
v_cos_f32 v151,v167
M v[40:43],a[72:75],v[80:83],0
v_sin_f32 v160,v160
M v[40:43],a[88:91],v[236:239],v[40:43]
v_sin_f32 v161,v161
M v[56:59],a[88:91],v[232:235],0
v_sin_f32 v162,v162
M v[56:59],a[72:75],v[88:91],v[56:59]
v_sin_f32 v163,v163
M v[44:47],a[76:79],v[80:83],0
v_sin_f32 v164,v164
M v[44:47],a[92:95],v[236:239],v[44:47]
v_sin_f32 v165,v165
M v[60:63],a[92:95],v[232:235],0
v_sin_f32 v166,v166
M v[60:63],a[76:79],v[88:91],v[60:63]
v_sin_f32 v167,v167
v_pk_fma_f32 v[152:153],v[28:29],v[148:149],v[144:145] neg_lo:[0,0,1] neg_hi:[0,0,1]
v_pk_fma_f32 v[154:155],v[28:29],v[150:151],v[146:147] neg_lo:[0,0,1] neg_hi:[0,0,1]
v_pk_fma_f32 v[156:157],v[28:29],v[152:153],v[148:149] neg_lo:[0,0,1] neg_hi:[0,0,1]
v_pk_fma_f32 v[158:159],v[28:29],v[154:155],v[150:151] neg_lo:[0,0,1] neg_hi:[0,0,1]
v_pk_fma_f32 v[168:169],v[28:29],v[164:165],v[160:161] neg_lo:[0,0,1] neg_hi:[0,0,1]
v_pk_fma_f32 v[170:171],v[28:29],v[166:167],v[162:163] neg_lo:[0,0,1] neg_hi:[0,0,1]
v_pk_fma_f32 v[172:173],v[28:29],v[168:169],v[164:165] neg_lo:[0,0,1] neg_hi:[0,0,1]
v_pk_fma_f32 v[174:175],v[28:29],v[170:171],v[166:167] neg_lo:[0,0,1] neg_hi:[0,0,1]
v_pk_mul_f32 v[176:177],v[32:33],v[144:145]
v_pk_mul_f32 v[180:181],v[48:49],v[144:145]
v_pk_fma_f32 v[176:177],v[48:49],v[160:161],v[176:177]
v_pk_fma_f32 v[180:181],v[32:33],v[160:161],v[180:181] neg_lo:[1,0,0] neg_hi:[1,0,0]
v_pk_mul_f32 v[178:179],v[34:35],v[146:147]
v_pk_mul_f32 v[182:183],v[50:51],v[146:147]
v_pk_fma_f32 v[178:179],v[50:51],v[162:163],v[178:179]
v_pk_fma_f32 v[182:183],v[34:35],v[162:163],v[182:183] neg_lo:[1,0,0] neg_hi:[1,0,0]
CV v64,v176,v177
CV v65,v178,v179
CV v72,v180,v181
CV v73,v182,v183
v_xor_b32 v192,0x80008000,v64
v_xor_b32 v193,0x80008000,v65
v_pk_mul_f32 v[176:177],v[36:37],v[148:149]
v_pk_mul_f32 v[180:181],v[52:53],v[148:149]
v_pk_fma_f32 v[176:177],v[52:53],v[164:165],v[176:177]
v_pk_fma_f32 v[180:181],v[36:37],v[164:165],v[180:181] neg_lo:[1,0,0] neg_hi:[1,0,0]
v_pk_mul_f32 v[178:179],v[38:39],v[150:151]
v_pk_mul_f32 v[182:183],v[54:55],v[150:151]
v_pk_fma_f32 v[178:179],v[54:55],v[166:167],v[178:179]
v_pk_fma_f32 v[182:183],v[38:39],v[166:167],v[182:183] neg_lo:[1,0,0] neg_hi:[1,0,0]
CV v66,v176,v177
CV v67,v178,v179
CV v74,v180,v181
CV v75,v182,v183
v_xor_b32 v194,0x80008000,v66
v_xor_b32 v195,0x80008000,v67
v_pk_mul_f32 v[176:177],v[40:41],v[152:153]
v_pk_mul_f32 v[180:181],v[56:57],v[152:153]
v_pk_fma_f32 v[176:177],v[56:57],v[168:169],v[176:177]
v_pk_fma_f32 v[180:181],v[40:41],v[168:169],v[180:181] neg_lo:[1,0,0] neg_hi:[1,0,0]
v_pk_mul_f32 v[178:179],v[42:43],v[154:155]
v_pk_mul_f32 v[182:183],v[58:59],v[154:155]
v_pk_fma_f32 v[178:179],v[58:59],v[170:171],v[178:179]
v_pk_fma_f32 v[182:183],v[42:43],v[170:171],v[182:183] neg_lo:[1,0,0] neg_hi:[1,0,0]
CV v68,v176,v177
CV v69,v178,v179
CV v76,v180,v181
CV v77,v182,v183
v_xor_b32 v196,0x80008000,v68
v_xor_b32 v197,0x80008000,v69
v_pk_mul_f32 v[176:177],v[44:45],v[156:157]
v_pk_mul_f32 v[180:181],v[60:61],v[156:157]
v_pk_fma_f32 v[176:177],v[60:61],v[172:173],v[176:177]
v_pk_fma_f32 v[180:181],v[44:45],v[172:173],v[180:181] neg_lo:[1,0,0] neg_hi:[1,0,0]
v_pk_mul_f32 v[178:179],v[46:47],v[158:159]
v_pk_mul_f32 v[182:183],v[62:63],v[158:159]
v_pk_fma_f32 v[178:179],v[62:63],v[174:175],v[178:179]
v_pk_fma_f32 v[182:183],v[46:47],v[174:175],v[182:183] neg_lo:[1,0,0] neg_hi:[1,0,0]
CV v70,v176,v177
CV v71,v178,v179
CV v78,v180,v181
CV v79,v182,v183
v_xor_b32 v198,0x80008000,v70
v_xor_b32 v199,0x80008000,v71
v_add_f32 v25,s46,v25
M v[32:35],a[128:131],v[64:67],0
s_waitcnt lgkmcnt(3)
v_lshlrev_b32 v96,16,v216
v_and_b32 v97,0xffff0000,v216
M v[32:35],a[160:163],v[72:75],v[32:35]
v_lshlrev_b32 v98,16,v217
v_and_b32 v99,0xffff0000,v217
M v[32:35],a[132:135],v[68:71],v[32:35]
v_lshlrev_b32 v100,16,v218
v_and_b32 v101,0xffff0000,v218
M v[32:35],a[164:167],v[76:79],v[32:35]
v_lshlrev_b32 v102,16,v219
v_and_b32 v103,0xffff0000,v219
M v[48:51],a[128:131],v[72:75],0
s_waitcnt lgkmcnt(2)
v_lshlrev_b32 v104,16,v220
v_and_b32 v105,0xffff0000,v220
M v[48:51],a[160:163],v[192:195],v[48:51]
v_lshlrev_b32 v106,16,v221
v_and_b32 v107,0xffff0000,v221
M v[48:51],a[132:135],v[76:79],v[48:51]
v_lshlrev_b32 v108,16,v222
v_and_b32 v109,0xffff0000,v222
M v[48:51],a[164:167],v[196:199],v[48:51]
v_lshlrev_b32 v110,16,v223
v_and_b32 v111,0xffff0000,v223
M v[36:39],a[136:139],v[64:67],0
s_waitcnt lgkmcnt(1)
v_lshlrev_b32 v240,16,v224
v_and_b32 v241,0xffff0000,v224
M v[36:39],a[168:171],v[72:75],v[36:39]
v_lshlrev_b32 v242,16,v225
v_and_b32 v243,0xffff0000,v225
M v[36:39],a[140:143],v[68:71],v[36:39]
v_lshlrev_b32 v244,16,v226
v_and_b32 v245,0xffff0000,v226
M v[36:39],a[172:175],v[76:79],v[36:39]
v_lshlrev_b32 v246,16,v227
v_and_b32 v247,0xffff0000,v227
M v[52:55],a[136:139],v[72:75],0
s_waitcnt lgkmcnt(0)
v_lshlrev_b32 v248,16,v228
v_and_b32 v249,0xffff0000,v228
M v[52:55],a[168:171],v[192:195],v[52:55]
v_lshlrev_b32 v250,16,v229
v_and_b32 v251,0xffff0000,v229
M v[52:55],a[140:143],v[76:79],v[52:55]
v_lshlrev_b32 v252,16,v230
v_and_b32 v253,0xffff0000,v230
M v[52:55],a[172:175],v[196:199],v[52:55]
v_lshlrev_b32 v254,16,v231
v_and_b32 v255,0xffff0000,v231
M v[40:43],a[144:147],v[64:67],0
v_add_f32 v26,0x00000000,v24
v_mul_f32 v26,0x3a000000,v26
M v[40:43],a[176:179],v[72:75],v[40:43]
v_mul_f32 v27,v25,v26
v_fmamk_f32 v160,v26,0x00000000,v27
M v[40:43],a[148:151],v[68:71],v[40:43]
v_fmamk_f32 v161,v26,0x3f800000,v27
v_fmamk_f32 v162,v26,0x40000000,v27
M v[40:43],a[180:183],v[76:79],v[40:43]
v_fmamk_f32 v163,v26,0x40400000,v27
v_add_f32 v26,0x41800000,v24
M v[56:59],a[144:147],v[72:75],0
v_mul_f32 v26,0x3a000000,v26
v_mul_f32 v27,v25,v26
M v[56:59],a[176:179],v[192:195],v[56:59]
v_fmamk_f32 v164,v26,0x00000000,v27
v_fmamk_f32 v165,v26,0x3f800000,v27
M v[56:59],a[148:151],v[76:79],v[56:59]
v_fmamk_f32 v166,v26,0x40000000,v27
v_fmamk_f32 v167,v26,0x40400000,v27
M v[56:59],a[180:183],v[196:199],v[56:59]
v_add_f32 v26,0x42000000,v24
v_mul_f32 v26,0x3a000000,v26
M v[44:47],a[152:155],v[64:67],0
v_mul_f32 v27,v25,v26
v_fmamk_f32 v168,v26,0x00000000,v27
M v[44:47],a[184:187],v[72:75],v[44:47]
v_fmamk_f32 v169,v26,0x3f800000,v27
v_fmamk_f32 v170,v26,0x40000000,v27
M v[44:47],a[156:159],v[68:71],v[44:47]
v_fmamk_f32 v171,v26,0x40400000,v27
v_add_f32 v26,0x42400000,v24
M v[44:47],a[188:191],v[76:79],v[44:47]
v_mul_f32 v26,0x3a000000,v26
v_mul_f32 v27,v25,v26
M v[60:63],a[152:155],v[72:75],0
v_fmamk_f32 v172,v26,0x00000000,v27
v_fmamk_f32 v173,v26,0x3f800000,v27
M v[60:63],a[184:187],v[192:195],v[60:63]
v_fmamk_f32 v174,v26,0x40000000,v27
v_fmamk_f32 v175,v26,0x40400000,v27
M v[60:63],a[156:159],v[76:79],v[60:63]
M v[60:63],a[188:191],v[196:199],v[60:63]
s_mov_b32 s47,0x36124925
s_cmp_eq_u32 s65,0x7ff00000
s_cselect_b32 s47,0x35924925,s47
v_mov_b32 v28,s47
v_mov_b32 v29,s47
v_pk_mul_f32 v[176:177],v[32:33],v[96:97]
v_pk_mul_f32 v[180:181],v[48:49],v[96:97]
v_pk_fma_f32 v[176:177],v[48:49],v[100:101],v[176:177] neg_lo:[1,0,0] neg_hi:[1,0,0]
v_pk_fma_f32 v[180:181],v[32:33],v[100:101],v[180:181]
v_pk_mul_f32 v[178:179],v[34:35],v[98:99]
v_pk_mul_f32 v[182:183],v[50:51],v[98:99]
v_pk_fma_f32 v[178:179],v[50:51],v[102:103],v[178:179] neg_lo:[1,0,0] neg_hi:[1,0,0]
v_pk_fma_f32 v[182:183],v[34:35],v[102:103],v[182:183]
CV v64,v176,v177
CV v65,v178,v179
CV v72,v180,v181
CV v73,v182,v183
v_xor_b32 v192,0x80008000,v72
v_xor_b32 v193,0x80008000,v73
v_pk_mul_f32 v[176:177],v[36:37],v[104:105]
v_pk_mul_f32 v[180:181],v[52:53],v[104:105]
v_pk_fma_f32 v[176:177],v[52:53],v[108:109],v[176:177] neg_lo:[1,0,0] neg_hi:[1,0,0]
v_pk_fma_f32 v[180:181],v[36:37],v[108:109],v[180:181]
v_pk_mul_f32 v[178:179],v[38:39],v[106:107]
v_pk_mul_f32 v[182:183],v[54:55],v[106:107]
v_pk_fma_f32 v[178:179],v[54:55],v[110:111],v[178:179] neg_lo:[1,0,0] neg_hi:[1,0,0]
v_pk_fma_f32 v[182:183],v[38:39],v[110:111],v[182:183]
CV v66,v176,v177
CV v67,v178,v179
CV v74,v180,v181
CV v75,v182,v183
v_xor_b32 v194,0x80008000,v74
v_xor_b32 v195,0x80008000,v75
v_pk_mul_f32 v[176:177],v[40:41],v[240:241]
v_pk_mul_f32 v[180:181],v[56:57],v[240:241]
v_pk_fma_f32 v[176:177],v[56:57],v[244:245],v[176:177] neg_lo:[1,0,0] neg_hi:[1,0,0]
v_pk_fma_f32 v[180:181],v[40:41],v[244:245],v[180:181]
v_pk_mul_f32 v[178:179],v[42:43],v[242:243]
v_pk_mul_f32 v[182:183],v[58:59],v[242:243]
v_pk_fma_f32 v[178:179],v[58:59],v[246:247],v[178:179] neg_lo:[1,0,0] neg_hi:[1,0,0]
v_pk_fma_f32 v[182:183],v[42:43],v[246:247],v[182:183]
CV v68,v176,v177
CV v69,v178,v179
CV v76,v180,v181
CV v77,v182,v183
v_xor_b32 v196,0x80008000,v76
v_xor_b32 v197,0x80008000,v77
v_pk_mul_f32 v[176:177],v[44:45],v[248:249]
v_pk_mul_f32 v[180:181],v[60:61],v[248:249]
v_pk_fma_f32 v[176:177],v[60:61],v[252:253],v[176:177] neg_lo:[1,0,0] neg_hi:[1,0,0]
v_pk_fma_f32 v[180:181],v[44:45],v[252:253],v[180:181]
v_pk_mul_f32 v[178:179],v[46:47],v[250:251]
v_pk_mul_f32 v[182:183],v[62:63],v[250:251]
v_pk_fma_f32 v[178:179],v[62:63],v[254:255],v[178:179] neg_lo:[1,0,0] neg_hi:[1,0,0]
v_pk_fma_f32 v[182:183],v[46:47],v[254:255],v[182:183]
CV v70,v176,v177
CV v71,v178,v179
CV v78,v180,v181
CV v79,v182,v183
v_xor_b32 v198,0x80008000,v78
v_xor_b32 v199,0x80008000,v79
M v[32:35],v[64:67],a[128:131],0
v_cos_f32 v144,v160
M v[32:35],v[192:195],a[160:163],v[32:35]
v_sin_f32 v160,v160
M v[32:35],v[68:71],a[132:135],v[32:35]
v_cos_f32 v145,v161
M v[32:35],v[196:199],a[164:167],v[32:35]
v_sin_f32 v161,v161
M v[48:51],v[72:75],a[128:131],0
v_cos_f32 v146,v162
M v[48:51],v[64:67],a[160:163],v[48:51]
v_sin_f32 v162,v162
M v[48:51],v[76:79],a[132:135],v[48:51]
v_cos_f32 v147,v163
M v[48:51],v[68:71],a[164:167],v[48:51]
v_sin_f32 v163,v163
M v[36:39],v[64:67],a[136:139],0
v_cos_f32 v148,v164
M v[36:39],v[192:195],a[168:171],v[36:39]
v_sin_f32 v164,v164
M v[36:39],v[68:71],a[140:143],v[36:39]
v_cos_f32 v149,v165
M v[36:39],v[196:199],a[172:175],v[36:39]
v_sin_f32 v165,v165
M v[52:55],v[72:75],a[136:139],0
v_cos_f32 v150,v166
M v[52:55],v[64:67],a[168:171],v[52:55]
v_sin_f32 v166,v166
M v[52:55],v[76:79],a[140:143],v[52:55]
v_cos_f32 v151,v167
M v[52:55],v[68:71],a[172:175],v[52:55]
v_sin_f32 v167,v167
M v[40:43],v[64:67],a[144:147],0
v_cos_f32 v152,v168
M v[40:43],v[192:195],a[176:179],v[40:43]
v_sin_f32 v168,v168
M v[40:43],v[68:71],a[148:151],v[40:43]
v_cos_f32 v153,v169
M v[40:43],v[196:199],a[180:183],v[40:43]
v_sin_f32 v169,v169
M v[56:59],v[72:75],a[144:147],0
v_cos_f32 v154,v170
M v[56:59],v[64:67],a[176:179],v[56:59]
v_sin_f32 v170,v170
M v[56:59],v[76:79],a[148:151],v[56:59]
v_cos_f32 v155,v171
M v[56:59],v[68:71],a[180:183],v[56:59]
v_sin_f32 v171,v171
M v[44:47],v[64:67],a[152:155],0
v_cos_f32 v156,v172
M v[44:47],v[192:195],a[184:187],v[44:47]
v_sin_f32 v172,v172
M v[44:47],v[68:71],a[156:159],v[44:47]
v_cos_f32 v157,v173
M v[44:47],v[196:199],a[188:191],v[44:47]
v_sin_f32 v173,v173
M v[60:63],v[72:75],a[152:155],0
v_cos_f32 v158,v174
M v[60:63],v[64:67],a[184:187],v[60:63]
v_sin_f32 v174,v174
M v[60:63],v[76:79],a[156:159],v[60:63]
v_cos_f32 v159,v175
M v[60:63],v[68:71],a[188:191],v[60:63]
v_sin_f32 v175,v175
s_lshr_b32 s46,s42,1
s_lshl_b32 s46,s46,13
s_add_u32 s46,s46,132608
s_and_b32 s66,s42,1
s_lshl_b32 s54,s66,3
s_add_u32 s54,s54,s46
v_add_u32 v30,s54,v4
s_lshl_b32 s54,s66,12
s_add_u32 s54,s54,s46
v_add_u32 v31,s54,v4
s_barrier
v_pk_mul_f32 v[144:145],v[144:145],v[28:29]
v_pk_mul_f32 v[146:147],v[146:147],v[28:29]
v_pk_mul_f32 v[148:149],v[148:149],v[28:29]
v_pk_mul_f32 v[150:151],v[150:151],v[28:29]
v_pk_mul_f32 v[152:153],v[152:153],v[28:29]
v_pk_mul_f32 v[154:155],v[154:155],v[28:29]
v_pk_mul_f32 v[156:157],v[156:157],v[28:29]
v_pk_mul_f32 v[158:159],v[158:159],v[28:29]
v_pk_mul_f32 v[160:161],v[160:161],v[28:29]
v_pk_mul_f32 v[162:163],v[162:163],v[28:29]
v_pk_mul_f32 v[164:165],v[164:165],v[28:29]
v_pk_mul_f32 v[166:167],v[166:167],v[28:29]
v_pk_mul_f32 v[168:169],v[168:169],v[28:29]
v_pk_mul_f32 v[170:171],v[170:171],v[28:29]
v_pk_mul_f32 v[172:173],v[172:173],v[28:29]
v_pk_mul_f32 v[174:175],v[174:175],v[28:29]
v_pk_mul_f32 v[176:177],v[32:33],v[144:145]
v_pk_mul_f32 v[180:181],v[48:49],v[144:145]
v_pk_fma_f32 v[176:177],v[48:49],v[160:161],v[176:177] neg_lo:[1,0,0] neg_hi:[1,0,0]
v_pk_fma_f32 v[180:181],v[32:33],v[160:161],v[180:181]
v_pk_mul_f32 v[178:179],v[34:35],v[146:147]
v_pk_mul_f32 v[182:183],v[50:51],v[146:147]
v_pk_fma_f32 v[178:179],v[50:51],v[162:163],v[178:179] neg_lo:[1,0,0] neg_hi:[1,0,0]
v_pk_fma_f32 v[182:183],v[34:35],v[162:163],v[182:183]
CV v200,v176,v177
CV v201,v178,v179
CV v202,v180,v181
CV v203,v182,v183
ds_write_b64 v30,v[200:201] offset:0
ds_write_b64 v30,v[202:203] offset:1024
v_pk_mul_f32 v[176:177],v[36:37],v[148:149]
v_pk_mul_f32 v[180:181],v[52:53],v[148:149]
v_pk_fma_f32 v[176:177],v[52:53],v[164:165],v[176:177] neg_lo:[1,0,0] neg_hi:[1,0,0]
v_pk_fma_f32 v[180:181],v[36:37],v[164:165],v[180:181]
v_pk_mul_f32 v[178:179],v[38:39],v[150:151]
v_pk_mul_f32 v[182:183],v[54:55],v[150:151]
v_pk_fma_f32 v[178:179],v[54:55],v[166:167],v[178:179] neg_lo:[1,0,0] neg_hi:[1,0,0]
v_pk_fma_f32 v[182:183],v[38:39],v[166:167],v[182:183]
CV v204,v176,v177
CV v205,v178,v179
CV v206,v180,v181
CV v207,v182,v183
ds_write_b64 v30,v[204:205] offset:2048
ds_write_b64 v30,v[206:207] offset:3072
v_pk_mul_f32 v[176:177],v[40:41],v[152:153]
v_pk_mul_f32 v[180:181],v[56:57],v[152:153]
v_pk_fma_f32 v[176:177],v[56:57],v[168:169],v[176:177] neg_lo:[1,0,0] neg_hi:[1,0,0]
v_pk_fma_f32 v[180:181],v[40:41],v[168:169],v[180:181]
v_pk_mul_f32 v[178:179],v[42:43],v[154:155]
v_pk_mul_f32 v[182:183],v[58:59],v[154:155]
v_pk_fma_f32 v[178:179],v[58:59],v[170:171],v[178:179] neg_lo:[1,0,0] neg_hi:[1,0,0]
v_pk_fma_f32 v[182:183],v[42:43],v[170:171],v[182:183]
CV v208,v176,v177
CV v209,v178,v179
CV v210,v180,v181
CV v211,v182,v183
ds_write_b64 v30,v[208:209] offset:4096
ds_write_b64 v30,v[210:211] offset:5120
v_pk_mul_f32 v[176:177],v[44:45],v[156:157]
v_pk_mul_f32 v[180:181],v[60:61],v[156:157]
v_pk_fma_f32 v[176:177],v[60:61],v[172:173],v[176:177] neg_lo:[1,0,0] neg_hi:[1,0,0]
v_pk_fma_f32 v[180:181],v[44:45],v[172:173],v[180:181]
v_pk_mul_f32 v[178:179],v[46:47],v[158:159]
v_pk_mul_f32 v[182:183],v[62:63],v[158:159]
v_pk_fma_f32 v[178:179],v[62:63],v[174:175],v[178:179] neg_lo:[1,0,0] neg_hi:[1,0,0]
v_pk_fma_f32 v[182:183],v[46:47],v[174:175],v[182:183]
CV v212,v176,v177
CV v213,v178,v179
CV v214,v180,v181
CV v215,v182,v183
ds_write_b64 v30,v[212:213] offset:6144
ds_write_b64 v30,v[214:215] offset:7168
s_waitcnt lgkmcnt(0)
s_barrier
DR v[72:75],v31,1024
DR v[64:67],v31,0
DR v[76:79],v31,3072
DR v[68:71],v31,2048
s_lshl_b32 s66,s66,11
s_add_u32 s64,s64,s66
s_add_u32 s65,s65,s66
s_waitcnt lgkmcnt(3)
v_xor_b32 v192,0x80008000,v72
v_xor_b32 v193,0x80008000,v73
v_xor_b32 v194,0x80008000,v74
v_xor_b32 v195,0x80008000,v75
s_waitcnt lgkmcnt(1)
v_xor_b32 v196,0x80008000,v76
v_xor_b32 v197,0x80008000,v77
v_xor_b32 v198,0x80008000,v78
v_xor_b32 v199,0x80008000,v79
M v[32:35],v[112:115],v[64:67],0
M v[32:35],v[128:131],v[192:195],v[32:35]
M v[48:51],v[112:115],v[72:75],0
M v[48:51],v[128:131],v[64:67],v[48:51]
M v[36:39],v[120:123],v[64:67],0
M v[36:39],v[136:139],v[192:195],v[36:39]
M v[52:55],v[120:123],v[72:75],0
M v[52:55],v[136:139],v[64:67],v[52:55]
s_waitcnt lgkmcnt(0)
M v[40:43],v[112:115],v[68:71],0
M v[40:43],v[128:131],v[196:199],v[40:43]
M v[56:59],v[112:115],v[76:79],0
M v[56:59],v[128:131],v[68:71],v[56:59]
M v[44:47],v[120:123],v[68:71],0
M v[44:47],v[136:139],v[196:199],v[44:47]
M v[60:63],v[120:123],v[76:79],0
M v[60:63],v[136:139],v[68:71],v[60:63]
CV v32,v32,v33
CV v33,v34,v35
CV v34,v36,v37
CV v35,v38,v39
buffer_store_dwordx4 v[32:35],v4,s[92:95],s64 offen offset:0 sc1
CV v40,v40,v41
CV v41,v42,v43
CV v42,v44,v45
CV v43,v46,v47
buffer_store_dwordx4 v[40:43],v4,s[92:95],s64 offen offset:1024 sc1
CV v48,v48,v49
CV v49,v50,v51
CV v50,v52,v53
CV v51,v54,v55
buffer_store_dwordx4 v[48:51],v4,s[92:95],s65 offen offset:0 sc1
CV v56,v56,v57
CV v57,v58,v59
CV v58,v60,v61
CV v59,v62,v63
buffer_store_dwordx4 v[56:59],v4,s[92:95],s65 offen offset:1024 sc1
s_load_dwordx2 s[78:79],s[0:1],64
s_cmp_eq_u32 s28,0
s_cselect_b32 s32,-1,s32
s_sub_u32 s49,5,s45
s_sub_u32 s48,s45,1
s_mov_b32 s53,s45
s_cmp_eq_u32 s45,0
s_cselect_b32 s50,11,9
s_or_b32 s50,s50,64
s_cmp_ge_u32 s45,6
s_cselect_b32 s50,64,s50
s_mov_b32 s72,s12
s_mov_b32 s73,s13
s_mov_b32 s74,0
s_mov_b32 s75,0x20000
v_lshrrev_b32 v0,4,v4
v_add_u32 v1,66304,v4
v_mov_b32 v2,v4
v_mov_b32 v7,0xf149f2ca
v_and_b32 v12,15,v0
v_lshrrev_b32 v13,4,v0
v_lshlrev_b32 v13,2,v13
v_sub_u32 v12,v12,v13
s_lshl_b32 s46,s42,4
v_add_u32 v5,s46,v12
s_sub_u32 s46,48,s46
v_add_u32 v6,s46,v12
s_branch L_attn
L_role_a:
s_waitcnt lgkmcnt(15)
M v[16:19],a[128:131],a[0:3],0
DR a[144:147],v1,512
M v[16:19],a[132:135],a[4:7],v[16:19]
DR a[148:151],v1,576
M v[20:23],a[132:135],a[12:15],0
DR a[152:155],v1,768
M v[20:23],a[128:131],a[8:11],v[20:23]
DR a[156:159],v1,832
M v[24:27],a[128:131],a[16:19],0
M v[24:27],a[132:135],a[20:23],v[24:27]
M v[28:31],a[132:135],a[28:31],0
M v[28:31],a[128:131],a[24:27],v[28:31]
M v[32:35],a[128:131],a[32:35],0
s_waitcnt lgkmcnt(15)
M v[32:35],a[132:135],a[36:39],v[32:35]
s_waitcnt lgkmcnt(14)
M v[36:39],a[132:135],a[44:47],0
M v[36:39],a[128:131],a[40:43],v[36:39]
s_waitcnt lgkmcnt(12)
M v[40:43],a[128:131],a[48:51],0
s_waitcnt lgkmcnt(10)
M v[40:43],a[132:135],a[52:55],v[40:43]
s_waitcnt lgkmcnt(6)
M v[44:47],a[132:135],a[60:63],0
s_mov_b32 m0,s68
M v[44:47],a[128:131],a[56:59],v[44:47]
s_waitcnt lgkmcnt(5)
M v[48:51],a[136:139],a[0:3],0
DR a[128:131],v1,1024
s_waitcnt lgkmcnt(5)
M v[48:51],a[140:143],a[4:7],v[48:51]
DR a[132:135],v1,1088
M v[52:55],a[140:143],a[12:15],0
s_waitcnt lgkmcnt(0)
s_barrier
M v[52:55],a[136:139],a[8:11],v[52:55]
M v[56:59],a[136:139],a[16:19],0
buffer_load_dwordx4 v5,s[8:11],s56 offen offset:0 lds
M v[56:59],a[140:143],a[20:23],v[56:59]
M v[60:63],a[140:143],a[28:31],0
M v[60:63],a[136:139],a[24:27],v[60:63]
buffer_load_dwordx4 v5,s[8:11],s57 offen offset:1024 lds
M v[64:67],a[136:139],a[32:35],0
M v[64:67],a[140:143],a[36:39],v[64:67]
buffer_load_dwordx4 v5,s[8:11],s58 offen offset:2048 lds
M v[68:71],a[140:143],a[44:47],0
M v[68:71],a[136:139],a[40:43],v[68:71]
M v[72:75],a[136:139],a[48:51],0
buffer_load_dwordx4 v5,s[8:11],s59 offen offset:3072 lds
M v[72:75],a[140:143],a[52:55],v[72:75]
s_mov_b32 m0,s69
M v[76:79],a[140:143],a[60:63],0
buffer_load_dwordx4 v5,s[8:11],s60 offen offset:0 lds
M v[76:79],a[136:139],a[56:59],v[76:79]
M v[80:83],a[144:147],a[0:3],0
DR a[136:139],v1,1280
M v[80:83],a[148:151],a[4:7],v[80:83]
DR a[140:143],v1,1344
M v[84:87],a[148:151],a[12:15],0
buffer_load_dwordx4 v5,s[8:11],s61 offen offset:1024 lds
M v[84:87],a[144:147],a[8:11],v[84:87]
buffer_load_dwordx4 v5,s[8:11],s62 offen offset:2048 lds
M v[88:91],a[144:147],a[16:19],0
M v[88:91],a[148:151],a[20:23],v[88:91]
M v[92:95],a[148:151],a[28:31],0
buffer_load_dwordx4 v5,s[8:11],s63 offen offset:3072 lds
M v[92:95],a[144:147],a[24:27],v[92:95]
s_add_u32 s8,s8,524288
s_addc_u32 s9,s9,0
s_sub_u32 s10,s10,524288
M v[96:99],a[144:147],a[32:35],0
M v[96:99],a[148:151],a[36:39],v[96:99]
M v[100:103],a[148:151],a[44:47],0
M v[100:103],a[144:147],a[40:43],v[100:103]
M v[104:107],a[144:147],a[48:51],0
s_waitcnt vmcnt(18)
s_barrier
M v[104:107],a[148:151],a[52:55],v[104:107]
DT a[64:65],v2,33152
M v[108:111],a[148:151],a[60:63],0
v_accvgpr_write_b32 a176,v128
v_accvgpr_write_b32 a177,v129
M v[108:111],a[144:147],a[56:59],v[108:111]
DT a[66:67],v2,33664
v_accvgpr_write_b32 a178,v130
M v[112:115],a[152:155],a[0:3],0
DR a[144:147],v1,1536
v_accvgpr_write_b32 a179,v131
M v[112:115],a[156:159],a[4:7],v[112:115]
DR a[148:151],v1,1600
v_accvgpr_write_b32 a180,v136
M v[116:119],a[156:159],a[12:15],0
DT a[68:69],v2,35200
v_accvgpr_write_b32 a181,v137
M v[116:119],a[152:155],a[8:11],v[116:119]
DT a[70:71],v2,35712
v_accvgpr_write_b32 a182,v138
M v[120:123],a[152:155],a[16:19],0
DT a[72:73],v2,33184
v_accvgpr_write_b32 a183,v139
M v[120:123],a[156:159],a[20:23],v[120:123]
DT a[74:75],v2,33696
M v[124:127],a[156:159],a[28:31],0
DT a[76:77],v2,35232
M v[124:127],a[152:155],a[24:27],v[124:127]
DT a[78:79],v2,35744
M v[128:131],a[152:155],a[32:35],0
DT a[80:81],v2,33216
M v[128:131],a[156:159],a[36:39],v[128:131]
DT a[82:83],v2,33728
M v[132:135],a[156:159],a[44:47],0
DT a[84:85],v2,35264
M v[132:135],a[152:155],a[40:43],v[132:135]
DT a[86:87],v2,35776
M v[136:139],a[152:155],a[48:51],0
DT a[88:89],v2,33248
M v[136:139],a[156:159],a[52:55],v[136:139]
buffer_load_dword a238,v15,s[88:91],s52 offen
M v[140:143],a[156:159],a[60:63],0
s_add_u32 s52,s52,1048576
DT a[90:91],v2,33760
M v[140:143],a[152:155],a[56:59],v[140:143]
DT a[92:93],v2,35296
M v[144:147],a[128:131],a[0:3],0
DR a[152:155],v1,1792
M v[144:147],a[132:135],a[4:7],v[144:147]
DR a[156:159],v1,1856
M v[148:151],a[132:135],a[12:15],0
DT a[94:95],v2,35808
M v[148:151],a[128:131],a[8:11],v[148:151]
DT a[96:97],v2,33280
M v[152:155],a[128:131],a[16:19],0
DT a[98:99],v2,33792
M v[152:155],a[132:135],a[20:23],v[152:155]
DT a[100:101],v2,35328
M v[156:159],a[132:135],a[28:31],0
DT a[102:103],v2,35840
M v[156:159],a[128:131],a[24:27],v[156:159]
DT a[104:105],v2,33312
M v[160:163],a[128:131],a[32:35],0
DT a[106:107],v2,33824
M v[160:163],a[132:135],a[36:39],v[160:163]
DT a[108:109],v2,35360
M v[164:167],a[132:135],a[44:47],0
DT a[110:111],v2,35872
M v[164:167],a[128:131],a[40:43],v[164:167]
DT a[112:113],v2,33344
M v[168:171],a[128:131],a[48:51],0
buffer_load_dword a238,v0,s[84:87],s51 offen
M v[168:171],a[132:135],a[52:55],v[168:171]
s_add_u32 s51,s51,256
DT a[114:115],v2,33856
M v[172:175],a[132:135],a[60:63],0
DT a[116:117],v2,35392
M v[172:175],a[128:131],a[56:59],v[172:175]
s_waitcnt lgkmcnt(15)
DT a[118:119],v2,35904
M v[176:179],a[136:139],a[0:3],0
DT a[120:121],v2,33376
M v[176:179],a[140:143],a[4:7],v[176:179]
M v[180:183],a[140:143],a[12:15],0
DT a[122:123],v2,33888
M v[180:183],a[136:139],a[8:11],v[180:183]
DT a[124:125],v2,35424
M v[184:187],a[136:139],a[16:19],0
DT a[126:127],v2,35936
M v[184:187],a[140:143],a[20:23],v[184:187]
M v[188:191],a[140:143],a[28:31],0
M v[188:191],a[136:139],a[24:27],v[188:191]
M v[192:195],a[136:139],a[32:35],0
M v[192:195],a[140:143],a[36:39],v[192:195]
M v[196:199],a[140:143],a[44:47],0
M v[196:199],a[136:139],a[40:43],v[196:199]
M v[200:203],a[136:139],a[48:51],0
M v[200:203],a[140:143],a[52:55],v[200:203]
M v[204:207],a[140:143],a[60:63],0
M v[204:207],a[136:139],a[56:59],v[204:207]
s_waitcnt vmcnt(12) lgkmcnt(0)
s_barrier
M v[208:211],a[144:147],a[0:3],0
s_mov_b32 m0,s36
DR a[128:131],v1,33152
M v[208:211],a[148:151],a[4:7],v[208:211]
DR a[132:135],v1,33216
M v[212:215],a[148:151],a[12:15],0
DR a[136:139],v1,33408
M v[212:215],a[144:147],a[8:11],v[212:215]
DR a[140:143],v1,33472
M v[216:219],a[144:147],a[16:19],0
buffer_load_dwordx4 v3,s[4:7],s28 offen offset:0 lds
M v[216:219],a[148:151],a[20:23],v[216:219]
M v[220:223],a[148:151],a[28:31],0
M v[220:223],a[144:147],a[24:27],v[220:223]
M v[224:227],a[144:147],a[32:35],0
buffer_load_dwordx4 v3,s[4:7],s29 offen offset:1024 lds
M v[224:227],a[148:151],a[36:39],v[224:227]
M v[228:231],a[148:151],a[44:47],0
M v[228:231],a[144:147],a[40:43],v[228:231]
M v[232:235],a[144:147],a[48:51],0
M v[232:235],a[148:151],a[52:55],v[232:235]
M v[236:239],a[148:151],a[60:63],0
buffer_load_dwordx4 v3,s[4:7],s30 offen offset:2048 lds
M v[236:239],a[144:147],a[56:59],v[236:239]
M v[240:243],a[152:155],a[0:3],0
DR a[144:147],v1,33664
M v[240:243],a[156:159],a[4:7],v[240:243]
DR a[148:151],v1,33728
M v[244:247],a[156:159],a[12:15],0
M v[244:247],a[152:155],a[8:11],v[244:247]
M v[248:251],a[152:155],a[16:19],0
buffer_load_dwordx4 v3,s[4:7],s31 offen offset:3072 lds
M v[248:251],a[156:159],a[20:23],v[248:251]
s_mov_b32 m0,s37
M v[252:255],a[156:159],a[28:31],0
M v[252:255],a[152:155],a[24:27],v[252:255]
M a[240:243],a[152:155],a[32:35],0
M a[240:243],a[156:159],a[36:39],a[240:243]
buffer_load_dwordx4 v3,s[4:7],s32 offen offset:0 lds
M a[244:247],a[156:159],a[44:47],0
M a[244:247],a[152:155],a[40:43],a[244:247]
M a[248:251],a[152:155],a[48:51],0
M a[248:251],a[156:159],a[52:55],a[248:251]
M a[252:255],a[156:159],a[60:63],0
M a[252:255],a[152:155],a[56:59],a[252:255]
s_waitcnt lgkmcnt(4)
M v[16:19],a[128:131],a[64:67],v[16:19]
DR a[152:155],v1,33920
M v[16:19],a[132:135],a[68:71],v[16:19]
DR a[156:159],v1,33984
M v[20:23],a[132:135],a[76:79],v[20:23]
buffer_load_dwordx4 v3,s[4:7],s33 offen offset:1024 lds
M v[20:23],a[128:131],a[72:75],v[20:23]
M v[24:27],a[128:131],a[80:83],v[24:27]
M v[24:27],a[132:135],a[84:87],v[24:27]
buffer_load_dwordx4 v3,s[4:7],s34 offen offset:2048 lds
M v[28:31],a[132:135],a[92:95],v[28:31]
M v[28:31],a[128:131],a[88:91],v[28:31]
M v[32:35],a[128:131],a[96:99],v[32:35]
M v[32:35],a[132:135],a[100:103],v[32:35]
M v[36:39],a[132:135],a[108:111],v[36:39]
M v[36:39],a[128:131],a[104:107],v[36:39]
buffer_load_dwordx4 v3,s[4:7],s35 offen offset:3072 lds
M v[40:43],a[128:131],a[112:115],v[40:43]
s_add_u32 s4,s4,128
s_addc_u32 s5,s5,0
s_sub_u32 s6,s6,128
M v[40:43],a[132:135],a[116:119],v[40:43]
M v[44:47],a[132:135],a[124:127],v[44:47]
s_mov_b32 m0,s70
M v[44:47],a[128:131],a[120:123],v[44:47]
s_waitcnt vmcnt(10) lgkmcnt(4)
s_barrier
M v[48:51],a[136:139],a[64:67],v[48:51]
DR a[128:131],v1,34176
M v[48:51],a[140:143],a[68:71],v[48:51]
DR a[132:135],v1,34240
M v[52:55],a[140:143],a[76:79],v[52:55]
DT a[0:1],v2,0
M v[52:55],a[136:139],a[72:75],v[52:55]
DT a[2:3],v2,512
M v[56:59],a[136:139],a[80:83],v[56:59]
buffer_load_dwordx4 v5,s[8:11],s56 offen offset:0 lds
M v[56:59],a[140:143],a[84:87],v[56:59]
DT a[4:5],v2,2048
M v[60:63],a[140:143],a[92:95],v[60:63]
M v[60:63],a[136:139],a[88:91],v[60:63]
DT a[6:7],v2,2560
M v[64:67],a[136:139],a[96:99],v[64:67]
M v[64:67],a[140:143],a[100:103],v[64:67]
DT a[8:9],v2,32
M v[68:71],a[140:143],a[108:111],v[68:71]
buffer_load_dwordx4 v5,s[8:11],s57 offen offset:1024 lds
M v[68:71],a[136:139],a[104:107],v[68:71]
DT a[10:11],v2,544
M v[72:75],a[136:139],a[112:115],v[72:75]
M v[72:75],a[140:143],a[116:119],v[72:75]
M v[76:79],a[140:143],a[124:127],v[76:79]
DT a[12:13],v2,2080
M v[76:79],a[136:139],a[120:123],v[76:79]
s_waitcnt lgkmcnt(11)
M v[80:83],a[144:147],a[64:67],v[80:83]
DR a[136:139],v1,34432
M v[80:83],a[148:151],a[68:71],v[80:83]
DR a[140:143],v1,34496
M v[84:87],a[148:151],a[76:79],v[84:87]
DT a[14:15],v2,2592
M v[84:87],a[144:147],a[72:75],v[84:87]
DT a[16:17],v2,64
M v[88:91],a[144:147],a[80:83],v[88:91]
DT a[18:19],v2,576
M v[88:91],a[148:151],a[84:87],v[88:91]
buffer_load_dwordx4 v5,s[8:11],s58 offen offset:2048 lds
M v[92:95],a[148:151],a[92:95],v[92:95]
DT a[20:21],v2,2112
M v[92:95],a[144:147],a[88:91],v[92:95]
buffer_load_dwordx4 v5,s[8:11],s59 offen offset:3072 lds
M v[96:99],a[144:147],a[96:99],v[96:99]
s_mov_b32 m0,s71
M v[96:99],a[148:151],a[100:103],v[96:99]
DT a[22:23],v2,2624
M v[100:103],a[148:151],a[108:111],v[100:103]
M v[100:103],a[144:147],a[104:107],v[100:103]
DT a[24:25],v2,96
M v[104:107],a[144:147],a[112:115],v[104:107]
buffer_load_dwordx4 v5,s[8:11],s60 offen offset:0 lds
M v[104:107],a[148:151],a[116:119],v[104:107]
DT a[26:27],v2,608
M v[108:111],a[148:151],a[124:127],v[108:111]
M v[108:111],a[144:147],a[120:123],v[108:111]
s_waitcnt lgkmcnt(15)
DT a[28:29],v2,2144
M v[112:115],a[152:155],a[64:67],v[112:115]
DR a[144:147],v1,34688
M v[112:115],a[156:159],a[68:71],v[112:115]
DR a[148:151],v1,34752
M v[116:119],a[156:159],a[76:79],v[116:119]
DT a[30:31],v2,2656
M v[116:119],a[152:155],a[72:75],v[116:119]
DT a[32:33],v2,128
M v[120:123],a[152:155],a[80:83],v[120:123]
buffer_load_dwordx4 v5,s[8:11],s61 offen offset:1024 lds
M v[120:123],a[156:159],a[84:87],v[120:123]
M v[124:127],a[156:159],a[92:95],v[124:127]
DT a[34:35],v2,640
M v[124:127],a[152:155],a[88:91],v[124:127]
buffer_load_dwordx4 v5,s[8:11],s62 offen offset:2048 lds
M v[128:131],a[152:155],a[96:99],v[128:131]
DT a[36:37],v2,2176
M v[128:131],a[156:159],a[100:103],v[128:131]
M v[132:135],a[156:159],a[108:111],v[132:135]
DT a[38:39],v2,2688
M v[132:135],a[152:155],a[104:107],v[132:135]
M v[136:139],a[152:155],a[112:115],v[136:139]
DT a[40:41],v2,160
M v[136:139],a[156:159],a[116:119],v[136:139]
buffer_load_dwordx4 v5,s[8:11],s63 offen offset:3072 lds
M v[140:143],a[156:159],a[124:127],v[140:143]
s_add_u32 s8,s8,524288
s_addc_u32 s9,s9,0
DT a[42:43],v2,672
M v[140:143],a[152:155],a[120:123],v[140:143]
s_sub_u32 s10,s10,524288
M v[144:147],a[128:131],a[64:67],v[144:147]
DR a[152:155],v1,34944
M v[144:147],a[132:135],a[68:71],v[144:147]
DR a[156:159],v1,35008
M v[148:151],a[132:135],a[76:79],v[148:151]
DT a[44:45],v2,2208
M v[148:151],a[128:131],a[72:75],v[148:151]
DT a[46:47],v2,2720
M v[152:155],a[128:131],a[80:83],v[152:155]
buffer_load_dword a238,v0,s[84:87],s51 offen
M v[152:155],a[132:135],a[84:87],v[152:155]
s_add_u32 s51,s51,256
s_mov_b32 s14,921600
s_mov_b32 s15,0x20000
M v[156:159],a[132:135],a[92:95],v[156:159]
s_mov_b32 s18,921600
s_mov_b32 s19,0x20000
s_lshr_b32 s46,s2,4
M v[156:159],a[128:131],a[88:91],v[156:159]
s_lshl_b32 s46,s46,6
s_lshl_b32 s47,s42,4
s_add_u32 s46,s46,s47
M v[160:163],a[128:131],a[96:99],v[160:163]
s_and_b32 s47,s2,15
s_add_u32 s46,s46,s47
DT a[48:49],v2,192
M v[160:163],a[132:135],a[100:103],v[160:163]
s_mul_i32 s46,s46,900
DT a[50:51],v2,704
v_lshrrev_b32 v6,2,v4
M v[164:167],a[132:135],a[108:111],v[164:167]
s_lshl_b32 s47,s42,11
s_add_u32 m0,s47,132608
DT a[52:53],v2,2240
M v[164:167],a[128:131],a[104:107],v[164:167]
buffer_load_dword v6,s[12:15],s46 offen offset:0 lds
M v[168:171],a[128:131],a[112:115],v[168:171]
buffer_load_dword v6,s[12:15],s46 offen offset:256 lds
M v[168:171],a[132:135],a[116:119],v[168:171]
buffer_load_dword v6,s[12:15],s46 offen offset:512 lds
M v[172:175],a[132:135],a[124:127],v[172:175]
buffer_load_dword v6,s[12:15],s46 offen offset:768 lds
M v[172:175],a[128:131],a[120:123],v[172:175]
s_waitcnt lgkmcnt(15)
s_add_u32 m0,s47,133632
DT a[54:55],v2,2752
M v[176:179],a[136:139],a[64:67],v[176:179]
buffer_load_dword v6,s[16:19],s46 offen offset:0 lds
M v[176:179],a[140:143],a[68:71],v[176:179]
DT a[56:57],v2,224
M v[180:183],a[140:143],a[76:79],v[180:183]
buffer_load_dword v6,s[16:19],s46 offen offset:256 lds
M v[180:183],a[136:139],a[72:75],v[180:183]
DT a[58:59],v2,736
M v[184:187],a[136:139],a[80:83],v[184:187]
buffer_load_dword v6,s[16:19],s46 offen offset:512 lds
M v[184:187],a[140:143],a[84:87],v[184:187]
DT a[60:61],v2,2272
M v[188:191],a[140:143],a[92:95],v[188:191]
buffer_load_dword v6,s[16:19],s46 offen offset:768 lds
M v[188:191],a[136:139],a[88:91],v[188:191]
DT a[62:63],v2,2784
M v[192:195],a[136:139],a[96:99],v[192:195]
M v[192:195],a[140:143],a[100:103],v[192:195]
M v[196:199],a[140:143],a[108:111],v[196:199]
M v[196:199],a[136:139],a[104:107],v[196:199]
M v[200:203],a[136:139],a[112:115],v[200:203]
M v[200:203],a[140:143],a[116:119],v[200:203]
M v[204:207],a[140:143],a[124:127],v[204:207]
M v[204:207],a[136:139],a[120:123],v[204:207]
s_waitcnt vmcnt(17) lgkmcnt(0)
s_barrier
M v[208:211],a[144:147],a[64:67],v[208:211]
s_mov_b32 m0,s38
DR a[128:131],v1,0
M v[208:211],a[148:151],a[68:71],v[208:211]
DR a[132:135],v1,64
M v[212:215],a[148:151],a[76:79],v[212:215]
DR a[136:139],v1,256
M v[212:215],a[144:147],a[72:75],v[212:215]
DR a[140:143],v1,320
M v[216:219],a[144:147],a[80:83],v[216:219]
buffer_load_dwordx4 v3,s[4:7],s28 offen offset:0 lds
M v[216:219],a[148:151],a[84:87],v[216:219]
M v[220:223],a[148:151],a[92:95],v[220:223]
M v[220:223],a[144:147],a[88:91],v[220:223]
M v[224:227],a[144:147],a[96:99],v[224:227]
buffer_load_dwordx4 v3,s[4:7],s29 offen offset:1024 lds
M v[224:227],a[148:151],a[100:103],v[224:227]
M v[228:231],a[148:151],a[108:111],v[228:231]
M v[228:231],a[144:147],a[104:107],v[228:231]
M v[232:235],a[144:147],a[112:115],v[232:235]
M v[232:235],a[148:151],a[116:119],v[232:235]
M v[236:239],a[148:151],a[124:127],v[236:239]
buffer_load_dwordx4 v3,s[4:7],s30 offen offset:2048 lds
M v[236:239],a[144:147],a[120:123],v[236:239]
M v[240:243],a[152:155],a[64:67],v[240:243]
DR a[144:147],v1,512
M v[240:243],a[156:159],a[68:71],v[240:243]
DR a[148:151],v1,576
M v[244:247],a[156:159],a[76:79],v[244:247]
M v[244:247],a[152:155],a[72:75],v[244:247]
M v[248:251],a[152:155],a[80:83],v[248:251]
buffer_load_dwordx4 v3,s[4:7],s31 offen offset:3072 lds
M v[248:251],a[156:159],a[84:87],v[248:251]
s_mov_b32 m0,s39
M v[252:255],a[156:159],a[92:95],v[252:255]
M v[252:255],a[152:155],a[88:91],v[252:255]
M a[240:243],a[152:155],a[96:99],a[240:243]
M a[240:243],a[156:159],a[100:103],a[240:243]
buffer_load_dwordx4 v3,s[4:7],s32 offen offset:0 lds
M a[244:247],a[156:159],a[108:111],a[244:247]
M a[244:247],a[152:155],a[104:107],a[244:247]
M a[248:251],a[152:155],a[112:115],a[248:251]
M a[248:251],a[156:159],a[116:119],a[248:251]
M a[252:255],a[156:159],a[124:127],a[252:255]
M a[252:255],a[152:155],a[120:123],a[252:255]
s_waitcnt lgkmcnt(4)
M v[16:19],a[128:131],a[0:3],v[16:19]
DR a[152:155],v1,768
M v[16:19],a[132:135],a[4:7],v[16:19]
DR a[156:159],v1,832
M v[20:23],a[132:135],a[12:15],v[20:23]
buffer_load_dwordx4 v3,s[4:7],s33 offen offset:1024 lds
M v[20:23],a[128:131],a[8:11],v[20:23]
M v[24:27],a[128:131],a[16:19],v[24:27]
M v[24:27],a[132:135],a[20:23],v[24:27]
buffer_load_dwordx4 v3,s[4:7],s34 offen offset:2048 lds
M v[28:31],a[132:135],a[28:31],v[28:31]
M v[28:31],a[128:131],a[24:27],v[28:31]
M v[32:35],a[128:131],a[32:35],v[32:35]
M v[32:35],a[132:135],a[36:39],v[32:35]
M v[36:39],a[132:135],a[44:47],v[36:39]
M v[36:39],a[128:131],a[40:43],v[36:39]
buffer_load_dwordx4 v3,s[4:7],s35 offen offset:3072 lds
M v[40:43],a[128:131],a[48:51],v[40:43]
s_add_u32 s4,s4,128
s_addc_u32 s5,s5,0
s_sub_u32 s6,s6,128
M v[40:43],a[132:135],a[52:55],v[40:43]
M v[44:47],a[132:135],a[60:63],v[44:47]
s_mov_b32 m0,s68
M v[44:47],a[128:131],a[56:59],v[44:47]
s_waitcnt vmcnt(17) lgkmcnt(4)
s_barrier
M v[48:51],a[136:139],a[0:3],v[48:51]
DR a[128:131],v1,1024
M v[48:51],a[140:143],a[4:7],v[48:51]
DR a[132:135],v1,1088
M v[52:55],a[140:143],a[12:15],v[52:55]
DT a[64:65],v2,33152
M v[52:55],a[136:139],a[8:11],v[52:55]
DT a[66:67],v2,33664
M v[56:59],a[136:139],a[16:19],v[56:59]
buffer_load_dwordx4 v5,s[8:11],s56 offen offset:0 lds
M v[56:59],a[140:143],a[20:23],v[56:59]
DT a[68:69],v2,35200
M v[60:63],a[140:143],a[28:31],v[60:63]
M v[60:63],a[136:139],a[24:27],v[60:63]
DT a[70:71],v2,35712
M v[64:67],a[136:139],a[32:35],v[64:67]
M v[64:67],a[140:143],a[36:39],v[64:67]
DT a[72:73],v2,33184
M v[68:71],a[140:143],a[44:47],v[68:71]
buffer_load_dwordx4 v5,s[8:11],s57 offen offset:1024 lds
M v[68:71],a[136:139],a[40:43],v[68:71]
DT a[74:75],v2,33696
M v[72:75],a[136:139],a[48:51],v[72:75]
M v[72:75],a[140:143],a[52:55],v[72:75]
M v[76:79],a[140:143],a[60:63],v[76:79]
DT a[76:77],v2,35232
M v[76:79],a[136:139],a[56:59],v[76:79]
s_waitcnt lgkmcnt(11)
M v[80:83],a[144:147],a[0:3],v[80:83]
DR a[136:139],v1,1280
M v[80:83],a[148:151],a[4:7],v[80:83]
DR a[140:143],v1,1344
M v[84:87],a[148:151],a[12:15],v[84:87]
DT a[78:79],v2,35744
M v[84:87],a[144:147],a[8:11],v[84:87]
DT a[80:81],v2,33216
M v[88:91],a[144:147],a[16:19],v[88:91]
DT a[82:83],v2,33728
M v[88:91],a[148:151],a[20:23],v[88:91]
buffer_load_dwordx4 v5,s[8:11],s58 offen offset:2048 lds
M v[92:95],a[148:151],a[28:31],v[92:95]
DT a[84:85],v2,35264
M v[92:95],a[144:147],a[24:27],v[92:95]
buffer_load_dwordx4 v5,s[8:11],s59 offen offset:3072 lds
M v[96:99],a[144:147],a[32:35],v[96:99]
s_mov_b32 m0,s69
M v[96:99],a[148:151],a[36:39],v[96:99]
DT a[86:87],v2,35776
M v[100:103],a[148:151],a[44:47],v[100:103]
M v[100:103],a[144:147],a[40:43],v[100:103]
DT a[88:89],v2,33248
M v[104:107],a[144:147],a[48:51],v[104:107]
buffer_load_dwordx4 v5,s[8:11],s60 offen offset:0 lds
M v[104:107],a[148:151],a[52:55],v[104:107]
DT a[90:91],v2,33760
M v[108:111],a[148:151],a[60:63],v[108:111]
M v[108:111],a[144:147],a[56:59],v[108:111]
s_waitcnt lgkmcnt(15)
DT a[92:93],v2,35296
M v[112:115],a[152:155],a[0:3],v[112:115]
DR a[144:147],v1,1536
M v[112:115],a[156:159],a[4:7],v[112:115]
DR a[148:151],v1,1600
M v[116:119],a[156:159],a[12:15],v[116:119]
DT a[94:95],v2,35808
M v[116:119],a[152:155],a[8:11],v[116:119]
DT a[96:97],v2,33280
M v[120:123],a[152:155],a[16:19],v[120:123]
buffer_load_dwordx4 v5,s[8:11],s61 offen offset:1024 lds
M v[120:123],a[156:159],a[20:23],v[120:123]
M v[124:127],a[156:159],a[28:31],v[124:127]
DT a[98:99],v2,33792
M v[124:127],a[152:155],a[24:27],v[124:127]
buffer_load_dwordx4 v5,s[8:11],s62 offen offset:2048 lds
M v[128:131],a[152:155],a[32:35],v[128:131]
DT a[100:101],v2,35328
M v[128:131],a[156:159],a[36:39],v[128:131]
M v[132:135],a[156:159],a[44:47],v[132:135]
DT a[102:103],v2,35840
M v[132:135],a[152:155],a[40:43],v[132:135]
M v[136:139],a[152:155],a[48:51],v[136:139]
DT a[104:105],v2,33312
M v[136:139],a[156:159],a[52:55],v[136:139]
buffer_load_dwordx4 v5,s[8:11],s63 offen offset:3072 lds
M v[140:143],a[156:159],a[60:63],v[140:143]
s_add_u32 s8,s8,524288
s_addc_u32 s9,s9,0
DT a[106:107],v2,33824
M v[140:143],a[152:155],a[56:59],v[140:143]
s_sub_u32 s10,s10,524288
M v[144:147],a[128:131],a[0:3],v[144:147]
buffer_store_dwordx4 a[176:179],v8,s[20:23],0 offen sc1
DR a[152:155],v1,1792
M v[144:147],a[132:135],a[4:7],v[144:147]
buffer_store_dwordx4 a[180:183],v9,s[20:23],0 offen sc1
DR a[156:159],v1,1856
M v[148:151],a[132:135],a[12:15],v[148:151]
DT a[108:109],v2,35360
M v[148:151],a[128:131],a[8:11],v[148:151]
DT a[110:111],v2,35872
M v[152:155],a[128:131],a[16:19],v[152:155]
buffer_load_dword a238,v15,s[88:91],s52 offen
M v[152:155],a[132:135],a[20:23],v[152:155]
s_add_u32 s52,s52,1048576
s_mov_b32 s92,s80
s_mov_b32 s93,s81
M v[156:159],a[132:135],a[28:31],v[156:159]
s_mov_b32 s94,256
s_mov_b32 s95,0x20000
DT a[112:113],v2,33344
M v[156:159],a[128:131],a[24:27],v[156:159]
buffer_load_dword v13,off,s[92:95],0 sc1
M v[160:163],a[128:131],a[32:35],v[160:163]
DT a[114:115],v2,33856
M v[160:163],a[132:135],a[36:39],v[160:163]
DT a[116:117],v2,35392
M v[164:167],a[132:135],a[44:47],v[164:167]
M v[164:167],a[128:131],a[40:43],v[164:167]
M v[168:171],a[128:131],a[48:51],v[168:171]
DT a[118:119],v2,35904
M v[168:171],a[132:135],a[52:55],v[168:171]
M v[172:175],a[132:135],a[60:63],v[172:175]
DT a[120:121],v2,33376
M v[172:175],a[128:131],a[56:59],v[172:175]
s_waitcnt lgkmcnt(15)
M v[176:179],a[136:139],a[0:3],v[176:179]
DT a[122:123],v2,33888
M v[176:179],a[140:143],a[4:7],v[176:179]
M v[180:183],a[140:143],a[12:15],v[180:183]
DT a[124:125],v2,35424
M v[180:183],a[136:139],a[8:11],v[180:183]
M v[184:187],a[136:139],a[16:19],v[184:187]
DT a[126:127],v2,35936
M v[184:187],a[140:143],a[20:23],v[184:187]
M v[188:191],a[140:143],a[28:31],v[188:191]
M v[188:191],a[136:139],a[24:27],v[188:191]
M v[192:195],a[136:139],a[32:35],v[192:195]
M v[192:195],a[140:143],a[36:39],v[192:195]
M v[196:199],a[140:143],a[44:47],v[196:199]
M v[196:199],a[136:139],a[40:43],v[196:199]
M v[200:203],a[136:139],a[48:51],v[200:203]
M v[200:203],a[140:143],a[52:55],v[200:203]
M v[204:207],a[140:143],a[60:63],v[204:207]
M v[204:207],a[136:139],a[56:59],v[204:207]
s_waitcnt vmcnt(12) lgkmcnt(0)
s_barrier
M v[208:211],a[144:147],a[0:3],v[208:211]
s_mov_b32 m0,s36
s_mul_i32 s46,s2,7296
DR a[128:131],v1,33152
M v[208:211],a[148:151],a[4:7],v[208:211]
s_add_u32 s20,s82,s46
s_addc_u32 s21,s83,0
DR a[132:135],v1,33216
M v[212:215],a[148:151],a[12:15],v[212:215]
s_add_u32 s20,s20,109051904
s_addc_u32 s21,s21,0
DR a[136:139],v1,33408
M v[212:215],a[144:147],a[8:11],v[212:215]
s_mov_b32 s22,7200
s_mov_b32 s23,0x20000
DR a[140:143],v1,33472
M v[216:219],a[144:147],a[16:19],v[216:219]
buffer_load_dwordx4 v3,s[4:7],s28 offen offset:0 lds
M v[216:219],a[148:151],a[20:23],v[216:219]
s_lshl_b32 s47,s42,10
v_add_u32 v12,s47,v4
v_bfe_u32 v10,v12,4,1
M v[220:223],a[148:151],a[28:31],v[220:223]
v_mul_u32_u24 v10,450,v10
v_lshrrev_b32 v6,5,v12
M v[220:223],a[144:147],a[24:27],v[220:223]
v_lshl_add_u32 v10,v6,1,v10
v_add_u32 v10,132608,v10
M v[224:227],a[144:147],a[32:35],v[224:227]
s_mov_b32 s46,4096
M v[224:227],a[148:151],a[36:39],v[224:227]
buffer_load_dwordx4 v3,s[4:7],s29 offen offset:1024 lds
M v[228:231],a[148:151],a[44:47],v[228:231]
M v[228:231],a[144:147],a[40:43],v[228:231]
M v[232:235],a[144:147],a[48:51],v[232:235]
M v[232:235],a[148:151],a[52:55],v[232:235]
M v[236:239],a[148:151],a[60:63],v[236:239]
buffer_load_dwordx4 v3,s[4:7],s30 offen offset:2048 lds
M v[236:239],a[144:147],a[56:59],v[236:239]
ds_read_u16 a160,v10 offset:0
M v[240:243],a[152:155],a[0:3],v[240:243]
DR a[144:147],v1,33664
M v[240:243],a[156:159],a[4:7],v[240:243]
DR a[148:151],v1,33728
M v[244:247],a[156:159],a[12:15],v[244:247]
ds_read_u16 a161,v10 offset:2048
M v[244:247],a[152:155],a[8:11],v[244:247]
ds_read_u16 a162,v10 offset:4096
M v[248:251],a[152:155],a[16:19],v[248:251]
buffer_load_dwordx4 v3,s[4:7],s31 offen offset:3072 lds
M v[248:251],a[156:159],a[20:23],v[248:251]
s_mov_b32 m0,s37
ds_read_u16 a163,v10 offset:6144
M v[252:255],a[156:159],a[28:31],v[252:255]
ds_read_u16 a164,v10 offset:1024
M v[252:255],a[152:155],a[24:27],v[252:255]
ds_read_u16 a165,v10 offset:3072
M a[240:243],a[152:155],a[32:35],a[240:243]
ds_read_u16 a166,v10 offset:5120
M a[240:243],a[156:159],a[36:39],a[240:243]
buffer_load_dwordx4 v3,s[4:7],s32 offen offset:0 lds
M a[244:247],a[156:159],a[44:47],a[244:247]
ds_read_u16 a167,v10 offset:7168
M a[244:247],a[152:155],a[40:43],a[244:247]
ds_read_u16 a168,v10 offset:256
M a[248:251],a[152:155],a[48:51],a[248:251]
ds_read_u16 a169,v10 offset:2304
M a[248:251],a[156:159],a[52:55],a[248:251]
ds_read_u16 a170,v10 offset:4352
M a[252:255],a[156:159],a[60:63],a[252:255]
ds_read_u16 a171,v10 offset:6400
M a[252:255],a[152:155],a[56:59],a[252:255]
s_waitcnt lgkmcnt(15)
ds_read_u16 a172,v10 offset:1280
M v[16:19],a[128:131],a[64:67],v[16:19]
DR a[152:155],v1,33920
M v[16:19],a[132:135],a[68:71],v[16:19]
DR a[156:159],v1,33984
M v[20:23],a[132:135],a[76:79],v[20:23]
buffer_load_dwordx4 v3,s[4:7],s33 offen offset:1024 lds
M v[20:23],a[128:131],a[72:75],v[20:23]
ds_read_u16 a173,v10 offset:3328
M v[24:27],a[128:131],a[80:83],v[24:27]
ds_read_u16 a174,v10 offset:5376
M v[24:27],a[132:135],a[84:87],v[24:27]
buffer_load_dwordx4 v3,s[4:7],s34 offen offset:2048 lds
M v[28:31],a[132:135],a[92:95],v[28:31]
ds_read_u16 a175,v10 offset:7424
M v[28:31],a[128:131],a[88:91],v[28:31]
M v[32:35],a[128:131],a[96:99],v[32:35]
M v[32:35],a[132:135],a[100:103],v[32:35]
M v[36:39],a[132:135],a[108:111],v[36:39]
M v[36:39],a[128:131],a[104:107],v[36:39]
buffer_load_dwordx4 v3,s[4:7],s35 offen offset:3072 lds
M v[40:43],a[128:131],a[112:115],v[40:43]
s_add_u32 s4,s4,128
s_addc_u32 s5,s5,0
s_sub_u32 s6,s6,128
M v[40:43],a[132:135],a[116:119],v[40:43]
M v[44:47],a[132:135],a[124:127],v[44:47]
s_waitcnt lgkmcnt(0)
s_mov_b32 m0,s70
v_accvgpr_read_b32 v6,a161
M v[44:47],a[128:131],a[120:123],v[44:47]
s_waitcnt vmcnt(12)
s_barrier
M v[48:51],a[136:139],a[64:67],v[48:51]
DR a[128:131],v1,34176
v_accvgpr_read_b32 v14,a160
M v[48:51],a[140:143],a[68:71],v[48:51]
DR a[132:135],v1,34240
v_lshl_or_b32 v6,v6,16,v14
M v[52:55],a[140:143],a[76:79],v[52:55]
DT a[0:1],v2,0
v_accvgpr_read_b32 v7,a163
M v[52:55],a[136:139],a[72:75],v[52:55]
DT a[2:3],v2,512
v_accvgpr_read_b32 v14,a162
M v[56:59],a[136:139],a[80:83],v[56:59]
buffer_load_dwordx4 v5,s[8:11],s56 offen offset:0 lds
M v[56:59],a[140:143],a[84:87],v[56:59]
DT a[4:5],v2,2048
v_lshl_or_b32 v7,v7,16,v14
M v[60:63],a[140:143],a[92:95],v[60:63]
v_accvgpr_read_b32 v8,a165
v_accvgpr_read_b32 v14,a164
M v[60:63],a[136:139],a[88:91],v[60:63]
DT a[6:7],v2,2560
v_lshl_or_b32 v8,v8,16,v14
M v[64:67],a[136:139],a[96:99],v[64:67]
v_accvgpr_read_b32 v9,a167
v_accvgpr_read_b32 v14,a166
M v[64:67],a[140:143],a[100:103],v[64:67]
DT a[8:9],v2,32
v_lshl_or_b32 v9,v9,16,v14
M v[68:71],a[140:143],a[108:111],v[68:71]
buffer_load_dwordx4 v5,s[8:11],s57 offen offset:1024 lds
M v[68:71],a[136:139],a[104:107],v[68:71]
buffer_store_dwordx4 v[6:9],v12,s[20:23],0 offen sc1
DT a[10:11],v2,544
M v[72:75],a[136:139],a[112:115],v[72:75]
s_nop 0
v_accvgpr_read_b32 v6,a169
v_accvgpr_read_b32 v14,a168
M v[72:75],a[140:143],a[116:119],v[72:75]
v_lshl_or_b32 v6,v6,16,v14
v_accvgpr_read_b32 v7,a171
M v[76:79],a[140:143],a[124:127],v[76:79]
DT a[12:13],v2,2080
v_accvgpr_read_b32 v14,a170
M v[76:79],a[136:139],a[120:123],v[76:79]
v_lshl_or_b32 v7,v7,16,v14
v_accvgpr_read_b32 v8,a173
M v[80:83],a[144:147],a[64:67],v[80:83]
DR a[136:139],v1,34432
v_accvgpr_read_b32 v14,a172
M v[80:83],a[148:151],a[68:71],v[80:83]
DR a[140:143],v1,34496
v_lshl_or_b32 v8,v8,16,v14
M v[84:87],a[148:151],a[76:79],v[84:87]
DT a[14:15],v2,2592
v_accvgpr_read_b32 v9,a175
M v[84:87],a[144:147],a[72:75],v[84:87]
DT a[16:17],v2,64
v_accvgpr_read_b32 v14,a174
M v[88:91],a[144:147],a[80:83],v[88:91]
DT a[18:19],v2,576
v_lshl_or_b32 v9,v9,16,v14
M v[88:91],a[148:151],a[84:87],v[88:91]
buffer_load_dwordx4 v5,s[8:11],s58 offen offset:2048 lds
M v[92:95],a[148:151],a[92:95],v[92:95]
buffer_store_dwordx4 v[6:9],v12,s[20:23],s46 offen sc1
DT a[20:21],v2,2112
M v[92:95],a[144:147],a[88:91],v[92:95]
buffer_load_dwordx4 v5,s[8:11],s59 offen offset:3072 lds
M v[96:99],a[144:147],a[96:99],v[96:99]
s_mov_b32 m0,s71
s_nop 0
M v[96:99],a[148:151],a[100:103],v[96:99]
DT a[22:23],v2,2624
M v[100:103],a[148:151],a[108:111],v[100:103]
M v[100:103],a[144:147],a[104:107],v[100:103]
DT a[24:25],v2,96
M v[104:107],a[144:147],a[112:115],v[104:107]
buffer_load_dwordx4 v5,s[8:11],s60 offen offset:0 lds
M v[104:107],a[148:151],a[116:119],v[104:107]
DT a[26:27],v2,608
M v[108:111],a[148:151],a[124:127],v[108:111]
M v[108:111],a[144:147],a[120:123],v[108:111]
DT a[28:29],v2,2144
M v[112:115],a[152:155],a[64:67],v[112:115]
DR a[144:147],v1,34688
M v[112:115],a[156:159],a[68:71],v[112:115]
DR a[148:151],v1,34752
M v[116:119],a[156:159],a[76:79],v[116:119]
DT a[30:31],v2,2656
M v[116:119],a[152:155],a[72:75],v[116:119]
DT a[32:33],v2,128
M v[120:123],a[152:155],a[80:83],v[120:123]
buffer_load_dwordx4 v5,s[8:11],s61 offen offset:1024 lds
M v[120:123],a[156:159],a[84:87],v[120:123]
M v[124:127],a[156:159],a[92:95],v[124:127]
DT a[34:35],v2,640
M v[124:127],a[152:155],a[88:91],v[124:127]
buffer_load_dwordx4 v5,s[8:11],s62 offen offset:2048 lds
M v[128:131],a[152:155],a[96:99],v[128:131]
DT a[36:37],v2,2176
M v[128:131],a[156:159],a[100:103],v[128:131]
M v[132:135],a[156:159],a[108:111],v[132:135]
DT a[38:39],v2,2688
M v[132:135],a[152:155],a[104:107],v[132:135]
M v[136:139],a[152:155],a[112:115],v[136:139]
DT a[40:41],v2,160
M v[136:139],a[156:159],a[116:119],v[136:139]
buffer_load_dwordx4 v5,s[8:11],s63 offen offset:3072 lds
M v[140:143],a[156:159],a[124:127],v[140:143]
s_add_u32 s8,s8,524288
s_addc_u32 s9,s9,0
DT a[42:43],v2,672
M v[140:143],a[152:155],a[120:123],v[140:143]
s_waitcnt lgkmcnt(15)
s_sub_u32 s10,s10,524288
M v[144:147],a[128:131],a[64:67],v[144:147]
DR a[152:155],v1,34944
M v[144:147],a[132:135],a[68:71],v[144:147]
DR a[156:159],v1,35008
M v[148:151],a[132:135],a[76:79],v[148:151]
DT a[44:45],v2,2208
M v[148:151],a[128:131],a[72:75],v[148:151]
DT a[46:47],v2,2720
M v[152:155],a[128:131],a[80:83],v[152:155]
buffer_load_dword a238,v0,s[84:87],s51 offen
M v[152:155],a[132:135],a[84:87],v[152:155]
s_add_u32 s51,s51,256
DT a[48:49],v2,192
M v[156:159],a[132:135],a[92:95],v[156:159]
M v[156:159],a[128:131],a[88:91],v[156:159]
DT a[50:51],v2,704
M v[160:163],a[128:131],a[96:99],v[160:163]
M v[160:163],a[132:135],a[100:103],v[160:163]
DT a[52:53],v2,2240
M v[164:167],a[132:135],a[108:111],v[164:167]
M v[164:167],a[128:131],a[104:107],v[164:167]
M v[168:171],a[128:131],a[112:115],v[168:171]
DT a[54:55],v2,2752
M v[168:171],a[132:135],a[116:119],v[168:171]
M v[172:175],a[132:135],a[124:127],v[172:175]
DT a[56:57],v2,224
M v[172:175],a[128:131],a[120:123],v[172:175]
M v[176:179],a[136:139],a[64:67],v[176:179]
DT a[58:59],v2,736
M v[176:179],a[140:143],a[68:71],v[176:179]
M v[180:183],a[140:143],a[76:79],v[180:183]
DT a[60:61],v2,2272
M v[180:183],a[136:139],a[72:75],v[180:183]
M v[184:187],a[136:139],a[80:83],v[184:187]
DT a[62:63],v2,2784
M v[184:187],a[140:143],a[84:87],v[184:187]
M v[188:191],a[140:143],a[92:95],v[188:191]
M v[188:191],a[136:139],a[88:91],v[188:191]
M v[192:195],a[136:139],a[96:99],v[192:195]
M v[192:195],a[140:143],a[100:103],v[192:195]
M v[196:199],a[140:143],a[108:111],v[196:199]
M v[196:199],a[136:139],a[104:107],v[196:199]
M v[200:203],a[136:139],a[112:115],v[200:203]
M v[200:203],a[140:143],a[116:119],v[200:203]
M v[204:207],a[140:143],a[124:127],v[204:207]
M v[204:207],a[136:139],a[120:123],v[204:207]
s_waitcnt vmcnt(11) lgkmcnt(0)
s_barrier
v_mov_b32 v14,0x7ff00000
v_cmp_eq_u32 vcc,1,v13
s_nop 0
s_cmp_eq_u64 vcc,-1
s_cbranch_scc0 L_spin4
L_spun4:
s_getreg_b32 s54,hwreg(HW_REG_XCC_ID)
s_and_b32 s54,s54,15
s_or_b32 s54,s54,0x80
s_lshl_b32 s46,s43,4
s_add_u32 s46,s46,s44
s_lshr_b32 s47,s46,3
s_mul_i32 s47,s47,120
s_add_u32 s46,s46,s47
s_add_u32 s46,s46,4096
s_cmp_eq_u32 s42,0
s_cbranch_scc0 L_nopub3
s_mov_b64 exec,1
v_mov_b32 v12,s54
buffer_store_byte v12,off,s[24:27],s46 offset:16 sc1
s_mov_b64 exec,-1
L_nopub3:
s_lshl_b32 s54,s54,16
s_or_b32 s44,s44,s54
s_lshl_b32 s46,s45,4
s_and_b32 s47,s2,15
s_add_u32 s46,s46,s47
s_lshl_b32 s46,s46,2
s_add_u32 s46,s46,s42
s_add_u32 s46,s46,512
s_mov_b32 s92,s72
s_mov_b32 s93,s73
s_mov_b32 s94,1835008
s_mov_b32 s95,0x20000
s_mul_i32 s47,s46,1792
v_lshlrev_b32 v13,3,v4
v_cmp_gt_u32 vcc,224,v4
s_nop 1
v_cndmask_b32 v13,v14,v13,vcc
buffer_load_dword a238,v13,s[92:95],s47 offen
s_lshl_b32 s46,s45,4
s_and_b32 s47,s2,15
s_add_u32 s46,s46,s47
s_lshl_b32 s46,s46,2
s_add_u32 s46,s46,s42
s_mov_b32 s98,3670016
s_mov_b32 s99,0x20000
v_lshlrev_b32 v13,3,v4
v_cmp_gt_u32 vcc,192,v4
s_nop 1
v_cndmask_b32 v13,v14,v13,vcc
s_mul_i32 s3,s46,7168
s_add_u32 s46,s46,s47
s_lshl_b32 s46,s46,2
s_add_u32 s46,s46,s42
s_mov_b32 s48,5
.p2align 4
L_kv_loop_a:
M v[208:211],a[144:147],a[64:67],v[208:211]
s_mov_b32 m0,s38
DR a[128:131],v1,0
M v[208:211],a[148:151],a[68:71],v[208:211]
DR a[132:135],v1,64
M v[212:215],a[148:151],a[76:79],v[212:215]
DR a[136:139],v1,256
M v[212:215],a[144:147],a[72:75],v[212:215]
DR a[140:143],v1,320
M v[216:219],a[144:147],a[80:83],v[216:219]
buffer_load_dwordx4 v3,s[4:7],s28 offen offset:0 lds
M v[216:219],a[148:151],a[84:87],v[216:219]
M v[220:223],a[148:151],a[92:95],v[220:223]
M v[220:223],a[144:147],a[88:91],v[220:223]
M v[224:227],a[144:147],a[96:99],v[224:227]
buffer_load_dwordx4 v3,s[4:7],s29 offen offset:1024 lds
M v[224:227],a[148:151],a[100:103],v[224:227]
M v[228:231],a[148:151],a[108:111],v[228:231]
M v[228:231],a[144:147],a[104:107],v[228:231]
M v[232:235],a[144:147],a[112:115],v[232:235]
M v[232:235],a[148:151],a[116:119],v[232:235]
M v[236:239],a[148:151],a[124:127],v[236:239]
buffer_load_dwordx4 v3,s[4:7],s30 offen offset:2048 lds
M v[236:239],a[144:147],a[120:123],v[236:239]
M v[240:243],a[152:155],a[64:67],v[240:243]
DR a[144:147],v1,512
M v[240:243],a[156:159],a[68:71],v[240:243]
DR a[148:151],v1,576
M v[244:247],a[156:159],a[76:79],v[244:247]
M v[244:247],a[152:155],a[72:75],v[244:247]
M v[248:251],a[152:155],a[80:83],v[248:251]
buffer_load_dwordx4 v3,s[4:7],s31 offen offset:3072 lds
M v[248:251],a[156:159],a[84:87],v[248:251]
s_mov_b32 m0,s39
M v[252:255],a[156:159],a[92:95],v[252:255]
M v[252:255],a[152:155],a[88:91],v[252:255]
M a[240:243],a[152:155],a[96:99],a[240:243]
M a[240:243],a[156:159],a[100:103],a[240:243]
buffer_load_dwordx4 v3,s[4:7],s32 offen offset:0 lds
M a[244:247],a[156:159],a[108:111],a[244:247]
M a[244:247],a[152:155],a[104:107],a[244:247]
M a[248:251],a[152:155],a[112:115],a[248:251]
M a[248:251],a[156:159],a[116:119],a[248:251]
M a[252:255],a[156:159],a[124:127],a[252:255]
M a[252:255],a[152:155],a[120:123],a[252:255]
s_waitcnt lgkmcnt(4)
M v[16:19],a[128:131],a[0:3],v[16:19]
DR a[152:155],v1,768
M v[16:19],a[132:135],a[4:7],v[16:19]
DR a[156:159],v1,832
M v[20:23],a[132:135],a[12:15],v[20:23]
buffer_load_dwordx4 v3,s[4:7],s33 offen offset:1024 lds
M v[20:23],a[128:131],a[8:11],v[20:23]
M v[24:27],a[128:131],a[16:19],v[24:27]
M v[24:27],a[132:135],a[20:23],v[24:27]
buffer_load_dwordx4 v3,s[4:7],s34 offen offset:2048 lds
M v[28:31],a[132:135],a[28:31],v[28:31]
M v[28:31],a[128:131],a[24:27],v[28:31]
M v[32:35],a[128:131],a[32:35],v[32:35]
M v[32:35],a[132:135],a[36:39],v[32:35]
M v[36:39],a[132:135],a[44:47],v[36:39]
M v[36:39],a[128:131],a[40:43],v[36:39]
buffer_load_dwordx4 v3,s[4:7],s35 offen offset:3072 lds
M v[40:43],a[128:131],a[48:51],v[40:43]
s_add_u32 s4,s4,128
s_addc_u32 s5,s5,0
s_sub_u32 s6,s6,128
M v[40:43],a[132:135],a[52:55],v[40:43]
M v[44:47],a[132:135],a[60:63],v[44:47]
s_mov_b32 m0,s68
M v[44:47],a[128:131],a[56:59],v[44:47]
s_waitcnt vmcnt(9) lgkmcnt(4)
s_barrier
M v[48:51],a[136:139],a[0:3],v[48:51]
DR a[128:131],v1,1024
M v[48:51],a[140:143],a[4:7],v[48:51]
DR a[132:135],v1,1088
M v[52:55],a[140:143],a[12:15],v[52:55]
DT a[64:65],v2,33152
M v[52:55],a[136:139],a[8:11],v[52:55]
DT a[66:67],v2,33664
M v[56:59],a[136:139],a[16:19],v[56:59]
buffer_load_dwordx4 v5,s[8:11],s56 offen offset:0 lds
M v[56:59],a[140:143],a[20:23],v[56:59]
DT a[68:69],v2,35200
M v[60:63],a[140:143],a[28:31],v[60:63]
M v[60:63],a[136:139],a[24:27],v[60:63]
DT a[70:71],v2,35712
M v[64:67],a[136:139],a[32:35],v[64:67]
M v[64:67],a[140:143],a[36:39],v[64:67]
DT a[72:73],v2,33184
M v[68:71],a[140:143],a[44:47],v[68:71]
buffer_load_dwordx4 v5,s[8:11],s57 offen offset:1024 lds
M v[68:71],a[136:139],a[40:43],v[68:71]
DT a[74:75],v2,33696
M v[72:75],a[136:139],a[48:51],v[72:75]
M v[72:75],a[140:143],a[52:55],v[72:75]
M v[76:79],a[140:143],a[60:63],v[76:79]
DT a[76:77],v2,35232
M v[76:79],a[136:139],a[56:59],v[76:79]
s_waitcnt lgkmcnt(11)
M v[80:83],a[144:147],a[0:3],v[80:83]
DR a[136:139],v1,1280
M v[80:83],a[148:151],a[4:7],v[80:83]
DR a[140:143],v1,1344
M v[84:87],a[148:151],a[12:15],v[84:87]
DT a[78:79],v2,35744
M v[84:87],a[144:147],a[8:11],v[84:87]
DT a[80:81],v2,33216
M v[88:91],a[144:147],a[16:19],v[88:91]
DT a[82:83],v2,33728
M v[88:91],a[148:151],a[20:23],v[88:91]
buffer_load_dwordx4 v5,s[8:11],s58 offen offset:2048 lds
M v[92:95],a[148:151],a[28:31],v[92:95]
DT a[84:85],v2,35264
M v[92:95],a[144:147],a[24:27],v[92:95]
buffer_load_dwordx4 v5,s[8:11],s59 offen offset:3072 lds
M v[96:99],a[144:147],a[32:35],v[96:99]
s_mov_b32 m0,s69
M v[96:99],a[148:151],a[36:39],v[96:99]
DT a[86:87],v2,35776
M v[100:103],a[148:151],a[44:47],v[100:103]
M v[100:103],a[144:147],a[40:43],v[100:103]
DT a[88:89],v2,33248
M v[104:107],a[144:147],a[48:51],v[104:107]
buffer_load_dwordx4 v5,s[8:11],s60 offen offset:0 lds
M v[104:107],a[148:151],a[52:55],v[104:107]
DT a[90:91],v2,33760
M v[108:111],a[148:151],a[60:63],v[108:111]
M v[108:111],a[144:147],a[56:59],v[108:111]
s_waitcnt lgkmcnt(15)
DT a[92:93],v2,35296
M v[112:115],a[152:155],a[0:3],v[112:115]
DR a[144:147],v1,1536
M v[112:115],a[156:159],a[4:7],v[112:115]
DR a[148:151],v1,1600
M v[116:119],a[156:159],a[12:15],v[116:119]
DT a[94:95],v2,35808
M v[116:119],a[152:155],a[8:11],v[116:119]
DT a[96:97],v2,33280
M v[120:123],a[152:155],a[16:19],v[120:123]
buffer_load_dwordx4 v5,s[8:11],s61 offen offset:1024 lds
M v[120:123],a[156:159],a[20:23],v[120:123]
M v[124:127],a[156:159],a[28:31],v[124:127]
DT a[98:99],v2,33792
M v[124:127],a[152:155],a[24:27],v[124:127]
buffer_load_dwordx4 v5,s[8:11],s62 offen offset:2048 lds
M v[128:131],a[152:155],a[32:35],v[128:131]
DT a[100:101],v2,35328
M v[128:131],a[156:159],a[36:39],v[128:131]
M v[132:135],a[156:159],a[44:47],v[132:135]
DT a[102:103],v2,35840
M v[132:135],a[152:155],a[40:43],v[132:135]
M v[136:139],a[152:155],a[48:51],v[136:139]
DT a[104:105],v2,33312
M v[136:139],a[156:159],a[52:55],v[136:139]
buffer_load_dwordx4 v5,s[8:11],s63 offen offset:3072 lds
M v[140:143],a[156:159],a[60:63],v[140:143]
s_add_u32 s8,s8,524288
s_addc_u32 s9,s9,0
DT a[106:107],v2,33824
M v[140:143],a[152:155],a[56:59],v[140:143]
s_sub_u32 s10,s10,524288
M v[144:147],a[128:131],a[0:3],v[144:147]
DR a[152:155],v1,1792
M v[144:147],a[132:135],a[4:7],v[144:147]
DR a[156:159],v1,1856
M v[148:151],a[132:135],a[12:15],v[148:151]
DT a[108:109],v2,35360
M v[148:151],a[128:131],a[8:11],v[148:151]
DT a[110:111],v2,35872
M v[152:155],a[128:131],a[16:19],v[152:155]
buffer_load_dword a238,v15,s[88:91],s52 offen
M v[152:155],a[132:135],a[20:23],v[152:155]
s_add_u32 s52,s52,1048576
DT a[112:113],v2,33344
M v[156:159],a[132:135],a[28:31],v[156:159]
buffer_load_dword a238,v13,s[96:99],s3 offen
M v[156:159],a[128:131],a[24:27],v[156:159]
s_add_u32 s3,s3,1536
DT a[114:115],v2,33856
M v[160:163],a[128:131],a[32:35],v[160:163]
M v[160:163],a[132:135],a[36:39],v[160:163]
DT a[116:117],v2,35392
M v[164:167],a[132:135],a[44:47],v[164:167]
M v[164:167],a[128:131],a[40:43],v[164:167]
M v[168:171],a[128:131],a[48:51],v[168:171]
DT a[118:119],v2,35904
M v[168:171],a[132:135],a[52:55],v[168:171]
M v[172:175],a[132:135],a[60:63],v[172:175]
DT a[120:121],v2,33376
M v[172:175],a[128:131],a[56:59],v[172:175]
s_waitcnt lgkmcnt(15)
M v[176:179],a[136:139],a[0:3],v[176:179]
DT a[122:123],v2,33888
M v[176:179],a[140:143],a[4:7],v[176:179]
M v[180:183],a[140:143],a[12:15],v[180:183]
DT a[124:125],v2,35424
M v[180:183],a[136:139],a[8:11],v[180:183]
M v[184:187],a[136:139],a[16:19],v[184:187]
DT a[126:127],v2,35936
M v[184:187],a[140:143],a[20:23],v[184:187]
M v[188:191],a[140:143],a[28:31],v[188:191]
M v[188:191],a[136:139],a[24:27],v[188:191]
M v[192:195],a[136:139],a[32:35],v[192:195]
M v[192:195],a[140:143],a[36:39],v[192:195]
M v[196:199],a[140:143],a[44:47],v[196:199]
M v[196:199],a[136:139],a[40:43],v[196:199]
M v[200:203],a[136:139],a[48:51],v[200:203]
M v[200:203],a[140:143],a[52:55],v[200:203]
M v[204:207],a[140:143],a[60:63],v[204:207]
M v[204:207],a[136:139],a[56:59],v[204:207]
s_waitcnt vmcnt(10) lgkmcnt(0)
s_barrier
M v[208:211],a[144:147],a[0:3],v[208:211]
s_mov_b32 m0,s36
DR a[128:131],v1,33152
M v[208:211],a[148:151],a[4:7],v[208:211]
DR a[132:135],v1,33216
M v[212:215],a[148:151],a[12:15],v[212:215]
DR a[136:139],v1,33408
M v[212:215],a[144:147],a[8:11],v[212:215]
DR a[140:143],v1,33472
M v[216:219],a[144:147],a[16:19],v[216:219]
buffer_load_dwordx4 v3,s[4:7],s28 offen offset:0 lds
M v[216:219],a[148:151],a[20:23],v[216:219]
M v[220:223],a[148:151],a[28:31],v[220:223]
M v[220:223],a[144:147],a[24:27],v[220:223]
M v[224:227],a[144:147],a[32:35],v[224:227]
buffer_load_dwordx4 v3,s[4:7],s29 offen offset:1024 lds
M v[224:227],a[148:151],a[36:39],v[224:227]
M v[228:231],a[148:151],a[44:47],v[228:231]
M v[228:231],a[144:147],a[40:43],v[228:231]
M v[232:235],a[144:147],a[48:51],v[232:235]
M v[232:235],a[148:151],a[52:55],v[232:235]
M v[236:239],a[148:151],a[60:63],v[236:239]
buffer_load_dwordx4 v3,s[4:7],s30 offen offset:2048 lds
M v[236:239],a[144:147],a[56:59],v[236:239]
M v[240:243],a[152:155],a[0:3],v[240:243]
DR a[144:147],v1,33664
M v[240:243],a[156:159],a[4:7],v[240:243]
DR a[148:151],v1,33728
M v[244:247],a[156:159],a[12:15],v[244:247]
M v[244:247],a[152:155],a[8:11],v[244:247]
M v[248:251],a[152:155],a[16:19],v[248:251]
buffer_load_dwordx4 v3,s[4:7],s31 offen offset:3072 lds
M v[248:251],a[156:159],a[20:23],v[248:251]
s_mov_b32 m0,s37
M v[252:255],a[156:159],a[28:31],v[252:255]
M v[252:255],a[152:155],a[24:27],v[252:255]
M a[240:243],a[152:155],a[32:35],a[240:243]
M a[240:243],a[156:159],a[36:39],a[240:243]
buffer_load_dwordx4 v3,s[4:7],s32 offen offset:0 lds
M a[244:247],a[156:159],a[44:47],a[244:247]
M a[244:247],a[152:155],a[40:43],a[244:247]
M a[248:251],a[152:155],a[48:51],a[248:251]
M a[248:251],a[156:159],a[52:55],a[248:251]
M a[252:255],a[156:159],a[60:63],a[252:255]
M a[252:255],a[152:155],a[56:59],a[252:255]
s_waitcnt lgkmcnt(4)
M v[16:19],a[128:131],a[64:67],v[16:19]
DR a[152:155],v1,33920
M v[16:19],a[132:135],a[68:71],v[16:19]
DR a[156:159],v1,33984
M v[20:23],a[132:135],a[76:79],v[20:23]
buffer_load_dwordx4 v3,s[4:7],s33 offen offset:1024 lds
M v[20:23],a[128:131],a[72:75],v[20:23]
M v[24:27],a[128:131],a[80:83],v[24:27]
M v[24:27],a[132:135],a[84:87],v[24:27]
buffer_load_dwordx4 v3,s[4:7],s34 offen offset:2048 lds
M v[28:31],a[132:135],a[92:95],v[28:31]
M v[28:31],a[128:131],a[88:91],v[28:31]
M v[32:35],a[128:131],a[96:99],v[32:35]
M v[32:35],a[132:135],a[100:103],v[32:35]
M v[36:39],a[132:135],a[108:111],v[36:39]
M v[36:39],a[128:131],a[104:107],v[36:39]
buffer_load_dwordx4 v3,s[4:7],s35 offen offset:3072 lds
M v[40:43],a[128:131],a[112:115],v[40:43]
s_add_u32 s4,s4,128
s_addc_u32 s5,s5,0
s_sub_u32 s6,s6,128
M v[40:43],a[132:135],a[116:119],v[40:43]
M v[44:47],a[132:135],a[124:127],v[44:47]
s_mov_b32 m0,s70
M v[44:47],a[128:131],a[120:123],v[44:47]
s_waitcnt vmcnt(10) lgkmcnt(4)
s_barrier
M v[48:51],a[136:139],a[64:67],v[48:51]
DR a[128:131],v1,34176
M v[48:51],a[140:143],a[68:71],v[48:51]
DR a[132:135],v1,34240
M v[52:55],a[140:143],a[76:79],v[52:55]
DT a[0:1],v2,0
M v[52:55],a[136:139],a[72:75],v[52:55]
DT a[2:3],v2,512
M v[56:59],a[136:139],a[80:83],v[56:59]
buffer_load_dwordx4 v5,s[8:11],s56 offen offset:0 lds
M v[56:59],a[140:143],a[84:87],v[56:59]
DT a[4:5],v2,2048
M v[60:63],a[140:143],a[92:95],v[60:63]
M v[60:63],a[136:139],a[88:91],v[60:63]
DT a[6:7],v2,2560
M v[64:67],a[136:139],a[96:99],v[64:67]
M v[64:67],a[140:143],a[100:103],v[64:67]
DT a[8:9],v2,32
M v[68:71],a[140:143],a[108:111],v[68:71]
buffer_load_dwordx4 v5,s[8:11],s57 offen offset:1024 lds
M v[68:71],a[136:139],a[104:107],v[68:71]
DT a[10:11],v2,544
M v[72:75],a[136:139],a[112:115],v[72:75]
M v[72:75],a[140:143],a[116:119],v[72:75]
M v[76:79],a[140:143],a[124:127],v[76:79]
DT a[12:13],v2,2080
M v[76:79],a[136:139],a[120:123],v[76:79]
s_waitcnt lgkmcnt(11)
M v[80:83],a[144:147],a[64:67],v[80:83]
DR a[136:139],v1,34432
M v[80:83],a[148:151],a[68:71],v[80:83]
DR a[140:143],v1,34496
M v[84:87],a[148:151],a[76:79],v[84:87]
DT a[14:15],v2,2592
M v[84:87],a[144:147],a[72:75],v[84:87]
DT a[16:17],v2,64
M v[88:91],a[144:147],a[80:83],v[88:91]
DT a[18:19],v2,576
M v[88:91],a[148:151],a[84:87],v[88:91]
buffer_load_dwordx4 v5,s[8:11],s58 offen offset:2048 lds
M v[92:95],a[148:151],a[92:95],v[92:95]
DT a[20:21],v2,2112
M v[92:95],a[144:147],a[88:91],v[92:95]
buffer_load_dwordx4 v5,s[8:11],s59 offen offset:3072 lds
M v[96:99],a[144:147],a[96:99],v[96:99]
s_mov_b32 m0,s71
M v[96:99],a[148:151],a[100:103],v[96:99]
DT a[22:23],v2,2624
M v[100:103],a[148:151],a[108:111],v[100:103]
M v[100:103],a[144:147],a[104:107],v[100:103]
DT a[24:25],v2,96
M v[104:107],a[144:147],a[112:115],v[104:107]
buffer_load_dwordx4 v5,s[8:11],s60 offen offset:0 lds
M v[104:107],a[148:151],a[116:119],v[104:107]
DT a[26:27],v2,608
M v[108:111],a[148:151],a[124:127],v[108:111]
M v[108:111],a[144:147],a[120:123],v[108:111]
s_waitcnt lgkmcnt(15)
DT a[28:29],v2,2144
M v[112:115],a[152:155],a[64:67],v[112:115]
DR a[144:147],v1,34688
M v[112:115],a[156:159],a[68:71],v[112:115]
DR a[148:151],v1,34752
M v[116:119],a[156:159],a[76:79],v[116:119]
DT a[30:31],v2,2656
M v[116:119],a[152:155],a[72:75],v[116:119]
DT a[32:33],v2,128
M v[120:123],a[152:155],a[80:83],v[120:123]
buffer_load_dwordx4 v5,s[8:11],s61 offen offset:1024 lds
M v[120:123],a[156:159],a[84:87],v[120:123]
M v[124:127],a[156:159],a[92:95],v[124:127]
DT a[34:35],v2,640
M v[124:127],a[152:155],a[88:91],v[124:127]
buffer_load_dwordx4 v5,s[8:11],s62 offen offset:2048 lds
M v[128:131],a[152:155],a[96:99],v[128:131]
DT a[36:37],v2,2176
M v[128:131],a[156:159],a[100:103],v[128:131]
M v[132:135],a[156:159],a[108:111],v[132:135]
DT a[38:39],v2,2688
M v[132:135],a[152:155],a[104:107],v[132:135]
M v[136:139],a[152:155],a[112:115],v[136:139]
DT a[40:41],v2,160
M v[136:139],a[156:159],a[116:119],v[136:139]
buffer_load_dwordx4 v5,s[8:11],s63 offen offset:3072 lds
M v[140:143],a[156:159],a[124:127],v[140:143]
s_add_u32 s8,s8,524288
s_addc_u32 s9,s9,0
DT a[42:43],v2,672
M v[140:143],a[152:155],a[120:123],v[140:143]
s_sub_u32 s10,s10,524288
M v[144:147],a[128:131],a[64:67],v[144:147]
DR a[152:155],v1,34944
M v[144:147],a[132:135],a[68:71],v[144:147]
DR a[156:159],v1,35008
M v[148:151],a[132:135],a[76:79],v[148:151]
DT a[44:45],v2,2208
M v[148:151],a[128:131],a[72:75],v[148:151]
DT a[46:47],v2,2720
M v[152:155],a[128:131],a[80:83],v[152:155]
buffer_load_dword a238,v0,s[84:87],s51 offen
M v[152:155],a[132:135],a[84:87],v[152:155]
s_add_u32 s51,s51,256
DT a[48:49],v2,192
M v[156:159],a[132:135],a[92:95],v[156:159]
M v[156:159],a[128:131],a[88:91],v[156:159]
DT a[50:51],v2,704
M v[160:163],a[128:131],a[96:99],v[160:163]
M v[160:163],a[132:135],a[100:103],v[160:163]
DT a[52:53],v2,2240
M v[164:167],a[132:135],a[108:111],v[164:167]
M v[164:167],a[128:131],a[104:107],v[164:167]
M v[168:171],a[128:131],a[112:115],v[168:171]
DT a[54:55],v2,2752
M v[168:171],a[132:135],a[116:119],v[168:171]
M v[172:175],a[132:135],a[124:127],v[172:175]
DT a[56:57],v2,224
M v[172:175],a[128:131],a[120:123],v[172:175]
s_waitcnt lgkmcnt(15)
M v[176:179],a[136:139],a[64:67],v[176:179]
DT a[58:59],v2,736
M v[176:179],a[140:143],a[68:71],v[176:179]
M v[180:183],a[140:143],a[76:79],v[180:183]
DT a[60:61],v2,2272
M v[180:183],a[136:139],a[72:75],v[180:183]
M v[184:187],a[136:139],a[80:83],v[184:187]
DT a[62:63],v2,2784
M v[184:187],a[140:143],a[84:87],v[184:187]
M v[188:191],a[140:143],a[92:95],v[188:191]
M v[188:191],a[136:139],a[88:91],v[188:191]
M v[192:195],a[136:139],a[96:99],v[192:195]
M v[192:195],a[140:143],a[100:103],v[192:195]
M v[196:199],a[140:143],a[108:111],v[196:199]
M v[196:199],a[136:139],a[104:107],v[196:199]
M v[200:203],a[136:139],a[112:115],v[200:203]
M v[200:203],a[140:143],a[116:119],v[200:203]
M v[204:207],a[140:143],a[124:127],v[204:207]
M v[204:207],a[136:139],a[120:123],v[204:207]
s_waitcnt vmcnt(9) lgkmcnt(0)
s_barrier
s_sub_u32 s48,s48,1
s_cmp_lg_u32 s48,0
s_cbranch_scc1 L_kv_loop_a
L_postloop_a:
s_lshl_b32 s3,s43,8
s_add_u32 s3,s3,4096
v_lshrrev_b32 v13,2,v4
v_and_b32 v13,4,v13
v_lshl_or_b32 v13,v4,2,v13
v_and_b32 v13,0x84,v13
buffer_load_dword a239,v13,s[24:27],s3 offen offset:16 sc1
M v[208:211],a[144:147],a[64:67],v[208:211]
s_mov_b32 m0,s38
DR a[128:131],v1,0
v_mov_b32 v14,0x7ff00000
M v[208:211],a[148:151],a[68:71],v[208:211]
s_mov_b32 s64,4096
s_mov_b32 s65,3072
DR a[132:135],v1,64
M v[212:215],a[148:151],a[76:79],v[212:215]
s_mov_b32 s66,5632
s_mov_b32 s67,4608
DR a[136:139],v1,256
M v[212:215],a[144:147],a[72:75],v[212:215]
s_lshl_b32 s46,s43,9
DR a[140:143],v1,320
M v[216:219],a[144:147],a[80:83],v[216:219]
buffer_load_dwordx4 v3,s[4:7],s28 offen offset:0 lds
M v[216:219],a[148:151],a[84:87],v[216:219]
s_add_u32 s16,s76,s46
s_addc_u32 s17,s77,0
s_sub_u32 s18,3670016,s46
M v[220:223],a[148:151],a[92:95],v[220:223]
s_mov_b32 s19,0x20000
s_sub_u32 s46,15,s45
M v[220:223],a[144:147],a[88:91],v[220:223]
s_bitcmp1_b32 s44,0
s_cselect_b32 s47,s46,s45
s_mul_i32 s46,s47,114688
M v[224:227],a[144:147],a[96:99],v[224:227]
buffer_load_dwordx4 v3,s[4:7],s29 offen offset:1024 lds
M v[224:227],a[148:151],a[100:103],v[224:227]
s_sub_u32 s12,s72,4096
s_subb_u32 s13,s73,0
M v[228:231],a[148:151],a[108:111],v[228:231]
s_add_u32 s12,s12,s46
s_addc_u32 s13,s13,0
s_sub_u32 s14,1839104,s46
M v[228:231],a[144:147],a[104:107],v[228:231]
s_mov_b32 s15,0x20000
s_lshl_b32 s46,s43,20
s_lshl_b32 s47,s45,17
M v[232:235],a[144:147],a[112:115],v[232:235]
s_add_u32 s46,s46,s47
s_lshr_b32 s47,s42,1
s_lshl_b32 s47,s47,16
M v[232:235],a[148:151],a[116:119],v[232:235]
s_add_u32 s46,s46,s47
s_and_b32 s47,s42,1
s_lshl_b32 s47,s47,14
M v[236:239],a[148:151],a[124:127],v[236:239]
buffer_load_dwordx4 v3,s[4:7],s30 offen offset:2048 lds
M v[236:239],a[144:147],a[120:123],v[236:239]
s_add_u32 s46,s46,s47
s_add_u32 s96,s82,s46
s_addc_u32 s97,s83,0
M v[240:243],a[152:155],a[64:67],v[240:243]
s_add_u32 s96,s96,16777216
s_addc_u32 s97,s97,0
DR a[144:147],v1,512
M v[240:243],a[156:159],a[68:71],v[240:243]
s_mov_b32 s98,131072
s_mov_b32 s99,0x20000
DR a[148:151],v1,576
M v[244:247],a[156:159],a[76:79],v[244:247]
s_lshl_b32 s46,s43,9
s_add_u32 s84,s76,s46
s_addc_u32 s85,s77,0
M v[244:247],a[152:155],a[72:75],v[244:247]
s_sub_u32 s86,3670016,s46
s_mov_b32 s87,0x20000
s_sub_u32 s46,15,s45
M v[248:251],a[152:155],a[80:83],v[248:251]
s_mul_i32 s46,s46,114688
s_add_u32 s88,s72,s46
s_addc_u32 s89,s73,0
M v[248:251],a[156:159],a[84:87],v[248:251]
s_sub_u32 s90,1835008,s46
s_mov_b32 s91,0x20000
s_lshl_b32 s46,s45,3
M v[252:255],a[156:159],a[92:95],v[252:255]
s_lshl_b32 s47,s42,1
s_add_u32 s46,s46,s47
v_lshrrev_b32 v13,6,v4
M v[252:255],a[152:155],a[88:91],v[252:255]
buffer_load_dwordx4 v3,s[4:7],s31 offen offset:3072 lds
M a[240:243],a[152:155],a[96:99],a[240:243]
s_mov_b32 m0,s39
v_add_u32 v13,s46,v13
v_and_b32 v0,48,v4
M a[240:243],a[156:159],a[100:103],a[240:243]
buffer_load_dwordx4 v3,s[4:7],s32 offen offset:0 lds
M a[244:247],a[156:159],a[108:111],a[244:247]
v_lshlrev_b32 v0,3,v0
v_lshl_add_u32 v13,v13,13,v0
M a[244:247],a[152:155],a[104:107],a[244:247]
v_cmp_gt_u32 vcc,128,v4
s_nop 1
v_cndmask_b32 v0,v14,v13,vcc
M a[248:251],a[152:155],a[112:115],a[248:251]
s_and_b32 s46,s43,1
s_lshl_b32 s46,s46,6
s_lshl_b32 s47,s42,4
M a[248:251],a[156:159],a[116:119],a[248:251]
s_add_u32 s46,s46,s47
v_lshrrev_b32 v13,4,v4
v_add_u32 v13,s46,v13
M a[252:255],a[156:159],a[124:127],a[252:255]
v_mul_u32_u24 v13,896,v13
v_cmp_gt_u32 vcc,256,v4
M a[252:255],a[152:155],a[120:123],a[252:255]
s_waitcnt lgkmcnt(4)
s_nop 0
v_cndmask_b32 v15,v14,v13,vcc
v_lshrrev_b32 v12,4,v4
M v[16:19],a[128:131],a[0:3],v[16:19]
s_lshr_b32 s46,s42,1
s_lshl_b32 s46,s46,2
DR a[152:155],v1,768
M v[16:19],a[132:135],a[4:7],v[16:19]
s_and_b32 s47,s42,1
s_add_u32 s46,s46,s47
DR a[156:159],v1,832
M v[20:23],a[132:135],a[12:15],v[20:23]
s_lshl_b32 s46,s46,1
v_lshrrev_b32 v6,5,v12
v_sub_u32 v7,7,v6
M v[20:23],a[128:131],a[8:11],v[20:23]
buffer_load_dwordx4 v3,s[4:7],s33 offen offset:1024 lds
M v[24:27],a[128:131],a[16:19],v[24:27]
v_and_b32 v8,16,v12
v_cmp_eq_u32 vcc,0,v8
M v[24:27],a[132:135],a[20:23],v[24:27]
buffer_load_dwordx4 v3,s[4:7],s34 offen offset:2048 lds
M v[28:31],a[132:135],a[28:31],v[28:31]
v_cndmask_b32 v6,v7,v6,vcc
v_mov_b32 v7,-28672
M v[28:31],a[128:131],a[24:27],v[28:31]
v_mov_b32 v8,28672
v_cndmask_b32 v9,v7,v8,vcc
M v[32:35],a[128:131],a[32:35],v[32:35]
v_lshlrev_b32 v6,4,v6
v_bfe_u32 v7,v12,3,1
M v[32:35],a[132:135],a[36:39],v[32:35]
v_add3_u32 v6,v6,v7,s46
v_mul_u32_u24 v6,896,v6
M v[36:39],a[132:135],a[44:47],v[36:39]
v_and_b32 v7,7,v12
v_lshl_add_u32 v8,v7,4,v6
M v[36:39],a[128:131],a[40:43],v[36:39]
buffer_load_dwordx4 v3,s[4:7],s35 offen offset:3072 lds
M v[40:43],a[128:131],a[48:51],v[40:43]
v_add_u32 v9,v9,v8
v_bfe_u32 v6,v12,3,1
M v[40:43],a[132:135],a[52:55],v[40:43]
v_lshlrev_b32 v6,2,v6
v_bfe_u32 v7,v12,1,1
M v[44:47],a[132:135],a[60:63],v[44:47]
v_lshl_or_b32 v6,v7,1,v6
v_bfe_u32 v7,v12,2,1
M v[44:47],a[128:131],a[56:59],v[44:47]
s_waitcnt vmcnt(10) lgkmcnt(4)
s_barrier
M v[48:51],a[136:139],a[0:3],v[48:51]
DR a[128:131],v1,1024
v_or_b32 v6,v6,v7
M v[48:51],a[140:143],a[4:7],v[48:51]
DR a[132:135],v1,1088
v_lshrrev_b32 v7,1,v6
M v[52:55],a[140:143],a[12:15],v[52:55]
DT a[64:65],v2,33152
v_lshlrev_b32 v7,5,v7
M v[52:55],a[136:139],a[8:11],v[52:55]
DT a[66:67],v2,33664
v_and_b32 v10,1,v12
M v[56:59],a[136:139],a[16:19],v[56:59]
v_lshl_add_u32 v7,v10,7,v7
v_lshrrev_b32 v10,4,v12
M v[56:59],a[140:143],a[20:23],v[56:59]
DT a[68:69],v2,35200
v_lshl_add_u32 v7,v10,4,v7
M v[60:63],a[140:143],a[28:31],v[60:63]
s_lshl_b32 s46,s42,9
v_lshl_add_u32 v6,v6,11,v7
v_add_u32 v6,s46,v6
s_lshr_b32 s53,s2,3
s_mul_i32 s53,s53,120
s_add_u32 s50,s2,s53
s_add_u32 s50,s50,4096
s_cmp_eq_u32 s42,0
s_cbranch_scc0 L_nopub4
s_mov_b64 exec,1
v_mov_b32 v13,1
buffer_store_byte v13,off,s[24:27],s50 offset:0 sc1
s_mov_b64 exec,-1
L_nopub4:
M v[60:63],a[136:139],a[24:27],v[60:63]
DT a[70:71],v2,35712
v_add_u32 v7,132608,v6
M v[64:67],a[136:139],a[32:35],v[64:67]
s_and_b32 s46,s42,1
s_lshl_b32 s46,s46,8
v_subrev_u32 v12,s46,v2
M v[64:67],a[140:143],a[36:39],v[64:67]
DT a[72:73],v2,33184
v_subrev_u32 v10,33152,v12
M v[68:71],a[140:143],a[44:47],v[68:71]
s_add_u32 s4,s4,128
s_addc_u32 s5,s5,0
s_sub_u32 s6,s6,128
M v[68:71],a[136:139],a[40:43],v[68:71]
s_nop 0
s_mov_b32 s54,0
DT a[74:75],v2,33696
M v[72:75],a[136:139],a[48:51],v[72:75]
buffer_load_dword a238,v0,s[84:87],s54 offen
M v[72:75],a[140:143],a[52:55],v[72:75]
buffer_load_dword a238,v15,s[88:91],0 offen offset:0
M v[76:79],a[140:143],a[60:63],v[76:79]
s_mov_b32 s54,524288
DT a[76:77],v2,35232
M v[76:79],a[136:139],a[56:59],v[76:79]
s_waitcnt lgkmcnt(11)
M v[80:83],a[144:147],a[0:3],v[80:83]
DR a[136:139],v1,1280
M v[80:83],a[148:151],a[4:7],v[80:83]
DR a[140:143],v1,1344
M v[84:87],a[148:151],a[12:15],v[84:87]
DT a[78:79],v2,35744
M v[84:87],a[144:147],a[8:11],v[84:87]
DT a[80:81],v2,33216
M v[88:91],a[144:147],a[16:19],v[88:91]
DT a[82:83],v2,33728
M v[88:91],a[148:151],a[20:23],v[88:91]
buffer_load_dword a238,v0,s[84:87],s54 offen
M v[92:95],a[148:151],a[28:31],v[92:95]
DT a[84:85],v2,35264
M v[92:95],a[144:147],a[24:27],v[92:95]
buffer_load_dword a238,v15,s[88:91],0 offen offset:128
M v[96:99],a[144:147],a[32:35],v[96:99]
M v[96:99],a[148:151],a[36:39],v[96:99]
DT a[86:87],v2,35776
M v[100:103],a[148:151],a[44:47],v[100:103]
M v[100:103],a[144:147],a[40:43],v[100:103]
DT a[88:89],v2,33248
M v[104:107],a[144:147],a[48:51],v[104:107]
M v[104:107],a[148:151],a[52:55],v[104:107]
DT a[90:91],v2,33760
M v[108:111],a[148:151],a[60:63],v[108:111]
M v[108:111],a[144:147],a[56:59],v[108:111]
s_waitcnt lgkmcnt(15)
DT a[92:93],v2,35296
M v[112:115],a[152:155],a[0:3],v[112:115]
DR a[144:147],v1,1536
M v[112:115],a[156:159],a[4:7],v[112:115]
DR a[148:151],v1,1600
M v[116:119],a[156:159],a[12:15],v[116:119]
DT a[94:95],v2,35808
M v[116:119],a[152:155],a[8:11],v[116:119]
DT a[96:97],v2,33280
M v[120:123],a[152:155],a[16:19],v[120:123]
M v[120:123],a[156:159],a[20:23],v[120:123]
M v[124:127],a[156:159],a[28:31],v[124:127]
DT a[98:99],v2,33792
M v[124:127],a[152:155],a[24:27],v[124:127]
M v[128:131],a[152:155],a[32:35],v[128:131]
DT a[100:101],v2,35328
M v[128:131],a[156:159],a[36:39],v[128:131]
M v[132:135],a[156:159],a[44:47],v[132:135]
s_mov_b32 m0,s68
DT a[102:103],v2,35840
M v[132:135],a[152:155],a[40:43],v[132:135]
M v[136:139],a[152:155],a[48:51],v[136:139]
DT a[104:105],v2,33312
M v[136:139],a[156:159],a[52:55],v[136:139]
M v[140:143],a[156:159],a[60:63],v[140:143]
DT a[106:107],v2,33824
M v[140:143],a[152:155],a[56:59],v[140:143]
M v[144:147],a[128:131],a[0:3],v[144:147]
DR a[152:155],v1,1792
M v[144:147],a[132:135],a[4:7],v[144:147]
DR a[156:159],v1,1856
M v[148:151],a[132:135],a[12:15],v[148:151]
DT a[108:109],v2,35360
M v[148:151],a[128:131],a[8:11],v[148:151]
DT a[110:111],v2,35872
M v[152:155],a[128:131],a[16:19],v[152:155]
buffer_load_dwordx4 v5,s[16:19],s56 offen offset:0 lds
M v[152:155],a[132:135],a[20:23],v[152:155]
DT a[112:113],v2,33344
M v[156:159],a[132:135],a[28:31],v[156:159]
buffer_load_dwordx4 v5,s[16:19],s57 offen offset:1024 lds
M v[156:159],a[128:131],a[24:27],v[156:159]
DT a[114:115],v2,33856
M v[160:163],a[128:131],a[32:35],v[160:163]
buffer_load_dwordx4 v5,s[16:19],s58 offen offset:2048 lds
M v[160:163],a[132:135],a[36:39],v[160:163]
DT a[116:117],v2,35392
M v[164:167],a[132:135],a[44:47],v[164:167]
buffer_load_dwordx4 v5,s[16:19],s59 offen offset:3072 lds
M v[164:167],a[128:131],a[40:43],v[164:167]
s_mov_b32 m0,s69
M v[168:171],a[128:131],a[48:51],v[168:171]
DT a[118:119],v2,35904
M v[168:171],a[132:135],a[52:55],v[168:171]
buffer_load_dwordx4 v5,s[16:19],s60 offen offset:0 lds
M v[172:175],a[132:135],a[60:63],v[172:175]
DT a[120:121],v2,33376
M v[172:175],a[128:131],a[56:59],v[172:175]
s_waitcnt lgkmcnt(15)
M v[176:179],a[136:139],a[0:3],v[176:179]
DT a[122:123],v2,33888
M v[176:179],a[140:143],a[4:7],v[176:179]
buffer_load_dwordx4 v5,s[16:19],s61 offen offset:1024 lds
M v[180:183],a[140:143],a[12:15],v[180:183]
DT a[124:125],v2,35424
M v[180:183],a[136:139],a[8:11],v[180:183]
buffer_load_dwordx4 v5,s[16:19],s62 offen offset:2048 lds
M v[184:187],a[136:139],a[16:19],v[184:187]
DT a[126:127],v2,35936
M v[184:187],a[140:143],a[20:23],v[184:187]
buffer_load_dwordx4 v5,s[16:19],s63 offen offset:3072 lds
M v[188:191],a[140:143],a[28:31],v[188:191]
s_add_u32 s16,s16,524288
s_addc_u32 s17,s17,0
s_sub_u32 s18,s18,524288
M v[188:191],a[136:139],a[24:27],v[188:191]
s_add_u32 m0,s40,132608
M v[192:195],a[136:139],a[32:35],v[192:195]
buffer_load_dwordx4 v8,s[12:15],s64 offen offset:0 lds
M v[192:195],a[140:143],a[36:39],v[192:195]
buffer_load_dwordx4 v9,s[12:15],s65 offen offset:1024 lds
M v[196:199],a[140:143],a[44:47],v[196:199]
buffer_load_dwordx4 v8,s[12:15],s66 offen offset:2048 lds
M v[196:199],a[136:139],a[40:43],v[196:199]
buffer_load_dwordx4 v9,s[12:15],s67 offen offset:3072 lds
M v[200:203],a[136:139],a[48:51],v[200:203]
s_add_u32 s12,s12,128
s_addc_u32 s13,s13,0
s_sub_u32 s14,s14,128
M v[200:203],a[140:143],a[52:55],v[200:203]
s_mov_b32 s54,1048576
M v[204:207],a[140:143],a[60:63],v[204:207]
buffer_load_dword a238,v0,s[84:87],s54 offen
M v[204:207],a[136:139],a[56:59],v[204:207]
buffer_load_dword a238,v15,s[88:91],0 offen offset:256
s_waitcnt vmcnt(18) lgkmcnt(0)
s_barrier
v_accvgpr_read_b32 v13,a239
v_and_b32 v14,0x80808080,v13
v_cmp_eq_u32 vcc,0x80808080,v14
s_nop 0
s_cmp_eq_u64 vcc,-1
s_cbranch_scc0 L_spin5
L_spun5:
s_lshr_b32 s46,s44,16
s_mul_i32 s46,s46,0x01010101
v_cmp_eq_u32 vcc,s46,v13
s_nop 0
s_cmp_eq_u64 vcc,-1
s_cselect_b32 s46,0,0x100
s_or_b32 s44,s44,s46
M v[208:211],a[144:147],a[0:3],v[208:211]
s_mov_b32 m0,s70
DR a[128:131],v1,33152
M v[208:211],a[148:151],a[4:7],v[208:211]
DR a[132:135],v1,33216
M v[212:215],a[148:151],a[12:15],v[212:215]
DR a[136:139],v1,33408
M v[212:215],a[144:147],a[8:11],v[212:215]
DR a[140:143],v1,33472
M v[216:219],a[144:147],a[16:19],v[216:219]
buffer_load_dwordx4 v5,s[16:19],s56 offen offset:0 lds
M v[216:219],a[148:151],a[20:23],v[216:219]
M v[220:223],a[148:151],a[28:31],v[220:223]
M v[220:223],a[144:147],a[24:27],v[220:223]
buffer_load_dwordx4 v5,s[16:19],s57 offen offset:1024 lds
M v[224:227],a[144:147],a[32:35],v[224:227]
M v[224:227],a[148:151],a[36:39],v[224:227]
M v[228:231],a[148:151],a[44:47],v[228:231]
buffer_load_dwordx4 v5,s[16:19],s58 offen offset:2048 lds
M v[228:231],a[144:147],a[40:43],v[228:231]
M v[232:235],a[144:147],a[48:51],v[232:235]
M v[232:235],a[148:151],a[52:55],v[232:235]
M v[236:239],a[148:151],a[60:63],v[236:239]
buffer_load_dwordx4 v5,s[16:19],s59 offen offset:3072 lds
M v[236:239],a[144:147],a[56:59],v[236:239]
s_mov_b32 m0,s71
M v[240:243],a[152:155],a[0:3],v[240:243]
DR a[144:147],v1,33664
M v[240:243],a[156:159],a[4:7],v[240:243]
DR a[148:151],v1,33728
M v[244:247],a[156:159],a[12:15],v[244:247]
buffer_load_dwordx4 v5,s[16:19],s60 offen offset:0 lds
M v[244:247],a[152:155],a[8:11],v[244:247]
M v[248:251],a[152:155],a[16:19],v[248:251]
M v[248:251],a[156:159],a[20:23],v[248:251]
buffer_load_dwordx4 v5,s[16:19],s61 offen offset:1024 lds
M v[252:255],a[156:159],a[28:31],v[252:255]
M v[252:255],a[152:155],a[24:27],v[252:255]
M a[240:243],a[152:155],a[32:35],a[240:243]
buffer_load_dwordx4 v5,s[16:19],s62 offen offset:2048 lds
M a[240:243],a[156:159],a[36:39],a[240:243]
M a[244:247],a[156:159],a[44:47],a[244:247]
M a[244:247],a[152:155],a[40:43],a[244:247]
buffer_load_dwordx4 v5,s[16:19],s63 offen offset:3072 lds
M a[248:251],a[152:155],a[48:51],a[248:251]
s_add_u32 s16,s16,524288
s_addc_u32 s17,s17,0
s_sub_u32 s18,s18,524288
M a[248:251],a[156:159],a[52:55],a[248:251]
s_add_u32 m0,s40,0
M a[252:255],a[156:159],a[60:63],a[252:255]
M a[252:255],a[152:155],a[56:59],a[252:255]
s_waitcnt lgkmcnt(4)
M v[16:19],a[128:131],a[64:67],v[16:19]
DR a[152:155],v1,33920
M v[16:19],a[132:135],a[68:71],v[16:19]
DR a[156:159],v1,33984
M v[20:23],a[132:135],a[76:79],v[20:23]
buffer_load_dwordx4 v8,s[12:15],s64 offen offset:0 lds
M v[20:23],a[128:131],a[72:75],v[20:23]
buffer_load_dwordx4 v9,s[12:15],s65 offen offset:1024 lds
M v[24:27],a[128:131],a[80:83],v[24:27]
M v[24:27],a[132:135],a[84:87],v[24:27]
M v[28:31],a[132:135],a[92:95],v[28:31]
buffer_load_dwordx4 v8,s[12:15],s66 offen offset:2048 lds
M v[28:31],a[128:131],a[88:91],v[28:31]
M v[32:35],a[128:131],a[96:99],v[32:35]
M v[32:35],a[132:135],a[100:103],v[32:35]
buffer_load_dwordx4 v9,s[12:15],s67 offen offset:3072 lds
M v[36:39],a[132:135],a[108:111],v[36:39]
s_add_u32 s12,s12,128
s_addc_u32 s13,s13,0
s_sub_u32 s14,s14,128
M v[36:39],a[128:131],a[104:107],v[36:39]
M v[40:43],a[128:131],a[112:115],v[40:43]
s_mov_b32 s54,1572864
M v[40:43],a[132:135],a[116:119],v[40:43]
buffer_load_dword a238,v0,s[84:87],s54 offen
M v[44:47],a[132:135],a[124:127],v[44:47]
buffer_load_dword a238,v15,s[88:91],0 offen offset:384
M v[44:47],a[128:131],a[120:123],v[44:47]
s_waitcnt lgkmcnt(4)
M v[48:51],a[136:139],a[64:67],v[48:51]
DR a[128:131],v1,34176
M v[48:51],a[140:143],a[68:71],v[48:51]
DR a[132:135],v1,34240
M v[52:55],a[140:143],a[76:79],v[52:55]
M v[52:55],a[136:139],a[72:75],v[52:55]
M v[56:59],a[136:139],a[80:83],v[56:59]
M v[56:59],a[140:143],a[84:87],v[56:59]
M v[60:63],a[140:143],a[92:95],v[60:63]
M v[60:63],a[136:139],a[88:91],v[60:63]
M v[64:67],a[136:139],a[96:99],v[64:67]
M v[64:67],a[140:143],a[100:103],v[64:67]
M v[68:71],a[140:143],a[108:111],v[68:71]
M v[68:71],a[136:139],a[104:107],v[68:71]
s_mov_b32 s54,0
M v[72:75],a[136:139],a[112:115],v[72:75]
M v[72:75],a[140:143],a[116:119],v[72:75]
M v[76:79],a[140:143],a[124:127],v[76:79]
M v[76:79],a[136:139],a[120:123],v[76:79]
s_waitcnt lgkmcnt(4)
M v[80:83],a[144:147],a[64:67],v[80:83]
DR a[136:139],v1,34432
M v[80:83],a[148:151],a[68:71],v[80:83]
DR a[140:143],v1,34496
M v[84:87],a[148:151],a[76:79],v[84:87]
M v[84:87],a[144:147],a[72:75],v[84:87]
M v[88:91],a[144:147],a[80:83],v[88:91]
M v[88:91],a[148:151],a[84:87],v[88:91]
CV v16,v16,v17
CV v17,v18,v19
M v[92:95],a[148:151],a[92:95],v[92:95]
CV v18,v48,v49
CV v19,v50,v51
M v[92:95],a[144:147],a[88:91],v[92:95]
buffer_store_dwordx4 v[16:19],v4,s[96:99],s54 offen offset:0
CV v20,v20,v21
M v[96:99],a[144:147],a[96:99],v[96:99]
s_mov_b32 s54,0
CV v21,v22,v23
CV v22,v52,v53
M v[96:99],a[148:151],a[100:103],v[96:99]
CV v23,v54,v55
CV v24,v24,v25
M v[100:103],a[148:151],a[108:111],v[100:103]
buffer_store_dwordx4 v[20:23],v4,s[96:99],s54 offen offset:2048
CV v25,v26,v27
M v[100:103],a[144:147],a[104:107],v[100:103]
CV v26,v56,v57
CV v27,v58,v59
M v[104:107],a[144:147],a[112:115],v[104:107]
s_mov_b32 s54,4096
CV v28,v28,v29
CV v29,v30,v31
M v[104:107],a[148:151],a[116:119],v[104:107]
buffer_store_dwordx4 v[24:27],v4,s[96:99],s54 offen offset:0
CV v30,v60,v61
M v[108:111],a[148:151],a[124:127],v[108:111]
CV v31,v62,v63
CV v32,v32,v33
M v[108:111],a[144:147],a[120:123],v[108:111]
s_waitcnt lgkmcnt(4)
CV v33,v34,v35
CV v34,v64,v65
M v[112:115],a[152:155],a[64:67],v[112:115]
DR a[144:147],v1,34688
CV v35,v66,v67
M v[112:115],a[156:159],a[68:71],v[112:115]
DR a[148:151],v1,34752
CV v36,v36,v37
M v[116:119],a[156:159],a[76:79],v[116:119]
CV v37,v38,v39
CV v38,v68,v69
M v[116:119],a[152:155],a[72:75],v[116:119]
CV v39,v70,v71
CV v40,v40,v41
M v[120:123],a[152:155],a[80:83],v[120:123]
s_mov_b32 s54,4096
CV v41,v42,v43
CV v42,v72,v73
M v[120:123],a[156:159],a[84:87],v[120:123]
buffer_store_dwordx4 v[28:31],v4,s[96:99],s54 offen offset:2048
CV v43,v74,v75
M v[124:127],a[156:159],a[92:95],v[124:127]
CV v44,v44,v45
CV v45,v46,v47
M v[124:127],a[152:155],a[88:91],v[124:127]
CV v46,v76,v77
CV v47,v78,v79
M v[128:131],a[152:155],a[96:99],v[128:131]
M v[128:131],a[156:159],a[100:103],v[128:131]
M v[132:135],a[156:159],a[108:111],v[132:135]
M v[132:135],a[152:155],a[104:107],v[132:135]
M v[136:139],a[152:155],a[112:115],v[136:139]
s_mov_b32 s54,8192
M v[136:139],a[156:159],a[116:119],v[136:139]
buffer_store_dwordx4 v[32:35],v4,s[96:99],s54 offen offset:0
M v[140:143],a[156:159],a[124:127],v[140:143]
M v[140:143],a[152:155],a[120:123],v[140:143]
s_waitcnt lgkmcnt(4)
M v[144:147],a[128:131],a[64:67],v[144:147]
DR a[152:155],v1,34944
M v[144:147],a[132:135],a[68:71],v[144:147]
DR a[156:159],v1,35008
M v[148:151],a[132:135],a[76:79],v[148:151]
M v[148:151],a[128:131],a[72:75],v[148:151]
M v[152:155],a[128:131],a[80:83],v[152:155]
M v[152:155],a[132:135],a[84:87],v[152:155]
s_mov_b32 s54,8192
CV v80,v80,v81
CV v81,v82,v83
M v[156:159],a[132:135],a[92:95],v[156:159]
buffer_store_dwordx4 v[36:39],v4,s[96:99],s54 offen offset:2048
CV v82,v112,v113
M v[156:159],a[128:131],a[88:91],v[156:159]
CV v83,v114,v115
CV v84,v84,v85
M v[160:163],a[128:131],a[96:99],v[160:163]
CV v85,v86,v87
CV v86,v116,v117
M v[160:163],a[132:135],a[100:103],v[160:163]
CV v87,v118,v119
CV v88,v88,v89
M v[164:167],a[132:135],a[108:111],v[164:167]
CV v89,v90,v91
CV v90,v120,v121
M v[164:167],a[128:131],a[104:107],v[164:167]
CV v91,v122,v123
CV v92,v92,v93
M v[168:171],a[128:131],a[112:115],v[168:171]
CV v93,v94,v95
CV v94,v124,v125
M v[168:171],a[132:135],a[116:119],v[168:171]
s_mov_b32 s54,12288
CV v95,v126,v127
CV v96,v96,v97
M v[172:175],a[132:135],a[124:127],v[172:175]
buffer_store_dwordx4 v[40:43],v4,s[96:99],s54 offen offset:0
CV v97,v98,v99
M v[172:175],a[128:131],a[120:123],v[172:175]
s_waitcnt lgkmcnt(4)
CV v98,v128,v129
CV v99,v130,v131
M v[176:179],a[136:139],a[64:67],v[176:179]
CV v100,v100,v101
CV v101,v102,v103
M v[176:179],a[140:143],a[68:71],v[176:179]
CV v102,v132,v133
CV v103,v134,v135
M v[180:183],a[140:143],a[76:79],v[180:183]
CV v104,v104,v105
CV v105,v106,v107
M v[180:183],a[136:139],a[72:75],v[180:183]
CV v106,v136,v137
CV v107,v138,v139
M v[184:187],a[136:139],a[80:83],v[184:187]
CV v108,v108,v109
CV v109,v110,v111
M v[184:187],a[140:143],a[84:87],v[184:187]
s_mov_b32 s54,12288
CV v110,v140,v141
CV v111,v142,v143
M v[188:191],a[140:143],a[92:95],v[188:191]
buffer_store_dwordx4 v[44:47],v4,s[96:99],s54 offen offset:2048
M v[188:191],a[136:139],a[88:91],v[188:191]
M v[192:195],a[136:139],a[96:99],v[192:195]
M v[192:195],a[140:143],a[100:103],v[192:195]
M v[196:199],a[140:143],a[108:111],v[196:199]
M v[196:199],a[136:139],a[104:107],v[196:199]
M v[200:203],a[136:139],a[112:115],v[200:203]
M v[200:203],a[140:143],a[116:119],v[200:203]
M v[204:207],a[140:143],a[124:127],v[204:207]
M v[204:207],a[136:139],a[120:123],v[204:207]
s_waitcnt vmcnt(24) lgkmcnt(0)
s_barrier
M v[208:211],a[144:147],a[64:67],v[208:211]
DR a[192:195],v7,0
DR a[196:199],v7,64
DR a[200:203],v7,256
M v[208:211],a[148:151],a[68:71],v[208:211]
s_add_u32 m0,s41,0
DR a[204:207],v7,320
M v[212:215],a[148:151],a[76:79],v[212:215]
DT a[0:1],v12,0
M v[212:215],a[144:147],a[72:75],v[212:215]
DT a[2:3],v12,512
M v[216:219],a[144:147],a[80:83],v[216:219]
DT a[4:5],v12,2048
M v[216:219],a[148:151],a[84:87],v[216:219]
DT a[6:7],v12,2560
CV v144,v144,v145
M v[220:223],a[148:151],a[92:95],v[220:223]
DT a[8:9],v12,32
CV v145,v146,v147
M v[220:223],a[144:147],a[88:91],v[220:223]
DT a[10:11],v12,544
CV v146,v176,v177
M v[224:227],a[144:147],a[96:99],v[224:227]
DT a[12:13],v12,2080
CV v147,v178,v179
M v[224:227],a[148:151],a[100:103],v[224:227]
DT a[14:15],v12,2592
DT a[16:17],v12,64
DT a[18:19],v12,576
M v[228:231],a[148:151],a[108:111],v[228:231]
DT a[20:21],v12,2112
CV v148,v148,v149
M v[228:231],a[144:147],a[104:107],v[228:231]
DT a[22:23],v12,2624
CV v149,v150,v151
M v[232:235],a[144:147],a[112:115],v[232:235]
DT a[24:25],v12,96
CV v150,v180,v181
M v[232:235],a[148:151],a[116:119],v[232:235]
DT a[26:27],v12,608
CV v151,v182,v183
M v[236:239],a[148:151],a[124:127],v[236:239]
DT a[28:29],v12,2144
CV v152,v152,v153
M v[236:239],a[144:147],a[120:123],v[236:239]
DT a[30:31],v12,2656
CV v153,v154,v155
M v[240:243],a[152:155],a[64:67],v[240:243]
buffer_load_dwordx4 v5,s[16:19],s56 offen offset:0 lds
DT a[32:33],v12,128
M v[240:243],a[156:159],a[68:71],v[240:243]
DT a[34:35],v12,640
CV v154,v184,v185
M v[244:247],a[156:159],a[76:79],v[244:247]
DT a[36:37],v12,2176
CV v155,v186,v187
M v[244:247],a[152:155],a[72:75],v[244:247]
DT a[38:39],v12,2688
CV v156,v156,v157
M v[248:251],a[152:155],a[80:83],v[248:251]
DT a[40:41],v12,160
CV v157,v158,v159
M v[248:251],a[156:159],a[84:87],v[248:251]
buffer_load_dwordx4 v5,s[16:19],s57 offen offset:1024 lds
DT a[42:43],v12,672
DT a[44:45],v12,2208
M v[252:255],a[156:159],a[92:95],v[252:255]
DT a[46:47],v12,2720
CV v158,v188,v189
M v[252:255],a[152:155],a[88:91],v[252:255]
DT a[48:49],v12,192
CV v159,v190,v191
M a[240:243],a[152:155],a[96:99],a[240:243]
DT a[50:51],v12,704
CV v160,v160,v161
M a[240:243],a[156:159],a[100:103],a[240:243]
buffer_load_dwordx4 v5,s[16:19],s58 offen offset:2048 lds
DT a[52:53],v12,2240
M a[244:247],a[156:159],a[108:111],a[244:247]
DT a[54:55],v12,2752
CV v161,v162,v163
M a[244:247],a[152:155],a[104:107],a[244:247]
DT a[56:57],v12,224
DT a[58:59],v12,736
DT a[60:61],v12,2272
M a[248:251],a[152:155],a[112:115],a[248:251]
DT a[62:63],v12,2784
CV v162,v192,v193
M a[248:251],a[156:159],a[116:119],a[248:251]
buffer_load_dwordx4 v5,s[16:19],s59 offen offset:3072 lds
M a[252:255],a[156:159],a[124:127],a[252:255]
s_add_u32 m0,s41,4128
CV v163,v194,v195
CV v164,v164,v165
M a[252:255],a[152:155],a[120:123],a[252:255]
s_waitcnt lgkmcnt(15)
CV v165,v166,v167
CV v166,v196,v197
M v[48:51],a[0:3],a[192:195],0
DT a[64:65],v12,256
DT a[66:67],v12,768
DT a[68:69],v12,2304
M v[48:51],a[4:7],a[196:199],v[48:51]
DT a[70:71],v12,2816
DT a[72:73],v12,288
DT a[74:75],v12,800
M v[52:55],a[4:7],a[204:207],0
buffer_load_dwordx4 v5,s[16:19],s60 offen offset:0 lds
M v[52:55],a[0:3],a[200:203],v[52:55]
DT a[76:77],v12,2336
CV v167,v198,v199
M v[56:59],a[8:11],a[192:195],0
DT a[78:79],v12,2848
CV v168,v168,v169
M v[56:59],a[12:15],a[196:199],v[56:59]
DT a[80:81],v12,320
CV v169,v170,v171
M v[60:63],a[12:15],a[204:207],0
DT a[82:83],v12,832
CV v170,v200,v201
M v[60:63],a[8:11],a[200:203],v[60:63]
buffer_load_dwordx4 v5,s[16:19],s61 offen offset:1024 lds
DT a[84:85],v12,2368
DT a[86:87],v12,2880
M v[64:67],a[16:19],a[192:195],0
DT a[88:89],v12,352
CV v171,v202,v203
M v[64:67],a[20:23],a[196:199],v[64:67]
DT a[90:91],v12,864
CV v172,v172,v173
M v[68:71],a[20:23],a[204:207],0
DT a[92:93],v12,2400
CV v173,v174,v175
M v[68:71],a[16:19],a[200:203],v[68:71]
buffer_load_dwordx4 v5,s[16:19],s62 offen offset:2048 lds
DT a[94:95],v12,2912
M v[72:75],a[24:27],a[192:195],0
DT a[96:97],v12,384
CV v174,v204,v205
M v[72:75],a[28:31],a[196:199],v[72:75]
DT a[98:99],v12,896
DT a[100:101],v12,2432
DT a[102:103],v12,2944
M v[76:79],a[28:31],a[204:207],0
DT a[104:105],v12,416
CV v175,v206,v207
M v[76:79],a[24:27],a[200:203],v[76:79]
s_waitcnt lgkmcnt(15)
DT a[106:107],v12,928
CV v208,v208,v209
M v[112:115],a[32:35],a[192:195],0
buffer_load_dwordx4 v5,s[16:19],s63 offen offset:3072 lds
M v[112:115],a[36:39],a[196:199],v[112:115]
DT a[108:109],v12,2464
CV v209,v210,v211
M v[116:119],a[36:39],a[204:207],0
DT a[110:111],v12,2976
CV v210,v240,v241
M v[116:119],a[32:35],a[200:203],v[116:119]
DT a[112:113],v12,448
DT a[114:115],v12,960
DT a[116:117],v12,2496
M v[120:123],a[40:43],a[192:195],0
DT a[118:119],v12,3008
CV v211,v242,v243
M v[120:123],a[44:47],a[196:199],v[120:123]
DT a[120:121],v12,480
CV v212,v212,v213
M v[124:127],a[44:47],a[204:207],0
DT a[122:123],v12,992
CV v213,v214,v215
M v[124:127],a[40:43],a[200:203],v[124:127]
DT a[124:125],v12,2528
CV v214,v244,v245
M v[128:131],a[48:51],a[192:195],0
DT a[126:127],v12,3040
CV v215,v246,v247
M v[128:131],a[52:55],a[196:199],v[128:131]
CV v216,v216,v217
CV v217,v218,v219
M v[132:135],a[52:55],a[204:207],0
CV v218,v248,v249
CV v219,v250,v251
M v[132:135],a[48:51],a[200:203],v[132:135]
CV v220,v220,v221
CV v221,v222,v223
M v[136:139],a[56:59],a[192:195],0
CV v222,v252,v253
CV v223,v254,v255
M v[136:139],a[60:63],a[196:199],v[136:139]
v_accvgpr_read_b32 v240,a240
v_accvgpr_read_b32 v241,a241
M v[140:143],a[60:63],a[204:207],0
v_accvgpr_read_b32 v242,a242
v_accvgpr_read_b32 v243,a243
M v[140:143],a[56:59],a[200:203],v[140:143]
CV v224,v224,v225
CV v225,v226,v227
CV v226,v240,v241
CV v227,v242,v243
v_accvgpr_read_b32 v240,a244
v_accvgpr_read_b32 v241,a245
v_accvgpr_read_b32 v242,a246
v_accvgpr_read_b32 v243,a247
CV v228,v228,v229
CV v229,v230,v231
CV v230,v240,v241
CV v231,v242,v243
v_accvgpr_read_b32 v240,a248
v_accvgpr_read_b32 v241,a249
v_accvgpr_read_b32 v242,a250
v_accvgpr_read_b32 v243,a251
CV v232,v232,v233
CV v233,v234,v235
CV v234,v240,v241
CV v235,v242,v243
v_accvgpr_read_b32 v240,a252
v_accvgpr_read_b32 v241,a253
v_accvgpr_read_b32 v242,a254
v_accvgpr_read_b32 v243,a255
CV v236,v236,v237
CV v237,v238,v239
CV v238,v240,v241
CV v239,v242,v243
s_add_u32 s16,s16,524288
s_addc_u32 s17,s17,0
s_sub_u32 s18,s18,524288
s_add_u32 m0,s40,16480
s_nop 0
buffer_load_dwordx4 v8,s[12:15],s64 offen offset:0 lds
buffer_load_dwordx4 v9,s[12:15],s65 offen offset:1024 lds
buffer_load_dwordx4 v8,s[12:15],s66 offen offset:2048 lds
buffer_load_dwordx4 v9,s[12:15],s67 offen offset:3072 lds
s_add_u32 s12,s12,128
s_addc_u32 s13,s13,0
s_sub_u32 s14,s14,128
s_mov_b32 s54,2097152
buffer_load_dword a238,v0,s[84:87],s54 offen
buffer_load_dword a238,v15,s[88:91],0 offen offset:512
s_waitcnt vmcnt(24) lgkmcnt(0)
s_barrier
M v[176:179],a[64:67],a[192:195],0
DR a[208:211],v6,0
DR a[212:215],v6,64
DR a[216:219],v6,256
M v[176:179],a[68:71],a[196:199],v[176:179]
s_mov_b32 m0,s68
DR a[220:223],v6,320
v_lshrrev_b32 v13,2,v4
M v[180:183],a[68:71],a[204:207],0
buffer_load_dwordx4 v5,s[16:19],s56 offen offset:0 lds
M v[180:183],a[64:67],a[200:203],v[180:183]
DT a[64:65],v12,33152
DT a[66:67],v12,33664
DT a[68:69],v12,35200
M v[184:187],a[72:75],a[192:195],0
DT a[70:71],v12,35712
v_and_b32 v13,28,v13
M v[184:187],a[76:79],a[196:199],v[184:187]
buffer_load_dwordx4 v5,s[16:19],s57 offen offset:1024 lds
M v[188:191],a[76:79],a[204:207],0
M v[188:191],a[72:75],a[200:203],v[188:191]
DT a[72:73],v12,33184
DT a[74:75],v12,33696
DT a[76:77],v12,35232
M v[192:195],a[80:83],a[192:195],0
DT a[78:79],v12,35744
M v[192:195],a[84:87],a[196:199],v[192:195]
buffer_load_dwordx4 v5,s[16:19],s58 offen offset:2048 lds
M v[196:199],a[84:87],a[204:207],0
M v[196:199],a[80:83],a[200:203],v[196:199]
DT a[80:81],v12,33216
DT a[82:83],v12,33728
DT a[84:85],v12,35264
M v[200:203],a[88:91],a[192:195],0
DT a[86:87],v12,35776
M v[200:203],a[92:95],a[196:199],v[200:203]
buffer_load_dwordx4 v5,s[16:19],s59 offen offset:3072 lds
M v[204:207],a[92:95],a[204:207],0
s_mov_b32 m0,s69
M v[204:207],a[88:91],a[200:203],v[204:207]
DT a[88:89],v12,33248
DT a[90:91],v12,33760
DT a[92:93],v12,35296
DT a[94:95],v12,35808
M v[240:243],a[96:99],a[192:195],0
buffer_load_dwordx4 v5,s[16:19],s60 offen offset:0 lds
M v[240:243],a[100:103],a[196:199],v[240:243]
buffer_load_dwordx4 v5,s[16:19],s61 offen offset:1024 lds
M v[244:247],a[100:103],a[204:207],0
M v[244:247],a[96:99],a[200:203],v[244:247]
DT a[96:97],v12,33280
DT a[98:99],v12,33792
DT a[100:101],v12,35328
DT a[102:103],v12,35840
M a[240:243],a[104:107],a[192:195],0
buffer_load_dwordx4 v5,s[16:19],s62 offen offset:2048 lds
M a[240:243],a[108:111],a[196:199],a[240:243]
M a[244:247],a[108:111],a[204:207],0
M a[244:247],a[104:107],a[200:203],a[244:247]
DT a[104:105],v12,33312
DT a[106:107],v12,33824
DT a[108:109],v12,35360
DT a[110:111],v12,35872
M v[248:251],a[112:115],a[192:195],0
buffer_load_dwordx4 v5,s[16:19],s63 offen offset:3072 lds
M v[248:251],a[116:119],a[196:199],v[248:251]
s_add_u32 s16,s16,524288
s_addc_u32 s17,s17,0
s_sub_u32 s18,s18,524288
M v[252:255],a[116:119],a[204:207],0
s_add_u32 m0,s40,132608
M v[252:255],a[112:115],a[200:203],v[252:255]
DT a[112:113],v12,33344
DT a[114:115],v12,33856
DT a[116:117],v12,35392
DT a[118:119],v12,35904
M a[248:251],a[120:123],a[192:195],0
buffer_load_dwordx4 v8,s[12:15],s64 offen offset:0 lds
M a[248:251],a[124:127],a[196:199],a[248:251]
buffer_load_dwordx4 v9,s[12:15],s65 offen offset:1024 lds
M a[252:255],a[124:127],a[204:207],0
M a[252:255],a[120:123],a[200:203],a[252:255]
s_waitcnt lgkmcnt(12)
DT a[120:121],v12,33376
DT a[122:123],v12,33888
DT a[124:125],v12,35424
DT a[126:127],v12,35936
DT a[128:129],v12,33408
DT a[130:131],v12,33920
M v[48:51],a[64:67],a[208:211],v[48:51]
DT a[132:133],v12,35456
M v[48:51],a[68:71],a[212:215],v[48:51]
DT a[134:135],v12,35968
DT a[136:137],v12,33440
DT a[138:139],v12,33952
M v[52:55],a[68:71],a[220:223],v[52:55]
DT a[140:141],v12,35488
M v[52:55],a[64:67],a[216:219],v[52:55]
DT a[142:143],v12,36000
M v[56:59],a[72:75],a[208:211],v[56:59]
DT a[144:145],v12,33472
M v[56:59],a[76:79],a[212:215],v[56:59]
DT a[146:147],v12,33984
M v[60:63],a[76:79],a[220:223],v[60:63]
DT a[148:149],v12,35520
M v[60:63],a[72:75],a[216:219],v[60:63]
DT a[150:151],v12,36032
M v[64:67],a[80:83],a[208:211],v[64:67]
DT a[152:153],v12,33504
M v[64:67],a[84:87],a[212:215],v[64:67]
DT a[154:155],v12,34016
M v[68:71],a[84:87],a[220:223],v[68:71]
DT a[156:157],v12,35552
M v[68:71],a[80:83],a[216:219],v[68:71]
DT a[158:159],v12,36064
M v[72:75],a[88:91],a[208:211],v[72:75]
DT a[160:161],v12,33536
M v[72:75],a[92:95],a[212:215],v[72:75]
DT a[162:163],v12,34048
DT a[164:165],v12,35584
DT a[166:167],v12,36096
M v[76:79],a[92:95],a[220:223],v[76:79]
buffer_load_dwordx4 v8,s[12:15],s66 offen offset:2048 lds
M v[76:79],a[88:91],a[216:219],v[76:79]
s_waitcnt lgkmcnt(15)
DT a[168:169],v12,33568
M v[112:115],a[96:99],a[208:211],v[112:115]
DT a[170:171],v12,34080
M v[112:115],a[100:103],a[212:215],v[112:115]
buffer_load_dwordx4 v9,s[12:15],s67 offen offset:3072 lds
DT a[172:173],v12,35616
M v[116:119],a[100:103],a[220:223],v[116:119]
s_add_u32 s12,s12,128
s_addc_u32 s13,s13,0
DT a[174:175],v12,36128
M v[116:119],a[96:99],a[216:219],v[116:119]
DT a[176:177],v12,33600
DT a[178:179],v12,34112
DT a[180:181],v12,35648
M v[120:123],a[104:107],a[208:211],v[120:123]
s_sub_u32 s14,s14,128
s_mov_b32 s54,2621440
DT a[182:183],v12,36160
M v[120:123],a[108:111],a[212:215],v[120:123]
DT a[184:185],v12,33632
M v[124:127],a[108:111],a[220:223],v[124:127]
DT a[186:187],v12,34144
M v[124:127],a[104:107],a[216:219],v[124:127]
DT a[188:189],v12,35680
M v[128:131],a[112:115],a[208:211],v[128:131]
DT a[190:191],v12,36192
M v[128:131],a[116:119],a[212:215],v[128:131]
buffer_load_dword a238,v0,s[84:87],s54 offen
M v[132:135],a[116:119],a[220:223],v[132:135]
buffer_load_dword a238,v15,s[88:91],0 offen offset:640
M v[132:135],a[112:115],a[216:219],v[132:135]
s_mov_b32 s54,0
M v[136:139],a[120:123],a[208:211],v[136:139]
buffer_store_dwordx4 v[80:83],v4,s[96:99],s54 offen offset:1024
M v[136:139],a[124:127],a[212:215],v[136:139]
s_mov_b32 s54,0
M v[140:143],a[124:127],a[220:223],v[140:143]
buffer_store_dwordx4 v[84:87],v4,s[96:99],s54 offen offset:3072
M v[140:143],a[120:123],a[216:219],v[140:143]
s_mov_b32 s54,4096
buffer_store_dwordx4 v[88:91],v4,s[96:99],s54 offen offset:1024
s_waitcnt vmcnt(19) lgkmcnt(0)
s_barrier
M v[176:179],a[128:131],a[208:211],v[176:179]
DR a[192:195],v6,16480
DR a[196:199],v6,16544
DR a[200:203],v6,16736
M v[176:179],a[132:135],a[212:215],v[176:179]
s_mov_b32 m0,s70
DR a[204:207],v6,16800
M v[180:183],a[132:135],a[220:223],v[180:183]
DT a[64:65],v10,0
M v[180:183],a[128:131],a[216:219],v[180:183]
DT a[66:67],v10,512
M v[184:187],a[136:139],a[208:211],v[184:187]
DT a[68:69],v10,2048
M v[184:187],a[140:143],a[212:215],v[184:187]
DT a[70:71],v10,2560
M v[188:191],a[140:143],a[220:223],v[188:191]
DT a[72:73],v10,32
M v[188:191],a[136:139],a[216:219],v[188:191]
DT a[74:75],v10,544
M v[192:195],a[144:147],a[208:211],v[192:195]
DT a[76:77],v10,2080
M v[192:195],a[148:151],a[212:215],v[192:195]
DT a[78:79],v10,2592
DT a[80:81],v10,64
DT a[82:83],v10,576
M v[196:199],a[148:151],a[220:223],v[196:199]
DT a[84:85],v10,2112
M v[196:199],a[144:147],a[216:219],v[196:199]
DT a[86:87],v10,2624
M v[200:203],a[152:155],a[208:211],v[200:203]
DT a[88:89],v10,96
M v[200:203],a[156:159],a[212:215],v[200:203]
DT a[90:91],v10,608
M v[204:207],a[156:159],a[220:223],v[204:207]
DT a[92:93],v10,2144
M v[204:207],a[152:155],a[216:219],v[204:207]
DT a[94:95],v10,2656
M v[240:243],a[160:163],a[208:211],v[240:243]
buffer_load_dwordx4 v5,s[16:19],s56 offen offset:0 lds
DT a[96:97],v10,128
M v[240:243],a[164:167],a[212:215],v[240:243]
DT a[98:99],v10,640
M v[244:247],a[164:167],a[220:223],v[244:247]
DT a[100:101],v10,2176
M v[244:247],a[160:163],a[216:219],v[244:247]
buffer_load_dwordx4 v5,s[16:19],s57 offen offset:1024 lds
DT a[102:103],v10,2688
M a[240:243],a[168:171],a[208:211],a[240:243]
DT a[104:105],v10,160
M a[240:243],a[172:175],a[212:215],a[240:243]
DT a[106:107],v10,672
DT a[108:109],v10,2208
DT a[110:111],v10,2720
M a[244:247],a[172:175],a[220:223],a[244:247]
buffer_load_dwordx4 v5,s[16:19],s58 offen offset:2048 lds
M a[244:247],a[168:171],a[216:219],a[244:247]
DT a[112:113],v10,192
M v[248:251],a[176:179],a[208:211],v[248:251]
DT a[114:115],v10,704
M v[248:251],a[180:183],a[212:215],v[248:251]
buffer_load_dwordx4 v5,s[16:19],s59 offen offset:3072 lds
DT a[116:117],v10,2240
M v[252:255],a[180:183],a[220:223],v[252:255]
s_mov_b32 m0,s71
DT a[118:119],v10,2752
M v[252:255],a[176:179],a[216:219],v[252:255]
DT a[120:121],v10,224
DT a[122:123],v10,736
DT a[124:125],v10,2272
M a[248:251],a[184:187],a[208:211],a[248:251]
buffer_load_dwordx4 v5,s[16:19],s60 offen offset:0 lds
M a[248:251],a[188:191],a[212:215],a[248:251]
DT a[126:127],v10,2784
M a[252:255],a[188:191],a[220:223],a[252:255]
DT a[128:129],v10,256
M a[252:255],a[184:187],a[216:219],a[252:255]
s_waitcnt lgkmcnt(15)
buffer_load_dwordx4 v5,s[16:19],s61 offen offset:1024 lds
DT a[130:131],v10,768
M v[48:51],a[64:67],a[192:195],v[48:51]
DT a[132:133],v10,2304
M v[48:51],a[68:71],a[196:199],v[48:51]
DT a[134:135],v10,2816
DT a[136:137],v10,288
DT a[138:139],v10,800
M v[52:55],a[68:71],a[204:207],v[52:55]
buffer_load_dwordx4 v5,s[16:19],s62 offen offset:2048 lds
M v[52:55],a[64:67],a[200:203],v[52:55]
DT a[140:141],v10,2336
M v[56:59],a[72:75],a[192:195],v[56:59]
DT a[142:143],v10,2848
M v[56:59],a[76:79],a[196:199],v[56:59]
buffer_load_dwordx4 v5,s[16:19],s63 offen offset:3072 lds
DT a[144:145],v10,320
M v[60:63],a[76:79],a[204:207],v[60:63]
s_add_u32 s16,s16,524288
s_addc_u32 s17,s17,0
DT a[146:147],v10,832
M v[60:63],a[72:75],a[200:203],v[60:63]
DT a[148:149],v10,2368
DT a[150:151],v10,2880
DT a[152:153],v10,352
M v[64:67],a[80:83],a[192:195],v[64:67]
s_sub_u32 s18,s18,524288
s_add_u32 m0,s40,0
DT a[154:155],v10,864
M v[64:67],a[84:87],a[196:199],v[64:67]
buffer_load_dwordx4 v8,s[12:15],s64 offen offset:0 lds
M v[68:71],a[84:87],a[204:207],v[68:71]
DT a[156:157],v10,2400
M v[68:71],a[80:83],a[200:203],v[68:71]
buffer_load_dwordx4 v9,s[12:15],s65 offen offset:1024 lds
DT a[158:159],v10,2912
M v[72:75],a[88:91],a[192:195],v[72:75]
DT a[160:161],v10,384
M v[72:75],a[92:95],a[196:199],v[72:75]
DT a[162:163],v10,896
DT a[164:165],v10,2432
DT a[166:167],v10,2944
M v[76:79],a[92:95],a[204:207],v[76:79]
buffer_load_dwordx4 v8,s[12:15],s66 offen offset:2048 lds
M v[76:79],a[88:91],a[200:203],v[76:79]
s_waitcnt lgkmcnt(15)
DT a[168:169],v10,416
M v[112:115],a[96:99],a[192:195],v[112:115]
DT a[170:171],v10,928
M v[112:115],a[100:103],a[196:199],v[112:115]
buffer_load_dwordx4 v9,s[12:15],s67 offen offset:3072 lds
DT a[172:173],v10,2464
M v[116:119],a[100:103],a[204:207],v[116:119]
s_add_u32 s12,s12,128
s_addc_u32 s13,s13,0
DT a[174:175],v10,2976
M v[116:119],a[96:99],a[200:203],v[116:119]
DT a[176:177],v10,448
DT a[178:179],v10,960
DT a[180:181],v10,2496
M v[120:123],a[104:107],a[192:195],v[120:123]
s_sub_u32 s14,s14,128
s_mov_b32 s54,3145728
DT a[182:183],v10,3008
M v[120:123],a[108:111],a[196:199],v[120:123]
DT a[184:185],v10,480
M v[124:127],a[108:111],a[204:207],v[124:127]
DT a[186:187],v10,992
M v[124:127],a[104:107],a[200:203],v[124:127]
DT a[188:189],v10,2528
M v[128:131],a[112:115],a[192:195],v[128:131]
DT a[190:191],v10,3040
M v[128:131],a[116:119],a[196:199],v[128:131]
buffer_load_dword a238,v0,s[84:87],s54 offen
M v[132:135],a[116:119],a[204:207],v[132:135]
buffer_load_dword a238,v15,s[88:91],0 offen offset:768
M v[132:135],a[112:115],a[200:203],v[132:135]
s_mov_b32 s54,4096
M v[136:139],a[120:123],a[192:195],v[136:139]
buffer_store_dwordx4 v[92:95],v4,s[96:99],s54 offen offset:3072
M v[136:139],a[124:127],a[196:199],v[136:139]
s_mov_b32 s54,8192
M v[140:143],a[124:127],a[204:207],v[140:143]
buffer_store_dwordx4 v[96:99],v4,s[96:99],s54 offen offset:1024
M v[140:143],a[120:123],a[200:203],v[140:143]
s_mov_b32 s54,8192
buffer_store_dwordx4 v[100:103],v4,s[96:99],s54 offen offset:3072
s_waitcnt vmcnt(22) lgkmcnt(0)
s_barrier
M v[176:179],a[128:131],a[192:195],v[176:179]
DR a[208:211],v7,0
DR a[212:215],v7,64
DR a[216:219],v7,256
M v[176:179],a[132:135],a[196:199],v[176:179]
s_add_u32 m0,s41,0
DR a[220:223],v7,320
M v[180:183],a[132:135],a[204:207],v[180:183]
DT a[64:65],v12,0
M v[180:183],a[128:131],a[200:203],v[180:183]
DT a[66:67],v12,512
M v[184:187],a[136:139],a[192:195],v[184:187]
DT a[68:69],v12,2048
M v[184:187],a[140:143],a[196:199],v[184:187]
DT a[70:71],v12,2560
M v[188:191],a[140:143],a[204:207],v[188:191]
DT a[72:73],v12,32
M v[188:191],a[136:139],a[200:203],v[188:191]
DT a[74:75],v12,544
M v[192:195],a[144:147],a[192:195],v[192:195]
DT a[76:77],v12,2080
M v[192:195],a[148:151],a[196:199],v[192:195]
DT a[78:79],v12,2592
DT a[80:81],v12,64
DT a[82:83],v12,576
M v[196:199],a[148:151],a[204:207],v[196:199]
DT a[84:85],v12,2112
M v[196:199],a[144:147],a[200:203],v[196:199]
DT a[86:87],v12,2624
M v[200:203],a[152:155],a[192:195],v[200:203]
DT a[88:89],v12,96
M v[200:203],a[156:159],a[196:199],v[200:203]
DT a[90:91],v12,608
M v[204:207],a[156:159],a[204:207],v[204:207]
DT a[92:93],v12,2144
M v[204:207],a[152:155],a[200:203],v[204:207]
DT a[94:95],v12,2656
M v[240:243],a[160:163],a[192:195],v[240:243]
buffer_load_dwordx4 v5,s[16:19],s56 offen offset:0 lds
DT a[96:97],v12,128
M v[240:243],a[164:167],a[196:199],v[240:243]
DT a[98:99],v12,640
M v[244:247],a[164:167],a[204:207],v[244:247]
DT a[100:101],v12,2176
M v[244:247],a[160:163],a[200:203],v[244:247]
buffer_load_dwordx4 v5,s[16:19],s57 offen offset:1024 lds
DT a[102:103],v12,2688
M a[240:243],a[168:171],a[192:195],a[240:243]
DT a[104:105],v12,160
M a[240:243],a[172:175],a[196:199],a[240:243]
DT a[106:107],v12,672
DT a[108:109],v12,2208
DT a[110:111],v12,2720
M a[244:247],a[172:175],a[204:207],a[244:247]
buffer_load_dwordx4 v5,s[16:19],s58 offen offset:2048 lds
M a[244:247],a[168:171],a[200:203],a[244:247]
DT a[112:113],v12,192
M v[248:251],a[176:179],a[192:195],v[248:251]
DT a[114:115],v12,704
M v[248:251],a[180:183],a[196:199],v[248:251]
buffer_load_dwordx4 v5,s[16:19],s59 offen offset:3072 lds
DT a[116:117],v12,2240
M v[252:255],a[180:183],a[204:207],v[252:255]
s_add_u32 m0,s41,4128
DT a[118:119],v12,2752
M v[252:255],a[176:179],a[200:203],v[252:255]
DT a[120:121],v12,224
DT a[122:123],v12,736
DT a[124:125],v12,2272
M a[248:251],a[184:187],a[192:195],a[248:251]
buffer_load_dwordx4 v5,s[16:19],s60 offen offset:0 lds
M a[248:251],a[188:191],a[196:199],a[248:251]
DT a[126:127],v12,2784
M a[252:255],a[188:191],a[204:207],a[252:255]
DT a[128:129],v12,256
M a[252:255],a[184:187],a[200:203],a[252:255]
s_waitcnt lgkmcnt(15)
buffer_load_dwordx4 v5,s[16:19],s61 offen offset:1024 lds
DT a[130:131],v12,768
M v[48:51],a[64:67],a[208:211],v[48:51]
DT a[132:133],v12,2304
M v[48:51],a[68:71],a[212:215],v[48:51]
DT a[134:135],v12,2816
DT a[136:137],v12,288
DT a[138:139],v12,800
M v[52:55],a[68:71],a[220:223],v[52:55]
buffer_load_dwordx4 v5,s[16:19],s62 offen offset:2048 lds
M v[52:55],a[64:67],a[216:219],v[52:55]
DT a[140:141],v12,2336
M v[56:59],a[72:75],a[208:211],v[56:59]
DT a[142:143],v12,2848
M v[56:59],a[76:79],a[212:215],v[56:59]
buffer_load_dwordx4 v5,s[16:19],s63 offen offset:3072 lds
DT a[144:145],v12,320
M v[60:63],a[76:79],a[220:223],v[60:63]
s_add_u32 s16,s16,524288
s_addc_u32 s17,s17,0
DT a[146:147],v12,832
M v[60:63],a[72:75],a[216:219],v[60:63]
DT a[148:149],v12,2368
DT a[150:151],v12,2880
DT a[152:153],v12,352
M v[64:67],a[80:83],a[208:211],v[64:67]
s_sub_u32 s18,s18,524288
s_add_u32 m0,s40,16480
DT a[154:155],v12,864
M v[64:67],a[84:87],a[212:215],v[64:67]
buffer_load_dwordx4 v8,s[12:15],s64 offen offset:0 lds
M v[68:71],a[84:87],a[220:223],v[68:71]
DT a[156:157],v12,2400
M v[68:71],a[80:83],a[216:219],v[68:71]
buffer_load_dwordx4 v9,s[12:15],s65 offen offset:1024 lds
DT a[158:159],v12,2912
M v[72:75],a[88:91],a[208:211],v[72:75]
DT a[160:161],v12,384
M v[72:75],a[92:95],a[212:215],v[72:75]
DT a[162:163],v12,896
DT a[164:165],v12,2432
DT a[166:167],v12,2944
M v[76:79],a[92:95],a[220:223],v[76:79]
buffer_load_dwordx4 v8,s[12:15],s66 offen offset:2048 lds
M v[76:79],a[88:91],a[216:219],v[76:79]
s_waitcnt lgkmcnt(15)
DT a[168:169],v12,416
M v[112:115],a[96:99],a[208:211],v[112:115]
DT a[170:171],v12,928
M v[112:115],a[100:103],a[212:215],v[112:115]
buffer_load_dwordx4 v9,s[12:15],s67 offen offset:3072 lds
DT a[172:173],v12,2464
M v[116:119],a[100:103],a[220:223],v[116:119]
s_add_u32 s12,s12,128
s_addc_u32 s13,s13,0
DT a[174:175],v12,2976
M v[116:119],a[96:99],a[216:219],v[116:119]
DT a[176:177],v12,448
DT a[178:179],v12,960
DT a[180:181],v12,2496
M v[120:123],a[104:107],a[208:211],v[120:123]
s_sub_u32 s14,s14,128
s_mov_b32 s54,12288
DT a[182:183],v12,3008
M v[120:123],a[108:111],a[212:215],v[120:123]
buffer_store_dwordx4 v[104:107],v4,s[96:99],s54 offen offset:1024
DT a[184:185],v12,480
M v[124:127],a[108:111],a[220:223],v[124:127]
s_mov_b32 s54,12288
DT a[186:187],v12,992
M v[124:127],a[104:107],a[216:219],v[124:127]
buffer_store_dwordx4 v[108:111],v4,s[96:99],s54 offen offset:3072
DT a[188:189],v12,2528
M v[128:131],a[112:115],a[208:211],v[128:131]
s_mov_b32 s54,32768
DT a[190:191],v12,3040
M v[128:131],a[116:119],a[212:215],v[128:131]
buffer_store_dwordx4 v[144:147],v4,s[96:99],s54 offen offset:0
M v[132:135],a[116:119],a[220:223],v[132:135]
M v[132:135],a[112:115],a[216:219],v[132:135]
M v[136:139],a[120:123],a[208:211],v[136:139]
M v[136:139],a[124:127],a[212:215],v[136:139]
M v[140:143],a[124:127],a[220:223],v[140:143]
M v[140:143],a[120:123],a[216:219],v[140:143]
s_waitcnt vmcnt(20) lgkmcnt(0)
s_barrier
M v[176:179],a[128:131],a[208:211],v[176:179]
DR a[192:195],v6,0
DR a[196:199],v6,64
DR a[200:203],v6,256
M v[176:179],a[132:135],a[212:215],v[176:179]
s_mov_b32 m0,s68
DR a[204:207],v6,320
M v[180:183],a[132:135],a[220:223],v[180:183]
DT a[64:65],v12,33152
M v[180:183],a[128:131],a[216:219],v[180:183]
DT a[66:67],v12,33664
M v[184:187],a[136:139],a[208:211],v[184:187]
DT a[68:69],v12,35200
M v[184:187],a[140:143],a[212:215],v[184:187]
DT a[70:71],v12,35712
M v[188:191],a[140:143],a[220:223],v[188:191]
DT a[72:73],v12,33184
M v[188:191],a[136:139],a[216:219],v[188:191]
DT a[74:75],v12,33696
M v[192:195],a[144:147],a[208:211],v[192:195]
DT a[76:77],v12,35232
M v[192:195],a[148:151],a[212:215],v[192:195]
DT a[78:79],v12,35744
DT a[80:81],v12,33216
DT a[82:83],v12,33728
M v[196:199],a[148:151],a[220:223],v[196:199]
DT a[84:85],v12,35264
M v[196:199],a[144:147],a[216:219],v[196:199]
DT a[86:87],v12,35776
M v[200:203],a[152:155],a[208:211],v[200:203]
DT a[88:89],v12,33248
M v[200:203],a[156:159],a[212:215],v[200:203]
DT a[90:91],v12,33760
M v[204:207],a[156:159],a[220:223],v[204:207]
DT a[92:93],v12,35296
M v[204:207],a[152:155],a[216:219],v[204:207]
DT a[94:95],v12,35808
M v[240:243],a[160:163],a[208:211],v[240:243]
buffer_load_dwordx4 v5,s[16:19],s56 offen offset:0 lds
DT a[96:97],v12,33280
M v[240:243],a[164:167],a[212:215],v[240:243]
DT a[98:99],v12,33792
M v[244:247],a[164:167],a[220:223],v[244:247]
DT a[100:101],v12,35328
M v[244:247],a[160:163],a[216:219],v[244:247]
buffer_load_dwordx4 v5,s[16:19],s57 offen offset:1024 lds
DT a[102:103],v12,35840
M a[240:243],a[168:171],a[208:211],a[240:243]
DT a[104:105],v12,33312
M a[240:243],a[172:175],a[212:215],a[240:243]
DT a[106:107],v12,33824
DT a[108:109],v12,35360
DT a[110:111],v12,35872
M a[244:247],a[172:175],a[220:223],a[244:247]
buffer_load_dwordx4 v5,s[16:19],s58 offen offset:2048 lds
M a[244:247],a[168:171],a[216:219],a[244:247]
DT a[112:113],v12,33344
M v[248:251],a[176:179],a[208:211],v[248:251]
DT a[114:115],v12,33856
M v[248:251],a[180:183],a[212:215],v[248:251]
buffer_load_dwordx4 v5,s[16:19],s59 offen offset:3072 lds
DT a[116:117],v12,35392
M v[252:255],a[180:183],a[220:223],v[252:255]
s_mov_b32 m0,s69
DT a[118:119],v12,35904
M v[252:255],a[176:179],a[216:219],v[252:255]
DT a[120:121],v12,33376
DT a[122:123],v12,33888
DT a[124:125],v12,35424
M a[248:251],a[184:187],a[208:211],a[248:251]
buffer_load_dwordx4 v5,s[16:19],s60 offen offset:0 lds
M a[248:251],a[188:191],a[212:215],a[248:251]
DT a[126:127],v12,35936
M a[252:255],a[188:191],a[220:223],a[252:255]
DT a[128:129],v12,33408
M a[252:255],a[184:187],a[216:219],a[252:255]
s_waitcnt lgkmcnt(15)
buffer_load_dwordx4 v5,s[16:19],s61 offen offset:1024 lds
DT a[130:131],v12,33920
M v[48:51],a[64:67],a[192:195],v[48:51]
DT a[132:133],v12,35456
M v[48:51],a[68:71],a[196:199],v[48:51]
DT a[134:135],v12,35968
DT a[136:137],v12,33440
DT a[138:139],v12,33952
M v[52:55],a[68:71],a[204:207],v[52:55]
buffer_load_dwordx4 v5,s[16:19],s62 offen offset:2048 lds
M v[52:55],a[64:67],a[200:203],v[52:55]
DT a[140:141],v12,35488
M v[56:59],a[72:75],a[192:195],v[56:59]
DT a[142:143],v12,36000
M v[56:59],a[76:79],a[196:199],v[56:59]
buffer_load_dwordx4 v5,s[16:19],s63 offen offset:3072 lds
DT a[144:145],v12,33472
M v[60:63],a[76:79],a[204:207],v[60:63]
s_add_u32 s16,s16,524288
s_addc_u32 s17,s17,0
DT a[146:147],v12,33984
M v[60:63],a[72:75],a[200:203],v[60:63]
DT a[148:149],v12,35520
DT a[150:151],v12,36032
DT a[152:153],v12,33504
M v[64:67],a[80:83],a[192:195],v[64:67]
s_sub_u32 s18,s18,524288
s_add_u32 m0,s40,132608
DT a[154:155],v12,34016
M v[64:67],a[84:87],a[196:199],v[64:67]
buffer_load_dwordx4 v8,s[12:15],s64 offen offset:0 lds
M v[68:71],a[84:87],a[204:207],v[68:71]
DT a[156:157],v12,35552
M v[68:71],a[80:83],a[200:203],v[68:71]
buffer_load_dwordx4 v9,s[12:15],s65 offen offset:1024 lds
DT a[158:159],v12,36064
M v[72:75],a[88:91],a[192:195],v[72:75]
DT a[160:161],v12,33536
M v[72:75],a[92:95],a[196:199],v[72:75]
DT a[162:163],v12,34048
DT a[164:165],v12,35584
DT a[166:167],v12,36096
M v[76:79],a[92:95],a[204:207],v[76:79]
buffer_load_dwordx4 v8,s[12:15],s66 offen offset:2048 lds
M v[76:79],a[88:91],a[200:203],v[76:79]
s_waitcnt lgkmcnt(15)
DT a[168:169],v12,33568
M v[112:115],a[96:99],a[192:195],v[112:115]
DT a[170:171],v12,34080
M v[112:115],a[100:103],a[196:199],v[112:115]
buffer_load_dwordx4 v9,s[12:15],s67 offen offset:3072 lds
DT a[172:173],v12,35616
M v[116:119],a[100:103],a[204:207],v[116:119]
s_add_u32 s12,s12,128
s_addc_u32 s13,s13,0
DT a[174:175],v12,36128
M v[116:119],a[96:99],a[200:203],v[116:119]
DT a[176:177],v12,33600
DT a[178:179],v12,34112
DT a[180:181],v12,35648
M v[120:123],a[104:107],a[192:195],v[120:123]
s_sub_u32 s14,s14,128
s_lshl_b32 s51,s43,7
DT a[182:183],v12,36160
M v[120:123],a[108:111],a[196:199],v[120:123]
s_lshl_b32 s46,s43,20
DT a[184:185],v12,33632
M v[124:127],a[108:111],a[204:207],v[124:127]
s_add_u32 s4,s82,s46
s_addc_u32 s5,s83,0
DT a[186:187],v12,34144
M v[124:127],a[104:107],a[200:203],v[124:127]
s_mov_b32 s6,1048576
s_mov_b32 s7,0x20000
DT a[188:189],v12,35680
M v[128:131],a[112:115],a[192:195],v[128:131]
s_add_u32 s8,s82,s46
s_addc_u32 s9,s83,0
DT a[190:191],v12,36192
M v[128:131],a[116:119],a[196:199],v[128:131]
s_add_u32 s8,s8,16777216
s_addc_u32 s9,s9,0
s_mov_b32 s10,1048576
M v[132:135],a[116:119],a[204:207],v[132:135]
s_mov_b32 s11,0x20000
s_add_u32 s12,s82,s46
s_addc_u32 s13,s83,0
M v[132:135],a[112:115],a[200:203],v[132:135]
s_add_u32 s12,s12,33554432
s_addc_u32 s13,s13,0
s_mov_b32 s14,1048576
M v[136:139],a[120:123],a[192:195],v[136:139]
s_mov_b32 s15,0x20000
s_lshl_b32 s47,s45,1
s_sub_u32 s47,12,s47
M v[136:139],a[124:127],a[196:199],v[136:139]
s_max_i32 s47,s47,0
s_lshl_b32 s47,s47,15
s_sub_u32 s52,15,s45
M v[140:143],a[124:127],a[204:207],v[140:143]
s_lshl_b32 s52,s52,16
s_mov_b32 s28,s47
s_mov_b32 s32,-1
M v[140:143],a[120:123],a[200:203],v[140:143]
s_mov_b32 s33,s32
s_add_u32 s29,s28,4096
s_mov_b32 s30,s28
s_mov_b32 s31,s29
s_lshl_b32 s46,s42,13
s_add_u32 s34,s46,99456
s_add_u32 s35,s46,103552
s_add_u32 s36,s46,66304
s_add_u32 s37,s46,70400
s_add_u32 s38,s46,0
s_add_u32 s39,s46,4096
s_add_u32 s40,s46,33152
s_add_u32 s41,s46,37248
v_add_u32 v3,s46,v4
buffer_load_dword v14,v13,s[24:27],s51 offen offset:0 sc1
s_mov_b32 s54,32768
buffer_store_dwordx4 v[148:151],v4,s[96:99],s54 offen offset:2048
s_mov_b32 s54,36864
buffer_store_dwordx4 v[152:155],v4,s[96:99],s54 offen offset:0
s_mov_b32 s54,36864
buffer_store_dwordx4 v[156:159],v4,s[96:99],s54 offen offset:2048
s_mov_b32 s54,40960
buffer_store_dwordx4 v[160:163],v4,s[96:99],s54 offen offset:0
s_mov_b32 s54,40960
buffer_store_dwordx4 v[164:167],v4,s[96:99],s54 offen offset:2048
s_mov_b32 s54,45056
buffer_store_dwordx4 v[168:171],v4,s[96:99],s54 offen offset:0
s_mov_b32 s54,45056
buffer_store_dwordx4 v[172:175],v4,s[96:99],s54 offen offset:2048
s_waitcnt vmcnt(23) lgkmcnt(0)
s_barrier
s_waitcnt vmcnt(7)
v_cmp_eq_u32 vcc,1,v14
s_nop 0
s_cmp_eq_u64 vcc,-1
s_cbranch_scc0 L_spin6
L_spun6:
s_bitcmp1_b32 s44,8
s_cbranch_scc1 L_acq6
L_acqd6:
M v[176:179],a[128:131],a[192:195],v[176:179]
DR a[208:211],v6,16480
DR a[212:215],v6,16544
DR a[216:219],v6,16736
M v[176:179],a[132:135],a[196:199],v[176:179]
s_mov_b32 m0,s34
DR a[220:223],v6,16800
M v[180:183],a[132:135],a[204:207],v[180:183]
DT a[64:65],v10,0
M v[180:183],a[128:131],a[200:203],v[180:183]
DT a[66:67],v10,512
M v[184:187],a[136:139],a[192:195],v[184:187]
DT a[68:69],v10,2048
M v[184:187],a[140:143],a[196:199],v[184:187]
DT a[70:71],v10,2560
M v[188:191],a[140:143],a[204:207],v[188:191]
DT a[72:73],v10,32
M v[188:191],a[136:139],a[200:203],v[188:191]
DT a[74:75],v10,544
M v[192:195],a[144:147],a[192:195],v[192:195]
DT a[76:77],v10,2080
M v[192:195],a[148:151],a[196:199],v[192:195]
DT a[78:79],v10,2592
DT a[80:81],v10,64
DT a[82:83],v10,576
M v[196:199],a[148:151],a[204:207],v[196:199]
DT a[84:85],v10,2112
M v[196:199],a[144:147],a[200:203],v[196:199]
DT a[86:87],v10,2624
M v[200:203],a[152:155],a[192:195],v[200:203]
DT a[88:89],v10,96
M v[200:203],a[156:159],a[196:199],v[200:203]
DT a[90:91],v10,608
M v[204:207],a[156:159],a[204:207],v[204:207]
DT a[92:93],v10,2144
M v[204:207],a[152:155],a[200:203],v[204:207]
buffer_load_dwordx4 v3,s[4:7],s28 offen offset:0 sc1 lds
DT a[94:95],v10,2656
M v[240:243],a[160:163],a[192:195],v[240:243]
DT a[96:97],v10,128
M v[240:243],a[164:167],a[196:199],v[240:243]
DT a[98:99],v10,640
M v[244:247],a[164:167],a[204:207],v[244:247]
buffer_load_dwordx4 v3,s[4:7],s28 offen offset:1024 sc1 lds
DT a[100:101],v10,2176
M v[244:247],a[160:163],a[200:203],v[244:247]
DT a[102:103],v10,2688
M a[240:243],a[168:171],a[192:195],a[240:243]
DT a[104:105],v10,160
M a[240:243],a[172:175],a[196:199],a[240:243]
buffer_load_dwordx4 v3,s[4:7],s28 offen offset:2048 sc1 lds
DT a[106:107],v10,672
DT a[108:109],v10,2208
M a[244:247],a[172:175],a[204:207],a[244:247]
DT a[110:111],v10,2720
M a[244:247],a[168:171],a[200:203],a[244:247]
DT a[112:113],v10,192
M v[248:251],a[176:179],a[192:195],v[248:251]
buffer_load_dwordx4 v3,s[4:7],s28 offen offset:3072 sc1 lds
DT a[114:115],v10,704
M v[248:251],a[180:183],a[196:199],v[248:251]
s_mov_b32 m0,s35
DT a[116:117],v10,2240
M v[252:255],a[180:183],a[204:207],v[252:255]
DT a[118:119],v10,2752
M v[252:255],a[176:179],a[200:203],v[252:255]
buffer_load_dwordx4 v3,s[4:7],s29 offen offset:0 sc1 lds
DT a[120:121],v10,224
DT a[122:123],v10,736
M a[248:251],a[184:187],a[192:195],a[248:251]
DT a[124:125],v10,2272
M a[248:251],a[188:191],a[196:199],a[248:251]
DT a[126:127],v10,2784
M a[252:255],a[188:191],a[204:207],a[252:255]
buffer_load_dwordx4 v3,s[4:7],s29 offen offset:1024 sc1 lds
DT a[128:129],v10,256
M a[252:255],a[184:187],a[200:203],a[252:255]
s_waitcnt lgkmcnt(15)
DT a[130:131],v10,768
M v[48:51],a[64:67],a[208:211],v[48:51]
DT a[132:133],v10,2304
M v[48:51],a[68:71],a[212:215],v[48:51]
buffer_load_dwordx4 v3,s[4:7],s29 offen offset:2048 sc1 lds
DT a[134:135],v10,2816
DT a[136:137],v10,288
M v[52:55],a[68:71],a[220:223],v[52:55]
DT a[138:139],v10,800
M v[52:55],a[64:67],a[216:219],v[52:55]
DT a[140:141],v10,2336
M v[56:59],a[72:75],a[208:211],v[56:59]
buffer_load_dwordx4 v3,s[4:7],s29 offen offset:3072 sc1 lds
DT a[142:143],v10,2848
M v[56:59],a[76:79],a[212:215],v[56:59]
s_add_u32 s28,s28,32768
DT a[144:145],v10,320
M v[60:63],a[76:79],a[220:223],v[60:63]
s_cmp_eq_u32 s28,s32
s_cselect_b32 s28,0,s28
DT a[146:147],v10,832
M v[60:63],a[72:75],a[216:219],v[60:63]
DT a[148:149],v10,2368
DT a[150:151],v10,2880
DT a[152:153],v10,352
M v[64:67],a[80:83],a[208:211],v[64:67]
s_add_u32 s29,s28,4096
s_mov_b32 s54,32768
DT a[154:155],v10,864
M v[64:67],a[84:87],a[212:215],v[64:67]
buffer_store_dwordx4 v[208:211],v4,s[96:99],s54 offen offset:1024
DT a[156:157],v10,2400
M v[68:71],a[84:87],a[220:223],v[68:71]
s_mov_b32 s54,32768
DT a[158:159],v10,2912
M v[68:71],a[80:83],a[216:219],v[68:71]
buffer_store_dwordx4 v[212:215],v4,s[96:99],s54 offen offset:3072
DT a[160:161],v10,384
M v[72:75],a[88:91],a[208:211],v[72:75]
s_mov_b32 s54,36864
DT a[162:163],v10,896
M v[72:75],a[92:95],a[212:215],v[72:75]
buffer_store_dwordx4 v[216:219],v4,s[96:99],s54 offen offset:1024
DT a[164:165],v10,2432
M v[76:79],a[92:95],a[220:223],v[76:79]
s_mov_b32 s54,36864
DT a[166:167],v10,2944
M v[76:79],a[88:91],a[216:219],v[76:79]
s_waitcnt lgkmcnt(15)
DT a[168:169],v10,416
M v[112:115],a[96:99],a[208:211],v[112:115]
buffer_store_dwordx4 v[220:223],v4,s[96:99],s54 offen offset:3072
DT a[170:171],v10,928
M v[112:115],a[100:103],a[212:215],v[112:115]
s_mov_b32 s54,40960
DT a[172:173],v10,2464
M v[116:119],a[100:103],a[220:223],v[116:119]
buffer_store_dwordx4 v[224:227],v4,s[96:99],s54 offen offset:1024
DT a[174:175],v10,2976
M v[116:119],a[96:99],a[216:219],v[116:119]
DT a[176:177],v10,448
DT a[178:179],v10,960
DT a[180:181],v10,2496
M v[120:123],a[104:107],a[208:211],v[120:123]
s_mov_b32 s54,40960
DT a[182:183],v10,3008
M v[120:123],a[108:111],a[212:215],v[120:123]
buffer_store_dwordx4 v[228:231],v4,s[96:99],s54 offen offset:3072
DT a[184:185],v10,480
M v[124:127],a[108:111],a[220:223],v[124:127]
s_mov_b32 s54,45056
DT a[186:187],v10,992
M v[124:127],a[104:107],a[216:219],v[124:127]
buffer_store_dwordx4 v[232:235],v4,s[96:99],s54 offen offset:1024
DT a[188:189],v10,2528
M v[128:131],a[112:115],a[208:211],v[128:131]
s_mov_b32 s54,45056
DT a[190:191],v10,3040
M v[128:131],a[116:119],a[212:215],v[128:131]
buffer_store_dwordx4 v[236:239],v4,s[96:99],s54 offen offset:3072
M v[132:135],a[116:119],a[220:223],v[132:135]
M v[132:135],a[112:115],a[216:219],v[132:135]
M v[136:139],a[120:123],a[208:211],v[136:139]
M v[136:139],a[124:127],a[212:215],v[136:139]
M v[140:143],a[124:127],a[220:223],v[140:143]
M v[140:143],a[120:123],a[216:219],v[140:143]
s_waitcnt lgkmcnt(0)
s_barrier
M v[176:179],a[128:131],a[208:211],v[176:179]
DR a[192:195],v7,0
DR a[196:199],v7,64
DR a[200:203],v7,256
M v[176:179],a[132:135],a[212:215],v[176:179]
DR a[204:207],v7,320
M v[180:183],a[132:135],a[220:223],v[180:183]
DT a[64:65],v12,0
M v[180:183],a[128:131],a[216:219],v[180:183]
DT a[66:67],v12,512
M v[184:187],a[136:139],a[208:211],v[184:187]
DT a[68:69],v12,2048
M v[184:187],a[140:143],a[212:215],v[184:187]
DT a[70:71],v12,2560
M v[188:191],a[140:143],a[220:223],v[188:191]
DT a[72:73],v12,32
M v[188:191],a[136:139],a[216:219],v[188:191]
DT a[74:75],v12,544
M v[192:195],a[144:147],a[208:211],v[192:195]
DT a[76:77],v12,2080
M v[192:195],a[148:151],a[212:215],v[192:195]
DT a[78:79],v12,2592
DT a[80:81],v12,64
DT a[82:83],v12,576
M v[196:199],a[148:151],a[220:223],v[196:199]
DT a[84:85],v12,2112
M v[196:199],a[144:147],a[216:219],v[196:199]
DT a[86:87],v12,2624
M v[200:203],a[152:155],a[208:211],v[200:203]
DT a[88:89],v12,96
M v[200:203],a[156:159],a[212:215],v[200:203]
DT a[90:91],v12,608
M v[204:207],a[156:159],a[220:223],v[204:207]
DT a[92:93],v12,2144
M v[204:207],a[152:155],a[216:219],v[204:207]
DT a[94:95],v12,2656
M v[240:243],a[160:163],a[208:211],v[240:243]
DT a[96:97],v12,128
M v[240:243],a[164:167],a[212:215],v[240:243]
DT a[98:99],v12,640
M v[244:247],a[164:167],a[220:223],v[244:247]
DT a[100:101],v12,2176
M v[244:247],a[160:163],a[216:219],v[244:247]
DT a[102:103],v12,2688
M a[240:243],a[168:171],a[208:211],a[240:243]
DT a[104:105],v12,160
M a[240:243],a[172:175],a[212:215],a[240:243]
DT a[106:107],v12,672
DT a[108:109],v12,2208
DT a[110:111],v12,2720
M a[244:247],a[172:175],a[220:223],a[244:247]
DT a[112:113],v12,192
M a[244:247],a[168:171],a[216:219],a[244:247]
DT a[114:115],v12,704
M v[248:251],a[176:179],a[208:211],v[248:251]
DT a[116:117],v12,2240
M v[248:251],a[180:183],a[212:215],v[248:251]
DT a[118:119],v12,2752
M v[252:255],a[180:183],a[220:223],v[252:255]
DT a[120:121],v12,224
M v[252:255],a[176:179],a[216:219],v[252:255]
DT a[122:123],v12,736
M a[248:251],a[184:187],a[208:211],a[248:251]
DT a[124:125],v12,2272
M a[248:251],a[188:191],a[212:215],a[248:251]
DT a[126:127],v12,2784
M a[252:255],a[188:191],a[220:223],a[252:255]
DT a[128:129],v12,256
M a[252:255],a[184:187],a[216:219],a[252:255]
s_waitcnt lgkmcnt(15)
DT a[130:131],v12,768
M v[48:51],a[64:67],a[192:195],v[48:51]
DT a[132:133],v12,2304
M v[48:51],a[68:71],a[196:199],v[48:51]
DT a[134:135],v12,2816
DT a[136:137],v12,288
DT a[138:139],v12,800
M v[52:55],a[68:71],a[204:207],v[52:55]
DT a[140:141],v12,2336
M v[52:55],a[64:67],a[200:203],v[52:55]
DT a[142:143],v12,2848
M v[56:59],a[72:75],a[192:195],v[56:59]
DT a[144:145],v12,320
M v[56:59],a[76:79],a[196:199],v[56:59]
DT a[146:147],v12,832
M v[60:63],a[76:79],a[204:207],v[60:63]
DT a[148:149],v12,2368
M v[60:63],a[72:75],a[200:203],v[60:63]
DT a[150:151],v12,2880
M v[64:67],a[80:83],a[192:195],v[64:67]
DT a[152:153],v12,352
M v[64:67],a[84:87],a[196:199],v[64:67]
DT a[154:155],v12,864
M v[68:71],a[84:87],a[204:207],v[68:71]
DT a[156:157],v12,2400
M v[68:71],a[80:83],a[200:203],v[68:71]
DT a[158:159],v12,2912
M v[72:75],a[88:91],a[192:195],v[72:75]
DT a[160:161],v12,384
M v[72:75],a[92:95],a[196:199],v[72:75]
DT a[162:163],v12,896
DT a[164:165],v12,2432
DT a[166:167],v12,2944
M v[76:79],a[92:95],a[204:207],v[76:79]
DT a[168:169],v12,416
v_mul_f32 v48,s49,v48
M v[76:79],a[88:91],a[200:203],v[76:79]
s_waitcnt lgkmcnt(15)
DT a[170:171],v12,928
v_mul_f32 v49,s49,v49
M v[112:115],a[96:99],a[192:195],v[112:115]
DT a[172:173],v12,2464
v_mul_f32 v50,s49,v50
M v[112:115],a[100:103],a[196:199],v[112:115]
DT a[174:175],v12,2976
v_mul_f32 v51,s49,v51
M v[116:119],a[100:103],a[204:207],v[116:119]
DT a[176:177],v12,448
v_mul_f32 v56,s49,v56
M v[116:119],a[96:99],a[200:203],v[116:119]
DT a[178:179],v12,960
v_mul_f32 v57,s49,v57
M v[120:123],a[104:107],a[192:195],v[120:123]
DT a[180:181],v12,2496
v_mul_f32 v58,s49,v58
M v[120:123],a[108:111],a[196:199],v[120:123]
DT a[182:183],v12,3008
v_mul_f32 v59,s49,v59
M v[124:127],a[108:111],a[204:207],v[124:127]
DT a[184:185],v12,480
CV v48,v48,v49
M v[124:127],a[104:107],a[200:203],v[124:127]
DT a[186:187],v12,992
CV v49,v50,v51
M v[128:131],a[112:115],a[192:195],v[128:131]
DT a[188:189],v12,2528
CV v50,v56,v57
M v[128:131],a[116:119],a[196:199],v[128:131]
DT a[190:191],v12,3040
CV v51,v58,v59
M v[132:135],a[116:119],a[204:207],v[132:135]
v_mul_f32 v52,s49,v52
v_mul_f32 v53,s49,v53
M v[132:135],a[112:115],a[200:203],v[132:135]
v_mul_f32 v54,s49,v54
v_mul_f32 v55,s49,v55
M v[136:139],a[120:123],a[192:195],v[136:139]
v_mul_f32 v60,s49,v60
v_mul_f32 v61,s49,v61
M v[136:139],a[124:127],a[196:199],v[136:139]
v_mul_f32 v62,s49,v62
v_mul_f32 v63,s49,v63
M v[140:143],a[124:127],a[204:207],v[140:143]
CV v52,v52,v53
CV v53,v54,v55
M v[140:143],a[120:123],a[200:203],v[140:143]
CV v54,v60,v61
CV v55,v62,v63
v_accvgpr_write_b32 a0,v48
v_accvgpr_write_b32 a1,v49
v_accvgpr_write_b32 a2,v50
v_accvgpr_write_b32 a3,v51
v_accvgpr_write_b32 a32,v52
v_accvgpr_write_b32 a33,v53
v_accvgpr_write_b32 a34,v54
v_accvgpr_write_b32 a35,v55
s_waitcnt vmcnt(0) lgkmcnt(0)
s_barrier
s_cmp_eq_u32 s42,0
s_cbranch_scc0 L_nopub5
s_bitcmp1_b32 s44,8
s_cbranch_scc1 L_rel5
L_reld5:
s_mov_b64 exec,1
v_mov_b32 v12,1
buffer_store_dword v12,off,s[24:27],s55 offset:32 sc1
s_mov_b64 exec,-1
L_nopub5:
M v[176:179],a[128:131],a[192:195],v[176:179]
v_mul_f32 v64,s49,v64
v_mul_f32 v65,s49,v65
M v[176:179],a[132:135],a[196:199],v[176:179]
v_mul_f32 v66,s49,v66
v_mul_f32 v67,s49,v67
M v[180:183],a[132:135],a[204:207],v[180:183]
v_mul_f32 v72,s49,v72
v_mul_f32 v73,s49,v73
M v[180:183],a[128:131],a[200:203],v[180:183]
v_mul_f32 v74,s49,v74
v_mul_f32 v75,s49,v75
M v[184:187],a[136:139],a[192:195],v[184:187]
CV v64,v64,v65
CV v65,v66,v67
M v[184:187],a[140:143],a[196:199],v[184:187]
CV v66,v72,v73
CV v67,v74,v75
M v[188:191],a[140:143],a[204:207],v[188:191]
v_mul_f32 v68,s49,v68
v_mul_f32 v69,s49,v69
M v[188:191],a[136:139],a[200:203],v[188:191]
v_mul_f32 v70,s49,v70
v_mul_f32 v71,s49,v71
M v[192:195],a[144:147],a[192:195],v[192:195]
v_mul_f32 v76,s49,v76
v_mul_f32 v77,s49,v77
M v[192:195],a[148:151],a[196:199],v[192:195]
v_mul_f32 v78,s49,v78
v_mul_f32 v79,s49,v79
M v[196:199],a[148:151],a[204:207],v[196:199]
CV v68,v68,v69
CV v69,v70,v71
M v[196:199],a[144:147],a[200:203],v[196:199]
CV v70,v76,v77
CV v71,v78,v79
M v[200:203],a[152:155],a[192:195],v[200:203]
v_mul_f32 v112,s49,v112
v_mul_f32 v113,s49,v113
M v[200:203],a[156:159],a[196:199],v[200:203]
v_mul_f32 v114,s49,v114
v_mul_f32 v115,s49,v115
M v[204:207],a[156:159],a[204:207],v[204:207]
v_mul_f32 v120,s49,v120
v_mul_f32 v121,s49,v121
M v[204:207],a[152:155],a[200:203],v[204:207]
v_mul_f32 v122,s49,v122
v_mul_f32 v123,s49,v123
M v[240:243],a[160:163],a[192:195],v[240:243]
CV v112,v112,v113
CV v113,v114,v115
M v[240:243],a[164:167],a[196:199],v[240:243]
CV v114,v120,v121
CV v115,v122,v123
M v[244:247],a[164:167],a[204:207],v[244:247]
v_mul_f32 v116,s49,v116
v_mul_f32 v117,s49,v117
M v[244:247],a[160:163],a[200:203],v[244:247]
v_mul_f32 v118,s49,v118
v_mul_f32 v119,s49,v119
M a[240:243],a[168:171],a[192:195],a[240:243]
v_mul_f32 v124,s49,v124
v_mul_f32 v125,s49,v125
M a[240:243],a[172:175],a[196:199],a[240:243]
v_mul_f32 v126,s49,v126
v_mul_f32 v127,s49,v127
M a[244:247],a[172:175],a[204:207],a[244:247]
CV v116,v116,v117
CV v117,v118,v119
M a[244:247],a[168:171],a[200:203],a[244:247]
CV v118,v124,v125
CV v119,v126,v127
M v[248:251],a[176:179],a[192:195],v[248:251]
v_accvgpr_write_b32 a4,v64
v_accvgpr_write_b32 a5,v65
M v[248:251],a[180:183],a[196:199],v[248:251]
v_accvgpr_write_b32 a6,v66
v_accvgpr_write_b32 a7,v67
M v[252:255],a[180:183],a[204:207],v[252:255]
v_accvgpr_write_b32 a36,v68
v_accvgpr_write_b32 a37,v69
M v[252:255],a[176:179],a[200:203],v[252:255]
v_accvgpr_write_b32 a38,v70
v_accvgpr_write_b32 a39,v71
M a[248:251],a[184:187],a[192:195],a[248:251]
v_accvgpr_write_b32 a8,v112
v_accvgpr_write_b32 a9,v113
M a[248:251],a[188:191],a[196:199],a[248:251]
v_accvgpr_write_b32 a10,v114
v_accvgpr_write_b32 a11,v115
M a[252:255],a[188:191],a[204:207],a[252:255]
v_accvgpr_write_b32 a40,v116
v_accvgpr_write_b32 a41,v117
M a[252:255],a[184:187],a[200:203],a[252:255]
v_accvgpr_write_b32 a42,v118
v_accvgpr_write_b32 a43,v119
s_mov_b32 m0,s36
s_nop 0
buffer_load_dwordx4 v3,s[4:7],s28 offen offset:0 sc1 lds
buffer_load_dwordx4 v3,s[4:7],s28 offen offset:1024 sc1 lds
buffer_load_dwordx4 v3,s[4:7],s28 offen offset:2048 sc1 lds
buffer_load_dwordx4 v3,s[4:7],s28 offen offset:3072 sc1 lds
s_mov_b32 m0,s37
s_nop 0
buffer_load_dwordx4 v3,s[4:7],s29 offen offset:0 sc1 lds
buffer_load_dwordx4 v3,s[4:7],s29 offen offset:1024 sc1 lds
buffer_load_dwordx4 v3,s[4:7],s29 offen offset:2048 sc1 lds
buffer_load_dwordx4 v3,s[4:7],s29 offen offset:3072 sc1 lds
s_add_u32 s28,s28,32768
s_cmp_eq_u32 s28,s32
s_cselect_b32 s28,0,s28
s_add_u32 s29,s28,4096
v_mov_b32 v6,s49
v_mov_b32 v7,s49
s_lshl_b32 s76,s42,13
s_add_u32 s77,s52,57344
s_sub_u32 s77,s77,s76
s_add_u32 s76,s76,s52
v_pk_mul_f32 v[128:129],v[128:129],v[6:7]
v_pk_mul_f32 v[130:131],v[130:131],v[6:7]
v_pk_mul_f32 v[136:137],v[136:137],v[6:7]
v_pk_mul_f32 v[138:139],v[138:139],v[6:7]
CV v128,v128,v129
CV v129,v130,v131
CV v130,v136,v137
CV v131,v138,v139
v_accvgpr_write_b32 a12,v128
v_accvgpr_write_b32 a13,v129
v_accvgpr_write_b32 a14,v130
v_accvgpr_write_b32 a15,v131
v_pk_mul_f32 v[132:133],v[132:133],v[6:7]
v_pk_mul_f32 v[134:135],v[134:135],v[6:7]
v_pk_mul_f32 v[140:141],v[140:141],v[6:7]
v_pk_mul_f32 v[142:143],v[142:143],v[6:7]
CV v132,v132,v133
CV v133,v134,v135
CV v134,v140,v141
CV v135,v142,v143
v_accvgpr_write_b32 a44,v132
v_accvgpr_write_b32 a45,v133
v_accvgpr_write_b32 a46,v134
v_accvgpr_write_b32 a47,v135
v_pk_mul_f32 v[176:177],v[176:177],v[6:7]
v_pk_mul_f32 v[178:179],v[178:179],v[6:7]
v_pk_mul_f32 v[184:185],v[184:185],v[6:7]
v_pk_mul_f32 v[186:187],v[186:187],v[6:7]
CV v176,v176,v177
CV v177,v178,v179
CV v178,v184,v185
CV v179,v186,v187
v_accvgpr_write_b32 a16,v176
v_accvgpr_write_b32 a17,v177
v_accvgpr_write_b32 a18,v178
v_accvgpr_write_b32 a19,v179
v_pk_mul_f32 v[180:181],v[180:181],v[6:7]
v_pk_mul_f32 v[182:183],v[182:183],v[6:7]
v_pk_mul_f32 v[188:189],v[188:189],v[6:7]
v_pk_mul_f32 v[190:191],v[190:191],v[6:7]
CV v180,v180,v181
CV v181,v182,v183
CV v182,v188,v189
CV v183,v190,v191
v_accvgpr_write_b32 a48,v180
v_accvgpr_write_b32 a49,v181
v_accvgpr_write_b32 a50,v182
v_accvgpr_write_b32 a51,v183
v_pk_mul_f32 v[192:193],v[192:193],v[6:7]
v_pk_mul_f32 v[194:195],v[194:195],v[6:7]
v_pk_mul_f32 v[200:201],v[200:201],v[6:7]
v_pk_mul_f32 v[202:203],v[202:203],v[6:7]
CV v192,v192,v193
CV v193,v194,v195
CV v194,v200,v201
CV v195,v202,v203
v_accvgpr_write_b32 a20,v192
v_accvgpr_write_b32 a21,v193
v_accvgpr_write_b32 a22,v194
v_accvgpr_write_b32 a23,v195
v_pk_mul_f32 v[196:197],v[196:197],v[6:7]
v_pk_mul_f32 v[198:199],v[198:199],v[6:7]
v_pk_mul_f32 v[204:205],v[204:205],v[6:7]
v_pk_mul_f32 v[206:207],v[206:207],v[6:7]
CV v196,v196,v197
CV v197,v198,v199
CV v198,v204,v205
CV v199,v206,v207
v_accvgpr_write_b32 a52,v196
v_accvgpr_write_b32 a53,v197
v_accvgpr_write_b32 a54,v198
v_accvgpr_write_b32 a55,v199
v_accvgpr_read_b32 v56,a240
v_accvgpr_read_b32 v57,a241
v_accvgpr_read_b32 v58,a242
v_accvgpr_read_b32 v59,a243
v_pk_mul_f32 v[240:241],v[240:241],v[6:7]
v_pk_mul_f32 v[242:243],v[242:243],v[6:7]
v_pk_mul_f32 v[56:57],v[56:57],v[6:7]
v_pk_mul_f32 v[58:59],v[58:59],v[6:7]
CV v240,v240,v241
CV v241,v242,v243
CV v242,v56,v57
CV v243,v58,v59
v_accvgpr_write_b32 a24,v240
v_accvgpr_write_b32 a25,v241
v_accvgpr_write_b32 a26,v242
v_accvgpr_write_b32 a27,v243
v_accvgpr_read_b32 v60,a244
v_accvgpr_read_b32 v61,a245
v_accvgpr_read_b32 v62,a246
v_accvgpr_read_b32 v63,a247
v_pk_mul_f32 v[244:245],v[244:245],v[6:7]
v_pk_mul_f32 v[246:247],v[246:247],v[6:7]
v_pk_mul_f32 v[60:61],v[60:61],v[6:7]
v_pk_mul_f32 v[62:63],v[62:63],v[6:7]
CV v244,v244,v245
CV v245,v246,v247
CV v246,v60,v61
CV v247,v62,v63
v_accvgpr_write_b32 a56,v244
v_accvgpr_write_b32 a57,v245
v_accvgpr_write_b32 a58,v246
v_accvgpr_write_b32 a59,v247
v_accvgpr_read_b32 v56,a248
v_accvgpr_read_b32 v57,a249
v_accvgpr_read_b32 v58,a250
v_accvgpr_read_b32 v59,a251
v_pk_mul_f32 v[248:249],v[248:249],v[6:7]
v_pk_mul_f32 v[250:251],v[250:251],v[6:7]
v_pk_mul_f32 v[56:57],v[56:57],v[6:7]
v_pk_mul_f32 v[58:59],v[58:59],v[6:7]
CV v248,v248,v249
CV v249,v250,v251
CV v250,v56,v57
CV v251,v58,v59
v_accvgpr_write_b32 a28,v248
v_accvgpr_write_b32 a29,v249
v_accvgpr_write_b32 a30,v250
v_accvgpr_write_b32 a31,v251
v_accvgpr_read_b32 v60,a252
v_accvgpr_read_b32 v61,a253
v_accvgpr_read_b32 v62,a254
v_accvgpr_read_b32 v63,a255
v_pk_mul_f32 v[252:253],v[252:253],v[6:7]
v_pk_mul_f32 v[254:255],v[254:255],v[6:7]
v_pk_mul_f32 v[60:61],v[60:61],v[6:7]
v_pk_mul_f32 v[62:63],v[62:63],v[6:7]
CV v252,v252,v253
CV v253,v254,v255
CV v254,v60,v61
CV v255,v62,v63
v_accvgpr_write_b32 a60,v252
v_accvgpr_write_b32 a61,v253
v_accvgpr_write_b32 a62,v254
v_accvgpr_write_b32 a63,v255
s_load_dwordx2 s[78:79],s[0:1],64
s_sub_u32 s53,15,s45
s_mov_b32 s49,0
s_cmp_gt_u32 s45,6
s_cselect_b32 s48,7,8
s_cmp_lt_u32 s45,6
s_cselect_b32 s50,20,16
s_mov_b32 s72,s12
s_mov_b32 s73,s13
s_mov_b32 s74,1048576
s_mov_b32 s75,0x20000
v_lshrrev_b32 v0,4,v4
v_add_u32 v1,66304,v4
v_mov_b32 v2,v4
v_mov_b32 v7,0xf149f2ca
v_and_b32 v12,15,v0
v_lshrrev_b32 v13,4,v0
v_lshlrev_b32 v13,2,v13
v_sub_u32 v12,v12,v13
s_lshl_b32 s46,s42,4
v_add_u32 v5,s46,v12
s_sub_u32 s46,48,s46
v_add_u32 v6,s46,v12
L_attn:
s_barrier
DR a[128:131],v1,33152
DR a[132:135],v1,34176
DR a[136:139],v1,35200
DR a[140:143],v1,36224
DR a[144:147],v1,37248
DR a[148:151],v1,38272
DR a[152:155],v1,39296
DR a[156:159],v1,40320
DR a[160:163],v1,41344
DR a[164:167],v1,42368
DR a[168:171],v1,43392
DR a[172:175],v1,44416
DR a[176:179],v1,45440
DR a[180:183],v1,46464
DR a[184:187],v1,47488
DR a[188:191],v1,48512
v_lshrrev_b32 v98,2,v4
v_and_b32 v98,28,v98
s_lshl_b32 s3,s43,7
buffer_load_dword v99,v98,s[24:27],s3 offen offset:32 sc1
s_bitcmp1_b32 s50,1
s_cselect_b32 s47,0,1000
v_add_u32 v100,s47,v5
s_waitcnt lgkmcnt(0)
M v[32:35],a[128:131],a[0:3],0
s_add_u32 s54,s76,0
s_lshl_b32 s46,s53,3
s_add_u32 s56,s46,s42
M v[32:35],a[132:135],a[4:7],v[32:35]
buffer_store_dwordx4 a[0:3],v4,s[72:75],s54 offen offset:0
M v[32:35],a[136:139],a[8:11],v[32:35]
s_add_u32 s57,s46,7
s_sub_u32 s57,s57,s42
s_mul_i32 s56,s56,229376
M v[32:35],a[140:143],a[12:15],v[32:35]
s_mul_i32 s57,s57,229376
s_lshl_b32 s46,s43,10
s_add_u32 s56,s56,s46
M v[32:35],a[144:147],a[16:19],v[32:35]
buffer_store_dwordx4 a[4:7],v4,s[72:75],s54 offen offset:1024
M v[32:35],a[148:151],a[20:23],v[32:35]
s_add_u32 s57,s57,s46
s_add_u32 s16,s82,50331648
s_addc_u32 s17,s83,0
M v[32:35],a[152:155],a[24:27],v[32:35]
s_mov_b32 s18,29360128
s_mov_b32 s19,0x20000
s_lshl_b32 s46,s43,3
M v[32:35],a[156:159],a[28:31],v[32:35]
buffer_store_dwordx4 a[8:11],v4,s[72:75],s54 offen offset:2048
M v[36:39],a[128:131],a[32:35],0
s_add_u32 s46,s46,s45
s_lshl_b32 s46,s46,17
DR a[128:131],v1,49536
M v[36:39],a[132:135],a[36:39],v[36:39]
s_lshl_b32 s47,s42,15
s_add_u32 s46,s46,s47
DR a[132:135],v1,50560
M v[36:39],a[136:139],a[40:43],v[36:39]
buffer_store_dwordx4 a[12:15],v4,s[72:75],s54 offen offset:3072
DR a[136:139],v1,51584
M v[36:39],a[140:143],a[44:47],v[36:39]
s_add_u32 s54,s76,4096
DR a[140:143],v1,52608
M v[36:39],a[144:147],a[48:51],v[36:39]
DR a[144:147],v1,53632
v_cmp_le_i32 s[58:59],0,v100
M v[36:39],a[148:151],a[52:55],v[36:39]
DR a[148:151],v1,54656
v_cmp_le_i32 s[60:61],1,v100
M v[36:39],a[152:155],a[56:59],v[36:39]
DR a[152:155],v1,55680
v_cmp_le_i32 s[62:63],2,v100
M v[36:39],a[156:159],a[60:63],v[36:39]
DR a[156:159],v1,56704
v_cmp_le_i32 s[64:65],3,v100
M v[40:43],a[160:163],a[0:3],0
buffer_store_dwordx4 a[16:19],v4,s[72:75],s54 offen offset:0
v_cndmask_b32 v32,v7,v32,s[58:59]
M v[40:43],a[164:167],a[4:7],v[40:43]
v_cndmask_b32 v33,v7,v33,s[60:61]
v_cndmask_b32 v34,v7,v34,s[62:63]
M v[40:43],a[168:171],a[8:11],v[40:43]
v_cndmask_b32 v35,v7,v35,s[64:65]
v_max3_f32 v96,v32,v33,v34
M v[40:43],a[172:175],a[12:15],v[40:43]
buffer_store_dwordx4 a[20:23],v4,s[72:75],s54 offen offset:1024
v_max_f32 v96,v96,v35
M v[40:43],a[176:179],a[16:19],v[40:43]
buffer_store_dwordx4 a[24:27],v4,s[72:75],s54 offen offset:2048
v_max3_f32 v97,v36,v37,v38
M v[40:43],a[180:183],a[20:23],v[40:43]
buffer_store_dwordx4 a[28:31],v4,s[72:75],s54 offen offset:3072
v_max_f32 v97,v97,v39
M v[40:43],a[184:187],a[24:27],v[40:43]
s_add_u32 s54,s77,0
s_add_u32 s20,s82,s46
s_addc_u32 s21,s83,0
M v[40:43],a[188:191],a[28:31],v[40:43]
buffer_store_dwordx4 a[32:35],v4,s[72:75],s54 offen offset:0
M v[44:47],a[160:163],a[32:35],0
s_add_u32 s20,s20,83886080
s_addc_u32 s21,s21,0
DR a[160:163],v1,57728
M v[44:47],a[164:167],a[36:39],v[44:47]
s_mov_b32 s22,32768
s_mov_b32 s23,0x20000
DR a[164:167],v1,58752
M v[44:47],a[168:171],a[40:43],v[44:47]
buffer_store_dwordx4 a[36:39],v4,s[72:75],s54 offen offset:1024
DR a[168:171],v1,59776
M v[44:47],a[172:175],a[44:47],v[44:47]
s_and_b32 s46,s50,12
s_cselect_b32 s22,32768,0
DR a[172:175],v1,60800
M v[44:47],a[176:179],a[48:51],v[44:47]
s_mov_b32 s51,0x4e800000
DR a[176:179],v1,61824
v_cmp_le_i32 s[58:59],16,v100
M v[44:47],a[180:183],a[52:55],v[44:47]
s_mov_b32 s84,0
DR a[180:183],v1,62848
v_cmp_le_i32 s[60:61],17,v100
M v[44:47],a[184:187],a[56:59],v[44:47]
s_mov_b32 s85,27648
DR a[184:187],v1,63872
v_cmp_le_i32 s[62:63],18,v100
M v[44:47],a[188:191],a[60:63],v[44:47]
s_waitcnt lgkmcnt(7)
DR a[188:191],v1,64896
v_cmp_le_i32 s[64:65],19,v100
M v[48:51],a[128:131],a[0:3],0
buffer_store_dwordx4 a[40:43],v4,s[72:75],s54 offen offset:2048
v_cndmask_b32 v40,v7,v40,s[58:59]
M v[48:51],a[132:135],a[4:7],v[48:51]
s_mov_b32 s86,55296
v_cndmask_b32 v41,v7,v41,s[60:61]
v_cndmask_b32 v42,v7,v42,s[62:63]
M v[48:51],a[136:139],a[8:11],v[48:51]
s_mov_b32 s87,82944
v_cndmask_b32 v43,v7,v43,s[64:65]
v_max3_f32 v96,v96,v40,v41
M v[48:51],a[140:143],a[12:15],v[48:51]
buffer_store_dwordx4 a[44:47],v4,s[72:75],s54 offen offset:3072
v_max3_f32 v96,v96,v42,v43
M v[48:51],a[144:147],a[16:19],v[48:51]
s_add_u32 s54,s77,4096
v_max3_f32 v97,v97,v44,v45
v_max3_f32 v97,v97,v46,v47
M v[48:51],a[148:151],a[20:23],v[48:51]
buffer_store_dwordx4 a[48:51],v4,s[72:75],s54 offen offset:0
M v[48:51],a[152:155],a[24:27],v[48:51]
buffer_store_dwordx4 a[52:55],v4,s[72:75],s54 offen offset:1024
M v[48:51],a[156:159],a[28:31],v[48:51]
buffer_store_dwordx4 a[56:59],v4,s[72:75],s54 offen offset:2048
M v[52:55],a[128:131],a[32:35],0
s_mov_b32 s88,114688
s_mov_b32 s89,142336
s_mov_b32 s90,169984
M v[52:55],a[132:135],a[36:39],v[52:55]
s_mov_b32 s91,197632
s_mul_i32 s67,s42,8224
s_lshl_b32 s46,s42,1
M v[52:55],a[136:139],a[40:43],v[52:55]
buffer_store_dwordx4 a[60:63],v4,s[72:75],s54 offen offset:3072
v_lshrrev_b32 v12,4,v0
M v[52:55],a[140:143],a[44:47],v[52:55]
v_lshlrev_b32 v12,3,v12
v_bfe_u32 v13,v0,3,1
M v[52:55],a[144:147],a[48:51],v[52:55]
v_add3_u32 v12,v12,v13,s46
v_mul_u32_u24 v12,896,v12
v_and_b32 v13,7,v0
v_lshl_add_u32 v120,v13,4,v12
v_bfe_u32 v12,v0,3,2
v_mul_u32_u24 v12,8224,v12
v_lshrrev_b32 v13,5,v0
v_lshl_add_u32 v12,v13,8,v12
v_bfe_u32 v13,v0,2,1
v_lshl_add_u32 v12,v13,7,v12
v_and_b32 v13,3,v0
v_lshl_add_u32 v122,v13,3,v12
v_add_u32 v121,66304,v122
v_bfe_u32 v24,v0,2,2
v_lshrrev_b32 v25,4,v0
v_cmp_eq_u32 vcc,v24,v25
v_and_b32 v24,1,v0
v_lshlrev_b32 v24,4,v24
v_mov_b32 v25,0x3f80
v_lshlrev_b32 v24,v24,v25
v_cndmask_b32 v24,0,v24,vcc
v_and_b32 v25,2,v0
v_cmp_eq_u32 vcc,0,v25
v_mov_b32 v26,0
s_nop 0
v_cndmask_b32 v25,0,v24,vcc
v_cndmask_b32 v24,v24,v26,vcc
v_accvgpr_write_b32 a192,v25
v_accvgpr_write_b32 a193,v24
v_accvgpr_write_b32 a194,v26
v_accvgpr_write_b32 a195,v26
v_accvgpr_write_b32 a196,v26
v_accvgpr_write_b32 a197,v26
v_accvgpr_write_b32 a198,v25
v_accvgpr_write_b32 a199,v24
M v[52:55],a[148:151],a[52:55],v[52:55]
s_mul_i32 s46,s43,229376
s_add_u32 s68,s78,s46
s_addc_u32 s69,s79,0
s_sub_u32 s70,3670016,s46
s_mov_b32 s71,0x20000
M v[52:55],a[152:155],a[56:59],v[52:55]
v_cmp_le_i32 s[58:59],32,v100
v_cmp_le_i32 s[60:61],33,v100
M v[52:55],a[156:159],a[60:63],v[52:55]
s_waitcnt vmcnt(17) lgkmcnt(0)
s_barrier
s_lshl_b32 s47,s45,4
s_and_b32 s54,s2,15
s_add_u32 s47,s47,s54
s_lshr_b32 s54,s47,3
s_mul_i32 s54,s54,120
s_add_u32 s47,s47,s54
s_add_u32 s47,s47,4096
s_bitcmp1_b32 s50,6
s_cbranch_scc0 L_nopub6
s_cmp_eq_u32 s42,0
s_cbranch_scc0 L_nopub6
s_mov_b64 exec,1
v_mov_b32 v14,1
buffer_store_byte v14,off,s[24:27],s47 offset:8 sc1
s_mov_b64 exec,-1
L_nopub6:
s_waitcnt vmcnt(16)
v_cmp_eq_u32 vcc,1,v99
s_nop 0
s_cmp_eq_u64 vcc,-1
s_cbranch_scc0 L_spin7
L_spun7:
s_bitcmp1_b32 s44,8
s_cbranch_scc1 L_acq7
L_acqd7:
M v[56:59],a[160:163],a[0:3],0
s_mov_b32 m0,s38
DR a[128:131],v1,0
v_cmp_le_i32 s[62:63],34,v100
M v[56:59],a[164:167],a[4:7],v[56:59]
DR a[132:135],v1,1024
v_cmp_le_i32 s[64:65],35,v100
M v[56:59],a[168:171],a[8:11],v[56:59]
DR a[136:139],v1,2048
v_cndmask_b32 v48,v7,v48,s[58:59]
M v[56:59],a[172:175],a[12:15],v[56:59]
DR a[140:143],v1,3072
v_cndmask_b32 v49,v7,v49,s[60:61]
M v[56:59],a[176:179],a[16:19],v[56:59]
DR a[144:147],v1,4096
v_cndmask_b32 v50,v7,v50,s[62:63]
M v[56:59],a[180:183],a[20:23],v[56:59]
DR a[148:151],v1,5120
v_cndmask_b32 v51,v7,v51,s[64:65]
M v[56:59],a[184:187],a[24:27],v[56:59]
DR a[152:155],v1,6144
v_max3_f32 v96,v96,v48,v49
M v[56:59],a[188:191],a[28:31],v[56:59]
DR a[156:159],v1,7168
v_max3_f32 v96,v96,v50,v51
M v[60:63],a[160:163],a[32:35],0
v_max3_f32 v97,v97,v52,v53
v_max3_f32 v97,v97,v54,v55
M v[60:63],a[164:167],a[36:39],v[60:63]
buffer_load_dwordx4 v3,s[8:11],s30 offen offset:0 sc1 lds
M v[60:63],a[168:171],a[40:43],v[60:63]
buffer_load_dwordx4 v3,s[8:11],s30 offen offset:1024 sc1 lds
M v[60:63],a[172:175],a[44:47],v[60:63]
buffer_load_dwordx4 v3,s[8:11],s30 offen offset:2048 sc1 lds
M v[60:63],a[176:179],a[48:51],v[60:63]
v_cmp_le_i32 s[58:59],48,v100
v_cmp_le_i32 s[60:61],49,v100
M v[60:63],a[180:183],a[52:55],v[60:63]
v_cmp_le_i32 s[62:63],50,v100
v_cmp_le_i32 s[64:65],51,v100
M v[60:63],a[184:187],a[56:59],v[60:63]
v_cndmask_b32 v56,v7,v56,s[58:59]
v_cndmask_b32 v57,v7,v57,s[60:61]
M v[60:63],a[188:191],a[60:63],v[60:63]
v_cndmask_b32 v58,v7,v58,s[62:63]
v_cndmask_b32 v59,v7,v59,s[64:65]
v_max3_f32 v96,v96,v56,v57
v_max3_f32 v96,v96,v58,v59
s_nop 3
v_max3_f32 v97,v97,v60,v61
v_max3_f32 v97,v97,v62,v63
buffer_load_dwordx4 v3,s[8:11],s30 offen offset:3072 sc1 lds
s_mov_b32 m0,s39
s_nop 0
buffer_load_dwordx4 v3,s[8:11],s31 offen offset:0 sc1 lds
buffer_load_dwordx4 v3,s[8:11],s31 offen offset:1024 sc1 lds
buffer_load_dwordx4 v3,s[8:11],s31 offen offset:2048 sc1 lds
buffer_load_dwordx4 v3,s[8:11],s31 offen offset:3072 sc1 lds
s_add_u32 s30,s30,32768
s_cmp_eq_u32 s30,s33
s_cselect_b32 s30,0,s30
s_add_u32 s31,s30,4096
v_mov_b32 v13,v96
v_mov_b32 v14,v97
s_nop 0
v_permlane16_swap_b32 v96,v13
v_permlane16_swap_b32 v97,v14
v_max_f32 v96,v96,v13
v_max_f32 v97,v97,v14
v_mov_b32 v13,v96
v_mov_b32 v14,v97
s_nop 0
v_permlane32_swap_b32 v96,v13
v_permlane32_swap_b32 v97,v14
v_max_f32 v96,v96,v13
v_max_f32 v97,v97,v14
v_sub_f32 v16,0,v96
v_sub_f32 v17,0,v96
v_sub_f32 v18,0,v96
v_sub_f32 v19,0,v96
v_sub_f32 v20,0,v97
v_sub_f32 v21,0,v97
v_sub_f32 v22,0,v97
v_sub_f32 v23,0,v97
v_pk_add_f32 v[32:33],v[32:33],v[16:17]
v_pk_add_f32 v[34:35],v[34:35],v[16:17]
v_exp_f32 v32,v32
v_exp_f32 v33,v33
v_exp_f32 v34,v34
v_exp_f32 v35,v35
s_mov_b32 m0,s34
s_nop 0
buffer_load_dwordx4 v3,s[4:7],s28 offen offset:0 sc1 lds
v_pk_add_f32 v[36:37],v[36:37],v[20:21]
v_pk_add_f32 v[38:39],v[38:39],v[20:21]
v_exp_f32 v36,v36
v_exp_f32 v37,v37
v_exp_f32 v38,v38
v_exp_f32 v39,v39
buffer_load_dwordx4 v3,s[4:7],s28 offen offset:1024 sc1 lds
buffer_load_dwordx4 v3,s[4:7],s28 offen offset:2048 sc1 lds
v_pk_add_f32 v[24:25],v[32:33],v[34:35]
CV v64,v32,v33
CV v65,v34,v35
v_pk_add_f32 v[26:27],v[36:37],v[38:39]
CV v68,v36,v37
CV v69,v38,v39
v_pk_add_f32 v[40:41],v[40:41],v[16:17]
v_pk_add_f32 v[42:43],v[42:43],v[16:17]
v_exp_f32 v40,v40
v_exp_f32 v41,v41
v_exp_f32 v42,v42
v_exp_f32 v43,v43
buffer_load_dwordx4 v3,s[4:7],s28 offen offset:3072 sc1 lds
s_mov_b32 m0,s35
v_pk_add_f32 v[44:45],v[44:45],v[20:21]
v_pk_add_f32 v[46:47],v[46:47],v[20:21]
v_exp_f32 v44,v44
v_exp_f32 v45,v45
v_exp_f32 v46,v46
v_exp_f32 v47,v47
buffer_load_dwordx4 v3,s[4:7],s29 offen offset:0 sc1 lds
buffer_load_dwordx4 v3,s[4:7],s29 offen offset:1024 sc1 lds
v_pk_add_f32 v[24:25],v[24:25],v[40:41]
v_pk_add_f32 v[24:25],v[24:25],v[42:43]
CV v66,v40,v41
CV v67,v42,v43
v_pk_add_f32 v[26:27],v[26:27],v[44:45]
v_pk_add_f32 v[26:27],v[26:27],v[46:47]
CV v70,v44,v45
CV v71,v46,v47
v_pk_add_f32 v[48:49],v[48:49],v[16:17]
v_pk_add_f32 v[50:51],v[50:51],v[16:17]
v_exp_f32 v48,v48
v_exp_f32 v49,v49
v_exp_f32 v50,v50
v_exp_f32 v51,v51
buffer_load_dwordx4 v3,s[4:7],s29 offen offset:2048 sc1 lds
buffer_load_dwordx4 v3,s[4:7],s29 offen offset:3072 sc1 lds
v_pk_add_f32 v[52:53],v[52:53],v[20:21]
v_pk_add_f32 v[54:55],v[54:55],v[20:21]
v_exp_f32 v52,v52
v_exp_f32 v53,v53
v_exp_f32 v54,v54
v_exp_f32 v55,v55
s_add_u32 s28,s28,32768
s_cmp_eq_u32 s28,s32
s_cselect_b32 s28,0,s28
v_pk_add_f32 v[24:25],v[24:25],v[48:49]
v_pk_add_f32 v[24:25],v[24:25],v[50:51]
CV v72,v48,v49
CV v73,v50,v51
v_pk_add_f32 v[26:27],v[26:27],v[52:53]
v_pk_add_f32 v[26:27],v[26:27],v[54:55]
CV v76,v52,v53
CV v77,v54,v55
v_pk_add_f32 v[56:57],v[56:57],v[16:17]
v_pk_add_f32 v[58:59],v[58:59],v[16:17]
v_exp_f32 v56,v56
v_exp_f32 v57,v57
v_exp_f32 v58,v58
v_exp_f32 v59,v59
s_add_u32 s29,s28,4096
v_pk_add_f32 v[60:61],v[60:61],v[20:21]
v_pk_add_f32 v[62:63],v[62:63],v[20:21]
v_exp_f32 v60,v60
v_exp_f32 v61,v61
v_exp_f32 v62,v62
v_exp_f32 v63,v63
v_pk_add_f32 v[24:25],v[24:25],v[56:57]
v_pk_add_f32 v[24:25],v[24:25],v[58:59]
CV v74,v56,v57
CV v75,v58,v59
v_pk_add_f32 v[26:27],v[26:27],v[60:61]
v_pk_add_f32 v[26:27],v[26:27],v[62:63]
CV v78,v60,v61
CV v79,v62,v63
v_add_f32 v8,v24,v25
v_add_f32 v9,v26,v27
s_waitcnt lgkmcnt(0)
s_bitcmp1_b32 s50,1
s_cbranch_scc1 L_d01z
M v[32:35],a[128:131],a[0:3],v[16:19]
s_mov_b32 m0,s40
DR a[160:163],v1,8192
M v[32:35],a[132:135],a[4:7],v[32:35]
buffer_load_dwordx4 v3,s[8:11],s30 offen offset:0 sc1 lds
M v[32:35],a[136:139],a[8:11],v[32:35]
DR a[164:167],v1,9216
M v[32:35],a[140:143],a[12:15],v[32:35]
DR a[168:171],v1,10240
M v[32:35],a[144:147],a[16:19],v[32:35]
DR a[172:175],v1,11264
M v[32:35],a[148:151],a[20:23],v[32:35]
DR a[176:179],v1,12288
M v[32:35],a[152:155],a[24:27],v[32:35]
buffer_load_dwordx4 v3,s[8:11],s30 offen offset:1024 sc1 lds
M v[32:35],a[156:159],a[28:31],v[32:35]
DR a[180:183],v1,13312
M v[36:39],a[128:131],a[32:35],v[20:23]
DR a[184:187],v1,14336
M v[36:39],a[132:135],a[36:39],v[36:39]
DR a[188:191],v1,15360
M v[36:39],a[136:139],a[40:43],v[36:39]
DR a[128:131],v1,16384
M v[36:39],a[140:143],a[44:47],v[36:39]
buffer_load_dwordx4 v3,s[8:11],s30 offen offset:2048 sc1 lds
M v[36:39],a[144:147],a[48:51],v[36:39]
v_exp_f32 v24,v32
M v[36:39],a[148:151],a[52:55],v[36:39]
v_exp_f32 v25,v33
M v[36:39],a[152:155],a[56:59],v[36:39]
v_exp_f32 v26,v34
M v[36:39],a[156:159],a[60:63],v[36:39]
s_waitcnt lgkmcnt(1)
v_exp_f32 v27,v35
M v[40:43],a[160:163],a[0:3],v[16:19]
buffer_load_dwordx4 v3,s[8:11],s30 offen offset:3072 sc1 lds
M v[40:43],a[164:167],a[4:7],v[40:43]
s_mov_b32 m0,s41
DR a[132:135],v1,17408
v_add_f32 v10,v24,v25
M v[40:43],a[168:171],a[8:11],v[40:43]
DR a[136:139],v1,18432
CV v80,v24,v25
M v[40:43],a[172:175],a[12:15],v[40:43]
DR a[140:143],v1,19456
v_add_f32 v10,v10,v26
M v[40:43],a[176:179],a[16:19],v[40:43]
DR a[144:147],v1,20480
v_add_f32 v10,v10,v27
M v[40:43],a[180:183],a[20:23],v[40:43]
buffer_load_dwordx4 v3,s[8:11],s31 offen offset:0 sc1 lds
M v[40:43],a[184:187],a[24:27],v[40:43]
DR a[148:151],v1,21504
CV v81,v26,v27
M v[40:43],a[188:191],a[28:31],v[40:43]
DR a[152:155],v1,22528
M v[44:47],a[160:163],a[32:35],v[20:23]
DR a[156:159],v1,23552
M v[44:47],a[164:167],a[36:39],v[44:47]
v_exp_f32 v28,v36
M v[44:47],a[168:171],a[40:43],v[44:47]
buffer_load_dwordx4 v3,s[8:11],s31 offen offset:1024 sc1 lds
M v[44:47],a[172:175],a[44:47],v[44:47]
v_exp_f32 v29,v37
M v[44:47],a[176:179],a[48:51],v[44:47]
v_exp_f32 v30,v38
M v[44:47],a[180:183],a[52:55],v[44:47]
v_exp_f32 v31,v39
M v[44:47],a[184:187],a[56:59],v[44:47]
DR a[160:163],v1,24576
v_add_f32 v12,v28,v29
M v[44:47],a[188:191],a[60:63],v[44:47]
s_waitcnt lgkmcnt(1)
DR a[164:167],v1,25600
CV v84,v28,v29
M v[48:51],a[128:131],a[0:3],v[16:19]
buffer_load_dwordx4 v3,s[8:11],s31 offen offset:2048 sc1 lds
M v[48:51],a[132:135],a[4:7],v[48:51]
DR a[168:171],v1,26624
v_add_f32 v12,v12,v30
M v[48:51],a[136:139],a[8:11],v[48:51]
DR a[172:175],v1,27648
v_add_f32 v12,v12,v31
M v[48:51],a[140:143],a[12:15],v[48:51]
DR a[176:179],v1,28672
CV v85,v30,v31
M v[48:51],a[144:147],a[16:19],v[48:51]
buffer_load_dwordx4 v3,s[8:11],s31 offen offset:3072 sc1 lds
M v[48:51],a[148:151],a[20:23],v[48:51]
s_add_u32 s30,s30,32768
DR a[180:183],v1,29696
M v[48:51],a[152:155],a[24:27],v[48:51]
s_cmp_eq_u32 s30,s33
s_cselect_b32 s30,0,s30
DR a[184:187],v1,30720
M v[48:51],a[156:159],a[28:31],v[48:51]
s_add_u32 s31,s30,4096
DR a[188:191],v1,31744
M v[52:55],a[128:131],a[32:35],v[20:23]
v_exp_f32 v112,v40
M v[52:55],a[132:135],a[36:39],v[52:55]
v_exp_f32 v113,v41
M v[52:55],a[136:139],a[40:43],v[52:55]
v_exp_f32 v114,v42
M v[52:55],a[140:143],a[44:47],v[52:55]
v_exp_f32 v115,v43
M v[52:55],a[144:147],a[48:51],v[52:55]
s_mov_b32 m0,s36
v_exp_f32 v116,v44
M v[52:55],a[148:151],a[52:55],v[52:55]
v_exp_f32 v117,v45
M v[52:55],a[152:155],a[56:59],v[52:55]
v_exp_f32 v118,v46
M v[52:55],a[156:159],a[60:63],v[52:55]
s_waitcnt vmcnt(16) lgkmcnt(0)
s_barrier
M v[56:59],a[160:163],a[0:3],v[16:19]
DR a[128:131],v2,0
v_add_f32 v10,v10,v112
M v[56:59],a[164:167],a[4:7],v[56:59]
DR a[132:135],v2,1024
v_add_f32 v10,v10,v113
M v[56:59],a[168:171],a[8:11],v[56:59]
buffer_load_dwordx4 v3,s[4:7],s28 offen offset:0 sc1 lds
M v[56:59],a[172:175],a[12:15],v[56:59]
DR a[136:139],v2,2048
CV v82,v112,v113
M v[56:59],a[176:179],a[16:19],v[56:59]
DR a[140:143],v2,3072
v_add_f32 v10,v10,v114
M v[56:59],a[180:183],a[20:23],v[56:59]
DR a[144:147],v2,4096
v_add_f32 v10,v10,v115
M v[56:59],a[184:187],a[24:27],v[56:59]
DR a[148:151],v2,5120
CV v83,v114,v115
M v[56:59],a[188:191],a[28:31],v[56:59]
DR a[152:155],v2,6144
v_add_f32 v12,v12,v116
M v[60:63],a[160:163],a[32:35],v[20:23]
v_exp_f32 v119,v47
M v[60:63],a[164:167],a[36:39],v[60:63]
DR a[156:159],v2,7168
v_add_f32 v12,v12,v117
M v[60:63],a[168:171],a[40:43],v[60:63]
buffer_load_dwordx4 v3,s[4:7],s28 offen offset:1024 sc1 lds
M v[60:63],a[172:175],a[44:47],v[60:63]
DR a[160:163],v2,8192
CV v86,v116,v117
M v[60:63],a[176:179],a[48:51],v[60:63]
DR a[164:167],v2,9216
v_add_f32 v12,v12,v118
M v[60:63],a[180:183],a[52:55],v[60:63]
DR a[168:171],v2,10240
v_add_f32 v12,v12,v119
M v[60:63],a[184:187],a[56:59],v[60:63]
buffer_load_dwordx4 v3,s[4:7],s28 offen offset:2048 sc1 lds
M v[60:63],a[188:191],a[60:63],v[60:63]
s_waitcnt lgkmcnt(3)
DR a[172:175],v2,11264
CV v87,v118,v119
M v[128:131],a[128:131],v[64:67],0
v_exp_f32 v24,v48
M v[128:131],a[132:135],v[72:75],v[128:131]
DR a[176:179],v2,12288
v_add_f32 v10,v10,v24
M v[132:135],a[132:135],v[76:79],0
v_exp_f32 v25,v49
M v[132:135],a[128:131],v[68:71],v[132:135]
v_exp_f32 v26,v50
M v[136:139],a[136:139],v[64:67],0
buffer_load_dwordx4 v3,s[4:7],s28 offen offset:3072 sc1 lds
M v[136:139],a[140:143],v[72:75],v[136:139]
s_mov_b32 m0,s37
v_exp_f32 v27,v51
M v[140:143],a[140:143],v[76:79],0
DR a[180:183],v2,13312
v_add_f32 v10,v10,v25
M v[140:143],a[136:139],v[68:71],v[140:143]
DR a[184:187],v2,14336
CV v88,v24,v25
M v[144:147],a[144:147],v[64:67],0
DR a[188:191],v2,15360
v_add_f32 v10,v10,v26
M v[144:147],a[148:151],v[72:75],v[144:147]
DR a[128:131],v2,16384
v_add_f32 v10,v10,v27
M v[148:151],a[148:151],v[76:79],0
buffer_load_dwordx4 v3,s[4:7],s29 offen offset:0 sc1 lds
M v[148:151],a[144:147],v[68:71],v[148:151]
v_exp_f32 v28,v52
M v[152:155],a[152:155],v[64:67],0
DR a[132:135],v2,17408
CV v89,v26,v27
M v[152:155],a[156:159],v[72:75],v[152:155]
v_exp_f32 v29,v53
M v[156:159],a[156:159],v[76:79],0
v_exp_f32 v30,v54
M v[156:159],a[152:155],v[68:71],v[156:159]
s_waitcnt lgkmcnt(2)
v_exp_f32 v31,v55
M v[160:163],a[160:163],v[64:67],0
buffer_load_dwordx4 v3,s[4:7],s29 offen offset:1024 sc1 lds
M v[160:163],a[164:167],v[72:75],v[160:163]
DR a[136:139],v2,18432
v_add_f32 v12,v12,v28
M v[164:167],a[164:167],v[76:79],0
DR a[140:143],v2,19456
v_add_f32 v12,v12,v29
M v[164:167],a[160:163],v[68:71],v[164:167]
DR a[144:147],v2,20480
CV v92,v28,v29
M v[168:171],a[168:171],v[64:67],0
DR a[148:151],v2,21504
v_add_f32 v12,v12,v30
M v[168:171],a[172:175],v[72:75],v[168:171]
DR a[152:155],v2,22528
v_add_f32 v12,v12,v31
M v[172:175],a[172:175],v[76:79],0
buffer_load_dwordx4 v3,s[4:7],s29 offen offset:2048 sc1 lds
M v[172:175],a[168:171],v[68:71],v[172:175]
DR a[156:159],v2,23552
CV v93,v30,v31
M v[176:179],a[176:179],v[64:67],0
v_exp_f32 v112,v56
M v[176:179],a[180:183],v[72:75],v[176:179]
v_exp_f32 v113,v57
M v[180:183],a[180:183],v[76:79],0
v_exp_f32 v114,v58
M v[180:183],a[176:179],v[68:71],v[180:183]
v_exp_f32 v115,v59
M v[184:187],a[184:187],v[64:67],0
buffer_load_dwordx4 v3,s[4:7],s29 offen offset:3072 sc1 lds
M v[184:187],a[188:191],v[72:75],v[184:187]
s_add_u32 s28,s28,32768
DR a[160:163],v2,24576
v_add_f32 v10,v10,v112
M v[188:191],a[188:191],v[76:79],0
DR a[164:167],v2,25600
v_add_f32 v10,v10,v113
M v[188:191],a[184:187],v[68:71],v[188:191]
s_waitcnt lgkmcnt(2)
DR a[168:171],v2,26624
CV v90,v112,v113
M v[192:195],a[128:131],v[64:67],0
DR a[172:175],v2,27648
v_add_f32 v10,v10,v114
M v[192:195],a[132:135],v[72:75],v[192:195]
DR a[176:179],v2,28672
v_add_f32 v10,v10,v115
M v[196:199],a[132:135],v[76:79],0
DR a[180:183],v2,29696
CV v91,v114,v115
M v[196:199],a[128:131],v[68:71],v[196:199]
s_cmp_eq_u32 s28,s32
s_cselect_b32 s28,0,s28
DR a[184:187],v2,30720
M v[200:203],a[136:139],v[64:67],0
s_add_u32 s29,s28,4096
DR a[188:191],v2,31744
M v[200:203],a[140:143],v[72:75],v[200:203]
v_exp_f32 v116,v60
M v[204:207],a[140:143],v[76:79],0
v_exp_f32 v117,v61
M v[204:207],a[136:139],v[68:71],v[204:207]
v_exp_f32 v118,v62
M v[208:211],a[144:147],v[64:67],0
v_exp_f32 v119,v63
M v[208:211],a[148:151],v[72:75],v[208:211]
v_add_f32 v12,v12,v116
v_add_f32 v12,v12,v117
M v[212:215],a[148:151],v[76:79],0
CV v94,v116,v117
v_add_f32 v12,v12,v118
M v[212:215],a[144:147],v[68:71],v[212:215]
v_add_f32 v12,v12,v119
CV v95,v118,v119
M v[216:219],a[152:155],v[64:67],0
v_max_f32 v13,v10,v12
v_cmp_nge_f32 vcc,s51,v13
M v[216:219],a[156:159],v[72:75],v[216:219]
M v[220:223],a[156:159],v[76:79],0
M v[220:223],a[152:155],v[68:71],v[220:223]
s_waitcnt vmcnt(16) lgkmcnt(0)
s_barrier
s_bitcmp1_b32 s50,4
s_cbranch_scc0 L_nopub7
s_cmp_eq_u32 s42,0
s_cbranch_scc0 L_nopub7
s_bitcmp1_b32 s44,8
s_cbranch_scc1 L_rel7
L_reld7:
s_mov_b64 exec,1
v_mov_b32 v98,1
buffer_store_dword v98,off,s[24:27],s55 offset:64 sc1
s_mov_b64 exec,-1
L_nopub7:
M v[224:227],a[160:163],v[64:67],0
DR a[128:131],v1,33152
M v[224:227],a[164:167],v[72:75],v[224:227]
DR a[132:135],v1,34176
M v[228:231],a[164:167],v[76:79],0
DR a[136:139],v1,35200
M v[228:231],a[160:163],v[68:71],v[228:231]
DR a[140:143],v1,36224
M v[232:235],a[168:171],v[64:67],0
DR a[144:147],v1,37248
M v[232:235],a[172:175],v[72:75],v[232:235]
DR a[148:151],v1,38272
M v[236:239],a[172:175],v[76:79],0
DR a[152:155],v1,39296
M v[236:239],a[168:171],v[68:71],v[236:239]
DR a[156:159],v1,40320
M v[240:243],a[176:179],v[64:67],0
M v[240:243],a[180:183],v[72:75],v[240:243]
M v[244:247],a[180:183],v[76:79],0
M v[244:247],a[176:179],v[68:71],v[244:247]
M v[248:251],a[184:187],v[64:67],0
M v[248:251],a[188:191],v[72:75],v[248:251]
M v[252:255],a[188:191],v[76:79],0
M v[252:255],a[184:187],v[68:71],v[252:255]
s_waitcnt lgkmcnt(0)
s_cbranch_vccnz L_rare0
L_ret0:
v_add_f32 v8,v8,v10
v_add_f32 v9,v9,v12
L_lentry:
s_cmp_eq_u32 s48,0
s_cbranch_scc1 L_lexit
.p2align 4
L_loop:
M v[32:35],a[128:131],a[0:3],v[16:19]
s_mov_b32 m0,s38
DR a[160:163],v1,41344
M v[32:35],a[132:135],a[4:7],v[32:35]
buffer_load_dwordx4 v3,s[8:11],s30 offen offset:0 sc1 lds
M v[32:35],a[136:139],a[8:11],v[32:35]
DR a[164:167],v1,42368
M v[32:35],a[140:143],a[12:15],v[32:35]
DR a[168:171],v1,43392
M v[32:35],a[144:147],a[16:19],v[32:35]
DR a[172:175],v1,44416
M v[32:35],a[148:151],a[20:23],v[32:35]
DR a[176:179],v1,45440
M v[32:35],a[152:155],a[24:27],v[32:35]
buffer_load_dwordx4 v3,s[8:11],s30 offen offset:1024 sc1 lds
M v[32:35],a[156:159],a[28:31],v[32:35]
DR a[180:183],v1,46464
M v[36:39],a[128:131],a[32:35],v[20:23]
DR a[184:187],v1,47488
M v[36:39],a[132:135],a[36:39],v[36:39]
DR a[188:191],v1,48512
M v[36:39],a[136:139],a[40:43],v[36:39]
DR a[128:131],v1,49536
M v[36:39],a[140:143],a[44:47],v[36:39]
buffer_load_dwordx4 v3,s[8:11],s30 offen offset:2048 sc1 lds
M v[36:39],a[144:147],a[48:51],v[36:39]
v_exp_f32 v24,v32
M v[36:39],a[148:151],a[52:55],v[36:39]
v_exp_f32 v25,v33
M v[36:39],a[152:155],a[56:59],v[36:39]
v_exp_f32 v26,v34
M v[36:39],a[156:159],a[60:63],v[36:39]
s_waitcnt lgkmcnt(1)
v_exp_f32 v27,v35
M v[40:43],a[160:163],a[0:3],v[16:19]
buffer_load_dwordx4 v3,s[8:11],s30 offen offset:3072 sc1 lds
M v[40:43],a[164:167],a[4:7],v[40:43]
s_mov_b32 m0,s39
DR a[132:135],v1,50560
v_add_f32 v10,v24,v25
M v[40:43],a[168:171],a[8:11],v[40:43]
DR a[136:139],v1,51584
CV v64,v24,v25
M v[40:43],a[172:175],a[12:15],v[40:43]
DR a[140:143],v1,52608
v_add_f32 v10,v10,v26
M v[40:43],a[176:179],a[16:19],v[40:43]
DR a[144:147],v1,53632
v_add_f32 v10,v10,v27
M v[40:43],a[180:183],a[20:23],v[40:43]
buffer_load_dwordx4 v3,s[8:11],s31 offen offset:0 sc1 lds
M v[40:43],a[184:187],a[24:27],v[40:43]
DR a[148:151],v1,54656
CV v65,v26,v27
M v[40:43],a[188:191],a[28:31],v[40:43]
DR a[152:155],v1,55680
M v[44:47],a[160:163],a[32:35],v[20:23]
DR a[156:159],v1,56704
M v[44:47],a[164:167],a[36:39],v[44:47]
v_exp_f32 v28,v36
M v[44:47],a[168:171],a[40:43],v[44:47]
buffer_load_dwordx4 v3,s[8:11],s31 offen offset:1024 sc1 lds
M v[44:47],a[172:175],a[44:47],v[44:47]
v_exp_f32 v29,v37
M v[44:47],a[176:179],a[48:51],v[44:47]
v_exp_f32 v30,v38
M v[44:47],a[180:183],a[52:55],v[44:47]
v_exp_f32 v31,v39
M v[44:47],a[184:187],a[56:59],v[44:47]
DR a[160:163],v1,57728
v_add_f32 v12,v28,v29
M v[44:47],a[188:191],a[60:63],v[44:47]
s_waitcnt lgkmcnt(1)
DR a[164:167],v1,58752
CV v68,v28,v29
M v[48:51],a[128:131],a[0:3],v[16:19]
buffer_load_dwordx4 v3,s[8:11],s31 offen offset:2048 sc1 lds
M v[48:51],a[132:135],a[4:7],v[48:51]
DR a[168:171],v1,59776
v_add_f32 v12,v12,v30
M v[48:51],a[136:139],a[8:11],v[48:51]
DR a[172:175],v1,60800
v_add_f32 v12,v12,v31
M v[48:51],a[140:143],a[12:15],v[48:51]
DR a[176:179],v1,61824
CV v69,v30,v31
M v[48:51],a[144:147],a[16:19],v[48:51]
buffer_load_dwordx4 v3,s[8:11],s31 offen offset:3072 sc1 lds
M v[48:51],a[148:151],a[20:23],v[48:51]
s_add_u32 s30,s30,32768
DR a[180:183],v1,62848
M v[48:51],a[152:155],a[24:27],v[48:51]
s_cmp_eq_u32 s30,s33
s_cselect_b32 s30,0,s30
DR a[184:187],v1,63872
M v[48:51],a[156:159],a[28:31],v[48:51]
s_add_u32 s31,s30,4096
DR a[188:191],v1,64896
M v[52:55],a[128:131],a[32:35],v[20:23]
v_exp_f32 v112,v40
M v[52:55],a[132:135],a[36:39],v[52:55]
v_exp_f32 v113,v41
M v[52:55],a[136:139],a[40:43],v[52:55]
v_exp_f32 v114,v42
M v[52:55],a[140:143],a[44:47],v[52:55]
v_exp_f32 v115,v43
M v[52:55],a[144:147],a[48:51],v[52:55]
s_mov_b32 m0,s34
v_exp_f32 v116,v44
M v[52:55],a[148:151],a[52:55],v[52:55]
v_exp_f32 v117,v45
M v[52:55],a[152:155],a[56:59],v[52:55]
v_exp_f32 v118,v46
M v[52:55],a[156:159],a[60:63],v[52:55]
s_waitcnt vmcnt(16) lgkmcnt(0)
s_barrier
M v[56:59],a[160:163],a[0:3],v[16:19]
DR a[128:131],v2,33152
v_add_f32 v10,v10,v112
M v[56:59],a[164:167],a[4:7],v[56:59]
DR a[132:135],v2,34176
v_add_f32 v10,v10,v113
M v[56:59],a[168:171],a[8:11],v[56:59]
buffer_load_dwordx4 v3,s[4:7],s28 offen offset:0 sc1 lds
M v[56:59],a[172:175],a[12:15],v[56:59]
DR a[136:139],v2,35200
CV v66,v112,v113
M v[56:59],a[176:179],a[16:19],v[56:59]
DR a[140:143],v2,36224
v_add_f32 v10,v10,v114
M v[56:59],a[180:183],a[20:23],v[56:59]
DR a[144:147],v2,37248
v_add_f32 v10,v10,v115
M v[56:59],a[184:187],a[24:27],v[56:59]
DR a[148:151],v2,38272
CV v67,v114,v115
M v[56:59],a[188:191],a[28:31],v[56:59]
DR a[152:155],v2,39296
v_add_f32 v12,v12,v116
M v[60:63],a[160:163],a[32:35],v[20:23]
v_exp_f32 v119,v47
M v[60:63],a[164:167],a[36:39],v[60:63]
DR a[156:159],v2,40320
v_add_f32 v12,v12,v117
M v[60:63],a[168:171],a[40:43],v[60:63]
buffer_load_dwordx4 v3,s[4:7],s28 offen offset:1024 sc1 lds
M v[60:63],a[172:175],a[44:47],v[60:63]
DR a[160:163],v2,41344
CV v70,v116,v117
M v[60:63],a[176:179],a[48:51],v[60:63]
DR a[164:167],v2,42368
v_add_f32 v12,v12,v118
M v[60:63],a[180:183],a[52:55],v[60:63]
DR a[168:171],v2,43392
v_add_f32 v12,v12,v119
M v[60:63],a[184:187],a[56:59],v[60:63]
buffer_load_dwordx4 v3,s[4:7],s28 offen offset:2048 sc1 lds
M v[60:63],a[188:191],a[60:63],v[60:63]
s_waitcnt lgkmcnt(3)
DR a[172:175],v2,44416
CV v71,v118,v119
M v[128:131],a[128:131],v[80:83],v[128:131]
v_exp_f32 v24,v48
M v[128:131],a[132:135],v[88:91],v[128:131]
DR a[176:179],v2,45440
v_add_f32 v10,v10,v24
M v[132:135],a[132:135],v[92:95],v[132:135]
v_exp_f32 v25,v49
M v[132:135],a[128:131],v[84:87],v[132:135]
v_exp_f32 v26,v50
M v[136:139],a[136:139],v[80:83],v[136:139]
buffer_load_dwordx4 v3,s[4:7],s28 offen offset:3072 sc1 lds
M v[136:139],a[140:143],v[88:91],v[136:139]
s_mov_b32 m0,s35
v_exp_f32 v27,v51
M v[140:143],a[140:143],v[92:95],v[140:143]
DR a[180:183],v2,46464
v_add_f32 v10,v10,v25
M v[140:143],a[136:139],v[84:87],v[140:143]
DR a[184:187],v2,47488
CV v72,v24,v25
M v[144:147],a[144:147],v[80:83],v[144:147]
DR a[188:191],v2,48512
v_add_f32 v10,v10,v26
M v[144:147],a[148:151],v[88:91],v[144:147]
DR a[128:131],v2,49536
v_add_f32 v10,v10,v27
M v[148:151],a[148:151],v[92:95],v[148:151]
buffer_load_dwordx4 v3,s[4:7],s29 offen offset:0 sc1 lds
M v[148:151],a[144:147],v[84:87],v[148:151]
v_exp_f32 v28,v52
M v[152:155],a[152:155],v[80:83],v[152:155]
DR a[132:135],v2,50560
CV v73,v26,v27
M v[152:155],a[156:159],v[88:91],v[152:155]
v_exp_f32 v29,v53
M v[156:159],a[156:159],v[92:95],v[156:159]
v_exp_f32 v30,v54
M v[156:159],a[152:155],v[84:87],v[156:159]
s_waitcnt lgkmcnt(2)
v_exp_f32 v31,v55
M v[160:163],a[160:163],v[80:83],v[160:163]
buffer_load_dwordx4 v3,s[4:7],s29 offen offset:1024 sc1 lds
M v[160:163],a[164:167],v[88:91],v[160:163]
DR a[136:139],v2,51584
v_add_f32 v12,v12,v28
M v[164:167],a[164:167],v[92:95],v[164:167]
DR a[140:143],v2,52608
v_add_f32 v12,v12,v29
M v[164:167],a[160:163],v[84:87],v[164:167]
DR a[144:147],v2,53632
CV v76,v28,v29
M v[168:171],a[168:171],v[80:83],v[168:171]
DR a[148:151],v2,54656
v_add_f32 v12,v12,v30
M v[168:171],a[172:175],v[88:91],v[168:171]
DR a[152:155],v2,55680
v_add_f32 v12,v12,v31
M v[172:175],a[172:175],v[92:95],v[172:175]
buffer_load_dwordx4 v3,s[4:7],s29 offen offset:2048 sc1 lds
M v[172:175],a[168:171],v[84:87],v[172:175]
DR a[156:159],v2,56704
CV v77,v30,v31
M v[176:179],a[176:179],v[80:83],v[176:179]
v_exp_f32 v112,v56
M v[176:179],a[180:183],v[88:91],v[176:179]
v_exp_f32 v113,v57
M v[180:183],a[180:183],v[92:95],v[180:183]
v_exp_f32 v114,v58
M v[180:183],a[176:179],v[84:87],v[180:183]
v_exp_f32 v115,v59
M v[184:187],a[184:187],v[80:83],v[184:187]
buffer_load_dwordx4 v3,s[4:7],s29 offen offset:3072 sc1 lds
M v[184:187],a[188:191],v[88:91],v[184:187]
s_add_u32 s28,s28,32768
DR a[160:163],v2,57728
v_add_f32 v10,v10,v112
M v[188:191],a[188:191],v[92:95],v[188:191]
DR a[164:167],v2,58752
v_add_f32 v10,v10,v113
M v[188:191],a[184:187],v[84:87],v[188:191]
s_waitcnt lgkmcnt(2)
DR a[168:171],v2,59776
CV v74,v112,v113
M v[192:195],a[128:131],v[80:83],v[192:195]
DR a[172:175],v2,60800
v_add_f32 v10,v10,v114
M v[192:195],a[132:135],v[88:91],v[192:195]
DR a[176:179],v2,61824
v_add_f32 v10,v10,v115
M v[196:199],a[132:135],v[92:95],v[196:199]
DR a[180:183],v2,62848
CV v75,v114,v115
M v[196:199],a[128:131],v[84:87],v[196:199]
s_cmp_eq_u32 s28,s32
s_cselect_b32 s28,0,s28
DR a[184:187],v2,63872
M v[200:203],a[136:139],v[80:83],v[200:203]
s_add_u32 s29,s28,4096
DR a[188:191],v2,64896
M v[200:203],a[140:143],v[88:91],v[200:203]
v_exp_f32 v116,v60
M v[204:207],a[140:143],v[92:95],v[204:207]
v_exp_f32 v117,v61
M v[204:207],a[136:139],v[84:87],v[204:207]
v_exp_f32 v118,v62
M v[208:211],a[144:147],v[80:83],v[208:211]
v_exp_f32 v119,v63
M v[208:211],a[148:151],v[88:91],v[208:211]
v_add_f32 v12,v12,v116
v_add_f32 v12,v12,v117
M v[212:215],a[148:151],v[92:95],v[212:215]
CV v78,v116,v117
v_add_f32 v12,v12,v118
M v[212:215],a[144:147],v[84:87],v[212:215]
v_add_f32 v12,v12,v119
CV v79,v118,v119
M v[216:219],a[152:155],v[80:83],v[216:219]
v_max_f32 v13,v10,v12
v_cmp_nge_f32 vcc,s51,v13
M v[216:219],a[156:159],v[88:91],v[216:219]
M v[220:223],a[156:159],v[92:95],v[220:223]
M v[220:223],a[152:155],v[84:87],v[220:223]
s_waitcnt vmcnt(16) lgkmcnt(0)
s_barrier
M v[224:227],a[160:163],v[80:83],v[224:227]
DR a[128:131],v1,0
M v[224:227],a[164:167],v[88:91],v[224:227]
DR a[132:135],v1,1024
M v[228:231],a[164:167],v[92:95],v[228:231]
DR a[136:139],v1,2048
M v[228:231],a[160:163],v[84:87],v[228:231]
DR a[140:143],v1,3072
M v[232:235],a[168:171],v[80:83],v[232:235]
DR a[144:147],v1,4096
M v[232:235],a[172:175],v[88:91],v[232:235]
DR a[148:151],v1,5120
M v[236:239],a[172:175],v[92:95],v[236:239]
DR a[152:155],v1,6144
M v[236:239],a[168:171],v[84:87],v[236:239]
DR a[156:159],v1,7168
M v[240:243],a[176:179],v[80:83],v[240:243]
s_sub_u32 s48,s48,1
M v[240:243],a[180:183],v[88:91],v[240:243]
M v[244:247],a[180:183],v[92:95],v[244:247]
M v[244:247],a[176:179],v[84:87],v[244:247]
M v[248:251],a[184:187],v[80:83],v[248:251]
M v[248:251],a[188:191],v[88:91],v[248:251]
M v[252:255],a[188:191],v[92:95],v[252:255]
M v[252:255],a[184:187],v[84:87],v[252:255]
s_waitcnt lgkmcnt(0)
s_cbranch_vccnz L_rare1
L_ret1:
M v[32:35],a[128:131],a[0:3],v[16:19]
s_mov_b32 m0,s40
DR a[160:163],v1,8192
v_add_f32 v8,v8,v10
M v[32:35],a[132:135],a[4:7],v[32:35]
buffer_load_dwordx4 v3,s[8:11],s30 offen offset:0 sc1 lds
M v[32:35],a[136:139],a[8:11],v[32:35]
DR a[164:167],v1,9216
v_add_f32 v9,v9,v12
M v[32:35],a[140:143],a[12:15],v[32:35]
DR a[168:171],v1,10240
M v[32:35],a[144:147],a[16:19],v[32:35]
DR a[172:175],v1,11264
M v[32:35],a[148:151],a[20:23],v[32:35]
DR a[176:179],v1,12288
M v[32:35],a[152:155],a[24:27],v[32:35]
buffer_load_dwordx4 v3,s[8:11],s30 offen offset:1024 sc1 lds
M v[32:35],a[156:159],a[28:31],v[32:35]
DR a[180:183],v1,13312
M v[36:39],a[128:131],a[32:35],v[20:23]
DR a[184:187],v1,14336
M v[36:39],a[132:135],a[36:39],v[36:39]
DR a[188:191],v1,15360
M v[36:39],a[136:139],a[40:43],v[36:39]
DR a[128:131],v1,16384
M v[36:39],a[140:143],a[44:47],v[36:39]
buffer_load_dwordx4 v3,s[8:11],s30 offen offset:2048 sc1 lds
M v[36:39],a[144:147],a[48:51],v[36:39]
v_exp_f32 v24,v32
M v[36:39],a[148:151],a[52:55],v[36:39]
v_exp_f32 v25,v33
M v[36:39],a[152:155],a[56:59],v[36:39]
v_exp_f32 v26,v34
M v[36:39],a[156:159],a[60:63],v[36:39]
s_waitcnt lgkmcnt(1)
v_exp_f32 v27,v35
M v[40:43],a[160:163],a[0:3],v[16:19]
buffer_load_dwordx4 v3,s[8:11],s30 offen offset:3072 sc1 lds
M v[40:43],a[164:167],a[4:7],v[40:43]
s_mov_b32 m0,s41
DR a[132:135],v1,17408
v_add_f32 v10,v24,v25
M v[40:43],a[168:171],a[8:11],v[40:43]
DR a[136:139],v1,18432
CV v80,v24,v25
M v[40:43],a[172:175],a[12:15],v[40:43]
DR a[140:143],v1,19456
v_add_f32 v10,v10,v26
M v[40:43],a[176:179],a[16:19],v[40:43]
DR a[144:147],v1,20480
v_add_f32 v10,v10,v27
M v[40:43],a[180:183],a[20:23],v[40:43]
buffer_load_dwordx4 v3,s[8:11],s31 offen offset:0 sc1 lds
M v[40:43],a[184:187],a[24:27],v[40:43]
DR a[148:151],v1,21504
CV v81,v26,v27
M v[40:43],a[188:191],a[28:31],v[40:43]
DR a[152:155],v1,22528
M v[44:47],a[160:163],a[32:35],v[20:23]
DR a[156:159],v1,23552
M v[44:47],a[164:167],a[36:39],v[44:47]
v_exp_f32 v28,v36
M v[44:47],a[168:171],a[40:43],v[44:47]
buffer_load_dwordx4 v3,s[8:11],s31 offen offset:1024 sc1 lds
M v[44:47],a[172:175],a[44:47],v[44:47]
v_exp_f32 v29,v37
M v[44:47],a[176:179],a[48:51],v[44:47]
v_exp_f32 v30,v38
M v[44:47],a[180:183],a[52:55],v[44:47]
v_exp_f32 v31,v39
M v[44:47],a[184:187],a[56:59],v[44:47]
DR a[160:163],v1,24576
v_add_f32 v12,v28,v29
M v[44:47],a[188:191],a[60:63],v[44:47]
s_waitcnt lgkmcnt(1)
DR a[164:167],v1,25600
CV v84,v28,v29
M v[48:51],a[128:131],a[0:3],v[16:19]
buffer_load_dwordx4 v3,s[8:11],s31 offen offset:2048 sc1 lds
M v[48:51],a[132:135],a[4:7],v[48:51]
DR a[168:171],v1,26624
v_add_f32 v12,v12,v30
M v[48:51],a[136:139],a[8:11],v[48:51]
DR a[172:175],v1,27648
v_add_f32 v12,v12,v31
M v[48:51],a[140:143],a[12:15],v[48:51]
DR a[176:179],v1,28672
CV v85,v30,v31
M v[48:51],a[144:147],a[16:19],v[48:51]
buffer_load_dwordx4 v3,s[8:11],s31 offen offset:3072 sc1 lds
M v[48:51],a[148:151],a[20:23],v[48:51]
s_add_u32 s30,s30,32768
DR a[180:183],v1,29696
M v[48:51],a[152:155],a[24:27],v[48:51]
s_cmp_eq_u32 s30,s33
s_cselect_b32 s30,0,s30
DR a[184:187],v1,30720
M v[48:51],a[156:159],a[28:31],v[48:51]
s_add_u32 s31,s30,4096
DR a[188:191],v1,31744
M v[52:55],a[128:131],a[32:35],v[20:23]
v_exp_f32 v112,v40
M v[52:55],a[132:135],a[36:39],v[52:55]
v_exp_f32 v113,v41
M v[52:55],a[136:139],a[40:43],v[52:55]
v_exp_f32 v114,v42
M v[52:55],a[140:143],a[44:47],v[52:55]
v_exp_f32 v115,v43
M v[52:55],a[144:147],a[48:51],v[52:55]
s_mov_b32 m0,s36
v_exp_f32 v116,v44
M v[52:55],a[148:151],a[52:55],v[52:55]
v_exp_f32 v117,v45
M v[52:55],a[152:155],a[56:59],v[52:55]
v_exp_f32 v118,v46
M v[52:55],a[156:159],a[60:63],v[52:55]
s_waitcnt vmcnt(16) lgkmcnt(0)
s_barrier
M v[56:59],a[160:163],a[0:3],v[16:19]
DR a[128:131],v2,0
v_add_f32 v10,v10,v112
M v[56:59],a[164:167],a[4:7],v[56:59]
DR a[132:135],v2,1024
v_add_f32 v10,v10,v113
M v[56:59],a[168:171],a[8:11],v[56:59]
buffer_load_dwordx4 v3,s[4:7],s28 offen offset:0 sc1 lds
M v[56:59],a[172:175],a[12:15],v[56:59]
DR a[136:139],v2,2048
CV v82,v112,v113
M v[56:59],a[176:179],a[16:19],v[56:59]
DR a[140:143],v2,3072
v_add_f32 v10,v10,v114
M v[56:59],a[180:183],a[20:23],v[56:59]
DR a[144:147],v2,4096
v_add_f32 v10,v10,v115
M v[56:59],a[184:187],a[24:27],v[56:59]
DR a[148:151],v2,5120
CV v83,v114,v115
M v[56:59],a[188:191],a[28:31],v[56:59]
DR a[152:155],v2,6144
v_add_f32 v12,v12,v116
M v[60:63],a[160:163],a[32:35],v[20:23]
v_exp_f32 v119,v47
M v[60:63],a[164:167],a[36:39],v[60:63]
DR a[156:159],v2,7168
v_add_f32 v12,v12,v117
M v[60:63],a[168:171],a[40:43],v[60:63]
buffer_load_dwordx4 v3,s[4:7],s28 offen offset:1024 sc1 lds
M v[60:63],a[172:175],a[44:47],v[60:63]
DR a[160:163],v2,8192
CV v86,v116,v117
M v[60:63],a[176:179],a[48:51],v[60:63]
DR a[164:167],v2,9216
v_add_f32 v12,v12,v118
M v[60:63],a[180:183],a[52:55],v[60:63]
DR a[168:171],v2,10240
v_add_f32 v12,v12,v119
M v[60:63],a[184:187],a[56:59],v[60:63]
buffer_load_dwordx4 v3,s[4:7],s28 offen offset:2048 sc1 lds
M v[60:63],a[188:191],a[60:63],v[60:63]
s_waitcnt lgkmcnt(3)
DR a[172:175],v2,11264
CV v87,v118,v119
M v[128:131],a[128:131],v[64:67],v[128:131]
v_exp_f32 v24,v48
M v[128:131],a[132:135],v[72:75],v[128:131]
DR a[176:179],v2,12288
v_add_f32 v10,v10,v24
M v[132:135],a[132:135],v[76:79],v[132:135]
v_exp_f32 v25,v49
M v[132:135],a[128:131],v[68:71],v[132:135]
v_exp_f32 v26,v50
M v[136:139],a[136:139],v[64:67],v[136:139]
buffer_load_dwordx4 v3,s[4:7],s28 offen offset:3072 sc1 lds
M v[136:139],a[140:143],v[72:75],v[136:139]
s_mov_b32 m0,s37
v_exp_f32 v27,v51
M v[140:143],a[140:143],v[76:79],v[140:143]
DR a[180:183],v2,13312
v_add_f32 v10,v10,v25
M v[140:143],a[136:139],v[68:71],v[140:143]
DR a[184:187],v2,14336
CV v88,v24,v25
M v[144:147],a[144:147],v[64:67],v[144:147]
DR a[188:191],v2,15360
v_add_f32 v10,v10,v26
M v[144:147],a[148:151],v[72:75],v[144:147]
DR a[128:131],v2,16384
v_add_f32 v10,v10,v27
M v[148:151],a[148:151],v[76:79],v[148:151]
buffer_load_dwordx4 v3,s[4:7],s29 offen offset:0 sc1 lds
M v[148:151],a[144:147],v[68:71],v[148:151]
v_exp_f32 v28,v52
M v[152:155],a[152:155],v[64:67],v[152:155]
DR a[132:135],v2,17408
CV v89,v26,v27
M v[152:155],a[156:159],v[72:75],v[152:155]
v_exp_f32 v29,v53
M v[156:159],a[156:159],v[76:79],v[156:159]
v_exp_f32 v30,v54
M v[156:159],a[152:155],v[68:71],v[156:159]
s_waitcnt lgkmcnt(2)
v_exp_f32 v31,v55
M v[160:163],a[160:163],v[64:67],v[160:163]
buffer_load_dwordx4 v3,s[4:7],s29 offen offset:1024 sc1 lds
M v[160:163],a[164:167],v[72:75],v[160:163]
DR a[136:139],v2,18432
v_add_f32 v12,v12,v28
M v[164:167],a[164:167],v[76:79],v[164:167]
DR a[140:143],v2,19456
v_add_f32 v12,v12,v29
M v[164:167],a[160:163],v[68:71],v[164:167]
DR a[144:147],v2,20480
CV v92,v28,v29
M v[168:171],a[168:171],v[64:67],v[168:171]
DR a[148:151],v2,21504
v_add_f32 v12,v12,v30
M v[168:171],a[172:175],v[72:75],v[168:171]
DR a[152:155],v2,22528
v_add_f32 v12,v12,v31
M v[172:175],a[172:175],v[76:79],v[172:175]
buffer_load_dwordx4 v3,s[4:7],s29 offen offset:2048 sc1 lds
M v[172:175],a[168:171],v[68:71],v[172:175]
DR a[156:159],v2,23552
CV v93,v30,v31
M v[176:179],a[176:179],v[64:67],v[176:179]
v_exp_f32 v112,v56
M v[176:179],a[180:183],v[72:75],v[176:179]
v_exp_f32 v113,v57
M v[180:183],a[180:183],v[76:79],v[180:183]
v_exp_f32 v114,v58
M v[180:183],a[176:179],v[68:71],v[180:183]
v_exp_f32 v115,v59
M v[184:187],a[184:187],v[64:67],v[184:187]
buffer_load_dwordx4 v3,s[4:7],s29 offen offset:3072 sc1 lds
M v[184:187],a[188:191],v[72:75],v[184:187]
s_add_u32 s28,s28,32768
DR a[160:163],v2,24576
v_add_f32 v10,v10,v112
M v[188:191],a[188:191],v[76:79],v[188:191]
DR a[164:167],v2,25600
v_add_f32 v10,v10,v113
M v[188:191],a[184:187],v[68:71],v[188:191]
s_waitcnt lgkmcnt(2)
DR a[168:171],v2,26624
CV v90,v112,v113
M v[192:195],a[128:131],v[64:67],v[192:195]
DR a[172:175],v2,27648
v_add_f32 v10,v10,v114
M v[192:195],a[132:135],v[72:75],v[192:195]
DR a[176:179],v2,28672
v_add_f32 v10,v10,v115
M v[196:199],a[132:135],v[76:79],v[196:199]
DR a[180:183],v2,29696
CV v91,v114,v115
M v[196:199],a[128:131],v[68:71],v[196:199]
s_cmp_eq_u32 s28,s32
s_cselect_b32 s28,0,s28
DR a[184:187],v2,30720
M v[200:203],a[136:139],v[64:67],v[200:203]
s_add_u32 s29,s28,4096
DR a[188:191],v2,31744
M v[200:203],a[140:143],v[72:75],v[200:203]
v_exp_f32 v116,v60
M v[204:207],a[140:143],v[76:79],v[204:207]
v_exp_f32 v117,v61
M v[204:207],a[136:139],v[68:71],v[204:207]
v_exp_f32 v118,v62
M v[208:211],a[144:147],v[64:67],v[208:211]
v_exp_f32 v119,v63
M v[208:211],a[148:151],v[72:75],v[208:211]
v_add_f32 v12,v12,v116
v_add_f32 v12,v12,v117
M v[212:215],a[148:151],v[76:79],v[212:215]
CV v94,v116,v117
v_add_f32 v12,v12,v118
M v[212:215],a[144:147],v[68:71],v[212:215]
v_add_f32 v12,v12,v119
CV v95,v118,v119
M v[216:219],a[152:155],v[64:67],v[216:219]
v_max_f32 v13,v10,v12
v_cmp_nge_f32 vcc,s51,v13
M v[216:219],a[156:159],v[72:75],v[216:219]
M v[220:223],a[156:159],v[76:79],v[220:223]
M v[220:223],a[152:155],v[68:71],v[220:223]
s_waitcnt vmcnt(16) lgkmcnt(0)
s_barrier
M v[224:227],a[160:163],v[64:67],v[224:227]
DR a[128:131],v1,33152
M v[224:227],a[164:167],v[72:75],v[224:227]
DR a[132:135],v1,34176
M v[228:231],a[164:167],v[76:79],v[228:231]
DR a[136:139],v1,35200
M v[228:231],a[160:163],v[68:71],v[228:231]
DR a[140:143],v1,36224
M v[232:235],a[168:171],v[64:67],v[232:235]
DR a[144:147],v1,37248
M v[232:235],a[172:175],v[72:75],v[232:235]
DR a[148:151],v1,38272
M v[236:239],a[172:175],v[76:79],v[236:239]
DR a[152:155],v1,39296
M v[236:239],a[168:171],v[68:71],v[236:239]
DR a[156:159],v1,40320
M v[240:243],a[176:179],v[64:67],v[240:243]
M v[240:243],a[180:183],v[72:75],v[240:243]
M v[244:247],a[180:183],v[76:79],v[244:247]
M v[244:247],a[176:179],v[68:71],v[244:247]
M v[248:251],a[184:187],v[64:67],v[248:251]
M v[248:251],a[188:191],v[72:75],v[248:251]
M v[252:255],a[188:191],v[76:79],v[252:255]
M v[252:255],a[184:187],v[68:71],v[252:255]
s_waitcnt lgkmcnt(0)
s_cbranch_vccnz L_rare2
L_ret2:
v_add_f32 v8,v8,v10
v_add_f32 v9,v9,v12
s_cmp_lg_u32 s48,0
s_cbranch_scc1 L_loop
L_lexit:
s_bitcmp1_b32 s50,0
s_cbranch_scc1 L_predm
M v[32:35],a[128:131],a[0:3],v[16:19]
s_mov_b32 m0,s38
DR a[160:163],v1,41344
v_mov_b32 v98,0
M v[32:35],a[132:135],a[4:7],v[32:35]
buffer_load_dwordx4 v3,s[8:11],s30 offen offset:0 sc1 lds
M v[32:35],a[136:139],a[8:11],v[32:35]
DR a[164:167],v1,42368
M v[32:35],a[140:143],a[12:15],v[32:35]
DR a[168:171],v1,43392
M v[32:35],a[144:147],a[16:19],v[32:35]
DR a[172:175],v1,44416
M v[32:35],a[148:151],a[20:23],v[32:35]
DR a[176:179],v1,45440
M v[32:35],a[152:155],a[24:27],v[32:35]
buffer_load_dwordx4 v3,s[8:11],s30 offen offset:1024 sc1 lds
M v[32:35],a[156:159],a[28:31],v[32:35]
DR a[180:183],v1,46464
M v[36:39],a[128:131],a[32:35],v[20:23]
DR a[184:187],v1,47488
M v[36:39],a[132:135],a[36:39],v[36:39]
DR a[188:191],v1,48512
M v[36:39],a[136:139],a[40:43],v[36:39]
DR a[128:131],v1,49536
M v[36:39],a[140:143],a[44:47],v[36:39]
buffer_load_dwordx4 v3,s[8:11],s30 offen offset:2048 sc1 lds
M v[36:39],a[144:147],a[48:51],v[36:39]
DR a[132:135],v1,50560
v_cmp_le_i32 s[58:59],0,v5
M v[36:39],a[148:151],a[52:55],v[36:39]
DR a[136:139],v1,51584
v_cmp_le_i32 s[60:61],1,v5
M v[36:39],a[152:155],a[56:59],v[36:39]
DR a[140:143],v1,52608
v_cmp_le_i32 s[62:63],2,v5
M v[36:39],a[156:159],a[60:63],v[36:39]
s_waitcnt lgkmcnt(4)
DR a[144:147],v1,53632
v_cmp_le_i32 s[64:65],3,v5
M v[40:43],a[160:163],a[0:3],v[16:19]
buffer_load_dwordx4 v3,s[8:11],s30 offen offset:3072 sc1 lds
M v[40:43],a[164:167],a[4:7],v[40:43]
s_mov_b32 m0,s39
DR a[148:151],v1,54656
v_cndmask_b32 v32,v7,v32,s[58:59]
M v[40:43],a[168:171],a[8:11],v[40:43]
DR a[152:155],v1,55680
v_cndmask_b32 v33,v7,v33,s[60:61]
M v[40:43],a[172:175],a[12:15],v[40:43]
DR a[156:159],v1,56704
v_cndmask_b32 v34,v7,v34,s[62:63]
M v[40:43],a[176:179],a[16:19],v[40:43]
v_cndmask_b32 v35,v7,v35,s[64:65]
M v[40:43],a[180:183],a[20:23],v[40:43]
v_exp_f32 v24,v32
M v[40:43],a[184:187],a[24:27],v[40:43]
v_exp_f32 v25,v33
M v[40:43],a[188:191],a[28:31],v[40:43]
v_exp_f32 v26,v34
M v[44:47],a[160:163],a[32:35],v[20:23]
v_exp_f32 v27,v35
M v[44:47],a[164:167],a[36:39],v[44:47]
buffer_load_dwordx4 v3,s[8:11],s31 offen offset:0 sc1 lds
M v[44:47],a[168:171],a[40:43],v[44:47]
buffer_load_dwordx4 v3,s[8:11],s31 offen offset:1024 sc1 lds
M v[44:47],a[172:175],a[44:47],v[44:47]
v_exp_f32 v28,v36
M v[44:47],a[176:179],a[48:51],v[44:47]
v_exp_f32 v29,v37
M v[44:47],a[180:183],a[52:55],v[44:47]
v_exp_f32 v30,v38
M v[44:47],a[184:187],a[56:59],v[44:47]
v_exp_f32 v31,v39
M v[44:47],a[188:191],a[60:63],v[44:47]
s_waitcnt lgkmcnt(0)
DR a[160:163],v1,57728
v_add_f32 v10,v24,v25
M v[48:51],a[128:131],a[0:3],v[16:19]
buffer_load_dwordx4 v3,s[8:11],s31 offen offset:2048 sc1 lds
M v[48:51],a[132:135],a[4:7],v[48:51]
DR a[164:167],v1,58752
CV v64,v24,v25
M v[48:51],a[136:139],a[8:11],v[48:51]
DR a[168:171],v1,59776
v_add_f32 v10,v10,v26
M v[48:51],a[140:143],a[12:15],v[48:51]
DR a[172:175],v1,60800
v_add_f32 v10,v10,v27
M v[48:51],a[144:147],a[16:19],v[48:51]
buffer_load_dwordx4 v3,s[8:11],s31 offen offset:3072 sc1 lds
M v[48:51],a[148:151],a[20:23],v[48:51]
s_add_u32 s30,s30,32768
DR a[176:179],v1,61824
CV v65,v26,v27
M v[48:51],a[152:155],a[24:27],v[48:51]
DR a[180:183],v1,62848
v_add_f32 v12,v28,v29
M v[48:51],a[156:159],a[28:31],v[48:51]
DR a[184:187],v1,63872
CV v68,v28,v29
M v[52:55],a[128:131],a[32:35],v[20:23]
DR a[188:191],v1,64896
v_add_f32 v12,v12,v30
M v[52:55],a[132:135],a[36:39],v[52:55]
s_cmp_eq_u32 s30,s33
s_cselect_b32 s30,0,s30
s_add_u32 s31,s30,4096
M v[52:55],a[136:139],a[40:43],v[52:55]
v_add_f32 v12,v12,v31
CV v69,v30,v31
M v[52:55],a[140:143],a[44:47],v[52:55]
v_cmp_le_i32 s[58:59],16,v5
v_cmp_le_i32 s[60:61],17,v5
M v[52:55],a[144:147],a[48:51],v[52:55]
s_add_u32 m0,s67,99456
v_cmp_le_i32 s[62:63],18,v5
v_cmp_le_i32 s[64:65],19,v5
M v[52:55],a[148:151],a[52:55],v[52:55]
v_cndmask_b32 v40,v7,v40,s[58:59]
v_cndmask_b32 v41,v7,v41,s[60:61]
M v[52:55],a[152:155],a[56:59],v[52:55]
v_cndmask_b32 v42,v7,v42,s[62:63]
v_cndmask_b32 v43,v7,v43,s[64:65]
M v[52:55],a[156:159],a[60:63],v[52:55]
s_waitcnt vmcnt(16) lgkmcnt(0)
s_barrier
M v[56:59],a[160:163],a[0:3],v[16:19]
v_exp_f32 v112,v40
M v[56:59],a[164:167],a[4:7],v[56:59]
v_exp_f32 v113,v41
M v[56:59],a[168:171],a[8:11],v[56:59]
v_exp_f32 v114,v42
M v[56:59],a[172:175],a[12:15],v[56:59]
DR a[128:131],v2,33152
v_add_f32 v10,v10,v112
M v[56:59],a[176:179],a[16:19],v[56:59]
DR a[132:135],v2,34176
v_add_f32 v10,v10,v113
M v[56:59],a[180:183],a[20:23],v[56:59]
DR a[136:139],v2,35200
CV v66,v112,v113
M v[56:59],a[184:187],a[24:27],v[56:59]
DR a[140:143],v2,36224
v_add_f32 v10,v10,v114
M v[56:59],a[188:191],a[28:31],v[56:59]
DR a[144:147],v2,37248
v_cmp_le_i32 s[58:59],32,v5
M v[60:63],a[160:163],a[32:35],v[20:23]
DR a[148:151],v2,38272
v_cmp_le_i32 s[60:61],33,v5
M v[60:63],a[164:167],a[36:39],v[60:63]
DR a[152:155],v2,39296
v_cmp_le_i32 s[62:63],34,v5
M v[60:63],a[168:171],a[40:43],v[60:63]
DR a[156:159],v2,40320
v_cmp_le_i32 s[64:65],35,v5
M v[60:63],a[172:175],a[44:47],v[60:63]
v_exp_f32 v115,v43
M v[60:63],a[176:179],a[48:51],v[60:63]
buffer_load_dwordx4 v120,s[68:71],s84 offen offset:0 lds
M v[60:63],a[180:183],a[52:55],v[60:63]
v_exp_f32 v116,v44
M v[60:63],a[184:187],a[56:59],v[60:63]
v_exp_f32 v117,v45
M v[60:63],a[188:191],a[60:63],v[60:63]
s_waitcnt lgkmcnt(0)
v_exp_f32 v118,v46
M v[128:131],a[128:131],v[80:83],v[128:131]
v_exp_f32 v119,v47
M v[128:131],a[132:135],v[88:91],v[128:131]
buffer_load_dwordx4 v120,s[68:71],s85 offen offset:1024 lds
M v[132:135],a[132:135],v[92:95],v[132:135]
buffer_load_dwordx4 v120,s[68:71],s86 offen offset:2048 lds
M v[132:135],a[128:131],v[84:87],v[132:135]
DR a[160:163],v2,41344
v_add_f32 v10,v10,v115
M v[136:139],a[136:139],v[80:83],v[136:139]
DR a[164:167],v2,42368
CV v67,v114,v115
M v[136:139],a[140:143],v[88:91],v[136:139]
DR a[168:171],v2,43392
v_add_f32 v12,v12,v116
M v[140:143],a[140:143],v[92:95],v[140:143]
DR a[172:175],v2,44416
v_add_f32 v12,v12,v117
M v[140:143],a[136:139],v[84:87],v[140:143]
DR a[176:179],v2,45440
CV v70,v116,v117
M v[144:147],a[144:147],v[80:83],v[144:147]
DR a[180:183],v2,46464
v_add_f32 v12,v12,v118
M v[144:147],a[148:151],v[88:91],v[144:147]
DR a[184:187],v2,47488
v_add_f32 v12,v12,v119
M v[148:151],a[148:151],v[92:95],v[148:151]
DR a[188:191],v2,48512
CV v71,v118,v119
M v[148:151],a[144:147],v[84:87],v[148:151]
buffer_load_dwordx4 v120,s[68:71],s87 offen offset:3072 lds
M v[152:155],a[152:155],v[80:83],v[152:155]
s_add_u32 m0,s67,103552
DR a[128:131],v2,49536
v_cndmask_b32 v48,v7,v48,s[58:59]
M v[152:155],a[156:159],v[88:91],v[152:155]
buffer_load_dwordx4 v120,s[68:71],s88 offen offset:0 lds
M v[156:159],a[156:159],v[92:95],v[156:159]
buffer_load_dwordx4 v120,s[68:71],s89 offen offset:1024 lds
M v[156:159],a[152:155],v[84:87],v[156:159]
s_waitcnt lgkmcnt(1)
DR a[132:135],v2,50560
v_cndmask_b32 v49,v7,v49,s[60:61]
M v[160:163],a[160:163],v[80:83],v[160:163]
buffer_load_dwordx4 v120,s[68:71],s90 offen offset:2048 lds
M v[160:163],a[164:167],v[88:91],v[160:163]
DR a[136:139],v2,51584
v_cndmask_b32 v50,v7,v50,s[62:63]
M v[164:167],a[164:167],v[92:95],v[164:167]
DR a[140:143],v2,52608
v_cndmask_b32 v51,v7,v51,s[64:65]
M v[164:167],a[160:163],v[84:87],v[164:167]
v_exp_f32 v24,v48
M v[168:171],a[168:171],v[80:83],v[168:171]
v_exp_f32 v25,v49
M v[168:171],a[172:175],v[88:91],v[168:171]
v_exp_f32 v26,v50
M v[172:175],a[172:175],v[92:95],v[172:175]
v_exp_f32 v27,v51
M v[172:175],a[168:171],v[84:87],v[172:175]
DR a[144:147],v2,53632
v_add_f32 v10,v10,v24
M v[176:179],a[176:179],v[80:83],v[176:179]
DR a[148:151],v2,54656
v_add_f32 v10,v10,v25
M v[176:179],a[180:183],v[88:91],v[176:179]
DR a[152:155],v2,55680
CV v72,v24,v25
M v[180:183],a[180:183],v[92:95],v[180:183]
DR a[156:159],v2,56704
v_add_f32 v10,v10,v26
M v[180:183],a[176:179],v[84:87],v[180:183]
v_exp_f32 v28,v52
M v[184:187],a[184:187],v[80:83],v[184:187]
v_exp_f32 v29,v53
M v[184:187],a[188:191],v[88:91],v[184:187]
v_exp_f32 v30,v54
M v[188:191],a[188:191],v[92:95],v[188:191]
v_exp_f32 v31,v55
M v[188:191],a[184:187],v[84:87],v[188:191]
s_waitcnt lgkmcnt(0)
DR a[160:163],v2,57728
v_add_f32 v10,v10,v27
M v[192:195],a[128:131],v[80:83],v[192:195]
buffer_load_dwordx4 v120,s[68:71],s91 offen offset:3072 lds
M v[192:195],a[132:135],v[88:91],v[192:195]
DR a[164:167],v2,58752
CV v73,v26,v27
M v[196:199],a[132:135],v[92:95],v[196:199]
DR a[168:171],v2,59776
v_add_f32 v12,v12,v28
M v[196:199],a[128:131],v[84:87],v[196:199]
DR a[172:175],v2,60800
v_add_f32 v12,v12,v29
M v[200:203],a[136:139],v[80:83],v[200:203]
s_add_u32 s68,s68,128
s_addc_u32 s69,s69,0
s_sub_u32 s70,s70,128
M v[200:203],a[140:143],v[88:91],v[200:203]
DR a[176:179],v2,61824
CV v76,v28,v29
M v[204:207],a[140:143],v[92:95],v[204:207]
DR a[180:183],v2,62848
v_add_f32 v12,v12,v30
M v[204:207],a[136:139],v[84:87],v[204:207]
DR a[184:187],v2,63872
v_add_f32 v12,v12,v31
M v[208:211],a[144:147],v[80:83],v[208:211]
DR a[188:191],v2,64896
CV v77,v30,v31
M v[208:211],a[148:151],v[88:91],v[208:211]
v_cmp_le_i32 s[58:59],48,v5
v_cmp_le_i32 s[60:61],49,v5
M v[212:215],a[148:151],v[92:95],v[212:215]
v_cmp_le_i32 s[62:63],50,v5
v_cmp_le_i32 s[64:65],51,v5
M v[212:215],a[144:147],v[84:87],v[212:215]
s_mov_b32 m0,s40
v_cndmask_b32 v56,v7,v56,s[58:59]
v_cndmask_b32 v57,v7,v57,s[60:61]
M v[216:219],a[152:155],v[80:83],v[216:219]
v_cndmask_b32 v58,v7,v58,s[62:63]
v_cndmask_b32 v59,v7,v59,s[64:65]
M v[216:219],a[156:159],v[88:91],v[216:219]
v_exp_f32 v112,v56
M v[220:223],a[156:159],v[92:95],v[220:223]
v_exp_f32 v113,v57
M v[220:223],a[152:155],v[84:87],v[220:223]
s_waitcnt vmcnt(16) lgkmcnt(0)
s_barrier
M v[224:227],a[160:163],v[80:83],v[224:227]
v_exp_f32 v114,v58
M v[224:227],a[164:167],v[88:91],v[224:227]
v_exp_f32 v115,v59
M v[228:231],a[164:167],v[92:95],v[228:231]
DR a[128:131],v1,0
v_add_f32 v10,v10,v112
M v[228:231],a[160:163],v[84:87],v[228:231]
buffer_load_dword v99,v98,s[24:27],s55 offen offset:96 sc1
DR a[132:135],v1,1024
M v[232:235],a[168:171],v[80:83],v[232:235]
DR a[136:139],v1,2048
v_add_f32 v10,v10,v113
M v[232:235],a[172:175],v[88:91],v[232:235]
DR a[140:143],v1,3072
CV v74,v112,v113
M v[236:239],a[172:175],v[92:95],v[236:239]
DR a[144:147],v1,4096
v_add_f32 v10,v10,v114
M v[236:239],a[168:171],v[84:87],v[236:239]
DR a[148:151],v1,5120
v_add_f32 v10,v10,v115
M v[240:243],a[176:179],v[80:83],v[240:243]
DR a[152:155],v1,6144
CV v75,v114,v115
M v[240:243],a[180:183],v[88:91],v[240:243]
DR a[156:159],v1,7168
M v[244:247],a[180:183],v[92:95],v[244:247]
v_exp_f32 v116,v60
M v[244:247],a[176:179],v[84:87],v[244:247]
v_exp_f32 v117,v61
M v[248:251],a[184:187],v[80:83],v[248:251]
v_exp_f32 v118,v62
M v[248:251],a[188:191],v[88:91],v[248:251]
v_exp_f32 v119,v63
M v[252:255],a[188:191],v[92:95],v[252:255]
buffer_load_dwordx4 v3,s[8:11],s30 offen offset:0 sc1 lds
M v[252:255],a[184:187],v[84:87],v[252:255]
s_waitcnt lgkmcnt(0)
v_add_f32 v12,v12,v116
v_add_f32 v12,v12,v117
CV v78,v116,v117
v_add_f32 v12,v12,v118
v_add_f32 v12,v12,v119
CV v79,v118,v119
buffer_load_dwordx4 v3,s[8:11],s30 offen offset:1024 sc1 lds
buffer_load_dwordx4 v3,s[8:11],s30 offen offset:2048 sc1 lds
buffer_load_dwordx4 v3,s[8:11],s30 offen offset:3072 sc1 lds
s_mov_b32 m0,s41
s_nop 0
buffer_load_dwordx4 v3,s[8:11],s31 offen offset:0 sc1 lds
buffer_load_dwordx4 v3,s[8:11],s31 offen offset:1024 sc1 lds
buffer_load_dwordx4 v3,s[8:11],s31 offen offset:2048 sc1 lds
buffer_load_dwordx4 v3,s[8:11],s31 offen offset:3072 sc1 lds
v_max_f32 v13,v10,v12
v_cmp_nge_f32 vcc,s51,v13
s_add_u32 s30,s30,32768
s_cmp_eq_u32 s30,s33
s_cselect_b32 s30,0,s30
s_add_u32 s31,s30,4096
s_cbranch_vccnz L_rare3
L_ret3:
v_add_f32 v8,v8,v10
v_add_f32 v9,v9,v12
M v[36:39],a[128:131],a[32:35],v[20:23]
DR a[160:163],v1,8192
DR a[164:167],v1,9216
DR a[168:171],v1,10240
DR a[172:175],v1,11264
M v[36:39],a[132:135],a[36:39],v[36:39]
DR a[176:179],v1,12288
DR a[180:183],v1,13312
DR a[184:187],v1,14336
M v[36:39],a[136:139],a[40:43],v[36:39]
DR a[188:191],v1,15360
M v[36:39],a[140:143],a[44:47],v[36:39]
DR a[128:131],v1,16384
M v[36:39],a[144:147],a[48:51],v[36:39]
DR a[132:135],v1,17408
M v[36:39],a[148:151],a[52:55],v[36:39]
DR a[136:139],v1,18432
M v[36:39],a[152:155],a[56:59],v[36:39]
DR a[140:143],v1,19456
M v[36:39],a[156:159],a[60:63],v[36:39]
DR a[144:147],v1,20480
s_waitcnt lgkmcnt(12)
M v[44:47],a[160:163],a[32:35],v[20:23]
DR a[148:151],v1,21504
s_waitcnt lgkmcnt(12)
M v[44:47],a[164:167],a[36:39],v[44:47]
DR a[152:155],v1,22528
s_waitcnt lgkmcnt(12)
M v[44:47],a[168:171],a[40:43],v[44:47]
DR a[156:159],v1,23552
s_waitcnt lgkmcnt(12)
M v[44:47],a[172:175],a[44:47],v[44:47]
DR a[160:163],v1,24576
s_waitcnt lgkmcnt(12)
M v[44:47],a[176:179],a[48:51],v[44:47]
DR a[164:167],v1,25600
v_cmp_le_i32 s[58:59],0,v6
s_waitcnt lgkmcnt(12)
M v[44:47],a[180:183],a[52:55],v[44:47]
DR a[168:171],v1,26624
v_cmp_le_i32 s[60:61],1,v6
s_waitcnt lgkmcnt(12)
M v[44:47],a[184:187],a[56:59],v[44:47]
DR a[172:175],v1,27648
v_cmp_le_i32 s[62:63],2,v6
s_waitcnt lgkmcnt(12)
M v[44:47],a[188:191],a[60:63],v[44:47]
DR a[176:179],v1,28672
DR a[180:183],v1,29696
DR a[184:187],v1,30720
s_waitcnt lgkmcnt(14)
M v[52:55],a[128:131],a[32:35],v[20:23]
DR a[188:191],v1,31744
v_cmp_le_i32 s[64:65],3,v6
s_waitcnt lgkmcnt(14)
M v[52:55],a[132:135],a[36:39],v[52:55]
v_cndmask_b32 v36,v7,v36,s[58:59]
v_cndmask_b32 v37,v7,v37,s[60:61]
s_waitcnt lgkmcnt(13)
M v[52:55],a[136:139],a[40:43],v[52:55]
s_add_u32 m0,s67,66304
v_cndmask_b32 v38,v7,v38,s[62:63]
v_cndmask_b32 v39,v7,v39,s[64:65]
s_waitcnt lgkmcnt(12)
M v[52:55],a[140:143],a[44:47],v[52:55]
v_exp_f32 v24,v36
s_waitcnt lgkmcnt(11)
M v[52:55],a[144:147],a[48:51],v[52:55]
v_exp_f32 v25,v37
s_waitcnt lgkmcnt(10)
M v[52:55],a[148:151],a[52:55],v[52:55]
s_waitcnt vmcnt(17) lgkmcnt(0)
s_barrier
M v[52:55],a[152:155],a[56:59],v[52:55]
DR a[128:131],v2,0
DR a[132:135],v2,1024
DR a[136:139],v2,2048
DR a[140:143],v2,3072
M v[52:55],a[156:159],a[60:63],v[52:55]
DR a[144:147],v2,4096
v_add_f32 v12,v24,v25
M v[60:63],a[160:163],a[32:35],v[20:23]
DR a[148:151],v2,5120
CV v84,v24,v25
M v[60:63],a[164:167],a[36:39],v[60:63]
DR a[152:155],v2,6144
v_cmp_le_i32 s[58:59],16,v6
M v[60:63],a[168:171],a[40:43],v[60:63]
DR a[156:159],v2,7168
v_cmp_le_i32 s[60:61],17,v6
M v[60:63],a[172:175],a[44:47],v[60:63]
v_exp_f32 v26,v38
M v[60:63],a[176:179],a[48:51],v[60:63]
v_exp_f32 v27,v39
M v[60:63],a[180:183],a[52:55],v[60:63]
buffer_load_dwordx4 v120,s[68:71],s84 offen offset:0 lds
M v[60:63],a[184:187],a[56:59],v[60:63]
buffer_load_dwordx4 v120,s[68:71],s85 offen offset:1024 lds
M v[60:63],a[188:191],a[60:63],v[60:63]
s_waitcnt lgkmcnt(0)
DR a[160:163],v2,8192
v_add_f32 v12,v12,v26
M v[128:131],a[128:131],v[64:67],v[128:131]
buffer_load_dwordx4 v120,s[68:71],s86 offen offset:2048 lds
M v[128:131],a[132:135],v[72:75],v[128:131]
buffer_load_dwordx4 v120,s[68:71],s87 offen offset:3072 lds
M v[132:135],a[132:135],v[76:79],v[132:135]
s_add_u32 m0,s67,70400
DR a[164:167],v2,9216
v_add_f32 v12,v12,v27
M v[132:135],a[128:131],v[68:71],v[132:135]
buffer_load_dwordx4 v120,s[68:71],s88 offen offset:0 lds
M v[136:139],a[136:139],v[64:67],v[136:139]
buffer_load_dwordx4 v120,s[68:71],s89 offen offset:1024 lds
M v[136:139],a[140:143],v[72:75],v[136:139]
DR a[168:171],v2,10240
CV v85,v26,v27
M v[140:143],a[140:143],v[76:79],v[140:143]
DR a[172:175],v2,11264
v_cmp_le_i32 s[62:63],18,v6
M v[140:143],a[136:139],v[68:71],v[140:143]
DR a[176:179],v2,12288
v_cmp_le_i32 s[64:65],19,v6
M v[144:147],a[144:147],v[64:67],v[144:147]
DR a[180:183],v2,13312
v_cndmask_b32 v44,v7,v44,s[58:59]
s_bitcmp1_b32 s50,2
s_cbranch_scc0 L_nocomb1
s_waitcnt vmcnt(14)
v_cmp_eq_u32 vcc,1,v99
s_nop 0
s_cmp_eq_u64 vcc,-1
s_cbranch_scc0 L_spin8
L_spun8:
L_nocomb1:
M v[144:147],a[148:151],v[72:75],v[144:147]
DR a[184:187],v2,14336
v_cndmask_b32 v45,v7,v45,s[60:61]
M v[148:151],a[148:151],v[76:79],v[148:151]
DR a[188:191],v2,15360
v_cndmask_b32 v46,v7,v46,s[62:63]
M v[148:151],a[144:147],v[68:71],v[148:151]
buffer_load_dwordx4 v120,s[68:71],s90 offen offset:2048 lds
M v[152:155],a[152:155],v[64:67],v[152:155]
buffer_load_dwordx4 v120,s[68:71],s91 offen offset:3072 lds
M v[152:155],a[156:159],v[72:75],v[152:155]
DR a[128:131],v2,16384
v_cndmask_b32 v47,v7,v47,s[64:65]
M v[156:159],a[156:159],v[76:79],v[156:159]
v_exp_f32 v28,v44
M v[156:159],a[152:155],v[68:71],v[156:159]
s_waitcnt lgkmcnt(1)
v_exp_f32 v29,v45
M v[160:163],a[160:163],v[64:67],v[160:163]
v_exp_f32 v30,v46
M v[160:163],a[164:167],v[72:75],v[160:163]
v_exp_f32 v31,v47
M v[164:167],a[164:167],v[76:79],v[164:167]
DR a[132:135],v2,17408
v_add_f32 v12,v12,v28
M v[164:167],a[160:163],v[68:71],v[164:167]
DR a[136:139],v2,18432
v_add_f32 v12,v12,v29
M v[168:171],a[168:171],v[64:67],v[168:171]
DR a[140:143],v2,19456
CV v86,v28,v29
M v[168:171],a[172:175],v[72:75],v[168:171]
s_add_u32 s68,s68,128
s_addc_u32 s69,s69,0
s_sub_u32 s70,s70,128
s_mov_b32 s54,16384
M v[172:175],a[172:175],v[76:79],v[172:175]
buffer_load_dwordx4 v[104:107],v4,s[20:23],s54 offen sc1
M v[172:175],a[168:171],v[68:71],v[172:175]
s_mov_b32 s54,0
DR a[144:147],v2,20480
v_add_f32 v12,v12,v30
M v[176:179],a[176:179],v[64:67],v[176:179]
DR a[148:151],v2,21504
v_add_f32 v12,v12,v31
M v[176:179],a[180:183],v[72:75],v[176:179]
DR a[152:155],v2,22528
CV v87,v30,v31
M v[180:183],a[180:183],v[76:79],v[180:183]
DR a[156:159],v2,23552
v_cmp_le_i32 s[58:59],32,v6
M v[180:183],a[176:179],v[68:71],v[180:183]
buffer_load_dwordx4 a[64:67],v4,s[20:23],s54 offen offset:0 sc1
M v[184:187],a[184:187],v[64:67],v[184:187]
buffer_load_dwordx4 a[68:71],v4,s[20:23],s54 offen offset:1024 sc1
M v[184:187],a[188:191],v[72:75],v[184:187]
buffer_load_dwordx4 a[72:75],v4,s[20:23],s54 offen offset:2048 sc1
M v[188:191],a[188:191],v[76:79],v[188:191]
buffer_load_dwordx4 a[76:79],v4,s[20:23],s54 offen offset:3072 sc1
M v[188:191],a[184:187],v[68:71],v[188:191]
s_waitcnt lgkmcnt(0)
s_mov_b32 s54,4096
DR a[160:163],v2,24576
M v[192:195],a[128:131],v[64:67],v[192:195]
buffer_load_dwordx4 a[80:83],v4,s[20:23],s54 offen offset:0 sc1
M v[192:195],a[132:135],v[72:75],v[192:195]
buffer_load_dwordx4 a[84:87],v4,s[20:23],s54 offen offset:1024 sc1
M v[196:199],a[132:135],v[76:79],v[196:199]
buffer_load_dwordx4 a[88:91],v4,s[20:23],s54 offen offset:2048 sc1
M v[196:199],a[128:131],v[68:71],v[196:199]
buffer_load_dwordx4 a[92:95],v4,s[20:23],s54 offen offset:3072 sc1
M v[200:203],a[136:139],v[64:67],v[200:203]
s_mov_b32 s54,8192
DR a[164:167],v2,25600
v_cmp_le_i32 s[60:61],33,v6
M v[200:203],a[140:143],v[72:75],v[200:203]
DR a[168:171],v2,26624
v_cmp_le_i32 s[62:63],34,v6
M v[204:207],a[140:143],v[76:79],v[204:207]
DR a[172:175],v2,27648
v_cmp_le_i32 s[64:65],35,v6
M v[204:207],a[136:139],v[68:71],v[204:207]
DR a[176:179],v2,28672
v_cndmask_b32 v52,v7,v52,s[58:59]
M v[208:211],a[144:147],v[64:67],v[208:211]
DR a[180:183],v2,29696
v_cndmask_b32 v53,v7,v53,s[60:61]
M v[208:211],a[148:151],v[72:75],v[208:211]
DR a[184:187],v2,30720
v_cndmask_b32 v54,v7,v54,s[62:63]
M v[212:215],a[148:151],v[76:79],v[212:215]
DR a[188:191],v2,31744
v_cndmask_b32 v55,v7,v55,s[64:65]
M v[212:215],a[144:147],v[68:71],v[212:215]
v_exp_f32 v112,v52
M v[216:219],a[152:155],v[64:67],v[216:219]
v_exp_f32 v113,v53
M v[216:219],a[156:159],v[72:75],v[216:219]
v_exp_f32 v114,v54
M v[220:223],a[156:159],v[76:79],v[220:223]
v_exp_f32 v115,v55
M v[220:223],a[152:155],v[68:71],v[220:223]
s_waitcnt vmcnt(17) lgkmcnt(0)
s_barrier
M v[224:227],a[160:163],v[64:67],v[224:227]
buffer_load_dwordx4 a[96:99],v4,s[20:23],s54 offen offset:0 sc1
M v[224:227],a[164:167],v[72:75],v[224:227]
buffer_load_dwordx4 a[100:103],v4,s[20:23],s54 offen offset:1024 sc1
M v[228:231],a[164:167],v[76:79],v[228:231]
DR a[128:131],v2,33152
v_add_f32 v12,v12,v112
M v[228:231],a[160:163],v[68:71],v[228:231]
DR a[132:135],v2,34176
v_add_f32 v12,v12,v113
M v[232:235],a[168:171],v[64:67],v[232:235]
DR a[136:139],v2,35200
CV v92,v112,v113
M v[232:235],a[172:175],v[72:75],v[232:235]
DR a[140:143],v2,36224
v_add_f32 v12,v12,v114
M v[236:239],a[172:175],v[76:79],v[236:239]
DR a[144:147],v2,37248
v_add_f32 v12,v12,v115
M v[236:239],a[168:171],v[68:71],v[236:239]
DR a[148:151],v2,38272
CV v93,v114,v115
M v[240:243],a[176:179],v[64:67],v[240:243]
DR a[152:155],v2,39296
v_cmp_le_i32 s[58:59],48,v6
M v[240:243],a[180:183],v[72:75],v[240:243]
buffer_load_dwordx4 a[104:107],v4,s[20:23],s54 offen offset:2048 sc1
DR a[156:159],v2,40320
M v[244:247],a[180:183],v[76:79],v[244:247]
buffer_load_dwordx4 a[108:111],v4,s[20:23],s54 offen offset:3072 sc1
M v[244:247],a[176:179],v[68:71],v[244:247]
s_mov_b32 s54,12288
v_cmp_le_i32 s[60:61],49,v6
v_cmp_le_i32 s[62:63],50,v6
M v[248:251],a[184:187],v[64:67],v[248:251]
buffer_load_dwordx4 a[112:115],v4,s[20:23],s54 offen offset:0 sc1
M v[248:251],a[188:191],v[72:75],v[248:251]
buffer_load_dwordx4 a[116:119],v4,s[20:23],s54 offen offset:1024 sc1
M v[252:255],a[188:191],v[76:79],v[252:255]
buffer_load_dwordx4 a[120:123],v4,s[20:23],s54 offen offset:2048 sc1
M v[252:255],a[184:187],v[68:71],v[252:255]
s_waitcnt lgkmcnt(0)
v_cmp_le_i32 s[64:65],51,v6
v_cndmask_b32 v60,v7,v60,s[58:59]
v_cndmask_b32 v61,v7,v61,s[60:61]
v_cndmask_b32 v62,v7,v62,s[62:63]
v_cndmask_b32 v63,v7,v63,s[64:65]
v_exp_f32 v116,v60
v_exp_f32 v117,v61
v_exp_f32 v118,v62
v_exp_f32 v119,v63
v_add_f32 v12,v12,v116
v_add_f32 v12,v12,v117
CV v94,v116,v117
v_add_f32 v12,v12,v118
v_add_f32 v12,v12,v119
CV v95,v118,v119
buffer_load_dwordx4 a[124:127],v4,s[20:23],s54 offen offset:3072 sc1
v_cmp_nge_f32 vcc,s51,v12
s_nop 0
s_cbranch_vccnz L_rare4
L_ret4:
v_add_f32 v9,v9,v12
L_end:
M v[132:135],a[128:131],v[84:87],v[132:135]
DR a[160:163],v2,41344
DR a[164:167],v2,42368
DR a[168:171],v2,43392
DR a[172:175],v2,44416
M v[132:135],a[132:135],v[92:95],v[132:135]
s_add_u32 m0,s67,0
DR a[176:179],v2,45440
DR a[180:183],v2,46464
M v[140:143],a[136:139],v[84:87],v[140:143]
DR a[184:187],v2,47488
DR a[188:191],v2,48512
DR a[128:131],v2,49536
M v[140:143],a[140:143],v[92:95],v[140:143]
buffer_load_dwordx4 v120,s[68:71],s84 offen offset:0 lds
M v[148:151],a[144:147],v[84:87],v[148:151]
buffer_load_dwordx4 v120,s[68:71],s85 offen offset:1024 lds
M v[148:151],a[148:151],v[92:95],v[148:151]
DR a[132:135],v2,50560
M v[156:159],a[152:155],v[84:87],v[156:159]
DR a[136:139],v2,51584
M v[156:159],a[156:159],v[92:95],v[156:159]
DR a[140:143],v2,52608
s_waitcnt lgkmcnt(11)
M v[164:167],a[160:163],v[84:87],v[164:167]
DR a[144:147],v2,53632
s_waitcnt lgkmcnt(11)
M v[164:167],a[164:167],v[92:95],v[164:167]
DR a[148:151],v2,54656
s_waitcnt lgkmcnt(11)
M v[172:175],a[168:171],v[84:87],v[172:175]
DR a[152:155],v2,55680
DR a[156:159],v2,56704
DR a[160:163],v2,57728
s_waitcnt lgkmcnt(13)
M v[172:175],a[172:175],v[92:95],v[172:175]
buffer_load_dwordx4 v120,s[68:71],s86 offen offset:2048 lds
s_waitcnt lgkmcnt(12)
M v[180:183],a[176:179],v[84:87],v[180:183]
buffer_load_dwordx4 v120,s[68:71],s87 offen offset:3072 lds
s_waitcnt lgkmcnt(11)
M v[180:183],a[180:183],v[92:95],v[180:183]
s_add_u32 m0,s67,4096
DR a[164:167],v2,58752
s_waitcnt lgkmcnt(11)
M v[188:191],a[184:187],v[84:87],v[188:191]
DR a[168:171],v2,59776
s_waitcnt lgkmcnt(11)
M v[188:191],a[188:191],v[92:95],v[188:191]
DR a[172:175],v2,60800
s_waitcnt lgkmcnt(11)
M v[196:199],a[128:131],v[84:87],v[196:199]
buffer_load_dwordx4 v120,s[68:71],s88 offen offset:0 lds
s_waitcnt lgkmcnt(10)
M v[196:199],a[132:135],v[92:95],v[196:199]
DR a[176:179],v2,61824
DR a[180:183],v2,62848
DR a[184:187],v2,63872
s_waitcnt lgkmcnt(12)
M v[204:207],a[136:139],v[84:87],v[204:207]
DR a[188:191],v2,64896
s_waitcnt lgkmcnt(12)
M v[204:207],a[140:143],v[92:95],v[204:207]
buffer_load_dwordx4 v120,s[68:71],s89 offen offset:1024 lds
s_waitcnt lgkmcnt(11)
M v[212:215],a[144:147],v[84:87],v[212:215]
s_waitcnt lgkmcnt(10)
M v[212:215],a[148:151],v[92:95],v[212:215]
buffer_load_dwordx4 v120,s[68:71],s90 offen offset:2048 lds
s_waitcnt lgkmcnt(9)
M v[220:223],a[152:155],v[84:87],v[220:223]
s_waitcnt lgkmcnt(8)
M v[220:223],a[156:159],v[92:95],v[220:223]
s_waitcnt lgkmcnt(7)
M v[228:231],a[160:163],v[84:87],v[228:231]
s_waitcnt lgkmcnt(6)
M v[228:231],a[164:167],v[92:95],v[228:231]
buffer_load_dwordx4 v120,s[68:71],s91 offen offset:3072 lds
s_waitcnt lgkmcnt(5)
M v[236:239],a[168:171],v[84:87],v[236:239]
s_add_u32 s68,s68,128
s_addc_u32 s69,s69,0
s_sub_u32 s70,s70,128
s_waitcnt lgkmcnt(4)
M v[236:239],a[172:175],v[92:95],v[236:239]
s_waitcnt lgkmcnt(3)
M v[244:247],a[176:179],v[84:87],v[244:247]
s_waitcnt lgkmcnt(2)
M v[244:247],a[180:183],v[92:95],v[244:247]
s_waitcnt lgkmcnt(1)
M v[252:255],a[184:187],v[84:87],v[252:255]
s_waitcnt lgkmcnt(0)
M v[252:255],a[188:191],v[92:95],v[252:255]
s_waitcnt lgkmcnt(0)
s_barrier
DT a[0:1],v121,33152
DT a[2:3],v121,33664
DT a[4:5],v121,34176
DT a[6:7],v121,34688
DT a[8:9],v121,35200
DT a[10:11],v121,35712
DT a[12:13],v121,36224
DT a[14:15],v121,36736
DT a[16:17],v121,37248
DT a[18:19],v121,37760
DT a[20:21],v121,38272
DT a[22:23],v121,38784
DT a[24:25],v121,39296
DT a[26:27],v121,39808
DT a[28:29],v121,40320
DT a[30:31],v121,40832
DT a[32:33],v121,33184
DT a[34:35],v121,33696
DT a[36:37],v121,34208
DT a[38:39],v121,34720
DT a[40:41],v121,35232
DT a[42:43],v121,35744
DT a[44:45],v121,36256
DT a[46:47],v121,36768
DT a[48:49],v121,37280
DT a[50:51],v121,37792
DT a[52:53],v121,38304
DT a[54:55],v121,38816
DT a[56:57],v121,39328
DT a[58:59],v121,39840
DT a[60:61],v121,40352
DT a[62:63],v121,40864
s_add_u32 m0,s67,33152
s_nop 0
buffer_load_dwordx4 v120,s[68:71],s84 offen offset:0 lds
buffer_load_dwordx4 v120,s[68:71],s85 offen offset:1024 lds
buffer_load_dwordx4 v120,s[68:71],s86 offen offset:2048 lds
buffer_load_dwordx4 v120,s[68:71],s87 offen offset:3072 lds
s_add_u32 m0,s67,37248
s_nop 0
buffer_load_dwordx4 v120,s[68:71],s88 offen offset:0 lds
buffer_load_dwordx4 v120,s[68:71],s89 offen offset:1024 lds
buffer_load_dwordx4 v120,s[68:71],s90 offen offset:2048 lds
buffer_load_dwordx4 v120,s[68:71],s91 offen offset:3072 lds
s_add_u32 s68,s68,128
s_addc_u32 s69,s69,0
s_sub_u32 s70,s70,128
s_bitcmp1_b32 s50,2
s_cbranch_scc1 L_comb2
v_mov_b32 v13,v8
s_nop 1
v_permlane16_swap_b32 v8,v13
v_add_f32 v8,v8,v13
v_mov_b32 v13,v8
s_nop 1
v_permlane32_swap_b32 v8,v13
v_add_f32 v8,v8,v13
v_rcp_f32 v123,v8
v_mov_b32 v14,v9
s_nop 1
v_permlane16_swap_b32 v9,v14
v_add_f32 v9,v9,v14
v_mov_b32 v14,v9
s_nop 1
v_permlane32_swap_b32 v9,v14
v_add_f32 v9,v9,v14
v_rcp_f32 v124,v9
CV v128,v128,v129
CV v129,v130,v131
CV v130,v136,v137
CV v131,v138,v139
CV v144,v144,v145
CV v145,v146,v147
CV v146,v152,v153
CV v147,v154,v155
CV v160,v160,v161
CV v161,v162,v163
CV v162,v168,v169
CV v163,v170,v171
CV v176,v176,v177
CV v177,v178,v179
CV v178,v184,v185
CV v179,v186,v187
CV v192,v192,v193
CV v193,v194,v195
CV v194,v200,v201
CV v195,v202,v203
CV v208,v208,v209
CV v209,v210,v211
CV v210,v216,v217
CV v211,v218,v219
CV v224,v224,v225
CV v225,v226,v227
CV v226,v232,v233
CV v227,v234,v235
CV v240,v240,v241
CV v241,v242,v243
CV v242,v248,v249
CV v243,v250,v251
CV v132,v132,v133
CV v133,v134,v135
CV v134,v140,v141
CV v135,v142,v143
CV v148,v148,v149
CV v149,v150,v151
CV v150,v156,v157
CV v151,v158,v159
CV v164,v164,v165
CV v165,v166,v167
CV v166,v172,v173
CV v167,v174,v175
CV v180,v180,v181
CV v181,v182,v183
CV v182,v188,v189
CV v183,v190,v191
CV v196,v196,v197
CV v197,v198,v199
CV v198,v204,v205
CV v199,v206,v207
CV v212,v212,v213
CV v213,v214,v215
CV v214,v220,v221
CV v215,v222,v223
CV v228,v228,v229
CV v229,v230,v231
CV v230,v236,v237
CV v231,v238,v239
CV v244,v244,v245
CV v245,v246,v247
CV v246,v252,v253
CV v247,v254,v255
s_branch L_l2_done
L_comb2:
s_waitcnt vmcnt(32)
v_sub_f32 v108,v104,v16
v_min_f32 v108,0x42200000,v108
v_exp_f32 v108,v108
s_nop 0
v_fma_f32 v8,v8,v108,v105
v_mov_b32 v109,v108
v_pk_mul_f32 v[128:129],v[128:129],v[108:109]
v_pk_mul_f32 v[130:131],v[130:131],v[108:109]
v_pk_mul_f32 v[136:137],v[136:137],v[108:109]
v_pk_mul_f32 v[138:139],v[138:139],v[108:109]
v_pk_mul_f32 v[144:145],v[144:145],v[108:109]
v_pk_mul_f32 v[146:147],v[146:147],v[108:109]
v_pk_mul_f32 v[152:153],v[152:153],v[108:109]
v_pk_mul_f32 v[154:155],v[154:155],v[108:109]
v_pk_mul_f32 v[160:161],v[160:161],v[108:109]
v_pk_mul_f32 v[162:163],v[162:163],v[108:109]
v_pk_mul_f32 v[168:169],v[168:169],v[108:109]
v_pk_mul_f32 v[170:171],v[170:171],v[108:109]
v_pk_mul_f32 v[176:177],v[176:177],v[108:109]
v_pk_mul_f32 v[178:179],v[178:179],v[108:109]
v_pk_mul_f32 v[184:185],v[184:185],v[108:109]
v_pk_mul_f32 v[186:187],v[186:187],v[108:109]
v_pk_mul_f32 v[192:193],v[192:193],v[108:109]
v_pk_mul_f32 v[194:195],v[194:195],v[108:109]
v_pk_mul_f32 v[200:201],v[200:201],v[108:109]
v_pk_mul_f32 v[202:203],v[202:203],v[108:109]
v_pk_mul_f32 v[208:209],v[208:209],v[108:109]
v_pk_mul_f32 v[210:211],v[210:211],v[108:109]
v_pk_mul_f32 v[216:217],v[216:217],v[108:109]
v_pk_mul_f32 v[218:219],v[218:219],v[108:109]
v_pk_mul_f32 v[224:225],v[224:225],v[108:109]
v_pk_mul_f32 v[226:227],v[226:227],v[108:109]
v_pk_mul_f32 v[232:233],v[232:233],v[108:109]
v_pk_mul_f32 v[234:235],v[234:235],v[108:109]
v_pk_mul_f32 v[240:241],v[240:241],v[108:109]
v_pk_mul_f32 v[242:243],v[242:243],v[108:109]
v_pk_mul_f32 v[248:249],v[248:249],v[108:109]
v_pk_mul_f32 v[250:251],v[250:251],v[108:109]
v_sub_f32 v110,v106,v20
v_min_f32 v110,0x42200000,v110
v_exp_f32 v110,v110
s_nop 0
v_fma_f32 v9,v9,v110,v107
v_mov_b32 v111,v110
v_pk_mul_f32 v[132:133],v[132:133],v[110:111]
v_pk_mul_f32 v[134:135],v[134:135],v[110:111]
v_pk_mul_f32 v[140:141],v[140:141],v[110:111]
v_pk_mul_f32 v[142:143],v[142:143],v[110:111]
v_pk_mul_f32 v[148:149],v[148:149],v[110:111]
v_pk_mul_f32 v[150:151],v[150:151],v[110:111]
v_pk_mul_f32 v[156:157],v[156:157],v[110:111]
v_pk_mul_f32 v[158:159],v[158:159],v[110:111]
v_pk_mul_f32 v[164:165],v[164:165],v[110:111]
v_pk_mul_f32 v[166:167],v[166:167],v[110:111]
v_pk_mul_f32 v[172:173],v[172:173],v[110:111]
v_pk_mul_f32 v[174:175],v[174:175],v[110:111]
v_pk_mul_f32 v[180:181],v[180:181],v[110:111]
v_pk_mul_f32 v[182:183],v[182:183],v[110:111]
v_pk_mul_f32 v[188:189],v[188:189],v[110:111]
v_pk_mul_f32 v[190:191],v[190:191],v[110:111]
v_pk_mul_f32 v[196:197],v[196:197],v[110:111]
v_pk_mul_f32 v[198:199],v[198:199],v[110:111]
v_pk_mul_f32 v[204:205],v[204:205],v[110:111]
v_pk_mul_f32 v[206:207],v[206:207],v[110:111]
v_pk_mul_f32 v[212:213],v[212:213],v[110:111]
v_pk_mul_f32 v[214:215],v[214:215],v[110:111]
v_pk_mul_f32 v[220:221],v[220:221],v[110:111]
v_pk_mul_f32 v[222:223],v[222:223],v[110:111]
v_pk_mul_f32 v[228:229],v[228:229],v[110:111]
v_pk_mul_f32 v[230:231],v[230:231],v[110:111]
v_pk_mul_f32 v[236:237],v[236:237],v[110:111]
v_pk_mul_f32 v[238:239],v[238:239],v[110:111]
v_pk_mul_f32 v[244:245],v[244:245],v[110:111]
v_pk_mul_f32 v[246:247],v[246:247],v[110:111]
v_pk_mul_f32 v[252:253],v[252:253],v[110:111]
v_pk_mul_f32 v[254:255],v[254:255],v[110:111]
s_waitcnt vmcnt(31)
M v[128:131],a[192:195],a[64:67],v[128:131]
v_mov_b32 v13,v8
s_nop 1
v_permlane16_swap_b32 v8,v13
v_add_f32 v8,v8,v13
M v[136:139],a[196:199],a[64:67],v[136:139]
v_mov_b32 v13,v8
s_nop 1
v_permlane32_swap_b32 v8,v13
v_add_f32 v8,v8,v13
s_waitcnt vmcnt(30)
M v[144:147],a[192:195],a[68:71],v[144:147]
v_rcp_f32 v123,v8
v_mov_b32 v13,v9
M v[152:155],a[196:199],a[68:71],v[152:155]
s_nop 0
v_permlane16_swap_b32 v9,v13
v_add_f32 v9,v9,v13
v_mov_b32 v13,v9
s_waitcnt vmcnt(29)
M v[160:163],a[192:195],a[72:75],v[160:163]
s_nop 0
v_permlane32_swap_b32 v9,v13
v_add_f32 v9,v9,v13
M v[168:171],a[196:199],a[72:75],v[168:171]
v_rcp_f32 v124,v9
s_waitcnt vmcnt(28)
M v[176:179],a[192:195],a[76:79],v[176:179]
M v[184:187],a[196:199],a[76:79],v[184:187]
CV v128,v128,v129
CV v129,v130,v131
CV v130,v136,v137
s_waitcnt vmcnt(27)
M v[192:195],a[192:195],a[80:83],v[192:195]
CV v131,v138,v139
M v[200:203],a[196:199],a[80:83],v[200:203]
CV v144,v144,v145
CV v145,v146,v147
CV v146,v152,v153
s_waitcnt vmcnt(26)
M v[208:211],a[192:195],a[84:87],v[208:211]
CV v147,v154,v155
M v[216:219],a[196:199],a[84:87],v[216:219]
CV v160,v160,v161
CV v161,v162,v163
CV v162,v168,v169
s_waitcnt vmcnt(25)
M v[224:227],a[192:195],a[88:91],v[224:227]
CV v163,v170,v171
M v[232:235],a[196:199],a[88:91],v[232:235]
CV v176,v176,v177
CV v177,v178,v179
CV v178,v184,v185
s_waitcnt vmcnt(24)
M v[240:243],a[192:195],a[92:95],v[240:243]
CV v179,v186,v187
M v[248:251],a[196:199],a[92:95],v[248:251]
CV v192,v192,v193
CV v193,v194,v195
CV v194,v200,v201
s_waitcnt vmcnt(23)
M v[132:135],a[192:195],a[96:99],v[132:135]
CV v195,v202,v203
M v[140:143],a[196:199],a[96:99],v[140:143]
CV v208,v208,v209
CV v209,v210,v211
CV v210,v216,v217
s_waitcnt vmcnt(22)
M v[148:151],a[192:195],a[100:103],v[148:151]
CV v211,v218,v219
M v[156:159],a[196:199],a[100:103],v[156:159]
CV v224,v224,v225
CV v225,v226,v227
CV v226,v232,v233
s_waitcnt vmcnt(21)
M v[164:167],a[192:195],a[104:107],v[164:167]
CV v227,v234,v235
M v[172:175],a[196:199],a[104:107],v[172:175]
CV v240,v240,v241
CV v241,v242,v243
CV v242,v248,v249
s_waitcnt vmcnt(20)
M v[180:183],a[192:195],a[108:111],v[180:183]
CV v243,v250,v251
M v[188:191],a[196:199],a[108:111],v[188:191]
CV v132,v132,v133
CV v133,v134,v135
CV v134,v140,v141
s_waitcnt vmcnt(19)
M v[196:199],a[192:195],a[112:115],v[196:199]
CV v135,v142,v143
M v[204:207],a[196:199],a[112:115],v[204:207]
CV v148,v148,v149
CV v149,v150,v151
CV v150,v156,v157
s_waitcnt vmcnt(18)
M v[212:215],a[192:195],a[116:119],v[212:215]
CV v151,v158,v159
M v[220:223],a[196:199],a[116:119],v[220:223]
CV v164,v164,v165
CV v165,v166,v167
CV v166,v172,v173
s_waitcnt vmcnt(17)
M v[228:231],a[192:195],a[120:123],v[228:231]
CV v167,v174,v175
M v[236:239],a[196:199],a[120:123],v[236:239]
CV v180,v180,v181
CV v181,v182,v183
CV v182,v188,v189
s_waitcnt vmcnt(16)
M v[244:247],a[192:195],a[124:127],v[244:247]
CV v183,v190,v191
M v[252:255],a[196:199],a[124:127],v[252:255]
CV v196,v196,v197
CV v197,v198,v199
CV v198,v204,v205
CV v199,v206,v207
CV v212,v212,v213
CV v213,v214,v215
CV v214,v220,v221
CV v215,v222,v223
CV v228,v228,v229
CV v229,v230,v231
CV v230,v236,v237
CV v231,v238,v239
CV v244,v244,v245
CV v245,v246,v247
CV v246,v252,v253
CV v247,v254,v255
L_l2_done:
s_waitcnt lgkmcnt(15)
M v[32:35],a[0:3],v[128:131],0
s_lshr_b32 s46,s2,3
s_mul_i32 s12,s46,9363
s_waitcnt vmcnt(31)
DT a[64:65],v121,33216
M v[32:35],a[4:7],v[144:147],v[32:35]
s_lshr_b32 s12,s12,16
s_mul_i32 s47,s12,7
DT a[66:67],v121,33728
M v[32:35],a[8:11],v[160:163],v[32:35]
s_sub_u32 s13,s46,s47
s_and_b32 s47,s2,7
s_waitcnt vmcnt(30)
DT a[68:69],v121,34240
M v[32:35],a[12:15],v[176:179],v[32:35]
s_lshl_b32 s47,s47,2
s_add_u32 s12,s12,s47
DT a[70:71],v121,34752
M v[32:35],a[16:19],v[192:195],v[32:35]
s_lshl_b32 s47,s12,7
s_waitcnt vmcnt(29)
DT a[72:73],v121,35264
M v[32:35],a[20:23],v[208:211],v[32:35]
s_add_u32 s8,s82,s47
s_addc_u32 s9,s83,0
DT a[74:75],v121,35776
M v[32:35],a[24:27],v[224:227],v[32:35]
s_add_u32 s8,s8,104857600
s_addc_u32 s9,s9,0
s_waitcnt vmcnt(28)
DT a[76:77],v121,36288
M v[32:35],a[28:31],v[240:243],v[32:35]
s_sub_u32 s10,1835008,s47
DT a[78:79],v121,36800
M v[36:39],a[0:3],v[132:135],0
s_cmp_ge_u32 s46,28
s_cselect_b32 s10,0,s10
s_waitcnt vmcnt(27)
DT a[80:81],v121,37312
M v[36:39],a[4:7],v[148:151],v[36:39]
s_mov_b32 s11,0x20000
s_mov_b32 s28,0
DT a[82:83],v121,37824
M v[36:39],a[8:11],v[164:167],v[36:39]
s_mov_b32 s29,130048
s_mov_b32 s30,260096
s_waitcnt vmcnt(26)
DT a[84:85],v121,38336
M v[36:39],a[12:15],v[180:183],v[36:39]
s_mov_b32 s31,390144
s_mov_b32 s32,524288
DT a[86:87],v121,38848
M v[36:39],a[16:19],v[196:199],v[36:39]
s_mov_b32 s33,654336
s_mov_b32 s34,784384
s_waitcnt vmcnt(25)
DT a[88:89],v121,39360
M v[36:39],a[20:23],v[212:215],v[36:39]
s_mov_b32 s35,914432
s_mov_b32 s36,1048576
DT a[90:91],v121,39872
M v[36:39],a[24:27],v[228:231],v[36:39]
s_mov_b32 s37,1178624
s_mov_b32 s38,1308672
s_waitcnt vmcnt(24)
DT a[92:93],v121,40384
M v[36:39],a[28:31],v[244:247],v[36:39]
s_waitcnt lgkmcnt(15)
s_mov_b32 s39,1438720
DT a[94:95],v121,40896
M v[40:43],a[32:35],v[128:131],0
s_mov_b32 s40,1572864
s_mov_b32 s41,1702912
s_waitcnt vmcnt(23)
DT a[96:97],v121,33248
M v[40:43],a[36:39],v[144:147],v[40:43]
s_lshl_b32 s47,s42,1
DT a[98:99],v121,33760
v_lshrrev_b32 v125,4,v0
M v[40:43],a[40:43],v[160:163],v[40:43]
s_waitcnt vmcnt(22)
DT a[100:101],v121,34272
v_lshlrev_b32 v125,3,v125
M v[40:43],a[44:47],v[176:179],v[40:43]
DT a[102:103],v121,34784
v_bfe_u32 v126,v0,3,1
M v[40:43],a[48:51],v[192:195],v[40:43]
s_waitcnt vmcnt(21)
DT a[104:105],v121,35296
v_add3_u32 v125,v125,v126,s47
M v[40:43],a[52:55],v[208:211],v[40:43]
DT a[106:107],v121,35808
v_and_b32 v126,7,v0
M v[40:43],a[56:59],v[224:227],v[40:43]
s_waitcnt vmcnt(20)
DT a[108:109],v121,36320
v_lshlrev_b32 v126,4,v126
M v[40:43],a[60:63],v[240:243],v[40:43]
DT a[110:111],v121,36832
v_lshl_add_u32 v125,v125,12,v126
M v[44:47],a[32:35],v[132:135],0
s_waitcnt vmcnt(19)
DT a[112:113],v121,37344
v_add_u32 v126,33152,v122
M v[44:47],a[36:39],v[148:151],v[44:47]
DT a[114:115],v121,37856
v_bfe_u32 v127,v0,3,2
M v[44:47],a[40:43],v[164:167],v[44:47]
s_waitcnt vmcnt(18)
DT a[116:117],v121,38368
v_lshlrev_b32 v127,11,v127
M v[44:47],a[44:47],v[180:183],v[44:47]
DT a[118:119],v121,38880
v_sub_u32 v127,v122,v127
M v[44:47],a[48:51],v[196:199],v[44:47]
s_waitcnt vmcnt(17)
DT a[120:121],v121,39392
v_add_u32 v127,132608,v127
M v[44:47],a[52:55],v[212:215],v[44:47]
s_mul_i32 s14,s42,6176
DT a[122:123],v121,39904
v_mul_f32 v32,v32,v123
M v[44:47],a[56:59],v[228:231],v[44:47]
s_waitcnt vmcnt(16)
DT a[124:125],v121,40416
DT a[126:127],v121,40928
v_mul_f32 v33,v33,v123
M v[44:47],a[60:63],v[244:247],v[44:47]
s_waitcnt lgkmcnt(15)
s_barrier
M v[48:51],a[64:67],v[128:131],0
DT a[0:1],v121,0
v_mul_f32 v34,v34,v123
M v[48:51],a[68:71],v[144:147],v[48:51]
DT a[2:3],v121,512
v_mul_f32 v35,v35,v123
M v[48:51],a[72:75],v[160:163],v[48:51]
DT a[4:5],v121,1024
v_mul_f32 v40,v40,v123
M v[48:51],a[76:79],v[176:179],v[48:51]
DT a[6:7],v121,1536
v_mul_f32 v41,v41,v123
M v[48:51],a[80:83],v[192:195],v[48:51]
DT a[8:9],v121,2048
v_mul_f32 v42,v42,v123
M v[48:51],a[84:87],v[208:211],v[48:51]
DT a[10:11],v121,2560
v_mul_f32 v43,v43,v123
M v[48:51],a[88:91],v[224:227],v[48:51]
DT a[12:13],v121,3072
CV v136,v32,v33
M v[48:51],a[92:95],v[240:243],v[48:51]
DT a[14:15],v121,3584
CV v137,v34,v35
M v[52:55],a[64:67],v[132:135],0
DT a[16:17],v121,4096
CV v138,v40,v41
M v[52:55],a[68:71],v[148:151],v[52:55]
DT a[18:19],v121,4608
CV v139,v42,v43
M v[52:55],a[72:75],v[164:167],v[52:55]
DT a[20:21],v121,5120
v_mul_f32 v36,v36,v124
M v[52:55],a[76:79],v[180:183],v[52:55]
DT a[22:23],v121,5632
v_mul_f32 v37,v37,v124
M v[52:55],a[80:83],v[196:199],v[52:55]
DT a[24:25],v121,6144
v_mul_f32 v38,v38,v124
M v[52:55],a[84:87],v[212:215],v[52:55]
DT a[26:27],v121,6656
v_mul_f32 v39,v39,v124
M v[52:55],a[88:91],v[228:231],v[52:55]
DT a[28:29],v121,7168
v_mul_f32 v44,v44,v124
M v[52:55],a[92:95],v[244:247],v[52:55]
s_waitcnt lgkmcnt(15)
DT a[30:31],v121,7680
v_mul_f32 v45,v45,v124
M v[56:59],a[96:99],v[128:131],0
DT a[32:33],v121,32
v_mul_f32 v46,v46,v124
M v[56:59],a[100:103],v[144:147],v[56:59]
DT a[34:35],v121,544
v_mul_f32 v47,v47,v124
M v[56:59],a[104:107],v[160:163],v[56:59]
DT a[36:37],v121,1056
CV v140,v36,v37
M v[56:59],a[108:111],v[176:179],v[56:59]
DT a[38:39],v121,1568
CV v141,v38,v39
M v[56:59],a[112:115],v[192:195],v[56:59]
DT a[40:41],v121,2080
CV v142,v44,v45
M v[56:59],a[116:119],v[208:211],v[56:59]
DT a[42:43],v121,2592
CV v143,v46,v47
M v[56:59],a[120:123],v[224:227],v[56:59]
DT a[44:45],v121,3104
v_lshrrev_b32 v118,2,v4
v_and_b32 v118,4,v118
v_lshl_or_b32 v118,v4,2,v118
v_and_b32 v118,0x784,v118
M v[56:59],a[124:127],v[240:243],v[56:59]
s_nop 0
DT a[46:47],v121,3616
M v[60:63],a[96:99],v[132:135],0
DT a[48:49],v121,4128
M v[60:63],a[100:103],v[148:151],v[60:63]
DT a[50:51],v121,4640
M v[60:63],a[104:107],v[164:167],v[60:63]
DT a[52:53],v121,5152
M v[60:63],a[108:111],v[180:183],v[60:63]
DT a[54:55],v121,5664
M v[60:63],a[112:115],v[196:199],v[60:63]
DT a[56:57],v121,6176
M v[60:63],a[116:119],v[212:215],v[60:63]
DT a[58:59],v121,6688
M v[60:63],a[120:123],v[228:231],v[60:63]
DT a[60:61],v121,7200
M v[60:63],a[124:127],v[244:247],v[60:63]
s_waitcnt lgkmcnt(15)
DT a[62:63],v121,7712
M v[32:35],a[0:3],v[128:131],0
s_mov_b32 s3,4096
DT a[64:65],v121,64
v_mul_f32 v48,v48,v123
M v[32:35],a[4:7],v[144:147],v[32:35]
s_add_u32 s54,s56,0
DT a[66:67],v121,576
v_mul_f32 v49,v49,v123
M v[32:35],a[8:11],v[160:163],v[32:35]
DT a[68:69],v121,1088
v_mul_f32 v50,v50,v123
M v[32:35],a[12:15],v[176:179],v[32:35]
DT a[70:71],v121,1600
v_mul_f32 v51,v51,v123
M v[32:35],a[16:19],v[192:195],v[32:35]
DT a[72:73],v121,2112
v_mul_f32 v56,v56,v123
M v[32:35],a[20:23],v[208:211],v[32:35]
DT a[74:75],v121,2624
v_mul_f32 v57,v57,v123
M v[32:35],a[24:27],v[224:227],v[32:35]
DT a[76:77],v121,3136
v_mul_f32 v58,v58,v123
M v[32:35],a[28:31],v[240:243],v[32:35]
DT a[78:79],v121,3648
v_mul_f32 v59,v59,v123
M v[36:39],a[0:3],v[132:135],0
DT a[80:81],v121,4160
CV v152,v48,v49
M v[36:39],a[4:7],v[148:151],v[36:39]
DT a[82:83],v121,4672
CV v153,v50,v51
M v[36:39],a[8:11],v[164:167],v[36:39]
DT a[84:85],v121,5184
CV v154,v56,v57
M v[36:39],a[12:15],v[180:183],v[36:39]
DT a[86:87],v121,5696
CV v155,v58,v59
M v[36:39],a[16:19],v[196:199],v[36:39]
DT a[88:89],v121,6208
v_mul_f32 v52,v52,v124
M v[36:39],a[20:23],v[212:215],v[36:39]
DT a[90:91],v121,6720
v_mul_f32 v53,v53,v124
M v[36:39],a[24:27],v[228:231],v[36:39]
DT a[92:93],v121,7232
v_mul_f32 v54,v54,v124
M v[36:39],a[28:31],v[244:247],v[36:39]
s_waitcnt lgkmcnt(15)
buffer_load_dword v112,v118,s[24:27],s3 offen offset:8 sc1
DT a[94:95],v121,7744
M v[40:43],a[32:35],v[128:131],0
DT a[96:97],v121,96
v_mul_f32 v55,v55,v124
M v[40:43],a[36:39],v[144:147],v[40:43]
DT a[98:99],v121,608
v_mul_f32 v60,v60,v124
M v[40:43],a[40:43],v[160:163],v[40:43]
DT a[100:101],v121,1120
v_mul_f32 v61,v61,v124
M v[40:43],a[44:47],v[176:179],v[40:43]
DT a[102:103],v121,1632
v_mul_f32 v62,v62,v124
M v[40:43],a[48:51],v[192:195],v[40:43]
DT a[104:105],v121,2144
v_mul_f32 v63,v63,v124
M v[40:43],a[52:55],v[208:211],v[40:43]
DT a[106:107],v121,2656
CV v156,v52,v53
M v[40:43],a[56:59],v[224:227],v[40:43]
DT a[108:109],v121,3168
CV v157,v54,v55
M v[40:43],a[60:63],v[240:243],v[40:43]
DT a[110:111],v121,3680
CV v158,v60,v61
M v[44:47],a[32:35],v[132:135],0
DT a[112:113],v121,4192
CV v159,v62,v63
M v[44:47],a[36:39],v[148:151],v[44:47]
buffer_store_dwordx4 v[136:139],v4,s[16:19],s54 offen sc1
DT a[114:115],v121,4704
M v[44:47],a[40:43],v[164:167],v[44:47]
s_add_u32 s54,s57,0
DT a[116:117],v121,5216
M v[44:47],a[44:47],v[180:183],v[44:47]
buffer_store_dwordx4 v[140:143],v4,s[16:19],s54 offen sc1
DT a[118:119],v121,5728
M v[44:47],a[48:51],v[196:199],v[44:47]
s_add_u32 s54,s56,16384
DT a[120:121],v121,6240
M v[44:47],a[52:55],v[212:215],v[44:47]
DT a[122:123],v121,6752
v_mul_f32 v32,v32,v123
M v[44:47],a[56:59],v[228:231],v[44:47]
DT a[124:125],v121,7264
DT a[126:127],v121,7776
v_mul_f32 v33,v33,v123
M v[44:47],a[60:63],v[244:247],v[44:47]
s_waitcnt vmcnt(11) lgkmcnt(15)
s_barrier
M v[48:51],a[64:67],v[128:131],0
s_add_u32 m0,s67,99456
DT a[0:1],v122,0
v_mul_f32 v34,v34,v123
M v[48:51],a[68:71],v[144:147],v[48:51]
DT a[2:3],v122,512
v_mul_f32 v35,v35,v123
M v[48:51],a[72:75],v[160:163],v[48:51]
DT a[4:5],v122,1024
v_mul_f32 v40,v40,v123
M v[48:51],a[76:79],v[176:179],v[48:51]
DT a[6:7],v122,1536
v_mul_f32 v41,v41,v123
M v[48:51],a[80:83],v[192:195],v[48:51]
DT a[8:9],v122,2048
v_mul_f32 v42,v42,v123
M v[48:51],a[84:87],v[208:211],v[48:51]
DT a[10:11],v122,2560
v_mul_f32 v43,v43,v123
M v[48:51],a[88:91],v[224:227],v[48:51]
DT a[12:13],v122,3072
CV v168,v32,v33
M v[48:51],a[92:95],v[240:243],v[48:51]
DT a[14:15],v122,3584
CV v169,v34,v35
M v[52:55],a[64:67],v[132:135],0
DT a[16:17],v122,4096
CV v170,v40,v41
M v[52:55],a[68:71],v[148:151],v[52:55]
DT a[18:19],v122,4608
CV v171,v42,v43
M v[52:55],a[72:75],v[164:167],v[52:55]
DT a[20:21],v122,5120
v_mul_f32 v36,v36,v124
M v[52:55],a[76:79],v[180:183],v[52:55]
DT a[22:23],v122,5632
v_mul_f32 v37,v37,v124
M v[52:55],a[80:83],v[196:199],v[52:55]
DT a[24:25],v122,6144
v_mul_f32 v38,v38,v124
M v[52:55],a[84:87],v[212:215],v[52:55]
DT a[26:27],v122,6656
v_mul_f32 v39,v39,v124
M v[52:55],a[88:91],v[228:231],v[52:55]
DT a[28:29],v122,7168
v_mul_f32 v44,v44,v124
M v[52:55],a[92:95],v[244:247],v[52:55]
s_waitcnt lgkmcnt(15)
buffer_load_dwordx4 v120,s[68:71],s84 offen offset:0 lds
DT a[30:31],v122,7680
M v[56:59],a[96:99],v[128:131],0
DT a[32:33],v122,32
v_mul_f32 v45,v45,v124
M v[56:59],a[100:103],v[144:147],v[56:59]
DT a[34:35],v122,544
v_mul_f32 v46,v46,v124
M v[56:59],a[104:107],v[160:163],v[56:59]
DT a[36:37],v122,1056
v_mul_f32 v47,v47,v124
M v[56:59],a[108:111],v[176:179],v[56:59]
buffer_load_dwordx4 v120,s[68:71],s85 offen offset:1024 lds
DT a[38:39],v122,1568
M v[56:59],a[112:115],v[192:195],v[56:59]
DT a[40:41],v122,2080
CV v172,v36,v37
M v[56:59],a[116:119],v[208:211],v[56:59]
DT a[42:43],v122,2592
CV v173,v38,v39
M v[56:59],a[120:123],v[224:227],v[56:59]
DT a[44:45],v122,3104
CV v174,v44,v45
M v[56:59],a[124:127],v[240:243],v[56:59]
buffer_load_dwordx4 v120,s[68:71],s86 offen offset:2048 lds
DT a[46:47],v122,3616
M v[60:63],a[96:99],v[132:135],0
DT a[48:49],v122,4128
CV v175,v46,v47
M v[60:63],a[100:103],v[148:151],v[60:63]
buffer_store_dwordx4 v[152:155],v4,s[16:19],s54 offen sc1
DT a[50:51],v122,4640
M v[60:63],a[104:107],v[164:167],v[60:63]
buffer_load_dwordx4 v120,s[68:71],s87 offen offset:3072 lds
DT a[52:53],v122,5152
M v[60:63],a[108:111],v[180:183],v[60:63]
s_add_u32 m0,s67,103552
s_add_u32 s54,s57,16384
DT a[54:55],v122,5664
M v[60:63],a[112:115],v[196:199],v[60:63]
buffer_store_dwordx4 v[156:159],v4,s[16:19],s54 offen sc1
DT a[56:57],v122,6176
M v[60:63],a[116:119],v[212:215],v[60:63]
DT a[58:59],v122,6688
M v[60:63],a[120:123],v[228:231],v[60:63]
buffer_load_dwordx4 v120,s[68:71],s88 offen offset:0 lds
DT a[60:61],v122,7200
M v[60:63],a[124:127],v[244:247],v[60:63]
s_waitcnt lgkmcnt(15)
DT a[62:63],v122,7712
buffer_load_dwordx4 v120,s[68:71],s89 offen offset:1024 lds
buffer_load_dwordx4 v120,s[68:71],s90 offen offset:2048 lds
buffer_load_dwordx4 v120,s[68:71],s91 offen offset:3072 lds
s_add_u32 s68,s68,128
s_addc_u32 s69,s69,0
s_sub_u32 s70,s70,128
M v[32:35],a[0:3],v[128:131],0
s_add_u32 s54,s56,32768
DT a[64:65],v122,64
v_mul_f32 v48,v48,v123
M v[32:35],a[4:7],v[144:147],v[32:35]
DT a[66:67],v122,576
v_mul_f32 v49,v49,v123
M v[32:35],a[8:11],v[160:163],v[32:35]
DT a[68:69],v122,1088
v_mul_f32 v50,v50,v123
M v[32:35],a[12:15],v[176:179],v[32:35]
DT a[70:71],v122,1600
v_mul_f32 v51,v51,v123
M v[32:35],a[16:19],v[192:195],v[32:35]
DT a[72:73],v122,2112
v_mul_f32 v56,v56,v123
M v[32:35],a[20:23],v[208:211],v[32:35]
DT a[74:75],v122,2624
v_mul_f32 v57,v57,v123
M v[32:35],a[24:27],v[224:227],v[32:35]
DT a[76:77],v122,3136
v_mul_f32 v58,v58,v123
M v[32:35],a[28:31],v[240:243],v[32:35]
DT a[78:79],v122,3648
v_mul_f32 v59,v59,v123
M v[36:39],a[0:3],v[132:135],0
DT a[80:81],v122,4160
CV v184,v48,v49
M v[36:39],a[4:7],v[148:151],v[36:39]
DT a[82:83],v122,4672
CV v185,v50,v51
M v[36:39],a[8:11],v[164:167],v[36:39]
DT a[84:85],v122,5184
CV v186,v56,v57
M v[36:39],a[12:15],v[180:183],v[36:39]
DT a[86:87],v122,5696
CV v187,v58,v59
M v[36:39],a[16:19],v[196:199],v[36:39]
DT a[88:89],v122,6208
v_mul_f32 v52,v52,v124
M v[36:39],a[20:23],v[212:215],v[36:39]
DT a[90:91],v122,6720
v_mul_f32 v53,v53,v124
M v[36:39],a[24:27],v[228:231],v[36:39]
DT a[92:93],v122,7232
v_mul_f32 v54,v54,v124
M v[36:39],a[28:31],v[244:247],v[36:39]
s_waitcnt lgkmcnt(15)
DT a[94:95],v122,7744
v_mul_f32 v55,v55,v124
M v[40:43],a[32:35],v[128:131],0
DT a[96:97],v122,96
v_mul_f32 v60,v60,v124
M v[40:43],a[36:39],v[144:147],v[40:43]
DT a[98:99],v122,608
v_mul_f32 v61,v61,v124
M v[40:43],a[40:43],v[160:163],v[40:43]
DT a[100:101],v122,1120
v_mul_f32 v62,v62,v124
M v[40:43],a[44:47],v[176:179],v[40:43]
DT a[102:103],v122,1632
v_mul_f32 v63,v63,v124
M v[40:43],a[48:51],v[192:195],v[40:43]
DT a[104:105],v122,2144
CV v188,v52,v53
M v[40:43],a[52:55],v[208:211],v[40:43]
DT a[106:107],v122,2656
CV v189,v54,v55
M v[40:43],a[56:59],v[224:227],v[40:43]
DT a[108:109],v122,3168
CV v190,v60,v61
M v[40:43],a[60:63],v[240:243],v[40:43]
DT a[110:111],v122,3680
CV v191,v62,v63
M v[44:47],a[32:35],v[132:135],0
buffer_store_dwordx4 v[168:171],v4,s[16:19],s54 offen sc1
DT a[112:113],v122,4192
M v[44:47],a[36:39],v[148:151],v[44:47]
s_add_u32 s54,s57,32768
DT a[114:115],v122,4704
M v[44:47],a[40:43],v[164:167],v[44:47]
buffer_store_dwordx4 v[172:175],v4,s[16:19],s54 offen sc1
DT a[116:117],v122,5216
M v[44:47],a[44:47],v[180:183],v[44:47]
s_add_u32 s54,s56,49152
DT a[118:119],v122,5728
M v[44:47],a[48:51],v[196:199],v[44:47]
buffer_store_dwordx4 v[184:187],v4,s[16:19],s54 offen sc1
DT a[120:121],v122,6240
M v[44:47],a[52:55],v[212:215],v[44:47]
s_add_u32 s54,s57,49152
DT a[122:123],v122,6752
v_mul_f32 v32,v32,v123
M v[44:47],a[56:59],v[228:231],v[44:47]
DT a[124:125],v122,7264
DT a[126:127],v122,7776
v_mul_f32 v33,v33,v123
M v[44:47],a[60:63],v[244:247],v[44:47]
s_waitcnt vmcnt(16) lgkmcnt(15)
s_barrier
M v[48:51],a[64:67],v[128:131],0
s_add_u32 m0,s67,66304
DT a[0:1],v122,33152
v_mul_f32 v34,v34,v123
M v[48:51],a[68:71],v[144:147],v[48:51]
DT a[2:3],v122,33664
v_mul_f32 v35,v35,v123
M v[48:51],a[72:75],v[160:163],v[48:51]
DT a[4:5],v122,34176
v_mul_f32 v40,v40,v123
M v[48:51],a[76:79],v[176:179],v[48:51]
DT a[6:7],v122,34688
v_mul_f32 v41,v41,v123
M v[48:51],a[80:83],v[192:195],v[48:51]
DT a[8:9],v122,35200
v_mul_f32 v42,v42,v123
M v[48:51],a[84:87],v[208:211],v[48:51]
DT a[10:11],v122,35712
v_mul_f32 v43,v43,v123
M v[48:51],a[88:91],v[224:227],v[48:51]
DT a[12:13],v122,36224
CV v200,v32,v33
M v[48:51],a[92:95],v[240:243],v[48:51]
DT a[14:15],v122,36736
CV v201,v34,v35
M v[52:55],a[64:67],v[132:135],0
DT a[16:17],v122,37248
CV v202,v40,v41
M v[52:55],a[68:71],v[148:151],v[52:55]
DT a[18:19],v122,37760
CV v203,v42,v43
M v[52:55],a[72:75],v[164:167],v[52:55]
DT a[20:21],v122,38272
v_mul_f32 v36,v36,v124
M v[52:55],a[76:79],v[180:183],v[52:55]
DT a[22:23],v122,38784
v_mul_f32 v37,v37,v124
M v[52:55],a[80:83],v[196:199],v[52:55]
DT a[24:25],v122,39296
v_mul_f32 v38,v38,v124
M v[52:55],a[84:87],v[212:215],v[52:55]
DT a[26:27],v122,39808
v_mul_f32 v39,v39,v124
M v[52:55],a[88:91],v[228:231],v[52:55]
DT a[28:29],v122,40320
v_mul_f32 v44,v44,v124
M v[52:55],a[92:95],v[244:247],v[52:55]
s_waitcnt lgkmcnt(15)
buffer_load_dwordx4 v120,s[68:71],s84 offen offset:0 lds
DT a[30:31],v122,40832
M v[56:59],a[96:99],v[128:131],0
DT a[32:33],v122,33184
v_mul_f32 v45,v45,v124
M v[56:59],a[100:103],v[144:147],v[56:59]
DT a[34:35],v122,33696
v_mul_f32 v46,v46,v124
M v[56:59],a[104:107],v[160:163],v[56:59]
DT a[36:37],v122,34208
v_mul_f32 v47,v47,v124
M v[56:59],a[108:111],v[176:179],v[56:59]
buffer_load_dwordx4 v120,s[68:71],s85 offen offset:1024 lds
DT a[38:39],v122,34720
M v[56:59],a[112:115],v[192:195],v[56:59]
DT a[40:41],v122,35232
CV v204,v36,v37
M v[56:59],a[116:119],v[208:211],v[56:59]
DT a[42:43],v122,35744
CV v205,v38,v39
M v[56:59],a[120:123],v[224:227],v[56:59]
DT a[44:45],v122,36256
CV v206,v44,v45
M v[56:59],a[124:127],v[240:243],v[56:59]
buffer_load_dwordx4 v120,s[68:71],s86 offen offset:2048 lds
DT a[46:47],v122,36768
M v[60:63],a[96:99],v[132:135],0
DT a[48:49],v122,37280
CV v207,v46,v47
M v[60:63],a[100:103],v[148:151],v[60:63]
buffer_store_dwordx4 v[188:191],v4,s[16:19],s54 offen sc1
DT a[50:51],v122,37792
M v[60:63],a[104:107],v[164:167],v[60:63]
buffer_load_dwordx4 v120,s[68:71],s87 offen offset:3072 lds
DT a[52:53],v122,38304
M v[60:63],a[108:111],v[180:183],v[60:63]
s_add_u32 m0,s67,70400
DT a[54:55],v122,38816
M v[60:63],a[112:115],v[196:199],v[60:63]
DT a[56:57],v122,39328
M v[60:63],a[116:119],v[212:215],v[60:63]
DT a[58:59],v122,39840
M v[60:63],a[120:123],v[228:231],v[60:63]
buffer_load_dwordx4 v120,s[68:71],s88 offen offset:0 lds
DT a[60:61],v122,40352
M v[60:63],a[124:127],v[244:247],v[60:63]
s_waitcnt lgkmcnt(15)
DT a[62:63],v122,40864
buffer_load_dwordx4 v120,s[68:71],s89 offen offset:1024 lds
buffer_load_dwordx4 v120,s[68:71],s90 offen offset:2048 lds
buffer_load_dwordx4 v120,s[68:71],s91 offen offset:3072 lds
s_add_u32 s68,s68,128
s_addc_u32 s69,s69,0
s_sub_u32 s70,s70,128
s_waitcnt vmcnt(24)
v_cmp_eq_u32 vcc,0x01010101,v112
s_nop 0
s_cmp_eq_u64 vcc,-1
s_cbranch_scc0 L_spin9
L_spun9:
M v[32:35],a[0:3],v[128:131],0
s_add_u32 s54,s56,65536
DT a[64:65],v122,33216
v_mul_f32 v48,v48,v123
M v[32:35],a[4:7],v[144:147],v[32:35]
DT a[66:67],v122,33728
v_mul_f32 v49,v49,v123
M v[32:35],a[8:11],v[160:163],v[32:35]
DT a[68:69],v122,34240
v_mul_f32 v50,v50,v123
M v[32:35],a[12:15],v[176:179],v[32:35]
DT a[70:71],v122,34752
v_mul_f32 v51,v51,v123
M v[32:35],a[16:19],v[192:195],v[32:35]
DT a[72:73],v122,35264
v_mul_f32 v56,v56,v123
M v[32:35],a[20:23],v[208:211],v[32:35]
DT a[74:75],v122,35776
v_mul_f32 v57,v57,v123
M v[32:35],a[24:27],v[224:227],v[32:35]
DT a[76:77],v122,36288
v_mul_f32 v58,v58,v123
M v[32:35],a[28:31],v[240:243],v[32:35]
DT a[78:79],v122,36800
v_mul_f32 v59,v59,v123
M v[36:39],a[0:3],v[132:135],0
DT a[80:81],v122,37312
CV v216,v48,v49
M v[36:39],a[4:7],v[148:151],v[36:39]
DT a[82:83],v122,37824
CV v217,v50,v51
M v[36:39],a[8:11],v[164:167],v[36:39]
DT a[84:85],v122,38336
CV v218,v56,v57
M v[36:39],a[12:15],v[180:183],v[36:39]
DT a[86:87],v122,38848
CV v219,v58,v59
M v[36:39],a[16:19],v[196:199],v[36:39]
DT a[88:89],v122,39360
v_mul_f32 v52,v52,v124
M v[36:39],a[20:23],v[212:215],v[36:39]
DT a[90:91],v122,39872
v_mul_f32 v53,v53,v124
M v[36:39],a[24:27],v[228:231],v[36:39]
DT a[92:93],v122,40384
v_mul_f32 v54,v54,v124
M v[36:39],a[28:31],v[244:247],v[36:39]
s_waitcnt lgkmcnt(15)
DT a[94:95],v122,40896
v_mul_f32 v55,v55,v124
M v[40:43],a[32:35],v[128:131],0
DT a[96:97],v122,33248
v_mul_f32 v60,v60,v124
M v[40:43],a[36:39],v[144:147],v[40:43]
DT a[98:99],v122,33760
v_mul_f32 v61,v61,v124
M v[40:43],a[40:43],v[160:163],v[40:43]
DT a[100:101],v122,34272
v_mul_f32 v62,v62,v124
M v[40:43],a[44:47],v[176:179],v[40:43]
DT a[102:103],v122,34784
v_mul_f32 v63,v63,v124
M v[40:43],a[48:51],v[192:195],v[40:43]
DT a[104:105],v122,35296
CV v220,v52,v53
M v[40:43],a[52:55],v[208:211],v[40:43]
DT a[106:107],v122,35808
CV v221,v54,v55
M v[40:43],a[56:59],v[224:227],v[40:43]
DT a[108:109],v122,36320
CV v222,v60,v61
M v[40:43],a[60:63],v[240:243],v[40:43]
DT a[110:111],v122,36832
CV v223,v62,v63
M v[44:47],a[32:35],v[132:135],0
buffer_store_dwordx4 v[200:203],v4,s[16:19],s54 offen sc1
DT a[112:113],v122,37344
M v[44:47],a[36:39],v[148:151],v[44:47]
s_add_u32 s54,s57,65536
DT a[114:115],v122,37856
M v[44:47],a[40:43],v[164:167],v[44:47]
buffer_store_dwordx4 v[204:207],v4,s[16:19],s54 offen sc1
DT a[116:117],v122,38368
M v[44:47],a[44:47],v[180:183],v[44:47]
s_add_u32 s54,s56,81920
DT a[118:119],v122,38880
M v[44:47],a[48:51],v[196:199],v[44:47]
buffer_store_dwordx4 v[216:219],v4,s[16:19],s54 offen sc1
DT a[120:121],v122,39392
M v[44:47],a[52:55],v[212:215],v[44:47]
s_add_u32 s54,s57,81920
DT a[122:123],v122,39904
v_mul_f32 v32,v32,v123
M v[44:47],a[56:59],v[228:231],v[44:47]
DT a[124:125],v122,40416
DT a[126:127],v122,40928
v_mul_f32 v33,v33,v123
M v[44:47],a[60:63],v[244:247],v[44:47]
s_waitcnt vmcnt(15) lgkmcnt(15)
s_barrier
M v[48:51],a[64:67],v[128:131],0
s_add_u32 m0,s67,0
DT a[0:1],v121,33152
v_mul_f32 v34,v34,v123
M v[48:51],a[68:71],v[144:147],v[48:51]
DT a[2:3],v121,33664
v_mul_f32 v35,v35,v123
M v[48:51],a[72:75],v[160:163],v[48:51]
DT a[4:5],v121,34176
v_mul_f32 v40,v40,v123
M v[48:51],a[76:79],v[176:179],v[48:51]
DT a[6:7],v121,34688
v_mul_f32 v41,v41,v123
M v[48:51],a[80:83],v[192:195],v[48:51]
DT a[8:9],v121,35200
v_mul_f32 v42,v42,v123
M v[48:51],a[84:87],v[208:211],v[48:51]
DT a[10:11],v121,35712
v_mul_f32 v43,v43,v123
M v[48:51],a[88:91],v[224:227],v[48:51]
DT a[12:13],v121,36224
CV v232,v32,v33
M v[48:51],a[92:95],v[240:243],v[48:51]
DT a[14:15],v121,36736
CV v233,v34,v35
M v[52:55],a[64:67],v[132:135],0
DT a[16:17],v121,37248
CV v234,v40,v41
M v[52:55],a[68:71],v[148:151],v[52:55]
DT a[18:19],v121,37760
CV v235,v42,v43
M v[52:55],a[72:75],v[164:167],v[52:55]
DT a[20:21],v121,38272
v_mul_f32 v36,v36,v124
M v[52:55],a[76:79],v[180:183],v[52:55]
DT a[22:23],v121,38784
v_mul_f32 v37,v37,v124
M v[52:55],a[80:83],v[196:199],v[52:55]
DT a[24:25],v121,39296
v_mul_f32 v38,v38,v124
M v[52:55],a[84:87],v[212:215],v[52:55]
DT a[26:27],v121,39808
v_mul_f32 v39,v39,v124
M v[52:55],a[88:91],v[228:231],v[52:55]
DT a[28:29],v121,40320
v_mul_f32 v44,v44,v124
M v[52:55],a[92:95],v[244:247],v[52:55]
s_waitcnt lgkmcnt(15)
buffer_load_dwordx4 v120,s[68:71],s84 offen offset:0 lds
DT a[30:31],v121,40832
M v[56:59],a[96:99],v[128:131],0
DT a[32:33],v121,33184
v_mul_f32 v45,v45,v124
M v[56:59],a[100:103],v[144:147],v[56:59]
DT a[34:35],v121,33696
v_mul_f32 v46,v46,v124
M v[56:59],a[104:107],v[160:163],v[56:59]
DT a[36:37],v121,34208
v_mul_f32 v47,v47,v124
M v[56:59],a[108:111],v[176:179],v[56:59]
buffer_load_dwordx4 v120,s[68:71],s85 offen offset:1024 lds
DT a[38:39],v121,34720
M v[56:59],a[112:115],v[192:195],v[56:59]
DT a[40:41],v121,35232
CV v236,v36,v37
M v[56:59],a[116:119],v[208:211],v[56:59]
DT a[42:43],v121,35744
CV v237,v38,v39
M v[56:59],a[120:123],v[224:227],v[56:59]
DT a[44:45],v121,36256
CV v238,v44,v45
M v[56:59],a[124:127],v[240:243],v[56:59]
buffer_load_dwordx4 v120,s[68:71],s86 offen offset:2048 lds
DT a[46:47],v121,36768
M v[60:63],a[96:99],v[132:135],0
DT a[48:49],v121,37280
CV v239,v46,v47
M v[60:63],a[100:103],v[148:151],v[60:63]
buffer_store_dwordx4 v[220:223],v4,s[16:19],s54 offen sc1
DT a[50:51],v121,37792
M v[60:63],a[104:107],v[164:167],v[60:63]
buffer_load_dwordx4 v120,s[68:71],s87 offen offset:3072 lds
DT a[52:53],v121,38304
M v[60:63],a[108:111],v[180:183],v[60:63]
s_add_u32 m0,s67,4096
DT a[54:55],v121,38816
M v[60:63],a[112:115],v[196:199],v[60:63]
DT a[56:57],v121,39328
M v[60:63],a[116:119],v[212:215],v[60:63]
DT a[58:59],v121,39840
M v[60:63],a[120:123],v[228:231],v[60:63]
buffer_load_dwordx4 v120,s[68:71],s88 offen offset:0 lds
DT a[60:61],v121,40352
M v[60:63],a[124:127],v[244:247],v[60:63]
s_waitcnt lgkmcnt(15)
DT a[62:63],v121,40864
buffer_load_dwordx4 v120,s[68:71],s89 offen offset:1024 lds
buffer_load_dwordx4 v120,s[68:71],s90 offen offset:2048 lds
buffer_load_dwordx4 v120,s[68:71],s91 offen offset:3072 lds
s_add_u32 s68,s68,128
s_addc_u32 s69,s69,0
s_sub_u32 s70,s70,128
M v[32:35],a[0:3],v[128:131],0
s_add_u32 m0,s14,132608
DT a[64:65],v121,33216
v_mul_f32 v48,v48,v123
M v[32:35],a[4:7],v[144:147],v[32:35]
s_add_u32 s54,s56,98304
DT a[66:67],v121,33728
v_mul_f32 v49,v49,v123
M v[32:35],a[8:11],v[160:163],v[32:35]
DT a[68:69],v121,34240
v_mul_f32 v50,v50,v123
M v[32:35],a[12:15],v[176:179],v[32:35]
DT a[70:71],v121,34752
v_mul_f32 v51,v51,v123
M v[32:35],a[16:19],v[192:195],v[32:35]
DT a[72:73],v121,35264
v_mul_f32 v56,v56,v123
M v[32:35],a[20:23],v[208:211],v[32:35]
DT a[74:75],v121,35776
v_mul_f32 v57,v57,v123
M v[32:35],a[24:27],v[224:227],v[32:35]
DT a[76:77],v121,36288
v_mul_f32 v58,v58,v123
M v[32:35],a[28:31],v[240:243],v[32:35]
DT a[78:79],v121,36800
v_mul_f32 v59,v59,v123
M v[36:39],a[0:3],v[132:135],0
DT a[80:81],v121,37312
CV v248,v48,v49
M v[36:39],a[4:7],v[148:151],v[36:39]
DT a[82:83],v121,37824
CV v249,v50,v51
M v[36:39],a[8:11],v[164:167],v[36:39]
DT a[84:85],v121,38336
CV v250,v56,v57
M v[36:39],a[12:15],v[180:183],v[36:39]
DT a[86:87],v121,38848
CV v251,v58,v59
M v[36:39],a[16:19],v[196:199],v[36:39]
DT a[88:89],v121,39360
v_mul_f32 v52,v52,v124
M v[36:39],a[20:23],v[212:215],v[36:39]
DT a[90:91],v121,39872
v_mul_f32 v53,v53,v124
M v[36:39],a[24:27],v[228:231],v[36:39]
DT a[92:93],v121,40384
v_mul_f32 v54,v54,v124
M v[36:39],a[28:31],v[244:247],v[36:39]
s_waitcnt lgkmcnt(15)
DT a[94:95],v121,40896
v_mul_f32 v55,v55,v124
M v[40:43],a[32:35],v[128:131],0
buffer_load_dwordx4 v125,s[8:11],s36 offen offset:0 sc1 lds
DT a[96:97],v121,33248
M v[40:43],a[36:39],v[144:147],v[40:43]
DT a[98:99],v121,33760
v_mul_f32 v60,v60,v124
M v[40:43],a[40:43],v[160:163],v[40:43]
DT a[100:101],v121,34272
v_mul_f32 v61,v61,v124
M v[40:43],a[44:47],v[176:179],v[40:43]
DT a[102:103],v121,34784
v_mul_f32 v62,v62,v124
M v[40:43],a[48:51],v[192:195],v[40:43]
DT a[104:105],v121,35296
v_mul_f32 v63,v63,v124
M v[40:43],a[52:55],v[208:211],v[40:43]
DT a[106:107],v121,35808
CV v252,v52,v53
M v[40:43],a[56:59],v[224:227],v[40:43]
DT a[108:109],v121,36320
CV v253,v54,v55
M v[40:43],a[60:63],v[240:243],v[40:43]
DT a[110:111],v121,36832
CV v254,v60,v61
M v[44:47],a[32:35],v[132:135],0
DT a[112:113],v121,37344
CV v255,v62,v63
M v[44:47],a[36:39],v[148:151],v[44:47]
buffer_store_dwordx4 v[232:235],v4,s[16:19],s54 offen sc1
DT a[114:115],v121,37856
M v[44:47],a[40:43],v[164:167],v[44:47]
buffer_load_dwordx4 v125,s[8:11],s37 offen offset:1024 sc1 lds
DT a[116:117],v121,38368
M v[44:47],a[44:47],v[180:183],v[44:47]
s_add_u32 s54,s57,98304
DT a[118:119],v121,38880
M v[44:47],a[48:51],v[196:199],v[44:47]
buffer_store_dwordx4 v[236:239],v4,s[16:19],s54 offen sc1
DT a[120:121],v121,39392
M v[44:47],a[52:55],v[212:215],v[44:47]
s_add_u32 s54,s56,114688
DT a[122:123],v121,39904
v_mul_f32 v32,v32,v123
M v[44:47],a[56:59],v[228:231],v[44:47]
DT a[124:125],v121,40416
DT a[126:127],v121,40928
v_mul_f32 v33,v33,v123
M v[44:47],a[60:63],v[244:247],v[44:47]
s_waitcnt vmcnt(16) lgkmcnt(15)
s_barrier
M v[48:51],a[64:67],v[128:131],0
DT a[0:1],v121,0
v_mul_f32 v34,v34,v123
M v[48:51],a[68:71],v[144:147],v[48:51]
DT a[2:3],v121,512
v_mul_f32 v35,v35,v123
M v[48:51],a[72:75],v[160:163],v[48:51]
DT a[4:5],v121,1024
v_mul_f32 v40,v40,v123
M v[48:51],a[76:79],v[176:179],v[48:51]
DT a[6:7],v121,1536
v_mul_f32 v41,v41,v123
M v[48:51],a[80:83],v[192:195],v[48:51]
buffer_load_dwordx4 v125,s[8:11],s38 offen offset:2048 sc1 lds
DT a[8:9],v121,2048
M v[48:51],a[84:87],v[208:211],v[48:51]
DT a[10:11],v121,2560
v_mul_f32 v42,v42,v123
M v[48:51],a[88:91],v[224:227],v[48:51]
DT a[12:13],v121,3072
v_mul_f32 v43,v43,v123
M v[48:51],a[92:95],v[240:243],v[48:51]
DT a[14:15],v121,3584
CV v64,v32,v33
M v[52:55],a[64:67],v[132:135],0
DT a[16:17],v121,4096
CV v65,v34,v35
M v[52:55],a[68:71],v[148:151],v[52:55]
DT a[18:19],v121,4608
CV v66,v40,v41
M v[52:55],a[72:75],v[164:167],v[52:55]
DT a[20:21],v121,5120
CV v67,v42,v43
M v[52:55],a[76:79],v[180:183],v[52:55]
DT a[22:23],v121,5632
v_mul_f32 v36,v36,v124
M v[52:55],a[80:83],v[196:199],v[52:55]
DT a[24:25],v121,6144
v_mul_f32 v37,v37,v124
M v[52:55],a[84:87],v[212:215],v[52:55]
buffer_load_dwordx4 v125,s[8:11],s39 offen offset:3072 sc1 lds
DT a[26:27],v121,6656
M v[52:55],a[88:91],v[228:231],v[52:55]
s_add_u32 m0,s14,136704
DT a[28:29],v121,7168
v_mul_f32 v38,v38,v124
M v[52:55],a[92:95],v[244:247],v[52:55]
s_waitcnt lgkmcnt(15)
DT a[30:31],v121,7680
v_mul_f32 v39,v39,v124
M v[56:59],a[96:99],v[128:131],0
DT a[32:33],v121,32
v_mul_f32 v44,v44,v124
M v[56:59],a[100:103],v[144:147],v[56:59]
DT a[34:35],v121,544
v_mul_f32 v45,v45,v124
M v[56:59],a[104:107],v[160:163],v[56:59]
DT a[36:37],v121,1056
v_mul_f32 v46,v46,v124
M v[56:59],a[108:111],v[176:179],v[56:59]
DT a[38:39],v121,1568
v_mul_f32 v47,v47,v124
M v[56:59],a[112:115],v[192:195],v[56:59]
DT a[40:41],v121,2080
CV v68,v36,v37
M v[56:59],a[116:119],v[208:211],v[56:59]
DT a[42:43],v121,2592
CV v69,v38,v39
M v[56:59],a[120:123],v[224:227],v[56:59]
DT a[44:45],v121,3104
CV v70,v44,v45
M v[56:59],a[124:127],v[240:243],v[56:59]
buffer_load_dwordx4 v125,s[8:11],s40 offen offset:0 sc1 lds
DT a[46:47],v121,3616
M v[60:63],a[96:99],v[132:135],0
DT a[48:49],v121,4128
CV v71,v46,v47
M v[60:63],a[100:103],v[148:151],v[60:63]
buffer_store_dwordx4 v[248:251],v4,s[16:19],s54 offen sc1
DT a[50:51],v121,4640
M v[60:63],a[104:107],v[164:167],v[60:63]
s_add_u32 s54,s57,114688
DT a[52:53],v121,5152
M v[60:63],a[108:111],v[180:183],v[60:63]
buffer_store_dwordx4 v[252:255],v4,s[16:19],s54 offen sc1
DT a[54:55],v121,5664
M v[60:63],a[112:115],v[196:199],v[60:63]
DT a[56:57],v121,6176
M v[60:63],a[116:119],v[212:215],v[60:63]
DT a[58:59],v121,6688
M v[60:63],a[120:123],v[228:231],v[60:63]
DT a[60:61],v121,7200
M v[60:63],a[124:127],v[244:247],v[60:63]
s_waitcnt lgkmcnt(15)
DT a[62:63],v121,7712
buffer_load_dwordx4 v125,s[8:11],s41 offen offset:1024 sc1 lds
M v[32:35],a[0:3],v[128:131],0
s_add_u32 m0,s67,33152
DT a[64:65],v121,64
v_mul_f32 v48,v48,v123
M v[32:35],a[4:7],v[144:147],v[32:35]
s_add_u32 s54,s56,131072
DT a[66:67],v121,576
v_mul_f32 v49,v49,v123
M v[32:35],a[8:11],v[160:163],v[32:35]
DT a[68:69],v121,1088
v_mul_f32 v50,v50,v123
M v[32:35],a[12:15],v[176:179],v[32:35]
DT a[70:71],v121,1600
v_mul_f32 v51,v51,v123
M v[32:35],a[16:19],v[192:195],v[32:35]
DT a[72:73],v121,2112
v_mul_f32 v56,v56,v123
M v[32:35],a[20:23],v[208:211],v[32:35]
DT a[74:75],v121,2624
v_mul_f32 v57,v57,v123
M v[32:35],a[24:27],v[224:227],v[32:35]
DT a[76:77],v121,3136
v_mul_f32 v58,v58,v123
M v[32:35],a[28:31],v[240:243],v[32:35]
DT a[78:79],v121,3648
v_mul_f32 v59,v59,v123
M v[36:39],a[0:3],v[132:135],0
DT a[80:81],v121,4160
CV v72,v48,v49
M v[36:39],a[4:7],v[148:151],v[36:39]
DT a[82:83],v121,4672
CV v73,v50,v51
M v[36:39],a[8:11],v[164:167],v[36:39]
DT a[84:85],v121,5184
CV v74,v56,v57
M v[36:39],a[12:15],v[180:183],v[36:39]
DT a[86:87],v121,5696
CV v75,v58,v59
M v[36:39],a[16:19],v[196:199],v[36:39]
DT a[88:89],v121,6208
v_mul_f32 v52,v52,v124
M v[36:39],a[20:23],v[212:215],v[36:39]
DT a[90:91],v121,6720
v_mul_f32 v53,v53,v124
M v[36:39],a[24:27],v[228:231],v[36:39]
DT a[92:93],v121,7232
v_mul_f32 v54,v54,v124
M v[36:39],a[28:31],v[244:247],v[36:39]
s_waitcnt lgkmcnt(15)
DT a[94:95],v121,7744
v_mul_f32 v55,v55,v124
M v[40:43],a[32:35],v[128:131],0
buffer_load_dwordx4 v125,s[8:11],s28 offen offset:0 sc1 lds
DT a[96:97],v121,96
M v[40:43],a[36:39],v[144:147],v[40:43]
DT a[98:99],v121,608
v_mul_f32 v60,v60,v124
M v[40:43],a[40:43],v[160:163],v[40:43]
DT a[100:101],v121,1120
v_mul_f32 v61,v61,v124
M v[40:43],a[44:47],v[176:179],v[40:43]
DT a[102:103],v121,1632
v_mul_f32 v62,v62,v124
M v[40:43],a[48:51],v[192:195],v[40:43]
DT a[104:105],v121,2144
v_mul_f32 v63,v63,v124
M v[40:43],a[52:55],v[208:211],v[40:43]
DT a[106:107],v121,2656
CV v76,v52,v53
M v[40:43],a[56:59],v[224:227],v[40:43]
DT a[108:109],v121,3168
CV v77,v54,v55
M v[40:43],a[60:63],v[240:243],v[40:43]
DT a[110:111],v121,3680
CV v78,v60,v61
M v[44:47],a[32:35],v[132:135],0
buffer_load_dwordx4 v125,s[8:11],s29 offen offset:1024 sc1 lds
DT a[112:113],v121,4192
M v[44:47],a[36:39],v[148:151],v[44:47]
DT a[114:115],v121,4704
CV v79,v62,v63
M v[44:47],a[40:43],v[164:167],v[44:47]
buffer_store_dwordx4 v[64:67],v4,s[16:19],s54 offen sc1
DT a[116:117],v121,5216
M v[44:47],a[44:47],v[180:183],v[44:47]
s_add_u32 s54,s57,131072
DT a[118:119],v121,5728
M v[44:47],a[48:51],v[196:199],v[44:47]
buffer_store_dwordx4 v[68:71],v4,s[16:19],s54 offen sc1
DT a[120:121],v121,6240
M v[44:47],a[52:55],v[212:215],v[44:47]
DT a[122:123],v121,6752
v_mul_f32 v32,v32,v123
M v[44:47],a[56:59],v[228:231],v[44:47]
DT a[124:125],v121,7264
DT a[126:127],v121,7776
v_mul_f32 v33,v33,v123
M v[44:47],a[60:63],v[244:247],v[44:47]
s_waitcnt vmcnt(5) lgkmcnt(15)
s_barrier
buffer_load_dwordx4 v125,s[8:11],s30 offen offset:2048 sc1 lds
s_lshl_b32 s46,s53,5
s_add_u32 s46,s46,s43
s_lshl_b32 s46,s46,2
s_add_u32 s46,s46,4096
s_bitcmp1_b32 s50,4
s_cbranch_scc0 L_nopub8
s_cmp_eq_u32 s42,0
s_cbranch_scc0 L_nopub8
s_mov_b64 exec,1
v_mov_b32 v14,1
buffer_store_dword v14,off,s[24:27],s46 offset:64 sc1
s_mov_b64 exec,-1
L_nopub8:
M v[48:51],a[64:67],v[128:131],0
s_add_u32 s54,s56,147456
DT a[0:1],v122,0
v_mul_f32 v34,v34,v123
M v[48:51],a[68:71],v[144:147],v[48:51]
DT a[2:3],v122,512
v_mul_f32 v35,v35,v123
M v[48:51],a[72:75],v[160:163],v[48:51]
DT a[4:5],v122,1024
v_mul_f32 v40,v40,v123
M v[48:51],a[76:79],v[176:179],v[48:51]
DT a[6:7],v122,1536
v_mul_f32 v41,v41,v123
M v[48:51],a[80:83],v[192:195],v[48:51]
DT a[8:9],v122,2048
v_mul_f32 v42,v42,v123
M v[48:51],a[84:87],v[208:211],v[48:51]
DT a[10:11],v122,2560
v_mul_f32 v43,v43,v123
M v[48:51],a[88:91],v[224:227],v[48:51]
buffer_load_dwordx4 v125,s[8:11],s31 offen offset:3072 sc1 lds
DT a[12:13],v122,3072
M v[48:51],a[92:95],v[240:243],v[48:51]
s_add_u32 m0,s67,37248
DT a[14:15],v122,3584
CV v80,v32,v33
M v[52:55],a[64:67],v[132:135],0
DT a[16:17],v122,4096
CV v81,v34,v35
M v[52:55],a[68:71],v[148:151],v[52:55]
DT a[18:19],v122,4608
CV v82,v40,v41
M v[52:55],a[72:75],v[164:167],v[52:55]
DT a[20:21],v122,5120
CV v83,v42,v43
M v[52:55],a[76:79],v[180:183],v[52:55]
DT a[22:23],v122,5632
v_mul_f32 v36,v36,v124
M v[52:55],a[80:83],v[196:199],v[52:55]
DT a[24:25],v122,6144
v_mul_f32 v37,v37,v124
M v[52:55],a[84:87],v[212:215],v[52:55]
buffer_load_dwordx4 v125,s[8:11],s32 offen offset:0 sc1 lds
DT a[26:27],v122,6656
M v[52:55],a[88:91],v[228:231],v[52:55]
DT a[28:29],v122,7168
v_mul_f32 v38,v38,v124
M v[52:55],a[92:95],v[244:247],v[52:55]
s_waitcnt lgkmcnt(15)
DT a[30:31],v122,7680
v_mul_f32 v39,v39,v124
M v[56:59],a[96:99],v[128:131],0
DT a[32:33],v122,32
v_mul_f32 v44,v44,v124
M v[56:59],a[100:103],v[144:147],v[56:59]
DT a[34:35],v122,544
v_mul_f32 v45,v45,v124
M v[56:59],a[104:107],v[160:163],v[56:59]
DT a[36:37],v122,1056
v_mul_f32 v46,v46,v124
M v[56:59],a[108:111],v[176:179],v[56:59]
DT a[38:39],v122,1568
v_mul_f32 v47,v47,v124
M v[56:59],a[112:115],v[192:195],v[56:59]
DT a[40:41],v122,2080
CV v84,v36,v37
M v[56:59],a[116:119],v[208:211],v[56:59]
buffer_load_dwordx4 v125,s[8:11],s33 offen offset:1024 sc1 lds
DT a[42:43],v122,2592
M v[56:59],a[120:123],v[224:227],v[56:59]
DT a[44:45],v122,3104
CV v85,v38,v39
M v[56:59],a[124:127],v[240:243],v[56:59]
DT a[46:47],v122,3616
CV v86,v44,v45
M v[60:63],a[96:99],v[132:135],0
DT a[48:49],v122,4128
CV v87,v46,v47
M v[60:63],a[100:103],v[148:151],v[60:63]
buffer_store_dwordx4 v[72:75],v4,s[16:19],s54 offen sc1
DT a[50:51],v122,4640
M v[60:63],a[104:107],v[164:167],v[60:63]
s_add_u32 s54,s57,147456
DT a[52:53],v122,5152
M v[60:63],a[108:111],v[180:183],v[60:63]
buffer_store_dwordx4 v[76:79],v4,s[16:19],s54 offen sc1
DT a[54:55],v122,5664
M v[60:63],a[112:115],v[196:199],v[60:63]
buffer_load_dwordx4 v125,s[8:11],s34 offen offset:2048 sc1 lds
DT a[56:57],v122,6176
M v[60:63],a[116:119],v[212:215],v[60:63]
DT a[58:59],v122,6688
M v[60:63],a[120:123],v[228:231],v[60:63]
DT a[60:61],v122,7200
M v[60:63],a[124:127],v[244:247],v[60:63]
s_waitcnt lgkmcnt(15)
DT a[62:63],v122,7712
buffer_load_dwordx4 v125,s[8:11],s35 offen offset:3072 sc1 lds
M v[32:35],a[0:3],v[128:131],0
s_add_u32 s54,s56,163840
DT a[64:65],v122,64
v_mul_f32 v48,v48,v123
M v[32:35],a[4:7],v[144:147],v[32:35]
DT a[66:67],v122,576
v_mul_f32 v49,v49,v123
M v[32:35],a[8:11],v[160:163],v[32:35]
DT a[68:69],v122,1088
v_mul_f32 v50,v50,v123
M v[32:35],a[12:15],v[176:179],v[32:35]
DT a[70:71],v122,1600
v_mul_f32 v51,v51,v123
M v[32:35],a[16:19],v[192:195],v[32:35]
DT a[72:73],v122,2112
v_mul_f32 v56,v56,v123
M v[32:35],a[20:23],v[208:211],v[32:35]
DT a[74:75],v122,2624
v_mul_f32 v57,v57,v123
M v[32:35],a[24:27],v[224:227],v[32:35]
DT a[76:77],v122,3136
v_mul_f32 v58,v58,v123
M v[32:35],a[28:31],v[240:243],v[32:35]
DT a[78:79],v122,3648
v_mul_f32 v59,v59,v123
M v[36:39],a[0:3],v[132:135],0
DT a[80:81],v122,4160
CV v88,v48,v49
M v[36:39],a[4:7],v[148:151],v[36:39]
DT a[82:83],v122,4672
CV v89,v50,v51
M v[36:39],a[8:11],v[164:167],v[36:39]
DT a[84:85],v122,5184
CV v90,v56,v57
M v[36:39],a[12:15],v[180:183],v[36:39]
DT a[86:87],v122,5696
CV v91,v58,v59
M v[36:39],a[16:19],v[196:199],v[36:39]
DT a[88:89],v122,6208
v_mul_f32 v52,v52,v124
M v[36:39],a[20:23],v[212:215],v[36:39]
DT a[90:91],v122,6720
v_mul_f32 v53,v53,v124
M v[36:39],a[24:27],v[228:231],v[36:39]
DT a[92:93],v122,7232
v_mul_f32 v54,v54,v124
M v[36:39],a[28:31],v[244:247],v[36:39]
s_waitcnt lgkmcnt(15)
DT a[94:95],v122,7744
v_mul_f32 v55,v55,v124
M v[40:43],a[32:35],v[128:131],0
DT a[96:97],v122,96
v_mul_f32 v60,v60,v124
M v[40:43],a[36:39],v[144:147],v[40:43]
DT a[98:99],v122,608
v_mul_f32 v61,v61,v124
M v[40:43],a[40:43],v[160:163],v[40:43]
DT a[100:101],v122,1120
v_mul_f32 v62,v62,v124
M v[40:43],a[44:47],v[176:179],v[40:43]
DT a[102:103],v122,1632
v_mul_f32 v63,v63,v124
M v[40:43],a[48:51],v[192:195],v[40:43]
DT a[104:105],v122,2144
CV v92,v52,v53
M v[40:43],a[52:55],v[208:211],v[40:43]
DT a[106:107],v122,2656
CV v93,v54,v55
M v[40:43],a[56:59],v[224:227],v[40:43]
DT a[108:109],v122,3168
CV v94,v60,v61
M v[40:43],a[60:63],v[240:243],v[40:43]
DT a[110:111],v122,3680
CV v95,v62,v63
M v[44:47],a[32:35],v[132:135],0
buffer_store_dwordx4 v[80:83],v4,s[16:19],s54 offen sc1
DT a[112:113],v122,4192
M v[44:47],a[36:39],v[148:151],v[44:47]
s_add_u32 s54,s57,163840
DT a[114:115],v122,4704
M v[44:47],a[40:43],v[164:167],v[44:47]
buffer_store_dwordx4 v[84:87],v4,s[16:19],s54 offen sc1
DT a[116:117],v122,5216
M v[44:47],a[44:47],v[180:183],v[44:47]
s_add_u32 s54,s56,180224
DT a[118:119],v122,5728
M v[44:47],a[48:51],v[196:199],v[44:47]
buffer_store_dwordx4 v[88:91],v4,s[16:19],s54 offen sc1
DT a[120:121],v122,6240
M v[44:47],a[52:55],v[212:215],v[44:47]
DT a[122:123],v122,6752
v_mul_f32 v32,v32,v123
M v[44:47],a[56:59],v[228:231],v[44:47]
DT a[124:125],v122,7264
DT a[126:127],v122,7776
v_mul_f32 v33,v33,v123
M v[44:47],a[60:63],v[244:247],v[44:47]
s_waitcnt lgkmcnt(15)
v_mul_f32 v34,v34,v123
v_mul_f32 v35,v35,v123
M v[48:51],a[64:67],v[128:131],0
s_add_u32 s54,s57,180224
v_mul_f32 v40,v40,v123
v_mul_f32 v41,v41,v123
M v[48:51],a[68:71],v[144:147],v[48:51]
v_mul_f32 v42,v42,v123
v_mul_f32 v43,v43,v123
M v[48:51],a[72:75],v[160:163],v[48:51]
CV v136,v32,v33
CV v137,v34,v35
M v[48:51],a[76:79],v[176:179],v[48:51]
CV v138,v40,v41
CV v139,v42,v43
M v[48:51],a[80:83],v[192:195],v[48:51]
buffer_store_dwordx4 v[92:95],v4,s[16:19],s54 offen sc1
M v[48:51],a[84:87],v[208:211],v[48:51]
v_mul_f32 v36,v36,v124
v_mul_f32 v37,v37,v124
M v[48:51],a[88:91],v[224:227],v[48:51]
v_mul_f32 v38,v38,v124
v_mul_f32 v39,v39,v124
M v[48:51],a[92:95],v[240:243],v[48:51]
v_mul_f32 v44,v44,v124
v_mul_f32 v45,v45,v124
M v[52:55],a[64:67],v[132:135],0
v_mul_f32 v46,v46,v124
v_mul_f32 v47,v47,v124
M v[52:55],a[68:71],v[148:151],v[52:55]
s_add_u32 s54,s56,196608
CV v140,v36,v37
CV v141,v38,v39
M v[52:55],a[72:75],v[164:167],v[52:55]
CV v142,v44,v45
CV v143,v46,v47
M v[52:55],a[76:79],v[180:183],v[52:55]
buffer_store_dwordx4 v[136:139],v4,s[16:19],s54 offen sc1
M v[52:55],a[80:83],v[196:199],v[52:55]
M v[52:55],a[84:87],v[212:215],v[52:55]
M v[52:55],a[88:91],v[228:231],v[52:55]
M v[52:55],a[92:95],v[244:247],v[52:55]
s_waitcnt lgkmcnt(0)
M v[56:59],a[96:99],v[128:131],0
M v[56:59],a[100:103],v[144:147],v[56:59]
M v[56:59],a[104:107],v[160:163],v[56:59]
M v[56:59],a[108:111],v[176:179],v[56:59]
s_add_u32 s54,s57,196608
M v[56:59],a[112:115],v[192:195],v[56:59]
buffer_store_dwordx4 v[140:143],v4,s[16:19],s54 offen sc1
M v[56:59],a[116:119],v[208:211],v[56:59]
M v[56:59],a[120:123],v[224:227],v[56:59]
M v[56:59],a[124:127],v[240:243],v[56:59]
M v[60:63],a[96:99],v[132:135],0
M v[60:63],a[100:103],v[148:151],v[60:63]
M v[60:63],a[104:107],v[164:167],v[60:63]
M v[60:63],a[108:111],v[180:183],v[60:63]
M v[60:63],a[112:115],v[196:199],v[60:63]
M v[60:63],a[116:119],v[212:215],v[60:63]
M v[60:63],a[120:123],v[228:231],v[60:63]
M v[60:63],a[124:127],v[244:247],v[60:63]
s_add_u32 s54,s56,212992
v_mul_f32 v48,v48,v123
v_mul_f32 v49,v49,v123
v_mul_f32 v50,v50,v123
v_mul_f32 v51,v51,v123
v_mul_f32 v56,v56,v123
v_mul_f32 v57,v57,v123
v_mul_f32 v58,v58,v123
v_mul_f32 v59,v59,v123
CV v152,v48,v49
CV v153,v50,v51
CV v154,v56,v57
CV v155,v58,v59
v_mul_f32 v52,v52,v124
v_mul_f32 v53,v53,v124
v_mul_f32 v54,v54,v124
v_mul_f32 v55,v55,v124
v_mul_f32 v60,v60,v124
v_mul_f32 v61,v61,v124
v_mul_f32 v62,v62,v124
v_mul_f32 v63,v63,v124
CV v156,v52,v53
CV v157,v54,v55
CV v158,v60,v61
CV v159,v62,v63
buffer_store_dwordx4 v[152:155],v4,s[16:19],s54 offen sc1
s_add_u32 s54,s57,212992
buffer_store_dwordx4 v[156:159],v4,s[16:19],s54 offen sc1
s_load_dwordx2 s[78:79],s[0:1],72
s_waitcnt vmcnt(0)
s_barrier
s_lshl_b32 s3,s53,7
s_lshl_b32 s46,s43,2
s_add_u32 s46,s46,s3
s_cmp_eq_u32 s42,0
s_cbranch_scc0 L_nopub9
s_mov_b64 exec,1
v_mov_b32 v13,1
buffer_store_dword v13,off,s[24:27],s46 offset:2048 sc1
s_mov_b64 exec,-1
L_nopub9:
v_lshrrev_b32 v13,2,v4
v_and_b32 v13,60,v13
buffer_load_dword v12,v13,s[24:27],s3 offen offset:2048 sc1
DT a[128:129],v126,0
s_lshl_b32 s46,s13,6
s_lshl_b32 s47,s42,4
s_add_u32 s46,s46,s47
DT a[130:131],v126,512
v_and_b32 v24,15,v0
v_add_u32 v24,s46,v24
v_cvt_f32_u32 v24,v24
DT a[132:133],v126,32
v_mul_f32 v24,0x3b124925,v24
v_lshrrev_b32 v25,4,v0
v_lshlrev_b32 v25,2,v25
DT a[134:135],v126,544
v_cvt_f32_u32 v26,v25
v_mul_f32 v26,v26,v24
v_add_f32 v27,0x3e800000,v26
DT a[136:137],v126,64
v_mul_f32 v96,0x43600000,v24
v_cos_f32 v96,v96
v_cmp_gt_u32 s[60:61],16,v0
DT a[138:139],v126,576
v_mul_f32 v28,0x42000000,v24
v_cos_f32 v28,v28
s_nop 0
v_add_f32 v28,v28,v28
DT a[140:141],v126,96
v_mov_b32 v29,v28
v_fmamk_f32 v192,v24,0x00000000,v26
v_fmamk_f32 v193,v24,0x3f800000,v26
DT a[142:143],v126,608
v_fmamk_f32 v194,v24,0x40000000,v26
v_fmamk_f32 v195,v24,0x40400000,v26
v_fmamk_f32 v196,v24,0x41800000,v26
DT a[144:145],v126,1024
v_fmamk_f32 v197,v24,0x41880000,v26
v_fmamk_f32 v198,v24,0x41900000,v26
v_fmamk_f32 v199,v24,0x41980000,v26
DT a[146:147],v126,1536
v_cos_f32 v192,v192
v_cos_f32 v193,v193
v_cos_f32 v194,v194
DT a[148:149],v126,1056
v_cos_f32 v195,v195
v_cos_f32 v196,v196
v_cos_f32 v197,v197
DT a[150:151],v126,1568
v_cos_f32 v198,v198
v_cos_f32 v199,v199
v_fmamk_f32 v200,v24,0x42000000,v26
DT a[152:153],v126,1088
v_fmamk_f32 v201,v24,0x42040000,v26
v_fmamk_f32 v202,v24,0x42080000,v26
v_fmamk_f32 v203,v24,0x420c0000,v26
DT a[154:155],v126,1600
v_fmamk_f32 v204,v24,0x42400000,v26
v_fmamk_f32 v205,v24,0x42440000,v26
v_fmamk_f32 v206,v24,0x42480000,v26
DT a[156:157],v126,1120
v_fmamk_f32 v207,v24,0x424c0000,v26
v_cos_f32 v200,v200
v_cos_f32 v201,v201
DT a[158:159],v126,1632
v_cos_f32 v202,v202
v_cos_f32 v203,v203
v_cos_f32 v204,v204
DT a[160:161],v126,2048
v_cos_f32 v205,v205
v_cos_f32 v206,v206
v_cos_f32 v207,v207
DT a[162:163],v126,2560
CV v128,v192,v193
CV v129,v194,v195
CV v130,v196,v197
DT a[164:165],v126,2080
CV v131,v198,v199
CV v132,v200,v201
CV v133,v202,v203
DT a[166:167],v126,2592
CV v134,v204,v205
CV v135,v206,v207
v_pk_fma_f32 v[192:193],v[28:29],v[200:201],v[192:193] neg_lo:[0,0,1] neg_hi:[0,0,1]
DT a[168:169],v126,2112
v_pk_fma_f32 v[194:195],v[28:29],v[202:203],v[194:195] neg_lo:[0,0,1] neg_hi:[0,0,1]
v_pk_fma_f32 v[196:197],v[28:29],v[204:205],v[196:197] neg_lo:[0,0,1] neg_hi:[0,0,1]
v_pk_fma_f32 v[198:199],v[28:29],v[206:207],v[198:199] neg_lo:[0,0,1] neg_hi:[0,0,1]
DT a[170:171],v126,2624
CV v136,v192,v193
CV v137,v194,v195
CV v138,v196,v197
DT a[172:173],v126,2144
CV v139,v198,v199
v_pk_fma_f32 v[200:201],v[28:29],v[192:193],v[200:201] neg_lo:[0,0,1] neg_hi:[0,0,1]
v_pk_fma_f32 v[202:203],v[28:29],v[194:195],v[202:203] neg_lo:[0,0,1] neg_hi:[0,0,1]
DT a[174:175],v126,2656
v_pk_fma_f32 v[204:205],v[28:29],v[196:197],v[204:205] neg_lo:[0,0,1] neg_hi:[0,0,1]
v_pk_fma_f32 v[206:207],v[28:29],v[198:199],v[206:207] neg_lo:[0,0,1] neg_hi:[0,0,1]
CV v140,v200,v201
DT a[176:177],v126,3072
CV v141,v202,v203
CV v142,v204,v205
CV v143,v206,v207
DT a[178:179],v126,3584
v_pk_fma_f32 v[192:193],v[28:29],v[200:201],v[192:193] neg_lo:[0,0,1] neg_hi:[0,0,1]
v_pk_fma_f32 v[194:195],v[28:29],v[202:203],v[194:195] neg_lo:[0,0,1] neg_hi:[0,0,1]
v_pk_fma_f32 v[196:197],v[28:29],v[204:205],v[196:197] neg_lo:[0,0,1] neg_hi:[0,0,1]
DT a[180:181],v126,3104
v_pk_fma_f32 v[198:199],v[28:29],v[206:207],v[198:199] neg_lo:[0,0,1] neg_hi:[0,0,1]
CV v144,v192,v193
CV v145,v194,v195
DT a[182:183],v126,3616
CV v146,v196,v197
CV v147,v198,v199
v_pk_fma_f32 v[200:201],v[28:29],v[192:193],v[200:201] neg_lo:[0,0,1] neg_hi:[0,0,1]
DT a[184:185],v126,3136
v_pk_fma_f32 v[202:203],v[28:29],v[194:195],v[202:203] neg_lo:[0,0,1] neg_hi:[0,0,1]
v_pk_fma_f32 v[204:205],v[28:29],v[196:197],v[204:205] neg_lo:[0,0,1] neg_hi:[0,0,1]
v_pk_fma_f32 v[206:207],v[28:29],v[198:199],v[206:207] neg_lo:[0,0,1] neg_hi:[0,0,1]
DT a[186:187],v126,3648
CV v148,v200,v201
CV v149,v202,v203
CV v150,v204,v205
DT a[188:189],v126,3168
CV v151,v206,v207
v_pk_fma_f32 v[192:193],v[28:29],v[200:201],v[192:193] neg_lo:[0,0,1] neg_hi:[0,0,1]
v_pk_fma_f32 v[194:195],v[28:29],v[202:203],v[194:195] neg_lo:[0,0,1] neg_hi:[0,0,1]
DT a[190:191],v126,3680
v_pk_fma_f32 v[196:197],v[28:29],v[204:205],v[196:197] neg_lo:[0,0,1] neg_hi:[0,0,1]
v_pk_fma_f32 v[198:199],v[28:29],v[206:207],v[198:199] neg_lo:[0,0,1] neg_hi:[0,0,1]
CV v152,v192,v193
DT a[192:193],v126,4096
CV v153,v194,v195
CV v154,v196,v197
CV v155,v198,v199
DT a[194:195],v126,4608
v_fmamk_f32 v192,v24,0x00000000,v27
v_fmamk_f32 v193,v24,0x3f800000,v27
v_fmamk_f32 v194,v24,0x40000000,v27
DT a[196:197],v126,4128
v_fmamk_f32 v195,v24,0x40400000,v27
v_fmamk_f32 v196,v24,0x41800000,v27
v_fmamk_f32 v197,v24,0x41880000,v27
DT a[198:199],v126,4640
v_fmamk_f32 v198,v24,0x41900000,v27
v_fmamk_f32 v199,v24,0x41980000,v27
v_cos_f32 v192,v192
DT a[200:201],v126,4160
v_cos_f32 v193,v193
v_cos_f32 v194,v194
v_cos_f32 v195,v195
DT a[202:203],v126,4672
v_cos_f32 v196,v196
v_cos_f32 v197,v197
v_cos_f32 v198,v198
DT a[204:205],v126,4192
v_cos_f32 v199,v199
v_fmamk_f32 v200,v24,0x42000000,v27
v_fmamk_f32 v201,v24,0x42040000,v27
DT a[206:207],v126,4704
v_fmamk_f32 v202,v24,0x42080000,v27
v_fmamk_f32 v203,v24,0x420c0000,v27
v_fmamk_f32 v204,v24,0x42400000,v27
DT a[208:209],v126,5120
v_fmamk_f32 v205,v24,0x42440000,v27
v_fmamk_f32 v206,v24,0x42480000,v27
v_fmamk_f32 v207,v24,0x424c0000,v27
DT a[210:211],v126,5632
v_cos_f32 v200,v200
v_cos_f32 v201,v201
v_cos_f32 v202,v202
DT a[212:213],v126,5152
v_cos_f32 v203,v203
v_cos_f32 v204,v204
v_cos_f32 v205,v205
DT a[214:215],v126,5664
v_cos_f32 v206,v206
v_cos_f32 v207,v207
CV v156,v192,v193
DT a[216:217],v126,5184
CV v157,v194,v195
CV v158,v196,v197
CV v159,v198,v199
DT a[218:219],v126,5696
v_cndmask_b32 v30,v192,v96,s[60:61]
CV v156,v30,v193
CV v160,v200,v201
DT a[220:221],v126,5216
CV v161,v202,v203
CV v162,v204,v205
CV v163,v206,v207
DT a[222:223],v126,5728
v_pk_fma_f32 v[192:193],v[28:29],v[200:201],v[192:193] neg_lo:[0,0,1] neg_hi:[0,0,1]
v_pk_fma_f32 v[194:195],v[28:29],v[202:203],v[194:195] neg_lo:[0,0,1] neg_hi:[0,0,1]
v_pk_fma_f32 v[196:197],v[28:29],v[204:205],v[196:197] neg_lo:[0,0,1] neg_hi:[0,0,1]
DT a[224:225],v126,6144
v_pk_fma_f32 v[198:199],v[28:29],v[206:207],v[198:199] neg_lo:[0,0,1] neg_hi:[0,0,1]
CV v164,v192,v193
CV v165,v194,v195
DT a[226:227],v126,6656
CV v166,v196,v197
CV v167,v198,v199
v_pk_fma_f32 v[200:201],v[28:29],v[192:193],v[200:201] neg_lo:[0,0,1] neg_hi:[0,0,1]
DT a[228:229],v126,6176
v_pk_fma_f32 v[202:203],v[28:29],v[194:195],v[202:203] neg_lo:[0,0,1] neg_hi:[0,0,1]
v_pk_fma_f32 v[204:205],v[28:29],v[196:197],v[204:205] neg_lo:[0,0,1] neg_hi:[0,0,1]
v_pk_fma_f32 v[206:207],v[28:29],v[198:199],v[206:207] neg_lo:[0,0,1] neg_hi:[0,0,1]
DT a[230:231],v126,6688
CV v168,v200,v201
CV v169,v202,v203
CV v170,v204,v205
DT a[232:233],v126,6208
CV v171,v206,v207
v_pk_fma_f32 v[192:193],v[28:29],v[200:201],v[192:193] neg_lo:[0,0,1] neg_hi:[0,0,1]
v_pk_fma_f32 v[194:195],v[28:29],v[202:203],v[194:195] neg_lo:[0,0,1] neg_hi:[0,0,1]
DT a[234:235],v126,6720
v_pk_fma_f32 v[196:197],v[28:29],v[204:205],v[196:197] neg_lo:[0,0,1] neg_hi:[0,0,1]
v_pk_fma_f32 v[198:199],v[28:29],v[206:207],v[198:199] neg_lo:[0,0,1] neg_hi:[0,0,1]
CV v172,v192,v193
DT a[236:237],v126,6240
CV v173,v194,v195
CV v174,v196,v197
CV v175,v198,v199
DT a[238:239],v126,6752
v_pk_fma_f32 v[200:201],v[28:29],v[192:193],v[200:201] neg_lo:[0,0,1] neg_hi:[0,0,1]
v_pk_fma_f32 v[202:203],v[28:29],v[194:195],v[202:203] neg_lo:[0,0,1] neg_hi:[0,0,1]
v_pk_fma_f32 v[204:205],v[28:29],v[196:197],v[204:205] neg_lo:[0,0,1] neg_hi:[0,0,1]
DT a[240:241],v126,7168
v_pk_fma_f32 v[206:207],v[28:29],v[198:199],v[206:207] neg_lo:[0,0,1] neg_hi:[0,0,1]
CV v176,v200,v201
CV v177,v202,v203
DT a[242:243],v126,7680
CV v178,v204,v205
CV v179,v206,v207
v_pk_fma_f32 v[192:193],v[28:29],v[200:201],v[192:193] neg_lo:[0,0,1] neg_hi:[0,0,1]
DT a[244:245],v126,7200
v_pk_fma_f32 v[194:195],v[28:29],v[202:203],v[194:195] neg_lo:[0,0,1] neg_hi:[0,0,1]
v_pk_fma_f32 v[196:197],v[28:29],v[204:205],v[196:197] neg_lo:[0,0,1] neg_hi:[0,0,1]
v_pk_fma_f32 v[198:199],v[28:29],v[206:207],v[198:199] neg_lo:[0,0,1] neg_hi:[0,0,1]
DT a[246:247],v126,7712
CV v180,v192,v193
CV v181,v194,v195
CV v182,v196,v197
DT a[248:249],v126,7232
CV v183,v198,v199
s_bfe_u32 s47,s12,0x20001
s_lshl_b32 s47,s47,2
DT a[250:251],v126,7744
v_and_b32 v28,3,v0
v_bfe_u32 v29,v0,2,1
v_lshlrev_b32 v29,4,v29
DT a[252:253],v126,7264
v_add3_u32 v28,v28,v29,s47
v_lshlrev_b32 v28,6,v28
s_lshr_b32 s47,s12,3
DT a[254:255],v126,7776
s_lshl_b32 s47,s47,4
s_and_b32 s54,s12,1
s_lshl_b32 s54,s54,3
s_add_u32 s47,s47,s54
v_bfe_u32 v29,v0,3,1
v_add3_u32 v28,v28,v29,s47
v_mul_u32_u24 v28,1792,v28
s_lshl_b32 s46,s46,1
v_lshlrev_b32 v25,1,v25
v_add3_u32 v119,v28,v25,s46
s_cmp_eq_u32 s10,0
s_cselect_b32 s14,0x7ff00000,0
s_add_u32 s15,s14,7168
v_mov_b32 v36,0x3f80
v_bfe_u32 v32,v0,2,2
v_lshlrev_b32 v32,3,v32
v_and_b32 v33,3,v0
v_add3_u32 v32,v32,v33,0
v_bfe_u32 v33,v32,2,2
v_lshrrev_b32 v34,4,v0
v_cmp_eq_u32 s[60:61],v33,v34
v_bfe_u32 v34,v32,1,1
v_lshrrev_b32 v33,4,v32
v_lshl_add_u32 v34,v33,1,v34
v_and_b32 v35,1,v32
v_lshlrev_b32 v35,4,v35
v_lshlrev_b32 v35,v35,v36
v_cndmask_b32 v35,0,v35,s[60:61]
v_cmp_eq_u32 vcc,0,v34
s_nop 1
v_cndmask_b32 v20,0,v35,vcc
v_cmp_eq_u32 vcc,1,v34
s_nop 1
v_cndmask_b32 v21,0,v35,vcc
v_cmp_eq_u32 vcc,2,v34
s_nop 1
v_cndmask_b32 v22,0,v35,vcc
v_cmp_eq_u32 vcc,3,v34
s_nop 1
v_cndmask_b32 v23,0,v35,vcc
v_bfe_u32 v32,v0,2,2
v_lshlrev_b32 v32,3,v32
v_and_b32 v33,3,v0
v_add3_u32 v32,v32,v33,4
v_bfe_u32 v33,v32,2,2
v_lshrrev_b32 v34,4,v0
v_cmp_eq_u32 s[60:61],v33,v34
v_bfe_u32 v34,v32,1,1
v_lshrrev_b32 v33,4,v32
v_lshl_add_u32 v34,v33,1,v34
v_and_b32 v35,1,v32
v_lshlrev_b32 v35,4,v35
v_lshlrev_b32 v35,v35,v36
v_cndmask_b32 v35,0,v35,s[60:61]
v_cmp_eq_u32 vcc,0,v34
s_nop 1
v_cndmask_b32 v24,0,v35,vcc
v_cmp_eq_u32 vcc,1,v34
s_nop 1
v_cndmask_b32 v25,0,v35,vcc
v_cmp_eq_u32 vcc,2,v34
s_nop 1
v_cndmask_b32 v26,0,v35,vcc
v_cmp_eq_u32 vcc,3,v34
s_nop 1
v_cndmask_b32 v27,0,v35,vcc
s_waitcnt lgkmcnt(0)
s_mov_b32 s4,s78
s_mov_b32 s5,s79
s_mov_b32 s6,3670016
s_mov_b32 s7,0x20000
v_and_b32 v14,15,v0
v_mul_u32_u24 v14,1792,v14
v_lshrrev_b32 v15,4,v0
v_lshl_add_u32 v14,v15,4,v14
s_mul_i32 s29,s53,112
s_mul_i32 s47,s43,7
s_add_u32 s28,s29,s47
s_lshl_b32 s47,s42,1
s_add_u32 s28,s28,s47
s_mul_i32 s46,s43,3
s_add_u32 s46,s46,s42
s_mul_i32 s47,s46,10923
s_lshr_b32 s47,s47,16
s_lshl_b32 s47,s47,3
s_add_u32 s46,s46,s47
s_add_u32 s46,s46,8
s_add_u32 s46,s46,s29
s_bitcmp1_b32 s50,4
s_cselect_b32 s28,s46,s28
s_cselect_b32 s40,3,4
s_add_u32 s29,s28,1
s_mul_i32 s46,s28,4682
s_lshr_b32 s46,s46,16
s_mul_i32 s47,s46,14
s_sub_u32 s47,s28,s47
s_mul_i32 s46,s46,28672
s_lshl_b32 s47,s47,6
s_add_u32 s46,s46,s47
s_add_u32 s30,s46,896
s_lshl_b32 s28,s28,14
s_cmp_eq_u32 s42,s40
s_cselect_b32 s30,0x7ff00000,s30
s_cselect_b32 s28,0x7ff00000,s28
s_add_u32 s32,s28,0
s_add_u32 s33,s28,4096
s_add_u32 s34,s28,8192
s_add_u32 s35,s28,12288
s_mul_i32 s46,s29,4682
s_lshr_b32 s46,s46,16
s_mul_i32 s47,s46,14
s_sub_u32 s47,s29,s47
s_mul_i32 s46,s46,28672
s_lshl_b32 s47,s47,6
s_add_u32 s46,s46,s47
s_add_u32 s31,s46,896
s_lshl_b32 s29,s29,14
s_cmp_eq_u32 s42,3
s_cselect_b32 s31,0x7ff00000,s31
s_cselect_b32 s29,0x7ff00000,s29
s_add_u32 s36,s29,0
s_add_u32 s37,s29,4096
s_add_u32 s38,s29,8192
s_add_u32 s39,s29,12288
s_lshl_b32 s46,s43,2
v_cmp_eq_u32 vcc,s46,v13
s_waitcnt vmcnt(0)
s_nop 1
v_cndmask_b32 v12,v12,1,vcc
v_cmp_eq_u32 vcc,1,v12
s_nop 0
s_cmp_eq_u64 vcc,-1
s_cbranch_scc0 L_spin10
L_spun10:
buffer_load_dwordx4 a[0:3],v4,s[16:19],s32 offen offset:0 sc1
buffer_load_dwordx4 a[4:7],v4,s[16:19],s32 offen offset:1024 sc1
buffer_load_dwordx4 a[8:11],v4,s[16:19],s32 offen offset:2048 sc1
buffer_load_dwordx4 a[12:15],v4,s[16:19],s32 offen offset:3072 sc1
buffer_load_dwordx4 a[16:19],v4,s[16:19],s33 offen offset:0 sc1
buffer_load_dwordx4 a[20:23],v4,s[16:19],s33 offen offset:1024 sc1
buffer_load_dwordx4 a[24:27],v4,s[16:19],s33 offen offset:2048 sc1
buffer_load_dwordx4 a[28:31],v4,s[16:19],s33 offen offset:3072 sc1
buffer_load_dwordx4 a[32:35],v4,s[16:19],s34 offen offset:0 sc1
buffer_load_dwordx4 a[36:39],v4,s[16:19],s34 offen offset:1024 sc1
buffer_load_dwordx4 a[40:43],v4,s[16:19],s34 offen offset:2048 sc1
buffer_load_dwordx4 a[44:47],v4,s[16:19],s34 offen offset:3072 sc1
buffer_load_dwordx4 a[48:51],v4,s[16:19],s35 offen offset:0 sc1
buffer_load_dwordx4 a[52:55],v4,s[16:19],s35 offen offset:1024 sc1
buffer_load_dwordx4 a[56:59],v4,s[16:19],s35 offen offset:2048 sc1
buffer_load_dwordx4 a[60:63],v4,s[16:19],s35 offen offset:3072 sc1
s_bitcmp1_b32 s50,4
s_cbranch_scc1 L_red1
buffer_load_dwordx4 a[64:67],v4,s[16:19],s36 offen offset:0 sc1
buffer_load_dwordx4 a[68:71],v4,s[16:19],s36 offen offset:1024 sc1
buffer_load_dwordx4 a[72:75],v4,s[16:19],s36 offen offset:2048 sc1
buffer_load_dwordx4 a[76:79],v4,s[16:19],s36 offen offset:3072 sc1
buffer_load_dwordx4 a[80:83],v4,s[16:19],s37 offen offset:0 sc1
buffer_load_dwordx4 a[84:87],v4,s[16:19],s37 offen offset:1024 sc1
buffer_load_dwordx4 a[88:91],v4,s[16:19],s37 offen offset:2048 sc1
buffer_load_dwordx4 a[92:95],v4,s[16:19],s37 offen offset:3072 sc1
buffer_load_dwordx4 a[96:99],v4,s[16:19],s38 offen offset:0 sc1
buffer_load_dwordx4 a[100:103],v4,s[16:19],s38 offen offset:1024 sc1
buffer_load_dwordx4 a[104:107],v4,s[16:19],s38 offen offset:2048 sc1
buffer_load_dwordx4 a[108:111],v4,s[16:19],s38 offen offset:3072 sc1
buffer_load_dwordx4 a[112:115],v4,s[16:19],s39 offen offset:0 sc1
buffer_load_dwordx4 a[116:119],v4,s[16:19],s39 offen offset:1024 sc1
buffer_load_dwordx4 a[120:123],v4,s[16:19],s39 offen offset:2048 sc1
buffer_load_dwordx4 a[124:127],v4,s[16:19],s39 offen offset:3072 sc1
L_red1:
M v[96:99],v[128:131],a[128:131],0
DT a[128:129],v127,0
M v[100:103],v[128:131],a[132:135],0
DT a[130:131],v127,512
M v[104:107],v[128:131],a[136:139],0
DT a[132:133],v127,32
M v[108:111],v[128:131],a[140:143],0
DT a[134:135],v127,544
M v[96:99],v[132:135],a[144:147],v[96:99]
DT a[136:137],v127,64
M v[100:103],v[132:135],a[148:151],v[100:103]
DT a[138:139],v127,576
M v[104:107],v[132:135],a[152:155],v[104:107]
DT a[140:141],v127,96
M v[108:111],v[132:135],a[156:159],v[108:111]
DT a[142:143],v127,608
M v[96:99],v[136:139],a[160:163],v[96:99]
DT a[144:145],v127,1024
M v[100:103],v[136:139],a[164:167],v[100:103]
DT a[146:147],v127,1536
M v[104:107],v[136:139],a[168:171],v[104:107]
DT a[148:149],v127,1056
M v[108:111],v[136:139],a[172:175],v[108:111]
DT a[150:151],v127,1568
M v[96:99],v[140:143],a[176:179],v[96:99]
DT a[152:153],v127,1088
M v[100:103],v[140:143],a[180:183],v[100:103]
DT a[154:155],v127,1600
M v[104:107],v[140:143],a[184:187],v[104:107]
DT a[156:157],v127,1120
M v[108:111],v[140:143],a[188:191],v[108:111]
DT a[158:159],v127,1632
M v[96:99],v[144:147],a[192:195],v[96:99]
DT a[160:161],v127,2048
M v[100:103],v[144:147],a[196:199],v[100:103]
DT a[162:163],v127,2560
M v[104:107],v[144:147],a[200:203],v[104:107]
DT a[164:165],v127,2080
M v[108:111],v[144:147],a[204:207],v[108:111]
DT a[166:167],v127,2592
M v[96:99],v[148:151],a[208:211],v[96:99]
DT a[168:169],v127,2112
M v[100:103],v[148:151],a[212:215],v[100:103]
DT a[170:171],v127,2624
M v[104:107],v[148:151],a[216:219],v[104:107]
DT a[172:173],v127,2144
M v[108:111],v[148:151],a[220:223],v[108:111]
DT a[174:175],v127,2656
M v[96:99],v[152:155],a[224:227],v[96:99]
DT a[176:177],v127,3072
M v[100:103],v[152:155],a[228:231],v[100:103]
DT a[178:179],v127,3584
M v[104:107],v[152:155],a[232:235],v[104:107]
DT a[180:181],v127,3104
M v[108:111],v[152:155],a[236:239],v[108:111]
DT a[182:183],v127,3616
M v[96:99],v[156:159],a[240:243],v[96:99]
DT a[184:185],v127,3136
M v[100:103],v[156:159],a[244:247],v[100:103]
DT a[186:187],v127,3648
M v[104:107],v[156:159],a[248:251],v[104:107]
DT a[188:189],v127,3168
M v[108:111],v[156:159],a[252:255],v[108:111]
s_waitcnt lgkmcnt(15)
DT a[190:191],v127,3680
M v[96:99],v[160:163],a[128:131],v[96:99]
DT a[192:193],v127,4096
M v[100:103],v[160:163],a[132:135],v[100:103]
DT a[194:195],v127,4608
M v[104:107],v[160:163],a[136:139],v[104:107]
DT a[196:197],v127,4128
M v[108:111],v[160:163],a[140:143],v[108:111]
DT a[198:199],v127,4640
M v[96:99],v[164:167],a[144:147],v[96:99]
DT a[200:201],v127,4160
M v[100:103],v[164:167],a[148:151],v[100:103]
DT a[202:203],v127,4672
M v[104:107],v[164:167],a[152:155],v[104:107]
DT a[204:205],v127,4192
M v[108:111],v[164:167],a[156:159],v[108:111]
s_waitcnt lgkmcnt(15)
DT a[206:207],v127,4704
DT a[208:209],v127,5120
DT a[210:211],v127,5632
M v[96:99],v[168:171],a[160:163],v[96:99]
DT a[212:213],v127,5152
M v[100:103],v[168:171],a[164:167],v[100:103]
DT a[214:215],v127,5664
M v[104:107],v[168:171],a[168:171],v[104:107]
DT a[216:217],v127,5184
M v[108:111],v[168:171],a[172:175],v[108:111]
s_waitcnt lgkmcnt(13)
DT a[218:219],v127,5696
M v[96:99],v[172:175],a[176:179],v[96:99]
DT a[220:221],v127,5216
M v[100:103],v[172:175],a[180:183],v[100:103]
DT a[222:223],v127,5728
M v[104:107],v[172:175],a[184:187],v[104:107]
M v[108:111],v[172:175],a[188:191],v[108:111]
s_waitcnt lgkmcnt(8)
M v[96:99],v[176:179],a[192:195],v[96:99]
M v[100:103],v[176:179],a[196:199],v[100:103]
M v[104:107],v[176:179],a[200:203],v[104:107]
M v[108:111],v[176:179],a[204:207],v[108:111]
s_waitcnt lgkmcnt(0)
M v[96:99],v[180:183],a[208:211],v[96:99]
M v[100:103],v[180:183],a[212:215],v[100:103]
M v[104:107],v[180:183],a[216:219],v[104:107]
M v[108:111],v[180:183],a[220:223],v[108:111]
s_nop 4
CV v96,v96,v97
CV v97,v98,v99
buffer_store_dwordx2 v[96:97],v119,s[4:7],s14 offen offset:0
CV v100,v100,v101
CV v101,v102,v103
buffer_store_dwordx2 v[100:101],v119,s[4:7],s14 offen offset:3584
CV v104,v104,v105
CV v105,v106,v107
buffer_store_dwordx2 v[104:105],v119,s[4:7],s15 offen offset:0
CV v108,v108,v109
CV v109,v110,v111
buffer_store_dwordx2 v[108:109],v119,s[4:7],s15 offen offset:3584
s_waitcnt vmcnt(19)
M v[40:43],v[20:23],a[0:3],0
M v[44:47],v[24:27],a[0:3],0
s_waitcnt vmcnt(18)
M v[40:43],v[20:23],a[4:7],v[40:43]
M v[44:47],v[24:27],a[4:7],v[44:47]
s_waitcnt vmcnt(17)
M v[40:43],v[20:23],a[8:11],v[40:43]
M v[44:47],v[24:27],a[8:11],v[44:47]
s_waitcnt vmcnt(16)
M v[40:43],v[20:23],a[12:15],v[40:43]
M v[44:47],v[24:27],a[12:15],v[44:47]
s_waitcnt vmcnt(15)
M v[40:43],v[20:23],a[16:19],v[40:43]
M v[44:47],v[24:27],a[16:19],v[44:47]
s_waitcnt vmcnt(14)
M v[40:43],v[20:23],a[20:23],v[40:43]
M v[44:47],v[24:27],a[20:23],v[44:47]
s_waitcnt vmcnt(13)
M v[40:43],v[20:23],a[24:27],v[40:43]
M v[44:47],v[24:27],a[24:27],v[44:47]
s_waitcnt vmcnt(12)
M v[40:43],v[20:23],a[28:31],v[40:43]
M v[44:47],v[24:27],a[28:31],v[44:47]
s_waitcnt vmcnt(11)
M v[40:43],v[20:23],a[32:35],v[40:43]
M v[44:47],v[24:27],a[32:35],v[44:47]
s_waitcnt vmcnt(10)
M v[40:43],v[20:23],a[36:39],v[40:43]
M v[44:47],v[24:27],a[36:39],v[44:47]
s_waitcnt vmcnt(9)
M v[40:43],v[20:23],a[40:43],v[40:43]
M v[44:47],v[24:27],a[40:43],v[44:47]
s_waitcnt vmcnt(8)
M v[40:43],v[20:23],a[44:47],v[40:43]
M v[44:47],v[24:27],a[44:47],v[44:47]
s_waitcnt vmcnt(7)
M v[40:43],v[20:23],a[48:51],v[40:43]
M v[44:47],v[24:27],a[48:51],v[44:47]
s_waitcnt vmcnt(6)
M v[40:43],v[20:23],a[52:55],v[40:43]
M v[44:47],v[24:27],a[52:55],v[44:47]
s_waitcnt vmcnt(5)
M v[40:43],v[20:23],a[56:59],v[40:43]
M v[44:47],v[24:27],a[56:59],v[44:47]
s_waitcnt vmcnt(4)
M v[40:43],v[20:23],a[60:63],v[40:43]
M v[44:47],v[24:27],a[60:63],v[44:47]
s_nop 6
CV v40,v40,v41
CV v41,v42,v43
CV v42,v44,v45
CV v43,v46,v47
buffer_store_dwordx4 v[40:43],v14,s[4:7],s30 offen
s_bitcmp1_b32 s50,4
s_cbranch_scc1 L_red2
s_sub_u32 s28,15,s45
s_lshl_b32 s3,s28,7
s_add_u32 s3,s3,4096
buffer_load_dword v12,v13,s[24:27],s3 offen offset:64 sc1
M v[48:51],v[20:23],a[64:67],0
M v[52:55],v[24:27],a[64:67],0
M v[48:51],v[20:23],a[68:71],v[48:51]
M v[52:55],v[24:27],a[68:71],v[52:55]
M v[48:51],v[20:23],a[72:75],v[48:51]
M v[52:55],v[24:27],a[72:75],v[52:55]
M v[48:51],v[20:23],a[76:79],v[48:51]
M v[52:55],v[24:27],a[76:79],v[52:55]
M v[48:51],v[20:23],a[80:83],v[48:51]
M v[52:55],v[24:27],a[80:83],v[52:55]
M v[48:51],v[20:23],a[84:87],v[48:51]
M v[52:55],v[24:27],a[84:87],v[52:55]
M v[48:51],v[20:23],a[88:91],v[48:51]
M v[52:55],v[24:27],a[88:91],v[52:55]
M v[48:51],v[20:23],a[92:95],v[48:51]
M v[52:55],v[24:27],a[92:95],v[52:55]
M v[48:51],v[20:23],a[96:99],v[48:51]
M v[52:55],v[24:27],a[96:99],v[52:55]
M v[48:51],v[20:23],a[100:103],v[48:51]
M v[52:55],v[24:27],a[100:103],v[52:55]
M v[48:51],v[20:23],a[104:107],v[48:51]
M v[52:55],v[24:27],a[104:107],v[52:55]
M v[48:51],v[20:23],a[108:111],v[48:51]
M v[52:55],v[24:27],a[108:111],v[52:55]
M v[48:51],v[20:23],a[112:115],v[48:51]
M v[52:55],v[24:27],a[112:115],v[52:55]
M v[48:51],v[20:23],a[116:119],v[48:51]
M v[52:55],v[24:27],a[116:119],v[52:55]
M v[48:51],v[20:23],a[120:123],v[48:51]
M v[52:55],v[24:27],a[120:123],v[52:55]
M v[48:51],v[20:23],a[124:127],v[48:51]
M v[52:55],v[24:27],a[124:127],v[52:55]
s_nop 6
CV v48,v48,v49
CV v49,v50,v51
CV v50,v52,v53
CV v51,v54,v55
buffer_store_dwordx4 v[48:51],v14,s[4:7],s31 offen
s_mul_i32 s28,s28,112
s_lshl_b32 s46,s43,2
s_add_u32 s46,s46,s42
s_lshr_b32 s47,s46,3
s_mul_i32 s47,s47,6
s_add_u32 s46,s46,s47
s_add_u32 s28,s28,s46
s_mul_i32 s46,s28,4682
s_lshr_b32 s46,s46,16
s_mul_i32 s47,s46,14
s_sub_u32 s47,s28,s47
s_mul_i32 s46,s46,28672
s_lshl_b32 s47,s47,6
s_add_u32 s46,s46,s47
s_add_u32 s30,s46,896
s_lshl_b32 s28,s28,14
s_add_u32 s32,s28,0
s_add_u32 s33,s28,4096
s_add_u32 s34,s28,8192
s_add_u32 s35,s28,12288
s_waitcnt vmcnt(1)
v_cmp_eq_u32 vcc,1,v12
s_nop 0
s_cmp_eq_u64 vcc,-1
s_cbranch_scc0 L_spin11
L_spun11:
buffer_load_dwordx4 a[0:3],v4,s[16:19],s32 offen offset:0 sc1
buffer_load_dwordx4 a[4:7],v4,s[16:19],s32 offen offset:1024 sc1
buffer_load_dwordx4 a[8:11],v4,s[16:19],s32 offen offset:2048 sc1
buffer_load_dwordx4 a[12:15],v4,s[16:19],s32 offen offset:3072 sc1
buffer_load_dwordx4 a[16:19],v4,s[16:19],s33 offen offset:0 sc1
buffer_load_dwordx4 a[20:23],v4,s[16:19],s33 offen offset:1024 sc1
buffer_load_dwordx4 a[24:27],v4,s[16:19],s33 offen offset:2048 sc1
buffer_load_dwordx4 a[28:31],v4,s[16:19],s33 offen offset:3072 sc1
buffer_load_dwordx4 a[32:35],v4,s[16:19],s34 offen offset:0 sc1
buffer_load_dwordx4 a[36:39],v4,s[16:19],s34 offen offset:1024 sc1
buffer_load_dwordx4 a[40:43],v4,s[16:19],s34 offen offset:2048 sc1
buffer_load_dwordx4 a[44:47],v4,s[16:19],s34 offen offset:3072 sc1
buffer_load_dwordx4 a[48:51],v4,s[16:19],s35 offen offset:0 sc1
buffer_load_dwordx4 a[52:55],v4,s[16:19],s35 offen offset:1024 sc1
buffer_load_dwordx4 a[56:59],v4,s[16:19],s35 offen offset:2048 sc1
buffer_load_dwordx4 a[60:63],v4,s[16:19],s35 offen offset:3072 sc1
s_waitcnt vmcnt(15)
M v[40:43],v[20:23],a[0:3],0
M v[44:47],v[24:27],a[0:3],0
s_waitcnt vmcnt(14)
M v[40:43],v[20:23],a[4:7],v[40:43]
M v[44:47],v[24:27],a[4:7],v[44:47]
s_waitcnt vmcnt(13)
M v[40:43],v[20:23],a[8:11],v[40:43]
M v[44:47],v[24:27],a[8:11],v[44:47]
s_waitcnt vmcnt(12)
M v[40:43],v[20:23],a[12:15],v[40:43]
M v[44:47],v[24:27],a[12:15],v[44:47]
s_waitcnt vmcnt(11)
M v[40:43],v[20:23],a[16:19],v[40:43]
M v[44:47],v[24:27],a[16:19],v[44:47]
s_waitcnt vmcnt(10)
M v[40:43],v[20:23],a[20:23],v[40:43]
M v[44:47],v[24:27],a[20:23],v[44:47]
s_waitcnt vmcnt(9)
M v[40:43],v[20:23],a[24:27],v[40:43]
M v[44:47],v[24:27],a[24:27],v[44:47]
s_waitcnt vmcnt(8)
M v[40:43],v[20:23],a[28:31],v[40:43]
M v[44:47],v[24:27],a[28:31],v[44:47]
s_waitcnt vmcnt(7)
M v[40:43],v[20:23],a[32:35],v[40:43]
M v[44:47],v[24:27],a[32:35],v[44:47]
s_waitcnt vmcnt(6)
M v[40:43],v[20:23],a[36:39],v[40:43]
M v[44:47],v[24:27],a[36:39],v[44:47]
s_waitcnt vmcnt(5)
M v[40:43],v[20:23],a[40:43],v[40:43]
M v[44:47],v[24:27],a[40:43],v[44:47]
s_waitcnt vmcnt(4)
M v[40:43],v[20:23],a[44:47],v[40:43]
M v[44:47],v[24:27],a[44:47],v[44:47]
s_waitcnt vmcnt(3)
M v[40:43],v[20:23],a[48:51],v[40:43]
M v[44:47],v[24:27],a[48:51],v[44:47]
s_waitcnt vmcnt(2)
M v[40:43],v[20:23],a[52:55],v[40:43]
M v[44:47],v[24:27],a[52:55],v[44:47]
s_waitcnt vmcnt(1)
M v[40:43],v[20:23],a[56:59],v[40:43]
M v[44:47],v[24:27],a[56:59],v[44:47]
s_waitcnt vmcnt(0)
M v[40:43],v[20:23],a[60:63],v[40:43]
M v[44:47],v[24:27],a[60:63],v[44:47]
s_nop 6
CV v40,v40,v41
CV v41,v42,v43
CV v42,v44,v45
CV v43,v46,v47
buffer_store_dwordx4 v[40:43],v14,s[4:7],s30 offen
L_red2:
L_f_end:
s_endpgm
L_d01z:
M v[36:39],a[128:131],a[32:35],v[20:23]
DR a[160:163],v1,8192
DR a[164:167],v1,9216
DR a[168:171],v1,10240
DR a[172:175],v1,11264
M v[36:39],a[132:135],a[36:39],v[36:39]
DR a[176:179],v1,12288
DR a[180:183],v1,13312
v_mov_b32 v98,0
M v[36:39],a[136:139],a[40:43],v[36:39]
buffer_load_dword v99,v98,s[24:27],s55 offen offset:64 sc1
DR a[184:187],v1,14336
DR a[188:191],v1,15360
M v[36:39],a[140:143],a[44:47],v[36:39]
s_mov_b32 m0,s40
DR a[128:131],v1,16384
M v[36:39],a[144:147],a[48:51],v[36:39]
buffer_load_dwordx4 v3,s[8:11],s30 offen offset:0 sc1 lds
M v[36:39],a[148:151],a[52:55],v[36:39]
buffer_load_dwordx4 v3,s[8:11],s30 offen offset:1024 sc1 lds
M v[36:39],a[152:155],a[56:59],v[36:39]
DR a[132:135],v1,17408
M v[36:39],a[156:159],a[60:63],v[36:39]
DR a[136:139],v1,18432
s_waitcnt lgkmcnt(10)
M v[44:47],a[160:163],a[32:35],v[20:23]
DR a[140:143],v1,19456
s_waitcnt lgkmcnt(10)
M v[44:47],a[164:167],a[36:39],v[44:47]
DR a[144:147],v1,20480
DR a[148:151],v1,21504
DR a[152:155],v1,22528
s_waitcnt lgkmcnt(12)
M v[44:47],a[168:171],a[40:43],v[44:47]
DR a[156:159],v1,23552
s_waitcnt lgkmcnt(12)
M v[44:47],a[172:175],a[44:47],v[44:47]
buffer_load_dwordx4 v3,s[8:11],s30 offen offset:2048 sc1 lds
s_waitcnt lgkmcnt(11)
M v[44:47],a[176:179],a[48:51],v[44:47]
buffer_load_dwordx4 v3,s[8:11],s30 offen offset:3072 sc1 lds
s_waitcnt lgkmcnt(10)
M v[44:47],a[180:183],a[52:55],v[44:47]
s_mov_b32 m0,s41
DR a[160:163],v1,24576
DR a[164:167],v1,25600
s_waitcnt lgkmcnt(11)
M v[44:47],a[184:187],a[56:59],v[44:47]
DR a[168:171],v1,26624
DR a[172:175],v1,27648
DR a[176:179],v1,28672
s_waitcnt lgkmcnt(13)
M v[44:47],a[188:191],a[60:63],v[44:47]
DR a[180:183],v1,29696
v_cmp_le_i32 s[58:59],0,v6
s_waitcnt lgkmcnt(13)
M v[52:55],a[128:131],a[32:35],v[20:23]
DR a[184:187],v1,30720
DR a[188:191],v1,31744
v_cmp_le_i32 s[60:61],1,v6
s_waitcnt lgkmcnt(14)
M v[52:55],a[132:135],a[36:39],v[52:55]
buffer_load_dwordx4 v3,s[8:11],s31 offen offset:0 sc1 lds
s_waitcnt lgkmcnt(13)
M v[52:55],a[136:139],a[40:43],v[52:55]
buffer_load_dwordx4 v3,s[8:11],s31 offen offset:1024 sc1 lds
s_waitcnt lgkmcnt(12)
M v[52:55],a[140:143],a[44:47],v[52:55]
buffer_load_dwordx4 v3,s[8:11],s31 offen offset:2048 sc1 lds
s_waitcnt lgkmcnt(11)
M v[52:55],a[144:147],a[48:51],v[52:55]
buffer_load_dwordx4 v3,s[8:11],s31 offen offset:3072 sc1 lds
s_waitcnt lgkmcnt(10)
M v[52:55],a[148:151],a[52:55],v[52:55]
s_waitcnt vmcnt(17) lgkmcnt(0)
s_barrier
s_waitcnt vmcnt(8)
v_cmp_eq_u32 vcc,1,v99
s_nop 0
s_cmp_eq_u64 vcc,-1
s_cbranch_scc0 L_spin13
L_spun13:
s_bitcmp1_b32 s44,8
s_cbranch_scc1 L_acq13
L_acqd13:
M v[52:55],a[152:155],a[56:59],v[52:55]
DR a[128:131],v2,0
DR a[132:135],v2,1024
DR a[136:139],v2,2048
DR a[140:143],v2,3072
M v[52:55],a[156:159],a[60:63],v[52:55]
s_add_u32 s30,s30,32768
DR a[144:147],v2,4096
v_cmp_le_i32 s[62:63],2,v6
M v[60:63],a[160:163],a[32:35],v[20:23]
DR a[148:151],v2,5120
v_cmp_le_i32 s[64:65],3,v6
M v[60:63],a[164:167],a[36:39],v[60:63]
DR a[152:155],v2,6144
v_cndmask_b32 v36,v7,v36,s[58:59]
M v[60:63],a[168:171],a[40:43],v[60:63]
DR a[156:159],v2,7168
v_cndmask_b32 v37,v7,v37,s[60:61]
M v[60:63],a[172:175],a[44:47],v[60:63]
s_cmp_eq_u32 s30,s33
s_cselect_b32 s30,0,s30
s_add_u32 s31,s30,4096
M v[60:63],a[176:179],a[48:51],v[60:63]
s_lshl_b32 s46,s42,13
s_add_u32 s46,s46,s52
DR a[160:163],v2,8192
M v[60:63],a[180:183],a[52:55],v[60:63]
buffer_load_dwordx4 a[64:67],v4,s[12:15],s46 offen offset:0 sc1
M v[60:63],a[184:187],a[56:59],v[60:63]
buffer_load_dwordx4 a[68:71],v4,s[12:15],s46 offen offset:1024 sc1
M v[60:63],a[188:191],a[60:63],v[60:63]
s_waitcnt lgkmcnt(1)
DR a[164:167],v2,9216
v_cndmask_b32 v38,v7,v38,s[62:63]
M v[128:131],a[128:131],v[64:67],0
buffer_load_dwordx4 a[72:75],v4,s[12:15],s46 offen offset:2048 sc1
M v[128:131],a[132:135],v[72:75],v[128:131]
buffer_load_dwordx4 a[76:79],v4,s[12:15],s46 offen offset:3072 sc1
M v[132:135],a[132:135],v[76:79],0
s_lshl_b32 s47,s42,13
s_add_u32 s47,s47,s52
s_add_u32 s47,s47,4096
M v[132:135],a[128:131],v[68:71],v[132:135]
buffer_load_dwordx4 a[80:83],v4,s[12:15],s47 offen offset:0 sc1
M v[136:139],a[136:139],v[64:67],0
buffer_load_dwordx4 a[84:87],v4,s[12:15],s47 offen offset:1024 sc1
M v[136:139],a[140:143],v[72:75],v[136:139]
DR a[168:171],v2,10240
v_cndmask_b32 v39,v7,v39,s[64:65]
M v[140:143],a[140:143],v[76:79],0
DR a[172:175],v2,11264
v_cmp_le_i32 s[58:59],16,v6
M v[140:143],a[136:139],v[68:71],v[140:143]
DR a[176:179],v2,12288
v_cmp_le_i32 s[60:61],17,v6
M v[144:147],a[144:147],v[64:67],0
DR a[180:183],v2,13312
v_cmp_le_i32 s[62:63],18,v6
M v[144:147],a[148:151],v[72:75],v[144:147]
DR a[184:187],v2,14336
v_cmp_le_i32 s[64:65],19,v6
M v[148:151],a[148:151],v[76:79],0
DR a[188:191],v2,15360
v_cndmask_b32 v44,v7,v44,s[58:59]
M v[148:151],a[144:147],v[68:71],v[148:151]
v_exp_f32 v24,v36
M v[152:155],a[152:155],v[64:67],0
v_exp_f32 v25,v37
M v[152:155],a[156:159],v[72:75],v[152:155]
v_exp_f32 v26,v38
M v[156:159],a[156:159],v[76:79],0
v_exp_f32 v27,v39
M v[156:159],a[152:155],v[68:71],v[156:159]
s_waitcnt lgkmcnt(0)
DR a[128:131],v2,16384
v_add_f32 v12,v24,v25
M v[160:163],a[160:163],v[64:67],0
buffer_load_dwordx4 a[88:91],v4,s[12:15],s47 offen offset:2048 sc1
M v[160:163],a[164:167],v[72:75],v[160:163]
buffer_load_dwordx4 a[92:95],v4,s[12:15],s47 offen offset:3072 sc1
M v[164:167],a[164:167],v[76:79],0
s_sub_u32 s46,7,s42
s_lshl_b32 s46,s46,13
s_add_u32 s46,s46,s52
M v[164:167],a[160:163],v[68:71],v[164:167]
buffer_load_dwordx4 a[96:99],v4,s[12:15],s46 offen offset:0 sc1
M v[168:171],a[168:171],v[64:67],0
DR a[132:135],v2,17408
CV v84,v24,v25
M v[168:171],a[172:175],v[72:75],v[168:171]
DR a[136:139],v2,18432
v_add_f32 v12,v12,v26
M v[172:175],a[172:175],v[76:79],0
DR a[140:143],v2,19456
v_add_f32 v12,v12,v27
M v[172:175],a[168:171],v[68:71],v[172:175]
DR a[144:147],v2,20480
CV v85,v26,v27
M v[176:179],a[176:179],v[64:67],0
DR a[148:151],v2,21504
v_cndmask_b32 v45,v7,v45,s[60:61]
M v[176:179],a[180:183],v[72:75],v[176:179]
buffer_load_dwordx4 a[100:103],v4,s[12:15],s46 offen offset:1024 sc1
DR a[152:155],v2,22528
M v[180:183],a[180:183],v[76:79],0
DR a[156:159],v2,23552
v_cndmask_b32 v46,v7,v46,s[62:63]
M v[180:183],a[176:179],v[68:71],v[180:183]
buffer_load_dwordx4 a[104:107],v4,s[12:15],s46 offen offset:2048 sc1
M v[184:187],a[184:187],v[64:67],0
buffer_load_dwordx4 a[108:111],v4,s[12:15],s46 offen offset:3072 sc1
M v[184:187],a[188:191],v[72:75],v[184:187]
s_sub_u32 s47,7,s42
s_lshl_b32 s47,s47,13
s_add_u32 s47,s47,s52
s_add_u32 s47,s47,4096
M v[188:191],a[188:191],v[76:79],0
buffer_load_dwordx4 a[112:115],v4,s[12:15],s47 offen offset:0 sc1
M v[188:191],a[184:187],v[68:71],v[188:191]
s_waitcnt lgkmcnt(0)
DR a[160:163],v2,24576
v_cndmask_b32 v47,v7,v47,s[64:65]
M v[192:195],a[128:131],v[64:67],0
v_exp_f32 v28,v44
M v[192:195],a[132:135],v[72:75],v[192:195]
buffer_load_dwordx4 a[116:119],v4,s[12:15],s47 offen offset:1024 sc1
M v[196:199],a[132:135],v[76:79],0
v_exp_f32 v29,v45
M v[196:199],a[128:131],v[68:71],v[196:199]
buffer_load_dwordx4 a[120:123],v4,s[12:15],s47 offen offset:2048 sc1
M v[200:203],a[136:139],v[64:67],0
DR a[164:167],v2,25600
v_add_f32 v12,v12,v28
M v[200:203],a[140:143],v[72:75],v[200:203]
buffer_load_dwordx4 a[124:127],v4,s[12:15],s47 offen offset:3072 sc1
DR a[168:171],v2,26624
M v[204:207],a[140:143],v[76:79],0
s_mov_b32 m0,s36
DR a[172:175],v2,27648
v_add_f32 v12,v12,v29
M v[204:207],a[136:139],v[68:71],v[204:207]
DR a[176:179],v2,28672
CV v86,v28,v29
M v[208:211],a[144:147],v[64:67],0
buffer_load_dwordx4 v3,s[4:7],s28 offen offset:0 sc1 lds
DR a[180:183],v2,29696
M v[208:211],a[148:151],v[72:75],v[208:211]
DR a[184:187],v2,30720
v_cmp_le_i32 s[58:59],32,v6
M v[212:215],a[148:151],v[76:79],0
DR a[188:191],v2,31744
v_cmp_le_i32 s[60:61],33,v6
M v[212:215],a[144:147],v[68:71],v[212:215]
v_exp_f32 v30,v46
M v[216:219],a[152:155],v[64:67],0
buffer_load_dwordx4 v3,s[4:7],s28 offen offset:1024 sc1 lds
M v[216:219],a[156:159],v[72:75],v[216:219]
v_exp_f32 v31,v47
M v[220:223],a[156:159],v[76:79],0
buffer_load_dwordx4 v3,s[4:7],s28 offen offset:2048 sc1 lds
M v[220:223],a[152:155],v[68:71],v[220:223]
s_waitcnt lgkmcnt(0)
s_barrier
M v[224:227],a[160:163],v[64:67],0
buffer_load_dwordx4 v3,s[4:7],s28 offen offset:3072 sc1 lds
M v[224:227],a[164:167],v[72:75],v[224:227]
s_mov_b32 m0,s37
v_add_f32 v12,v12,v30
v_add_f32 v12,v12,v31
M v[228:231],a[164:167],v[76:79],0
DR a[128:131],v1,33152
CV v87,v30,v31
M v[228:231],a[160:163],v[68:71],v[228:231]
DR a[132:135],v1,34176
v_cmp_le_i32 s[62:63],34,v6
M v[232:235],a[168:171],v[64:67],0
DR a[136:139],v1,35200
v_cmp_le_i32 s[64:65],35,v6
M v[232:235],a[172:175],v[72:75],v[232:235]
buffer_load_dwordx4 v3,s[4:7],s29 offen offset:0 sc1 lds
DR a[140:143],v1,36224
M v[236:239],a[172:175],v[76:79],0
DR a[144:147],v1,37248
v_cndmask_b32 v52,v7,v52,s[58:59]
M v[236:239],a[168:171],v[68:71],v[236:239]
DR a[148:151],v1,38272
v_cndmask_b32 v53,v7,v53,s[60:61]
M v[240:243],a[176:179],v[64:67],0
DR a[152:155],v1,39296
v_cndmask_b32 v54,v7,v54,s[62:63]
M v[240:243],a[180:183],v[72:75],v[240:243]
buffer_load_dwordx4 v3,s[4:7],s29 offen offset:1024 sc1 lds
DR a[156:159],v1,40320
M v[244:247],a[180:183],v[76:79],0
buffer_load_dwordx4 v3,s[4:7],s29 offen offset:2048 sc1 lds
M v[244:247],a[176:179],v[68:71],v[244:247]
buffer_load_dwordx4 v3,s[4:7],s29 offen offset:3072 sc1 lds
M v[248:251],a[184:187],v[64:67],0
s_add_u32 s28,s28,32768
v_cndmask_b32 v55,v7,v55,s[64:65]
v_cmp_le_i32 s[58:59],48,v6
M v[248:251],a[188:191],v[72:75],v[248:251]
v_exp_f32 v112,v52
M v[252:255],a[188:191],v[76:79],0
v_exp_f32 v113,v53
M v[252:255],a[184:187],v[68:71],v[252:255]
s_waitcnt lgkmcnt(0)
v_exp_f32 v114,v54
v_exp_f32 v115,v55
v_add_f32 v12,v12,v112
v_add_f32 v12,v12,v113
CV v92,v112,v113
v_add_f32 v12,v12,v114
v_add_f32 v12,v12,v115
CV v93,v114,v115
v_cmp_le_i32 s[60:61],49,v6
v_cmp_le_i32 s[62:63],50,v6
v_cmp_le_i32 s[64:65],51,v6
v_cndmask_b32 v60,v7,v60,s[58:59]
v_cndmask_b32 v61,v7,v61,s[60:61]
v_cndmask_b32 v62,v7,v62,s[62:63]
v_cndmask_b32 v63,v7,v63,s[64:65]
v_exp_f32 v116,v60
v_exp_f32 v117,v61
v_exp_f32 v118,v62
v_exp_f32 v119,v63
v_add_f32 v12,v12,v116
v_add_f32 v12,v12,v117
CV v94,v116,v117
v_add_f32 v12,v12,v118
v_add_f32 v12,v12,v119
CV v95,v118,v119
s_cmp_eq_u32 s28,s32
s_cselect_b32 s28,0,s28
s_add_u32 s29,s28,4096
v_cmp_nge_f32 vcc,s51,v12
s_nop 0
s_cbranch_vccnz L_rare10
L_ret10:
v_add_f32 v9,v9,v12
s_branch L_t1
L_predm:
M v[32:35],a[128:131],a[0:3],v[16:19]
DR a[160:163],v1,41344
v_mov_b32 v98,0
M v[32:35],a[132:135],a[4:7],v[32:35]
buffer_load_dword v99,v98,s[24:27],s55 offen offset:64 sc1
M v[32:35],a[136:139],a[8:11],v[32:35]
s_mov_b32 m0,s38
DR a[164:167],v1,42368
M v[32:35],a[140:143],a[12:15],v[32:35]
buffer_load_dwordx4 v3,s[8:11],s30 offen offset:0 sc1 lds
M v[32:35],a[144:147],a[16:19],v[32:35]
DR a[168:171],v1,43392
M v[32:35],a[148:151],a[20:23],v[32:35]
DR a[172:175],v1,44416
M v[32:35],a[152:155],a[24:27],v[32:35]
DR a[176:179],v1,45440
M v[32:35],a[156:159],a[28:31],v[32:35]
buffer_load_dwordx4 v3,s[8:11],s30 offen offset:1024 sc1 lds
M v[36:39],a[128:131],a[32:35],v[20:23]
DR a[180:183],v1,46464
M v[36:39],a[132:135],a[36:39],v[36:39]
DR a[184:187],v1,47488
M v[36:39],a[136:139],a[40:43],v[36:39]
DR a[188:191],v1,48512
M v[36:39],a[140:143],a[44:47],v[36:39]
buffer_load_dwordx4 v3,s[8:11],s30 offen offset:2048 sc1 lds
M v[36:39],a[144:147],a[48:51],v[36:39]
DR a[128:131],v1,49536
v_cmp_le_i32 s[58:59],0,v5
M v[36:39],a[148:151],a[52:55],v[36:39]
DR a[132:135],v1,50560
v_cmp_le_i32 s[60:61],1,v5
M v[36:39],a[152:155],a[56:59],v[36:39]
DR a[136:139],v1,51584
v_cmp_le_i32 s[62:63],2,v5
M v[36:39],a[156:159],a[60:63],v[36:39]
s_waitcnt lgkmcnt(3)
DR a[140:143],v1,52608
v_cmp_le_i32 s[64:65],3,v5
M v[40:43],a[160:163],a[0:3],v[16:19]
buffer_load_dwordx4 v3,s[8:11],s30 offen offset:3072 sc1 lds
M v[40:43],a[164:167],a[4:7],v[40:43]
s_mov_b32 m0,s39
DR a[144:147],v1,53632
v_cndmask_b32 v32,v7,v32,s[58:59]
M v[40:43],a[168:171],a[8:11],v[40:43]
DR a[148:151],v1,54656
v_cndmask_b32 v33,v7,v33,s[60:61]
M v[40:43],a[172:175],a[12:15],v[40:43]
DR a[152:155],v1,55680
v_cndmask_b32 v34,v7,v34,s[62:63]
M v[40:43],a[176:179],a[16:19],v[40:43]
DR a[156:159],v1,56704
v_cndmask_b32 v35,v7,v35,s[64:65]
M v[40:43],a[180:183],a[20:23],v[40:43]
v_exp_f32 v24,v32
M v[40:43],a[184:187],a[24:27],v[40:43]
v_exp_f32 v25,v33
M v[40:43],a[188:191],a[28:31],v[40:43]
v_exp_f32 v26,v34
M v[44:47],a[160:163],a[32:35],v[20:23]
v_exp_f32 v27,v35
M v[44:47],a[164:167],a[36:39],v[44:47]
buffer_load_dwordx4 v3,s[8:11],s31 offen offset:0 sc1 lds
M v[44:47],a[168:171],a[40:43],v[44:47]
buffer_load_dwordx4 v3,s[8:11],s31 offen offset:1024 sc1 lds
M v[44:47],a[172:175],a[44:47],v[44:47]
v_exp_f32 v28,v36
M v[44:47],a[176:179],a[48:51],v[44:47]
v_exp_f32 v29,v37
M v[44:47],a[180:183],a[52:55],v[44:47]
v_exp_f32 v30,v38
M v[44:47],a[184:187],a[56:59],v[44:47]
v_exp_f32 v31,v39
M v[44:47],a[188:191],a[60:63],v[44:47]
s_waitcnt lgkmcnt(0)
DR a[160:163],v1,57728
v_add_f32 v10,v24,v25
M v[48:51],a[128:131],a[0:3],v[16:19]
buffer_load_dwordx4 v3,s[8:11],s31 offen offset:2048 sc1 lds
M v[48:51],a[132:135],a[4:7],v[48:51]
DR a[164:167],v1,58752
CV v64,v24,v25
M v[48:51],a[136:139],a[8:11],v[48:51]
DR a[168:171],v1,59776
v_add_f32 v10,v10,v26
M v[48:51],a[140:143],a[12:15],v[48:51]
DR a[172:175],v1,60800
v_add_f32 v10,v10,v27
M v[48:51],a[144:147],a[16:19],v[48:51]
buffer_load_dwordx4 v3,s[8:11],s31 offen offset:3072 sc1 lds
M v[48:51],a[148:151],a[20:23],v[48:51]
s_add_u32 s30,s30,32768
DR a[176:179],v1,61824
CV v65,v26,v27
M v[48:51],a[152:155],a[24:27],v[48:51]
DR a[180:183],v1,62848
v_add_f32 v12,v28,v29
M v[48:51],a[156:159],a[28:31],v[48:51]
DR a[184:187],v1,63872
CV v68,v28,v29
M v[52:55],a[128:131],a[32:35],v[20:23]
DR a[188:191],v1,64896
v_add_f32 v12,v12,v30
M v[52:55],a[132:135],a[36:39],v[52:55]
s_cmp_eq_u32 s30,s33
s_cselect_b32 s30,0,s30
s_add_u32 s31,s30,4096
M v[52:55],a[136:139],a[40:43],v[52:55]
v_add_f32 v12,v12,v31
CV v69,v30,v31
M v[52:55],a[140:143],a[44:47],v[52:55]
v_cmp_le_i32 s[58:59],16,v5
v_cmp_le_i32 s[60:61],17,v5
M v[52:55],a[144:147],a[48:51],v[52:55]
v_cmp_le_i32 s[62:63],18,v5
v_cmp_le_i32 s[64:65],19,v5
M v[52:55],a[148:151],a[52:55],v[52:55]
s_lshl_b32 s46,s42,13
s_add_u32 s46,s46,s52
v_cndmask_b32 v40,v7,v40,s[58:59]
M v[52:55],a[152:155],a[56:59],v[52:55]
v_cndmask_b32 v41,v7,v41,s[60:61]
v_cndmask_b32 v42,v7,v42,s[62:63]
M v[52:55],a[156:159],a[60:63],v[52:55]
s_waitcnt vmcnt(17) lgkmcnt(0)
s_barrier
s_waitcnt vmcnt(8)
v_cmp_eq_u32 vcc,1,v99
s_nop 0
s_cmp_eq_u64 vcc,-1
s_cbranch_scc0 L_spin12
L_spun12:
s_bitcmp1_b32 s44,8
s_cbranch_scc1 L_acq12
L_acqd12:
M v[56:59],a[160:163],a[0:3],v[16:19]
DR a[128:131],v2,33152
v_cndmask_b32 v43,v7,v43,s[64:65]
M v[56:59],a[164:167],a[4:7],v[56:59]
v_exp_f32 v112,v40
M v[56:59],a[168:171],a[8:11],v[56:59]
v_exp_f32 v113,v41
M v[56:59],a[172:175],a[12:15],v[56:59]
v_exp_f32 v114,v42
M v[56:59],a[176:179],a[16:19],v[56:59]
DR a[132:135],v2,34176
v_add_f32 v10,v10,v112
M v[56:59],a[180:183],a[20:23],v[56:59]
DR a[136:139],v2,35200
v_add_f32 v10,v10,v113
M v[56:59],a[184:187],a[24:27],v[56:59]
DR a[140:143],v2,36224
CV v66,v112,v113
M v[56:59],a[188:191],a[28:31],v[56:59]
DR a[144:147],v2,37248
v_add_f32 v10,v10,v114
M v[60:63],a[160:163],a[32:35],v[20:23]
DR a[148:151],v2,38272
v_cmp_le_i32 s[58:59],32,v5
M v[60:63],a[164:167],a[36:39],v[60:63]
DR a[152:155],v2,39296
v_cmp_le_i32 s[60:61],33,v5
M v[60:63],a[168:171],a[40:43],v[60:63]
DR a[156:159],v2,40320
v_cmp_le_i32 s[62:63],34,v5
M v[60:63],a[172:175],a[44:47],v[60:63]
v_exp_f32 v115,v43
M v[60:63],a[176:179],a[48:51],v[60:63]
buffer_load_dwordx4 a[64:67],v4,s[12:15],s46 offen offset:0 sc1
M v[60:63],a[180:183],a[52:55],v[60:63]
buffer_load_dwordx4 a[68:71],v4,s[12:15],s46 offen offset:1024 sc1
M v[60:63],a[184:187],a[56:59],v[60:63]
buffer_load_dwordx4 a[72:75],v4,s[12:15],s46 offen offset:2048 sc1
M v[60:63],a[188:191],a[60:63],v[60:63]
s_waitcnt lgkmcnt(0)
v_exp_f32 v116,v44
M v[128:131],a[128:131],v[80:83],v[128:131]
v_exp_f32 v117,v45
M v[128:131],a[132:135],v[88:91],v[128:131]
v_exp_f32 v118,v46
M v[132:135],a[132:135],v[92:95],v[132:135]
v_exp_f32 v119,v47
M v[132:135],a[128:131],v[84:87],v[132:135]
DR a[160:163],v2,41344
v_add_f32 v10,v10,v115
M v[136:139],a[136:139],v[80:83],v[136:139]
DR a[164:167],v2,42368
CV v67,v114,v115
M v[136:139],a[140:143],v[88:91],v[136:139]
DR a[168:171],v2,43392
v_add_f32 v12,v12,v116
M v[140:143],a[140:143],v[92:95],v[140:143]
DR a[172:175],v2,44416
v_add_f32 v12,v12,v117
M v[140:143],a[136:139],v[84:87],v[140:143]
buffer_load_dwordx4 a[76:79],v4,s[12:15],s46 offen offset:3072 sc1
DR a[176:179],v2,45440
M v[144:147],a[144:147],v[80:83],v[144:147]
s_lshl_b32 s47,s42,13
s_add_u32 s47,s47,s52
s_add_u32 s47,s47,4096
DR a[180:183],v2,46464
M v[144:147],a[148:151],v[88:91],v[144:147]
buffer_load_dwordx4 a[80:83],v4,s[12:15],s47 offen offset:0 sc1
DR a[184:187],v2,47488
M v[148:151],a[148:151],v[92:95],v[148:151]
DR a[188:191],v2,48512
CV v70,v116,v117
M v[148:151],a[144:147],v[84:87],v[148:151]
buffer_load_dwordx4 a[84:87],v4,s[12:15],s47 offen offset:1024 sc1
M v[152:155],a[152:155],v[80:83],v[152:155]
buffer_load_dwordx4 a[88:91],v4,s[12:15],s47 offen offset:2048 sc1
M v[152:155],a[156:159],v[88:91],v[152:155]
buffer_load_dwordx4 a[92:95],v4,s[12:15],s47 offen offset:3072 sc1
M v[156:159],a[156:159],v[92:95],v[156:159]
s_sub_u32 s46,7,s42
s_lshl_b32 s46,s46,13
s_add_u32 s46,s46,s52
M v[156:159],a[152:155],v[84:87],v[156:159]
s_waitcnt lgkmcnt(0)
DR a[128:131],v2,49536
v_add_f32 v12,v12,v118
M v[160:163],a[160:163],v[80:83],v[160:163]
buffer_load_dwordx4 a[96:99],v4,s[12:15],s46 offen offset:0 sc1
M v[160:163],a[164:167],v[88:91],v[160:163]
buffer_load_dwordx4 a[100:103],v4,s[12:15],s46 offen offset:1024 sc1
M v[164:167],a[164:167],v[92:95],v[164:167]
buffer_load_dwordx4 a[104:107],v4,s[12:15],s46 offen offset:2048 sc1
M v[164:167],a[160:163],v[84:87],v[164:167]
buffer_load_dwordx4 a[108:111],v4,s[12:15],s46 offen offset:3072 sc1
M v[168:171],a[168:171],v[80:83],v[168:171]
s_sub_u32 s47,7,s42
s_lshl_b32 s47,s47,13
s_add_u32 s47,s47,s52
s_add_u32 s47,s47,4096
DR a[132:135],v2,50560
M v[168:171],a[172:175],v[88:91],v[168:171]
DR a[136:139],v2,51584
v_add_f32 v12,v12,v119
M v[172:175],a[172:175],v[92:95],v[172:175]
DR a[140:143],v2,52608
CV v71,v118,v119
M v[172:175],a[168:171],v[84:87],v[172:175]
DR a[144:147],v2,53632
v_cmp_le_i32 s[64:65],35,v5
M v[176:179],a[176:179],v[80:83],v[176:179]
DR a[148:151],v2,54656
v_cndmask_b32 v48,v7,v48,s[58:59]
M v[176:179],a[180:183],v[88:91],v[176:179]
buffer_load_dwordx4 a[112:115],v4,s[12:15],s47 offen offset:0 sc1
DR a[152:155],v2,55680
M v[180:183],a[180:183],v[92:95],v[180:183]
DR a[156:159],v2,56704
v_cndmask_b32 v49,v7,v49,s[60:61]
M v[180:183],a[176:179],v[84:87],v[180:183]
buffer_load_dwordx4 a[116:119],v4,s[12:15],s47 offen offset:1024 sc1
M v[184:187],a[184:187],v[80:83],v[184:187]
buffer_load_dwordx4 a[120:123],v4,s[12:15],s47 offen offset:2048 sc1
M v[184:187],a[188:191],v[88:91],v[184:187]
buffer_load_dwordx4 a[124:127],v4,s[12:15],s47 offen offset:3072 sc1
M v[188:191],a[188:191],v[92:95],v[188:191]
s_mov_b32 m0,s34
DR a[160:163],v2,57728
v_cndmask_b32 v50,v7,v50,s[62:63]
M v[188:191],a[184:187],v[84:87],v[188:191]
s_waitcnt lgkmcnt(1)
DR a[164:167],v2,58752
v_cndmask_b32 v51,v7,v51,s[64:65]
M v[192:195],a[128:131],v[80:83],v[192:195]
v_exp_f32 v24,v48
M v[192:195],a[132:135],v[88:91],v[192:195]
v_exp_f32 v25,v49
M v[196:199],a[132:135],v[92:95],v[196:199]
buffer_load_dwordx4 v3,s[4:7],s28 offen offset:0 sc1 lds
M v[196:199],a[128:131],v[84:87],v[196:199]
v_exp_f32 v26,v50
M v[200:203],a[136:139],v[80:83],v[200:203]
v_exp_f32 v27,v51
M v[200:203],a[140:143],v[88:91],v[200:203]
DR a[168:171],v2,59776
v_add_f32 v10,v10,v24
M v[204:207],a[140:143],v[92:95],v[204:207]
buffer_load_dwordx4 v3,s[4:7],s28 offen offset:1024 sc1 lds
DR a[172:175],v2,60800
M v[204:207],a[136:139],v[84:87],v[204:207]
DR a[176:179],v2,61824
v_add_f32 v10,v10,v25
M v[208:211],a[144:147],v[80:83],v[208:211]
DR a[180:183],v2,62848
CV v72,v24,v25
M v[208:211],a[148:151],v[88:91],v[208:211]
buffer_load_dwordx4 v3,s[4:7],s28 offen offset:2048 sc1 lds
DR a[184:187],v2,63872
M v[212:215],a[148:151],v[92:95],v[212:215]
DR a[188:191],v2,64896
v_add_f32 v10,v10,v26
M v[212:215],a[144:147],v[84:87],v[212:215]
v_exp_f32 v28,v52
M v[216:219],a[152:155],v[80:83],v[216:219]
buffer_load_dwordx4 v3,s[4:7],s28 offen offset:3072 sc1 lds
M v[216:219],a[156:159],v[88:91],v[216:219]
s_mov_b32 m0,s35
v_exp_f32 v29,v53
M v[220:223],a[156:159],v[92:95],v[220:223]
v_exp_f32 v30,v54
M v[220:223],a[152:155],v[84:87],v[220:223]
s_waitcnt lgkmcnt(0)
s_barrier
buffer_load_dwordx4 v3,s[4:7],s29 offen offset:0 sc1 lds
M v[224:227],a[160:163],v[80:83],v[224:227]
v_exp_f32 v31,v55
M v[224:227],a[164:167],v[88:91],v[224:227]
buffer_load_dwordx4 v3,s[4:7],s29 offen offset:1024 sc1 lds
M v[228:231],a[164:167],v[92:95],v[228:231]
DR a[128:131],v1,0
v_add_f32 v10,v10,v27
M v[228:231],a[160:163],v[84:87],v[228:231]
DR a[132:135],v1,1024
CV v73,v26,v27
M v[232:235],a[168:171],v[80:83],v[232:235]
DR a[136:139],v1,2048
v_add_f32 v12,v12,v28
M v[232:235],a[172:175],v[88:91],v[232:235]
DR a[140:143],v1,3072
v_add_f32 v12,v12,v29
M v[236:239],a[172:175],v[92:95],v[236:239]
buffer_load_dwordx4 v3,s[4:7],s29 offen offset:2048 sc1 lds
DR a[144:147],v1,4096
M v[236:239],a[168:171],v[84:87],v[236:239]
DR a[148:151],v1,5120
CV v76,v28,v29
M v[240:243],a[176:179],v[80:83],v[240:243]
DR a[152:155],v1,6144
v_add_f32 v12,v12,v30
M v[240:243],a[180:183],v[88:91],v[240:243]
buffer_load_dwordx4 v3,s[4:7],s29 offen offset:3072 sc1 lds
DR a[156:159],v1,7168
M v[244:247],a[180:183],v[92:95],v[244:247]
s_add_u32 s28,s28,32768
s_cmp_eq_u32 s28,s32
s_cselect_b32 s28,0,s28
M v[244:247],a[176:179],v[84:87],v[244:247]
s_add_u32 s29,s28,4096
v_add_f32 v12,v12,v31
CV v77,v30,v31
M v[248:251],a[184:187],v[80:83],v[248:251]
v_cmp_le_i32 s[58:59],48,v5
v_cmp_le_i32 s[60:61],49,v5
M v[248:251],a[188:191],v[88:91],v[248:251]
v_cmp_le_i32 s[62:63],50,v5
v_cmp_le_i32 s[64:65],51,v5
M v[252:255],a[188:191],v[92:95],v[252:255]
v_cndmask_b32 v56,v7,v56,s[58:59]
v_cndmask_b32 v57,v7,v57,s[60:61]
M v[252:255],a[184:187],v[84:87],v[252:255]
s_waitcnt lgkmcnt(0)
v_cndmask_b32 v58,v7,v58,s[62:63]
v_cndmask_b32 v59,v7,v59,s[64:65]
v_exp_f32 v112,v56
v_exp_f32 v113,v57
v_exp_f32 v114,v58
v_exp_f32 v115,v59
v_add_f32 v10,v10,v112
v_add_f32 v10,v10,v113
CV v74,v112,v113
v_add_f32 v10,v10,v114
v_add_f32 v10,v10,v115
CV v75,v114,v115
v_exp_f32 v116,v60
v_exp_f32 v117,v61
v_exp_f32 v118,v62
v_exp_f32 v119,v63
v_add_f32 v12,v12,v116
v_add_f32 v12,v12,v117
CV v78,v116,v117
v_add_f32 v12,v12,v118
v_add_f32 v12,v12,v119
CV v79,v118,v119
v_max_f32 v13,v10,v12
v_cmp_nge_f32 vcc,s51,v13
s_nop 0
s_cbranch_vccnz L_rare5
L_ret5:
v_add_f32 v8,v8,v10
v_add_f32 v9,v9,v12
M v[36:39],a[128:131],a[32:35],v[20:23]
DR a[160:163],v1,8192
DR a[164:167],v1,9216
DR a[168:171],v1,10240
DR a[172:175],v1,11264
M v[36:39],a[132:135],a[36:39],v[36:39]
s_mov_b32 m0,s40
DR a[176:179],v1,12288
DR a[180:183],v1,13312
M v[36:39],a[136:139],a[40:43],v[36:39]
DR a[184:187],v1,14336
DR a[188:191],v1,15360
DR a[128:131],v1,16384
M v[36:39],a[140:143],a[44:47],v[36:39]
buffer_load_dwordx4 v3,s[8:11],s30 offen offset:0 sc1 lds
M v[36:39],a[144:147],a[48:51],v[36:39]
buffer_load_dwordx4 v3,s[8:11],s30 offen offset:1024 sc1 lds
M v[36:39],a[148:151],a[52:55],v[36:39]
DR a[132:135],v1,17408
M v[36:39],a[152:155],a[56:59],v[36:39]
DR a[136:139],v1,18432
M v[36:39],a[156:159],a[60:63],v[36:39]
buffer_load_dwordx4 v3,s[8:11],s30 offen offset:2048 sc1 lds
s_waitcnt lgkmcnt(10)
M v[44:47],a[160:163],a[32:35],v[20:23]
DR a[140:143],v1,19456
s_waitcnt lgkmcnt(10)
M v[44:47],a[164:167],a[36:39],v[44:47]
DR a[144:147],v1,20480
DR a[148:151],v1,21504
DR a[152:155],v1,22528
s_waitcnt lgkmcnt(12)
M v[44:47],a[168:171],a[40:43],v[44:47]
DR a[156:159],v1,23552
s_waitcnt lgkmcnt(12)
M v[44:47],a[172:175],a[44:47],v[44:47]
buffer_load_dwordx4 v3,s[8:11],s30 offen offset:3072 sc1 lds
s_waitcnt lgkmcnt(11)
M v[44:47],a[176:179],a[48:51],v[44:47]
s_mov_b32 m0,s41
DR a[160:163],v1,24576
v_cmp_le_i32 s[58:59],0,v6
s_waitcnt lgkmcnt(11)
M v[44:47],a[180:183],a[52:55],v[44:47]
DR a[164:167],v1,25600
v_cmp_le_i32 s[60:61],1,v6
s_waitcnt lgkmcnt(11)
M v[44:47],a[184:187],a[56:59],v[44:47]
DR a[168:171],v1,26624
DR a[172:175],v1,27648
DR a[176:179],v1,28672
s_waitcnt lgkmcnt(13)
M v[44:47],a[188:191],a[60:63],v[44:47]
DR a[180:183],v1,29696
v_cmp_le_i32 s[62:63],2,v6
s_waitcnt lgkmcnt(13)
M v[52:55],a[128:131],a[32:35],v[20:23]
DR a[184:187],v1,30720
DR a[188:191],v1,31744
v_cmp_le_i32 s[64:65],3,v6
s_waitcnt lgkmcnt(14)
M v[52:55],a[132:135],a[36:39],v[52:55]
buffer_load_dwordx4 v3,s[8:11],s31 offen offset:0 sc1 lds
s_waitcnt lgkmcnt(13)
M v[52:55],a[136:139],a[40:43],v[52:55]
buffer_load_dwordx4 v3,s[8:11],s31 offen offset:1024 sc1 lds
s_waitcnt lgkmcnt(12)
M v[52:55],a[140:143],a[44:47],v[52:55]
buffer_load_dwordx4 v3,s[8:11],s31 offen offset:2048 sc1 lds
s_waitcnt lgkmcnt(11)
M v[52:55],a[144:147],a[48:51],v[52:55]
buffer_load_dwordx4 v3,s[8:11],s31 offen offset:3072 sc1 lds
s_waitcnt lgkmcnt(10)
M v[52:55],a[148:151],a[52:55],v[52:55]
s_waitcnt vmcnt(32) lgkmcnt(0)
s_barrier
M v[52:55],a[152:155],a[56:59],v[52:55]
DR a[128:131],v2,0
DR a[132:135],v2,1024
DR a[136:139],v2,2048
DR a[140:143],v2,3072
M v[52:55],a[156:159],a[60:63],v[52:55]
s_add_u32 s30,s30,32768
DR a[144:147],v2,4096
v_cndmask_b32 v36,v7,v36,s[58:59]
M v[60:63],a[160:163],a[32:35],v[20:23]
DR a[148:151],v2,5120
v_cndmask_b32 v37,v7,v37,s[60:61]
M v[60:63],a[164:167],a[36:39],v[60:63]
DR a[152:155],v2,6144
v_cndmask_b32 v38,v7,v38,s[62:63]
M v[60:63],a[168:171],a[40:43],v[60:63]
DR a[156:159],v2,7168
v_cndmask_b32 v39,v7,v39,s[64:65]
M v[60:63],a[172:175],a[44:47],v[60:63]
v_exp_f32 v24,v36
M v[60:63],a[176:179],a[48:51],v[60:63]
v_exp_f32 v25,v37
M v[60:63],a[180:183],a[52:55],v[60:63]
v_exp_f32 v26,v38
M v[60:63],a[184:187],a[56:59],v[60:63]
v_exp_f32 v27,v39
M v[60:63],a[188:191],a[60:63],v[60:63]
s_waitcnt lgkmcnt(0)
s_cmp_eq_u32 s30,s33
s_cselect_b32 s30,0,s30
M v[128:131],a[128:131],v[64:67],v[128:131]
s_add_u32 s31,s30,4096
s_mov_b32 m0,s36
DR a[160:163],v2,8192
M v[128:131],a[132:135],v[72:75],v[128:131]
buffer_load_dwordx4 v3,s[4:7],s28 offen offset:0 sc1 lds
M v[132:135],a[132:135],v[76:79],v[132:135]
buffer_load_dwordx4 v3,s[4:7],s28 offen offset:1024 sc1 lds
M v[132:135],a[128:131],v[68:71],v[132:135]
DR a[164:167],v2,9216
v_add_f32 v12,v24,v25
M v[136:139],a[136:139],v[64:67],v[136:139]
DR a[168:171],v2,10240
CV v84,v24,v25
M v[136:139],a[140:143],v[72:75],v[136:139]
DR a[172:175],v2,11264
v_add_f32 v12,v12,v26
M v[140:143],a[140:143],v[76:79],v[140:143]
buffer_load_dwordx4 v3,s[4:7],s28 offen offset:2048 sc1 lds
M v[140:143],a[136:139],v[68:71],v[140:143]
DR a[176:179],v2,12288
v_add_f32 v12,v12,v27
M v[144:147],a[144:147],v[64:67],v[144:147]
DR a[180:183],v2,13312
CV v85,v26,v27
M v[144:147],a[148:151],v[72:75],v[144:147]
DR a[184:187],v2,14336
v_cmp_le_i32 s[58:59],16,v6
M v[148:151],a[148:151],v[76:79],v[148:151]
DR a[188:191],v2,15360
v_cmp_le_i32 s[60:61],17,v6
M v[148:151],a[144:147],v[68:71],v[148:151]
buffer_load_dwordx4 v3,s[4:7],s28 offen offset:3072 sc1 lds
M v[152:155],a[152:155],v[64:67],v[152:155]
s_mov_b32 m0,s37
DR a[128:131],v2,16384
v_cmp_le_i32 s[62:63],18,v6
M v[152:155],a[156:159],v[72:75],v[152:155]
DR a[132:135],v2,17408
v_cmp_le_i32 s[64:65],19,v6
M v[156:159],a[156:159],v[76:79],v[156:159]
DR a[136:139],v2,18432
v_cndmask_b32 v44,v7,v44,s[58:59]
M v[156:159],a[152:155],v[68:71],v[156:159]
s_waitcnt lgkmcnt(3)
DR a[140:143],v2,19456
v_cndmask_b32 v45,v7,v45,s[60:61]
M v[160:163],a[160:163],v[64:67],v[160:163]
buffer_load_dwordx4 v3,s[4:7],s29 offen offset:0 sc1 lds
M v[160:163],a[164:167],v[72:75],v[160:163]
DR a[144:147],v2,20480
v_cndmask_b32 v46,v7,v46,s[62:63]
M v[164:167],a[164:167],v[76:79],v[164:167]
DR a[148:151],v2,21504
v_cndmask_b32 v47,v7,v47,s[64:65]
M v[164:167],a[160:163],v[68:71],v[164:167]
v_exp_f32 v28,v44
M v[168:171],a[168:171],v[64:67],v[168:171]
v_exp_f32 v29,v45
M v[168:171],a[172:175],v[72:75],v[168:171]
v_exp_f32 v30,v46
M v[172:175],a[172:175],v[76:79],v[172:175]
v_exp_f32 v31,v47
M v[172:175],a[168:171],v[68:71],v[172:175]
buffer_load_dwordx4 v3,s[4:7],s29 offen offset:1024 sc1 lds
M v[176:179],a[176:179],v[64:67],v[176:179]
DR a[152:155],v2,22528
v_add_f32 v12,v12,v28
M v[176:179],a[180:183],v[72:75],v[176:179]
DR a[156:159],v2,23552
v_add_f32 v12,v12,v29
M v[180:183],a[180:183],v[76:79],v[180:183]
DR a[160:163],v2,24576
CV v86,v28,v29
M v[180:183],a[176:179],v[68:71],v[180:183]
DR a[164:167],v2,25600
v_add_f32 v12,v12,v30
M v[184:187],a[184:187],v[64:67],v[184:187]
buffer_load_dwordx4 v3,s[4:7],s29 offen offset:2048 sc1 lds
M v[184:187],a[188:191],v[72:75],v[184:187]
DR a[168:171],v2,26624
v_add_f32 v12,v12,v31
M v[188:191],a[188:191],v[76:79],v[188:191]
DR a[172:175],v2,27648
CV v87,v30,v31
M v[188:191],a[184:187],v[68:71],v[188:191]
s_waitcnt lgkmcnt(4)
DR a[176:179],v2,28672
v_cmp_le_i32 s[58:59],32,v6
M v[192:195],a[128:131],v[64:67],v[192:195]
DR a[180:183],v2,29696
v_cmp_le_i32 s[60:61],33,v6
M v[192:195],a[132:135],v[72:75],v[192:195]
DR a[184:187],v2,30720
v_cmp_le_i32 s[62:63],34,v6
M v[196:199],a[132:135],v[76:79],v[196:199]
buffer_load_dwordx4 v3,s[4:7],s29 offen offset:3072 sc1 lds
M v[196:199],a[128:131],v[68:71],v[196:199]
s_add_u32 s28,s28,32768
DR a[188:191],v2,31744
v_cmp_le_i32 s[64:65],35,v6
M v[200:203],a[136:139],v[64:67],v[200:203]
s_cmp_eq_u32 s28,s32
s_cselect_b32 s28,0,s28
s_add_u32 s29,s28,4096
M v[200:203],a[140:143],v[72:75],v[200:203]
v_cndmask_b32 v52,v7,v52,s[58:59]
v_cndmask_b32 v53,v7,v53,s[60:61]
M v[204:207],a[140:143],v[76:79],v[204:207]
v_cndmask_b32 v54,v7,v54,s[62:63]
v_cndmask_b32 v55,v7,v55,s[64:65]
M v[204:207],a[136:139],v[68:71],v[204:207]
v_exp_f32 v112,v52
M v[208:211],a[144:147],v[64:67],v[208:211]
v_exp_f32 v113,v53
M v[208:211],a[148:151],v[72:75],v[208:211]
v_exp_f32 v114,v54
M v[212:215],a[148:151],v[76:79],v[212:215]
v_exp_f32 v115,v55
M v[212:215],a[144:147],v[68:71],v[212:215]
v_add_f32 v12,v12,v112
v_add_f32 v12,v12,v113
M v[216:219],a[152:155],v[64:67],v[216:219]
CV v92,v112,v113
v_add_f32 v12,v12,v114
M v[216:219],a[156:159],v[72:75],v[216:219]
v_add_f32 v12,v12,v115
CV v93,v114,v115
M v[220:223],a[156:159],v[76:79],v[220:223]
v_cmp_le_i32 s[58:59],48,v6
v_cmp_le_i32 s[60:61],49,v6
M v[220:223],a[152:155],v[68:71],v[220:223]
s_waitcnt vmcnt(16) lgkmcnt(0)
s_barrier
M v[224:227],a[160:163],v[64:67],v[224:227]
DR a[128:131],v1,33152
v_cmp_le_i32 s[62:63],50,v6
M v[224:227],a[164:167],v[72:75],v[224:227]
DR a[132:135],v1,34176
v_cmp_le_i32 s[64:65],51,v6
M v[228:231],a[164:167],v[76:79],v[228:231]
DR a[136:139],v1,35200
v_cndmask_b32 v60,v7,v60,s[58:59]
M v[228:231],a[160:163],v[68:71],v[228:231]
DR a[140:143],v1,36224
v_cndmask_b32 v61,v7,v61,s[60:61]
M v[232:235],a[168:171],v[64:67],v[232:235]
DR a[144:147],v1,37248
v_cndmask_b32 v62,v7,v62,s[62:63]
M v[232:235],a[172:175],v[72:75],v[232:235]
DR a[148:151],v1,38272
v_cndmask_b32 v63,v7,v63,s[64:65]
M v[236:239],a[172:175],v[76:79],v[236:239]
v_exp_f32 v116,v60
M v[236:239],a[168:171],v[68:71],v[236:239]
v_exp_f32 v117,v61
M v[240:243],a[176:179],v[64:67],v[240:243]
DR a[152:155],v1,39296
v_add_f32 v12,v12,v116
M v[240:243],a[180:183],v[72:75],v[240:243]
DR a[156:159],v1,40320
v_add_f32 v12,v12,v117
M v[244:247],a[180:183],v[76:79],v[244:247]
v_exp_f32 v118,v62
M v[244:247],a[176:179],v[68:71],v[244:247]
v_exp_f32 v119,v63
M v[248:251],a[184:187],v[64:67],v[248:251]
CV v94,v116,v117
v_add_f32 v12,v12,v118
M v[248:251],a[188:191],v[72:75],v[248:251]
v_add_f32 v12,v12,v119
CV v95,v118,v119
M v[252:255],a[188:191],v[76:79],v[252:255]
v_cmp_nge_f32 vcc,s51,v12
M v[252:255],a[184:187],v[68:71],v[252:255]
s_waitcnt lgkmcnt(0)
s_cbranch_vccnz L_rare6
L_ret6:
v_add_f32 v9,v9,v12
L_t1:
s_mov_b32 s32,-1
s_mov_b32 s33,-1
s_waitcnt vmcnt(8)
M v[32:35],a[128:131],a[64:67],0
s_mov_b32 m0,s38
DR a[160:163],v1,41344
M v[32:35],a[132:135],a[68:71],v[32:35]
buffer_load_dwordx4 v3,s[8:11],s30 offen offset:0 sc1 lds
M v[32:35],a[136:139],a[72:75],v[32:35]
DR a[164:167],v1,42368
M v[32:35],a[140:143],a[76:79],v[32:35]
DR a[168:171],v1,43392
M v[32:35],a[144:147],a[80:83],v[32:35]
DR a[172:175],v1,44416
M v[32:35],a[148:151],a[84:87],v[32:35]
DR a[176:179],v1,45440
M v[32:35],a[152:155],a[88:91],v[32:35]
buffer_load_dwordx4 v3,s[8:11],s30 offen offset:1024 sc1 lds
M v[32:35],a[156:159],a[92:95],v[32:35]
DR a[180:183],v1,46464
M v[36:39],a[128:131],a[96:99],0
DR a[184:187],v1,47488
M v[36:39],a[132:135],a[100:103],v[36:39]
DR a[188:191],v1,48512
M v[36:39],a[136:139],a[104:107],v[36:39]
DR a[128:131],v1,49536
M v[36:39],a[140:143],a[108:111],v[36:39]
buffer_load_dwordx4 v3,s[8:11],s30 offen offset:2048 sc1 lds
M v[36:39],a[144:147],a[112:115],v[36:39]
DR a[132:135],v1,50560
v_max3_f32 v96,v32,v33,v34
v_max_f32 v96,v96,v35
M v[36:39],a[148:151],a[116:119],v[36:39]
DR a[136:139],v1,51584
M v[36:39],a[152:155],a[120:123],v[36:39]
DR a[140:143],v1,52608
M v[36:39],a[156:159],a[124:127],v[36:39]
s_waitcnt lgkmcnt(4)
DR a[144:147],v1,53632
M v[40:43],a[160:163],a[64:67],0
buffer_load_dwordx4 v3,s[8:11],s30 offen offset:3072 sc1 lds
M v[40:43],a[164:167],a[68:71],v[40:43]
s_mov_b32 m0,s39
DR a[148:151],v1,54656
M v[40:43],a[168:171],a[72:75],v[40:43]
DR a[152:155],v1,55680
M v[40:43],a[172:175],a[76:79],v[40:43]
DR a[156:159],v1,56704
M v[40:43],a[176:179],a[80:83],v[40:43]
v_max3_f32 v97,v36,v37,v38
v_max_f32 v97,v97,v39
M v[40:43],a[180:183],a[84:87],v[40:43]
buffer_load_dwordx4 v3,s[8:11],s31 offen offset:0 sc1 lds
M v[40:43],a[184:187],a[88:91],v[40:43]
M v[40:43],a[188:191],a[92:95],v[40:43]
M v[44:47],a[160:163],a[96:99],0
DR a[160:163],v1,57728
M v[44:47],a[164:167],a[100:103],v[44:47]
DR a[164:167],v1,58752
M v[44:47],a[168:171],a[104:107],v[44:47]
buffer_load_dwordx4 v3,s[8:11],s31 offen offset:1024 sc1 lds
M v[44:47],a[172:175],a[108:111],v[44:47]
DR a[168:171],v1,59776
M v[44:47],a[176:179],a[112:115],v[44:47]
DR a[172:175],v1,60800
v_max3_f32 v96,v96,v40,v41
v_max3_f32 v96,v96,v42,v43
M v[44:47],a[180:183],a[116:119],v[44:47]
DR a[176:179],v1,61824
M v[44:47],a[184:187],a[120:123],v[44:47]
DR a[180:183],v1,62848
M v[44:47],a[188:191],a[124:127],v[44:47]
s_waitcnt lgkmcnt(6)
DR a[184:187],v1,63872
M v[48:51],a[128:131],a[64:67],0
buffer_load_dwordx4 v3,s[8:11],s31 offen offset:2048 sc1 lds
M v[48:51],a[132:135],a[68:71],v[48:51]
DR a[188:191],v1,64896
M v[48:51],a[136:139],a[72:75],v[48:51]
M v[48:51],a[140:143],a[76:79],v[48:51]
M v[48:51],a[144:147],a[80:83],v[48:51]
buffer_load_dwordx4 v3,s[8:11],s31 offen offset:3072 sc1 lds
v_max3_f32 v97,v97,v44,v45
M v[48:51],a[148:151],a[84:87],v[48:51]
s_add_u32 s30,s30,32768
s_cmp_eq_u32 s30,s33
s_cselect_b32 s30,0,s30
v_max3_f32 v97,v97,v46,v47
M v[48:51],a[152:155],a[88:91],v[48:51]
s_add_u32 s31,s30,4096
M v[48:51],a[156:159],a[92:95],v[48:51]
M v[52:55],a[128:131],a[96:99],0
M v[52:55],a[132:135],a[100:103],v[52:55]
M v[52:55],a[136:139],a[104:107],v[52:55]
M v[52:55],a[140:143],a[108:111],v[52:55]
M v[52:55],a[144:147],a[112:115],v[52:55]
s_mov_b32 m0,s34
s_nop 1
v_max3_f32 v96,v96,v48,v49
v_max3_f32 v96,v96,v50,v51
M v[52:55],a[148:151],a[116:119],v[52:55]
M v[52:55],a[152:155],a[120:123],v[52:55]
M v[52:55],a[156:159],a[124:127],v[52:55]
s_waitcnt vmcnt(16) lgkmcnt(0)
s_barrier
M v[56:59],a[160:163],a[64:67],0
DR a[128:131],v2,33152
M v[56:59],a[164:167],a[68:71],v[56:59]
DR a[132:135],v2,34176
M v[56:59],a[168:171],a[72:75],v[56:59]
buffer_load_dwordx4 v3,s[4:7],s28 offen offset:0 sc1 lds
M v[56:59],a[172:175],a[76:79],v[56:59]
DR a[136:139],v2,35200
M v[56:59],a[176:179],a[80:83],v[56:59]
DR a[140:143],v2,36224
v_max3_f32 v97,v97,v52,v53
v_max3_f32 v97,v97,v54,v55
M v[56:59],a[180:183],a[84:87],v[56:59]
DR a[144:147],v2,37248
M v[56:59],a[184:187],a[88:91],v[56:59]
DR a[148:151],v2,38272
M v[56:59],a[188:191],a[92:95],v[56:59]
DR a[152:155],v2,39296
M v[60:63],a[160:163],a[96:99],0
buffer_load_dwordx4 v3,s[4:7],s28 offen offset:1024 sc1 lds
M v[60:63],a[164:167],a[100:103],v[60:63]
DR a[156:159],v2,40320
M v[60:63],a[168:171],a[104:107],v[60:63]
DR a[160:163],v2,41344
M v[60:63],a[172:175],a[108:111],v[60:63]
DR a[164:167],v2,42368
M v[60:63],a[176:179],a[112:115],v[60:63]
DR a[168:171],v2,43392
v_max3_f32 v96,v96,v56,v57
v_max3_f32 v96,v96,v58,v59
M v[60:63],a[180:183],a[116:119],v[60:63]
buffer_load_dwordx4 v3,s[4:7],s28 offen offset:2048 sc1 lds
M v[60:63],a[184:187],a[120:123],v[60:63]
DR a[172:175],v2,44416
M v[60:63],a[188:191],a[124:127],v[60:63]
DR a[176:179],v2,45440
s_waitcnt lgkmcnt(12)
M v[132:135],a[128:131],v[84:87],v[132:135]
DR a[180:183],v2,46464
s_waitcnt lgkmcnt(12)
M v[132:135],a[132:135],v[92:95],v[132:135]
DR a[184:187],v2,47488
s_waitcnt lgkmcnt(12)
M v[140:143],a[136:139],v[84:87],v[140:143]
DR a[188:191],v2,48512
s_waitcnt lgkmcnt(12)
M v[140:143],a[140:143],v[92:95],v[140:143]
buffer_load_dwordx4 v3,s[4:7],s28 offen offset:3072 sc1 lds
s_waitcnt lgkmcnt(11)
M v[148:151],a[144:147],v[84:87],v[148:151]
s_mov_b32 m0,s35
DR a[128:131],v2,49536
v_max3_f32 v97,v97,v60,v61
s_waitcnt lgkmcnt(11)
M v[148:151],a[148:151],v[92:95],v[148:151]
DR a[132:135],v2,50560
v_max3_f32 v97,v97,v62,v63
v_mov_b32 v104,v16
s_waitcnt lgkmcnt(11)
M v[156:159],a[152:155],v[84:87],v[156:159]
v_mov_b32 v105,v8
v_mov_b32 v106,v20
v_mov_b32 v107,v9
s_waitcnt lgkmcnt(10)
M v[156:159],a[156:159],v[92:95],v[156:159]
v_mov_b32 v13,v96
s_nop 1
v_permlane16_swap_b32 v96,v13
v_max_f32 v96,v96,v13
s_waitcnt lgkmcnt(9)
M v[164:167],a[160:163],v[84:87],v[164:167]
DR a[136:139],v2,51584
DR a[140:143],v2,52608
v_mov_b32 v13,v96
s_waitcnt lgkmcnt(10)
M v[164:167],a[164:167],v[92:95],v[164:167]
DR a[144:147],v2,53632
DR a[148:151],v2,54656
v_permlane32_swap_b32 v96,v13
s_waitcnt lgkmcnt(11)
M v[172:175],a[168:171],v[84:87],v[172:175]
DR a[152:155],v2,55680
DR a[156:159],v2,56704
v_max_f32 v96,v96,v13
s_waitcnt lgkmcnt(12)
M v[172:175],a[172:175],v[92:95],v[172:175]
v_sub_f32 v16,0,v96
v_sub_f32 v17,0,v96
v_sub_f32 v18,0,v96
s_waitcnt lgkmcnt(11)
M v[180:183],a[176:179],v[84:87],v[180:183]
v_sub_f32 v19,0,v96
v_mov_b32 v13,v97
s_nop 1
v_permlane16_swap_b32 v97,v13
s_waitcnt lgkmcnt(10)
M v[180:183],a[180:183],v[92:95],v[180:183]
v_max_f32 v97,v97,v13
v_mov_b32 v13,v97
s_nop 1
v_permlane32_swap_b32 v97,v13
s_waitcnt lgkmcnt(9)
M v[188:191],a[184:187],v[84:87],v[188:191]
v_max_f32 v97,v97,v13
v_sub_f32 v20,0,v97
v_sub_f32 v21,0,v97
s_waitcnt lgkmcnt(8)
M v[188:191],a[188:191],v[92:95],v[188:191]
DR a[160:163],v2,57728
DR a[164:167],v2,58752
v_sub_f32 v22,0,v97
s_waitcnt lgkmcnt(9)
M v[196:199],a[128:131],v[84:87],v[196:199]
DR a[168:171],v2,59776
DR a[172:175],v2,60800
v_sub_f32 v23,0,v97
s_waitcnt lgkmcnt(10)
M v[196:199],a[132:135],v[92:95],v[196:199]
DR a[176:179],v2,61824
DR a[180:183],v2,62848
v_add_f32 v24,v32,v16
s_waitcnt lgkmcnt(11)
M v[204:207],a[136:139],v[84:87],v[204:207]
DR a[184:187],v2,63872
DR a[188:191],v2,64896
v_add_f32 v28,v36,v20
s_waitcnt lgkmcnt(12)
M v[204:207],a[140:143],v[92:95],v[204:207]
v_exp_f32 v24,v24
v_add_f32 v25,v33,v16
s_waitcnt lgkmcnt(11)
M v[212:215],a[144:147],v[84:87],v[212:215]
v_exp_f32 v25,v25
v_add_f32 v26,v34,v16
s_waitcnt lgkmcnt(10)
M v[212:215],a[148:151],v[92:95],v[212:215]
s_waitcnt vmcnt(12) lgkmcnt(0)
s_barrier
buffer_load_dwordx4 v3,s[4:7],s29 offen offset:0 sc1 lds
M v[220:223],a[152:155],v[84:87],v[220:223]
DR a[128:131],v1,0
v_exp_f32 v26,v26
M v[220:223],a[156:159],v[92:95],v[220:223]
DR a[132:135],v1,1024
v_add_f32 v27,v35,v16
v_add_f32 v10,v24,v25
M v[228:231],a[160:163],v[84:87],v[228:231]
DR a[136:139],v1,2048
v_exp_f32 v27,v27
M v[228:231],a[164:167],v[92:95],v[228:231]
DR a[140:143],v1,3072
CV v64,v24,v25
v_add_f32 v10,v10,v26
M v[236:239],a[168:171],v[84:87],v[236:239]
DR a[144:147],v1,4096
v_add_f32 v10,v10,v27
CV v65,v26,v27
M v[236:239],a[172:175],v[92:95],v[236:239]
buffer_load_dwordx4 v3,s[4:7],s29 offen offset:1024 sc1 lds
DR a[148:151],v1,5120
M v[244:247],a[176:179],v[84:87],v[244:247]
DR a[152:155],v1,6144
v_exp_f32 v28,v28
M v[244:247],a[180:183],v[92:95],v[244:247]
DR a[156:159],v1,7168
v_add_f32 v29,v37,v20
v_add_f32 v112,v40,v16
M v[252:255],a[184:187],v[84:87],v[252:255]
v_exp_f32 v29,v29
v_add_f32 v30,v38,v20
M v[252:255],a[188:191],v[92:95],v[252:255]
s_waitcnt lgkmcnt(0)
v_exp_f32 v30,v30
v_add_f32 v31,v39,v20
v_exp_f32 v31,v31
v_add_f32 v12,v28,v29
CV v68,v28,v29
v_add_f32 v12,v12,v30
v_add_f32 v12,v12,v31
CV v69,v30,v31
v_exp_f32 v112,v112
v_add_f32 v113,v41,v16
v_exp_f32 v113,v113
v_add_f32 v114,v42,v16
v_exp_f32 v114,v114
v_add_f32 v115,v43,v16
v_exp_f32 v115,v115
v_add_f32 v10,v10,v112
v_add_f32 v10,v10,v113
CV v66,v112,v113
v_add_f32 v10,v10,v114
v_add_f32 v10,v10,v115
CV v67,v114,v115
v_add_f32 v116,v44,v20
v_exp_f32 v116,v116
v_add_f32 v117,v45,v20
v_exp_f32 v117,v117
v_add_f32 v118,v46,v20
v_exp_f32 v118,v118
v_add_f32 v119,v47,v20
v_exp_f32 v119,v119
v_add_f32 v12,v12,v116
v_add_f32 v12,v12,v117
CV v70,v116,v117
buffer_load_dwordx4 v3,s[4:7],s29 offen offset:2048 sc1 lds
v_add_f32 v12,v12,v118
v_add_f32 v12,v12,v119
CV v71,v118,v119
v_add_f32 v24,v48,v16
v_exp_f32 v24,v24
v_add_f32 v25,v49,v16
v_exp_f32 v25,v25
v_add_f32 v26,v50,v16
v_exp_f32 v26,v26
v_add_f32 v27,v51,v16
v_exp_f32 v27,v27
v_add_f32 v10,v10,v24
v_add_f32 v10,v10,v25
CV v72,v24,v25
v_add_f32 v10,v10,v26
v_add_f32 v10,v10,v27
CV v73,v26,v27
buffer_load_dwordx4 v3,s[4:7],s29 offen offset:3072 sc1 lds
v_add_f32 v28,v52,v20
v_exp_f32 v28,v28
v_add_f32 v29,v53,v20
v_exp_f32 v29,v29
v_add_f32 v30,v54,v20
v_exp_f32 v30,v30
v_add_f32 v31,v55,v20
v_exp_f32 v31,v31
v_add_f32 v12,v12,v28
v_add_f32 v12,v12,v29
CV v76,v28,v29
v_add_f32 v12,v12,v30
v_add_f32 v12,v12,v31
CV v77,v30,v31
v_add_f32 v112,v56,v16
v_exp_f32 v112,v112
v_add_f32 v113,v57,v16
v_exp_f32 v113,v113
v_add_f32 v114,v58,v16
v_exp_f32 v114,v114
v_add_f32 v115,v59,v16
v_exp_f32 v115,v115
v_add_f32 v10,v10,v112
v_add_f32 v10,v10,v113
CV v74,v112,v113
v_add_f32 v10,v10,v114
v_add_f32 v10,v10,v115
CV v75,v114,v115
v_add_f32 v116,v60,v20
v_exp_f32 v116,v116
v_add_f32 v117,v61,v20
v_exp_f32 v117,v117
v_add_f32 v118,v62,v20
v_exp_f32 v118,v118
v_add_f32 v119,v63,v20
v_exp_f32 v119,v119
v_add_f32 v12,v12,v116
v_add_f32 v12,v12,v117
CV v78,v116,v117
v_add_f32 v12,v12,v118
v_add_f32 v12,v12,v119
CV v79,v118,v119
v_mov_b32 v8,v10
v_mov_b32 v9,v12
s_add_u32 s28,s28,32768
s_cmp_eq_u32 s28,s32
s_cselect_b32 s28,0,s28
s_add_u32 s29,s28,4096
M v[32:35],a[128:131],a[64:67],v[16:19]
s_mov_b32 m0,s40
DR a[160:163],v1,8192
M v[32:35],a[132:135],a[68:71],v[32:35]
buffer_load_dwordx4 v3,s[8:11],s30 offen offset:0 sc1 lds
M v[32:35],a[136:139],a[72:75],v[32:35]
CV v128,v128,v129
CV v129,v130,v131
CV v130,v136,v137
M v[32:35],a[140:143],a[76:79],v[32:35]
CV v131,v138,v139
CV v132,v132,v133
CV v133,v134,v135
M v[32:35],a[144:147],a[80:83],v[32:35]
DR a[164:167],v1,9216
CV v134,v140,v141
CV v135,v142,v143
M v[32:35],a[148:151],a[84:87],v[32:35]
DR a[168:171],v1,10240
v_accvgpr_write_b32 a192,v128
v_accvgpr_write_b32 a193,v129
M v[32:35],a[152:155],a[88:91],v[32:35]
DR a[172:175],v1,11264
v_accvgpr_write_b32 a194,v130
v_accvgpr_write_b32 a195,v131
M v[32:35],a[156:159],a[92:95],v[32:35]
DR a[176:179],v1,12288
v_accvgpr_write_b32 a224,v132
v_accvgpr_write_b32 a225,v133
M v[36:39],a[128:131],a[96:99],v[20:23]
DR a[180:183],v1,13312
v_accvgpr_write_b32 a226,v134
v_accvgpr_write_b32 a227,v135
M v[36:39],a[132:135],a[100:103],v[36:39]
DR a[184:187],v1,14336
CV v144,v144,v145
CV v145,v146,v147
M v[36:39],a[136:139],a[104:107],v[36:39]
DR a[188:191],v1,15360
CV v146,v152,v153
CV v147,v154,v155
M v[36:39],a[140:143],a[108:111],v[36:39]
CV v148,v148,v149
CV v149,v150,v151
CV v150,v156,v157
M v[36:39],a[144:147],a[112:115],v[36:39]
CV v151,v158,v159
v_accvgpr_write_b32 a196,v144
v_accvgpr_write_b32 a197,v145
M v[36:39],a[148:151],a[116:119],v[36:39]
v_accvgpr_write_b32 a198,v146
v_accvgpr_write_b32 a199,v147
v_accvgpr_write_b32 a228,v148
M v[36:39],a[152:155],a[120:123],v[36:39]
v_accvgpr_write_b32 a229,v149
v_accvgpr_write_b32 a230,v150
v_accvgpr_write_b32 a231,v151
M v[36:39],a[156:159],a[124:127],v[36:39]
s_waitcnt lgkmcnt(0)
CV v160,v160,v161
CV v161,v162,v163
CV v162,v168,v169
M v[40:43],a[160:163],a[64:67],v[16:19]
CV v163,v170,v171
CV v164,v164,v165
CV v165,v166,v167
M v[40:43],a[164:167],a[68:71],v[40:43]
CV v166,v172,v173
CV v167,v174,v175
v_accvgpr_write_b32 a200,v160
M v[40:43],a[168:171],a[72:75],v[40:43]
v_accvgpr_write_b32 a201,v161
v_accvgpr_write_b32 a202,v162
v_accvgpr_write_b32 a203,v163
M v[40:43],a[172:175],a[76:79],v[40:43]
DR a[128:131],v1,16384
v_accvgpr_write_b32 a232,v164
v_accvgpr_write_b32 a233,v165
M v[40:43],a[176:179],a[80:83],v[40:43]
buffer_load_dwordx4 v3,s[8:11],s30 offen offset:1024 sc1 lds
DR a[132:135],v1,17408
M v[40:43],a[180:183],a[84:87],v[40:43]
DR a[136:139],v1,18432
v_accvgpr_write_b32 a234,v166
v_accvgpr_write_b32 a235,v167
M v[40:43],a[184:187],a[88:91],v[40:43]
DR a[140:143],v1,19456
CV v176,v176,v177
CV v177,v178,v179
M v[40:43],a[188:191],a[92:95],v[40:43]
DR a[144:147],v1,20480
CV v178,v184,v185
CV v179,v186,v187
M v[44:47],a[160:163],a[96:99],v[20:23]
DR a[148:151],v1,21504
CV v180,v180,v181
CV v181,v182,v183
M v[44:47],a[164:167],a[100:103],v[44:47]
buffer_load_dwordx4 v3,s[8:11],s30 offen offset:2048 sc1 lds
DR a[152:155],v1,22528
M v[44:47],a[168:171],a[104:107],v[44:47]
DR a[156:159],v1,23552
CV v182,v188,v189
CV v183,v190,v191
M v[44:47],a[172:175],a[108:111],v[44:47]
v_accvgpr_write_b32 a204,v176
v_accvgpr_write_b32 a205,v177
v_accvgpr_write_b32 a206,v178
M v[44:47],a[176:179],a[112:115],v[44:47]
v_accvgpr_write_b32 a207,v179
v_accvgpr_write_b32 a236,v180
v_accvgpr_write_b32 a237,v181
M v[44:47],a[180:183],a[116:119],v[44:47]
v_accvgpr_write_b32 a238,v182
v_accvgpr_write_b32 a239,v183
CV v192,v192,v193
M v[44:47],a[184:187],a[120:123],v[44:47]
buffer_load_dwordx4 v3,s[8:11],s30 offen offset:3072 sc1 lds
CV v193,v194,v195
M v[44:47],a[188:191],a[124:127],v[44:47]
s_waitcnt lgkmcnt(0)
s_mov_b32 m0,s41
CV v194,v200,v201
CV v195,v202,v203
M v[48:51],a[128:131],a[64:67],v[16:19]
CV v196,v196,v197
CV v197,v198,v199
CV v198,v204,v205
M v[48:51],a[132:135],a[68:71],v[48:51]
CV v199,v206,v207
v_accvgpr_write_b32 a208,v192
v_accvgpr_write_b32 a209,v193
M v[48:51],a[136:139],a[72:75],v[48:51]
v_accvgpr_write_b32 a210,v194
v_accvgpr_write_b32 a211,v195
v_accvgpr_write_b32 a240,v196
M v[48:51],a[140:143],a[76:79],v[48:51]
buffer_load_dwordx4 v3,s[8:11],s31 offen offset:0 sc1 lds
DR a[160:163],v1,24576
M v[48:51],a[144:147],a[80:83],v[48:51]
DR a[164:167],v1,25600
v_accvgpr_write_b32 a241,v197
v_accvgpr_write_b32 a242,v198
M v[48:51],a[148:151],a[84:87],v[48:51]
DR a[168:171],v1,26624
v_accvgpr_write_b32 a243,v199
CV v208,v208,v209
M v[48:51],a[152:155],a[88:91],v[48:51]
DR a[172:175],v1,27648
CV v209,v210,v211
CV v210,v216,v217
M v[48:51],a[156:159],a[92:95],v[48:51]
DR a[176:179],v1,28672
CV v211,v218,v219
CV v212,v212,v213
M v[52:55],a[128:131],a[96:99],v[20:23]
buffer_load_dwordx4 v3,s[8:11],s31 offen offset:1024 sc1 lds
DR a[180:183],v1,29696
M v[52:55],a[132:135],a[100:103],v[52:55]
DR a[184:187],v1,30720
CV v213,v214,v215
CV v214,v220,v221
M v[52:55],a[136:139],a[104:107],v[52:55]
DR a[188:191],v1,31744
CV v215,v222,v223
v_accvgpr_write_b32 a212,v208
M v[52:55],a[140:143],a[108:111],v[52:55]
v_accvgpr_write_b32 a213,v209
v_accvgpr_write_b32 a214,v210
v_accvgpr_write_b32 a215,v211
M v[52:55],a[144:147],a[112:115],v[52:55]
v_accvgpr_write_b32 a244,v212
v_accvgpr_write_b32 a245,v213
v_accvgpr_write_b32 a246,v214
M v[52:55],a[148:151],a[116:119],v[52:55]
buffer_load_dwordx4 v3,s[8:11],s31 offen offset:2048 sc1 lds
v_accvgpr_write_b32 a247,v215
M v[52:55],a[152:155],a[120:123],v[52:55]
v_exp_f32 v24,v32
CV v224,v224,v225
M v[52:55],a[156:159],a[124:127],v[52:55]
s_waitcnt vmcnt(15) lgkmcnt(0)
s_barrier
v_exp_f32 v25,v33
M v[56:59],a[160:163],a[64:67],v[16:19]
v_exp_f32 v26,v34
CV v225,v226,v227
M v[56:59],a[164:167],a[68:71],v[56:59]
v_exp_f32 v27,v35
CV v226,v232,v233
M v[56:59],a[168:171],a[72:75],v[56:59]
buffer_load_dwordx4 v3,s[8:11],s31 offen offset:3072 sc1 lds
CV v227,v234,v235
M v[56:59],a[172:175],a[76:79],v[56:59]
DR a[128:131],v2,0
CV v228,v228,v229
CV v229,v230,v231
M v[56:59],a[176:179],a[80:83],v[56:59]
DR a[132:135],v2,1024
CV v230,v236,v237
CV v231,v238,v239
M v[56:59],a[180:183],a[84:87],v[56:59]
DR a[136:139],v2,2048
v_accvgpr_write_b32 a216,v224
v_accvgpr_write_b32 a217,v225
M v[56:59],a[184:187],a[88:91],v[56:59]
DR a[140:143],v2,3072
v_accvgpr_write_b32 a218,v226
v_accvgpr_write_b32 a219,v227
M v[56:59],a[188:191],a[92:95],v[56:59]
DR a[144:147],v2,4096
v_accvgpr_write_b32 a248,v228
v_accvgpr_write_b32 a249,v229
M v[60:63],a[160:163],a[96:99],v[20:23]
DR a[148:151],v2,5120
v_accvgpr_write_b32 a250,v230
v_accvgpr_write_b32 a251,v231
M v[60:63],a[164:167],a[100:103],v[60:63]
DR a[152:155],v2,6144
CV v240,v240,v241
CV v241,v242,v243
M v[60:63],a[168:171],a[104:107],v[60:63]
DR a[156:159],v2,7168
CV v242,v248,v249
CV v243,v250,v251
M v[60:63],a[172:175],a[108:111],v[60:63]
CV v244,v244,v245
CV v245,v246,v247
CV v246,v252,v253
M v[60:63],a[176:179],a[112:115],v[60:63]
CV v247,v254,v255
v_accvgpr_write_b32 a220,v240
v_accvgpr_write_b32 a221,v241
M v[60:63],a[180:183],a[116:119],v[60:63]
v_accvgpr_write_b32 a222,v242
v_accvgpr_write_b32 a223,v243
v_accvgpr_write_b32 a252,v244
M v[60:63],a[184:187],a[120:123],v[60:63]
v_accvgpr_write_b32 a253,v245
v_accvgpr_write_b32 a254,v246
v_accvgpr_write_b32 a255,v247
M v[60:63],a[188:191],a[124:127],v[60:63]
s_waitcnt lgkmcnt(0)
v_exp_f32 v28,v36
v_add_f32 v10,v24,v25
M v[128:131],a[128:131],v[64:67],0
s_add_u32 s30,s30,32768
v_exp_f32 v29,v37
CV v80,v24,v25
M v[128:131],a[132:135],v[72:75],v[128:131]
v_exp_f32 v30,v38
v_add_f32 v10,v10,v26
M v[132:135],a[132:135],v[76:79],0
v_exp_f32 v31,v39
v_add_f32 v10,v10,v27
M v[132:135],a[128:131],v[68:71],v[132:135]
DR a[160:163],v2,8192
CV v81,v26,v27
v_add_f32 v12,v28,v29
M v[136:139],a[136:139],v[64:67],0
DR a[164:167],v2,9216
CV v84,v28,v29
v_add_f32 v12,v12,v30
M v[136:139],a[140:143],v[72:75],v[136:139]
DR a[168:171],v2,10240
v_add_f32 v12,v12,v31
CV v85,v30,v31
M v[140:143],a[140:143],v[76:79],0
DR a[172:175],v2,11264
v_exp_f32 v112,v40
M v[140:143],a[136:139],v[68:71],v[140:143]
DR a[176:179],v2,12288
v_add_f32 v10,v10,v112
M v[144:147],a[144:147],v[64:67],0
DR a[180:183],v2,13312
v_exp_f32 v113,v41
M v[144:147],a[148:151],v[72:75],v[144:147]
DR a[184:187],v2,14336
v_add_f32 v10,v10,v113
CV v82,v112,v113
M v[148:151],a[148:151],v[76:79],0
DR a[188:191],v2,15360
v_exp_f32 v114,v42
M v[148:151],a[144:147],v[68:71],v[148:151]
v_exp_f32 v115,v43
v_add_f32 v10,v10,v114
M v[152:155],a[152:155],v[64:67],0
s_cmp_eq_u32 s30,s33
s_cselect_b32 s30,0,s30
s_add_u32 s31,s30,4096
s_mov_b32 m0,s36
v_add_f32 v10,v10,v115
M v[152:155],a[156:159],v[72:75],v[152:155]
buffer_load_dwordx4 v3,s[4:7],s28 offen offset:0 sc1 lds
CV v83,v114,v115
M v[156:159],a[156:159],v[76:79],0
buffer_load_dwordx4 v3,s[4:7],s28 offen offset:1024 sc1 lds
v_mov_b32 v100,v105
M v[156:159],a[152:155],v[68:71],v[156:159]
s_waitcnt lgkmcnt(0)
buffer_load_dwordx4 v3,s[4:7],s28 offen offset:2048 sc1 lds
v_permlane16_swap_b32 v105,v100
M v[160:163],a[160:163],v[64:67],0
v_exp_f32 v116,v44
v_add_f32 v105,v105,v100
M v[160:163],a[164:167],v[72:75],v[160:163]
v_exp_f32 v117,v45
v_add_f32 v12,v12,v116
M v[164:167],a[164:167],v[76:79],0
buffer_load_dwordx4 v3,s[4:7],s28 offen offset:3072 sc1 lds
v_add_f32 v12,v12,v117
M v[164:167],a[160:163],v[68:71],v[164:167]
s_mov_b32 m0,s37
DR a[128:131],v2,16384
v_exp_f32 v118,v46
M v[168:171],a[168:171],v[64:67],0
DR a[132:135],v2,17408
CV v86,v116,v117
v_add_f32 v12,v12,v118
M v[168:171],a[172:175],v[72:75],v[168:171]
DR a[136:139],v2,18432
v_exp_f32 v119,v47
M v[172:175],a[172:175],v[76:79],0
DR a[140:143],v2,19456
v_add_f32 v12,v12,v119
CV v87,v118,v119
M v[172:175],a[168:171],v[68:71],v[172:175]
DR a[144:147],v2,20480
v_exp_f32 v24,v48
M v[176:179],a[176:179],v[64:67],0
buffer_load_dwordx4 v3,s[4:7],s29 offen offset:0 sc1 lds
DR a[148:151],v2,21504
M v[176:179],a[180:183],v[72:75],v[176:179]
DR a[152:155],v2,22528
v_exp_f32 v25,v49
M v[180:183],a[180:183],v[76:79],0
DR a[156:159],v2,23552
v_add_f32 v10,v10,v24
v_add_f32 v10,v10,v25
M v[180:183],a[176:179],v[68:71],v[180:183]
v_exp_f32 v26,v50
CV v88,v24,v25
M v[184:187],a[184:187],v[64:67],0
v_exp_f32 v27,v51
v_add_f32 v10,v10,v26
M v[184:187],a[188:191],v[72:75],v[184:187]
buffer_load_dwordx4 v3,s[4:7],s29 offen offset:1024 sc1 lds
v_add_f32 v10,v10,v27
M v[188:191],a[188:191],v[76:79],0
v_exp_f32 v28,v52
CV v89,v26,v27
M v[188:191],a[184:187],v[68:71],v[188:191]
s_waitcnt lgkmcnt(0)
v_exp_f32 v29,v53
v_add_f32 v12,v12,v28
M v[192:195],a[128:131],v[64:67],0
v_exp_f32 v30,v54
v_add_f32 v12,v12,v29
M v[192:195],a[132:135],v[72:75],v[192:195]
v_exp_f32 v31,v55
CV v92,v28,v29
M v[196:199],a[132:135],v[76:79],0
buffer_load_dwordx4 v3,s[4:7],s29 offen offset:2048 sc1 lds
v_add_f32 v12,v12,v30
M v[196:199],a[128:131],v[68:71],v[196:199]
DR a[160:163],v2,24576
v_add_f32 v12,v12,v31
CV v93,v30,v31
M v[200:203],a[136:139],v[64:67],0
DR a[164:167],v2,25600
v_exp_f32 v112,v56
M v[200:203],a[140:143],v[72:75],v[200:203]
DR a[168:171],v2,26624
v_add_f32 v10,v10,v112
v_mov_b32 v100,v105
M v[204:207],a[140:143],v[76:79],0
DR a[172:175],v2,27648
v_exp_f32 v113,v57
M v[204:207],a[136:139],v[68:71],v[204:207]
DR a[176:179],v2,28672
v_add_f32 v10,v10,v113
CV v90,v112,v113
M v[208:211],a[144:147],v[64:67],0
DR a[180:183],v2,29696
v_exp_f32 v114,v58
M v[208:211],a[148:151],v[72:75],v[208:211]
DR a[184:187],v2,30720
v_exp_f32 v115,v59
M v[212:215],a[148:151],v[76:79],0
buffer_load_dwordx4 v3,s[4:7],s29 offen offset:3072 sc1 lds
DR a[188:191],v2,31744
M v[212:215],a[144:147],v[68:71],v[212:215]
s_add_u32 s28,s28,32768
v_exp_f32 v116,v60
v_add_f32 v10,v10,v114
M v[216:219],a[152:155],v[64:67],0
v_exp_f32 v117,v61
v_add_f32 v10,v10,v115
M v[216:219],a[156:159],v[72:75],v[216:219]
v_exp_f32 v118,v62
CV v91,v114,v115
M v[220:223],a[156:159],v[76:79],0
v_exp_f32 v119,v63
v_add_f32 v12,v12,v116
M v[220:223],a[152:155],v[68:71],v[220:223]
s_waitcnt vmcnt(16) lgkmcnt(0)
s_barrier
v_add_f32 v12,v12,v117
M v[224:227],a[160:163],v[64:67],0
DR a[128:131],v1,33152
CV v94,v116,v117
v_add_f32 v12,v12,v118
M v[224:227],a[164:167],v[72:75],v[224:227]
s_cmp_eq_u32 s28,s32
s_cselect_b32 s28,0,s28
s_add_u32 s29,s28,4096
v_add_f32 v12,v12,v119
CV v95,v118,v119
M v[228:231],a[164:167],v[76:79],0
DR a[132:135],v1,34176
v_permlane32_swap_b32 v105,v100
v_add_f32 v105,v105,v100
M v[228:231],a[160:163],v[68:71],v[228:231]
DR a[136:139],v1,35200
v_rcp_f32 v123,v105
M v[232:235],a[168:171],v[64:67],0
DR a[140:143],v1,36224
v_mov_b32 v100,v107
s_nop 1
v_permlane16_swap_b32 v107,v100
M v[232:235],a[172:175],v[72:75],v[232:235]
DR a[144:147],v1,37248
v_add_f32 v107,v107,v100
v_mov_b32 v100,v107
M v[236:239],a[172:175],v[76:79],0
DR a[148:151],v1,38272
v_permlane32_swap_b32 v107,v100
v_add_f32 v107,v107,v100
M v[236:239],a[168:171],v[68:71],v[236:239]
DR a[152:155],v1,39296
v_rcp_f32 v124,v107
M v[240:243],a[176:179],v[64:67],0
DR a[156:159],v1,40320
v_max_f32 v13,v10,v12
v_cmp_nge_f32 vcc,s51,v13
M v[240:243],a[180:183],v[72:75],v[240:243]
M v[244:247],a[180:183],v[76:79],0
M v[244:247],a[176:179],v[68:71],v[244:247]
M v[248:251],a[184:187],v[64:67],0
M v[248:251],a[188:191],v[72:75],v[248:251]
M v[252:255],a[188:191],v[76:79],0
M v[252:255],a[184:187],v[68:71],v[252:255]
s_waitcnt lgkmcnt(0)
s_cbranch_vccnz L_rare7
L_ret7:
v_add_f32 v8,v8,v10
v_add_f32 v9,v9,v12
s_cmp_eq_u32 s49,0
s_cbranch_scc1 L_fin
.p2align 4
L_loop2:
M v[32:35],a[128:131],a[64:67],v[16:19]
s_mov_b32 m0,s38
DR a[160:163],v1,41344
M v[32:35],a[132:135],a[68:71],v[32:35]
buffer_load_dwordx4 v3,s[8:11],s30 offen offset:0 sc1 lds
M v[32:35],a[136:139],a[72:75],v[32:35]
DR a[164:167],v1,42368
M v[32:35],a[140:143],a[76:79],v[32:35]
DR a[168:171],v1,43392
M v[32:35],a[144:147],a[80:83],v[32:35]
DR a[172:175],v1,44416
M v[32:35],a[148:151],a[84:87],v[32:35]
DR a[176:179],v1,45440
M v[32:35],a[152:155],a[88:91],v[32:35]
buffer_load_dwordx4 v3,s[8:11],s30 offen offset:1024 sc1 lds
M v[32:35],a[156:159],a[92:95],v[32:35]
DR a[180:183],v1,46464
M v[36:39],a[128:131],a[96:99],v[20:23]
DR a[184:187],v1,47488
M v[36:39],a[132:135],a[100:103],v[36:39]
DR a[188:191],v1,48512
M v[36:39],a[136:139],a[104:107],v[36:39]
DR a[128:131],v1,49536
M v[36:39],a[140:143],a[108:111],v[36:39]
buffer_load_dwordx4 v3,s[8:11],s30 offen offset:2048 sc1 lds
M v[36:39],a[144:147],a[112:115],v[36:39]
v_exp_f32 v24,v32
M v[36:39],a[148:151],a[116:119],v[36:39]
v_exp_f32 v25,v33
M v[36:39],a[152:155],a[120:123],v[36:39]
v_exp_f32 v26,v34
M v[36:39],a[156:159],a[124:127],v[36:39]
s_waitcnt lgkmcnt(1)
v_exp_f32 v27,v35
M v[40:43],a[160:163],a[64:67],v[16:19]
buffer_load_dwordx4 v3,s[8:11],s30 offen offset:3072 sc1 lds
M v[40:43],a[164:167],a[68:71],v[40:43]
s_mov_b32 m0,s39
DR a[132:135],v1,50560
v_add_f32 v10,v24,v25
M v[40:43],a[168:171],a[72:75],v[40:43]
DR a[136:139],v1,51584
CV v64,v24,v25
M v[40:43],a[172:175],a[76:79],v[40:43]
DR a[140:143],v1,52608
v_add_f32 v10,v10,v26
M v[40:43],a[176:179],a[80:83],v[40:43]
DR a[144:147],v1,53632
v_add_f32 v10,v10,v27
M v[40:43],a[180:183],a[84:87],v[40:43]
buffer_load_dwordx4 v3,s[8:11],s31 offen offset:0 sc1 lds
M v[40:43],a[184:187],a[88:91],v[40:43]
DR a[148:151],v1,54656
CV v65,v26,v27
M v[40:43],a[188:191],a[92:95],v[40:43]
DR a[152:155],v1,55680
M v[44:47],a[160:163],a[96:99],v[20:23]
DR a[156:159],v1,56704
M v[44:47],a[164:167],a[100:103],v[44:47]
v_exp_f32 v28,v36
M v[44:47],a[168:171],a[104:107],v[44:47]
buffer_load_dwordx4 v3,s[8:11],s31 offen offset:1024 sc1 lds
M v[44:47],a[172:175],a[108:111],v[44:47]
v_exp_f32 v29,v37
M v[44:47],a[176:179],a[112:115],v[44:47]
v_exp_f32 v30,v38
M v[44:47],a[180:183],a[116:119],v[44:47]
v_exp_f32 v31,v39
M v[44:47],a[184:187],a[120:123],v[44:47]
DR a[160:163],v1,57728
v_add_f32 v12,v28,v29
M v[44:47],a[188:191],a[124:127],v[44:47]
s_waitcnt lgkmcnt(1)
DR a[164:167],v1,58752
CV v68,v28,v29
M v[48:51],a[128:131],a[64:67],v[16:19]
buffer_load_dwordx4 v3,s[8:11],s31 offen offset:2048 sc1 lds
M v[48:51],a[132:135],a[68:71],v[48:51]
DR a[168:171],v1,59776
v_add_f32 v12,v12,v30
M v[48:51],a[136:139],a[72:75],v[48:51]
DR a[172:175],v1,60800
v_add_f32 v12,v12,v31
M v[48:51],a[140:143],a[76:79],v[48:51]
DR a[176:179],v1,61824
CV v69,v30,v31
M v[48:51],a[144:147],a[80:83],v[48:51]
buffer_load_dwordx4 v3,s[8:11],s31 offen offset:3072 sc1 lds
M v[48:51],a[148:151],a[84:87],v[48:51]
s_add_u32 s30,s30,32768
DR a[180:183],v1,62848
M v[48:51],a[152:155],a[88:91],v[48:51]
s_cmp_eq_u32 s30,s33
s_cselect_b32 s30,0,s30
DR a[184:187],v1,63872
M v[48:51],a[156:159],a[92:95],v[48:51]
s_add_u32 s31,s30,4096
DR a[188:191],v1,64896
M v[52:55],a[128:131],a[96:99],v[20:23]
v_exp_f32 v112,v40
M v[52:55],a[132:135],a[100:103],v[52:55]
v_exp_f32 v113,v41
M v[52:55],a[136:139],a[104:107],v[52:55]
v_exp_f32 v114,v42
M v[52:55],a[140:143],a[108:111],v[52:55]
v_exp_f32 v115,v43
M v[52:55],a[144:147],a[112:115],v[52:55]
s_mov_b32 m0,s34
v_exp_f32 v116,v44
M v[52:55],a[148:151],a[116:119],v[52:55]
v_exp_f32 v117,v45
M v[52:55],a[152:155],a[120:123],v[52:55]
v_exp_f32 v118,v46
M v[52:55],a[156:159],a[124:127],v[52:55]
s_waitcnt vmcnt(16) lgkmcnt(0)
s_barrier
M v[56:59],a[160:163],a[64:67],v[16:19]
DR a[128:131],v2,33152
v_add_f32 v10,v10,v112
M v[56:59],a[164:167],a[68:71],v[56:59]
DR a[132:135],v2,34176
v_add_f32 v10,v10,v113
M v[56:59],a[168:171],a[72:75],v[56:59]
buffer_load_dwordx4 v3,s[4:7],s28 offen offset:0 sc1 lds
M v[56:59],a[172:175],a[76:79],v[56:59]
DR a[136:139],v2,35200
CV v66,v112,v113
M v[56:59],a[176:179],a[80:83],v[56:59]
DR a[140:143],v2,36224
v_add_f32 v10,v10,v114
M v[56:59],a[180:183],a[84:87],v[56:59]
DR a[144:147],v2,37248
v_add_f32 v10,v10,v115
M v[56:59],a[184:187],a[88:91],v[56:59]
DR a[148:151],v2,38272
CV v67,v114,v115
M v[56:59],a[188:191],a[92:95],v[56:59]
DR a[152:155],v2,39296
v_add_f32 v12,v12,v116
M v[60:63],a[160:163],a[96:99],v[20:23]
v_exp_f32 v119,v47
M v[60:63],a[164:167],a[100:103],v[60:63]
DR a[156:159],v2,40320
v_add_f32 v12,v12,v117
M v[60:63],a[168:171],a[104:107],v[60:63]
buffer_load_dwordx4 v3,s[4:7],s28 offen offset:1024 sc1 lds
M v[60:63],a[172:175],a[108:111],v[60:63]
DR a[160:163],v2,41344
CV v70,v116,v117
M v[60:63],a[176:179],a[112:115],v[60:63]
DR a[164:167],v2,42368
v_add_f32 v12,v12,v118
M v[60:63],a[180:183],a[116:119],v[60:63]
DR a[168:171],v2,43392
v_add_f32 v12,v12,v119
M v[60:63],a[184:187],a[120:123],v[60:63]
buffer_load_dwordx4 v3,s[4:7],s28 offen offset:2048 sc1 lds
M v[60:63],a[188:191],a[124:127],v[60:63]
s_waitcnt lgkmcnt(3)
DR a[172:175],v2,44416
CV v71,v118,v119
M v[128:131],a[128:131],v[80:83],v[128:131]
v_exp_f32 v24,v48
M v[128:131],a[132:135],v[88:91],v[128:131]
DR a[176:179],v2,45440
v_add_f32 v10,v10,v24
M v[132:135],a[132:135],v[92:95],v[132:135]
v_exp_f32 v25,v49
M v[132:135],a[128:131],v[84:87],v[132:135]
v_exp_f32 v26,v50
M v[136:139],a[136:139],v[80:83],v[136:139]
buffer_load_dwordx4 v3,s[4:7],s28 offen offset:3072 sc1 lds
M v[136:139],a[140:143],v[88:91],v[136:139]
s_mov_b32 m0,s35
v_exp_f32 v27,v51
M v[140:143],a[140:143],v[92:95],v[140:143]
DR a[180:183],v2,46464
v_add_f32 v10,v10,v25
M v[140:143],a[136:139],v[84:87],v[140:143]
DR a[184:187],v2,47488
CV v72,v24,v25
M v[144:147],a[144:147],v[80:83],v[144:147]
DR a[188:191],v2,48512
v_add_f32 v10,v10,v26
M v[144:147],a[148:151],v[88:91],v[144:147]
DR a[128:131],v2,49536
v_add_f32 v10,v10,v27
M v[148:151],a[148:151],v[92:95],v[148:151]
buffer_load_dwordx4 v3,s[4:7],s29 offen offset:0 sc1 lds
M v[148:151],a[144:147],v[84:87],v[148:151]
v_exp_f32 v28,v52
M v[152:155],a[152:155],v[80:83],v[152:155]
DR a[132:135],v2,50560
CV v73,v26,v27
M v[152:155],a[156:159],v[88:91],v[152:155]
v_exp_f32 v29,v53
M v[156:159],a[156:159],v[92:95],v[156:159]
v_exp_f32 v30,v54
M v[156:159],a[152:155],v[84:87],v[156:159]
s_waitcnt lgkmcnt(2)
v_exp_f32 v31,v55
M v[160:163],a[160:163],v[80:83],v[160:163]
buffer_load_dwordx4 v3,s[4:7],s29 offen offset:1024 sc1 lds
M v[160:163],a[164:167],v[88:91],v[160:163]
DR a[136:139],v2,51584
v_add_f32 v12,v12,v28
M v[164:167],a[164:167],v[92:95],v[164:167]
DR a[140:143],v2,52608
v_add_f32 v12,v12,v29
M v[164:167],a[160:163],v[84:87],v[164:167]
DR a[144:147],v2,53632
CV v76,v28,v29
M v[168:171],a[168:171],v[80:83],v[168:171]
DR a[148:151],v2,54656
v_add_f32 v12,v12,v30
M v[168:171],a[172:175],v[88:91],v[168:171]
DR a[152:155],v2,55680
v_add_f32 v12,v12,v31
M v[172:175],a[172:175],v[92:95],v[172:175]
buffer_load_dwordx4 v3,s[4:7],s29 offen offset:2048 sc1 lds
M v[172:175],a[168:171],v[84:87],v[172:175]
DR a[156:159],v2,56704
CV v77,v30,v31
M v[176:179],a[176:179],v[80:83],v[176:179]
v_exp_f32 v112,v56
M v[176:179],a[180:183],v[88:91],v[176:179]
v_exp_f32 v113,v57
M v[180:183],a[180:183],v[92:95],v[180:183]
v_exp_f32 v114,v58
M v[180:183],a[176:179],v[84:87],v[180:183]
v_exp_f32 v115,v59
M v[184:187],a[184:187],v[80:83],v[184:187]
buffer_load_dwordx4 v3,s[4:7],s29 offen offset:3072 sc1 lds
M v[184:187],a[188:191],v[88:91],v[184:187]
s_add_u32 s28,s28,32768
DR a[160:163],v2,57728
v_add_f32 v10,v10,v112
M v[188:191],a[188:191],v[92:95],v[188:191]
DR a[164:167],v2,58752
v_add_f32 v10,v10,v113
M v[188:191],a[184:187],v[84:87],v[188:191]
s_waitcnt lgkmcnt(2)
DR a[168:171],v2,59776
CV v74,v112,v113
M v[192:195],a[128:131],v[80:83],v[192:195]
DR a[172:175],v2,60800
v_add_f32 v10,v10,v114
M v[192:195],a[132:135],v[88:91],v[192:195]
DR a[176:179],v2,61824
v_add_f32 v10,v10,v115
M v[196:199],a[132:135],v[92:95],v[196:199]
DR a[180:183],v2,62848
CV v75,v114,v115
M v[196:199],a[128:131],v[84:87],v[196:199]
s_cmp_eq_u32 s28,s32
s_cselect_b32 s28,0,s28
DR a[184:187],v2,63872
M v[200:203],a[136:139],v[80:83],v[200:203]
s_add_u32 s29,s28,4096
DR a[188:191],v2,64896
M v[200:203],a[140:143],v[88:91],v[200:203]
v_exp_f32 v116,v60
M v[204:207],a[140:143],v[92:95],v[204:207]
v_exp_f32 v117,v61
M v[204:207],a[136:139],v[84:87],v[204:207]
v_exp_f32 v118,v62
M v[208:211],a[144:147],v[80:83],v[208:211]
v_exp_f32 v119,v63
M v[208:211],a[148:151],v[88:91],v[208:211]
v_add_f32 v12,v12,v116
v_add_f32 v12,v12,v117
M v[212:215],a[148:151],v[92:95],v[212:215]
CV v78,v116,v117
v_add_f32 v12,v12,v118
M v[212:215],a[144:147],v[84:87],v[212:215]
v_add_f32 v12,v12,v119
CV v79,v118,v119
M v[216:219],a[152:155],v[80:83],v[216:219]
v_max_f32 v13,v10,v12
v_cmp_nge_f32 vcc,s51,v13
M v[216:219],a[156:159],v[88:91],v[216:219]
M v[220:223],a[156:159],v[92:95],v[220:223]
M v[220:223],a[152:155],v[84:87],v[220:223]
s_waitcnt vmcnt(16) lgkmcnt(0)
s_barrier
M v[224:227],a[160:163],v[80:83],v[224:227]
DR a[128:131],v1,0
M v[224:227],a[164:167],v[88:91],v[224:227]
DR a[132:135],v1,1024
M v[228:231],a[164:167],v[92:95],v[228:231]
DR a[136:139],v1,2048
M v[228:231],a[160:163],v[84:87],v[228:231]
DR a[140:143],v1,3072
M v[232:235],a[168:171],v[80:83],v[232:235]
DR a[144:147],v1,4096
M v[232:235],a[172:175],v[88:91],v[232:235]
DR a[148:151],v1,5120
M v[236:239],a[172:175],v[92:95],v[236:239]
DR a[152:155],v1,6144
M v[236:239],a[168:171],v[84:87],v[236:239]
DR a[156:159],v1,7168
M v[240:243],a[176:179],v[80:83],v[240:243]
s_sub_u32 s49,s49,1
M v[240:243],a[180:183],v[88:91],v[240:243]
M v[244:247],a[180:183],v[92:95],v[244:247]
M v[244:247],a[176:179],v[84:87],v[244:247]
M v[248:251],a[184:187],v[80:83],v[248:251]
M v[248:251],a[188:191],v[88:91],v[248:251]
M v[252:255],a[188:191],v[92:95],v[252:255]
M v[252:255],a[184:187],v[84:87],v[252:255]
s_waitcnt lgkmcnt(0)
s_cbranch_vccnz L_rare8
L_ret8:
M v[32:35],a[128:131],a[64:67],v[16:19]
s_mov_b32 m0,s40
DR a[160:163],v1,8192
v_add_f32 v8,v8,v10
M v[32:35],a[132:135],a[68:71],v[32:35]
buffer_load_dwordx4 v3,s[8:11],s30 offen offset:0 sc1 lds
M v[32:35],a[136:139],a[72:75],v[32:35]
DR a[164:167],v1,9216
v_add_f32 v9,v9,v12
M v[32:35],a[140:143],a[76:79],v[32:35]
DR a[168:171],v1,10240
M v[32:35],a[144:147],a[80:83],v[32:35]
DR a[172:175],v1,11264
M v[32:35],a[148:151],a[84:87],v[32:35]
DR a[176:179],v1,12288
M v[32:35],a[152:155],a[88:91],v[32:35]
buffer_load_dwordx4 v3,s[8:11],s30 offen offset:1024 sc1 lds
M v[32:35],a[156:159],a[92:95],v[32:35]
DR a[180:183],v1,13312
M v[36:39],a[128:131],a[96:99],v[20:23]
DR a[184:187],v1,14336
M v[36:39],a[132:135],a[100:103],v[36:39]
DR a[188:191],v1,15360
M v[36:39],a[136:139],a[104:107],v[36:39]
DR a[128:131],v1,16384
M v[36:39],a[140:143],a[108:111],v[36:39]
buffer_load_dwordx4 v3,s[8:11],s30 offen offset:2048 sc1 lds
M v[36:39],a[144:147],a[112:115],v[36:39]
v_exp_f32 v24,v32
M v[36:39],a[148:151],a[116:119],v[36:39]
v_exp_f32 v25,v33
M v[36:39],a[152:155],a[120:123],v[36:39]
v_exp_f32 v26,v34
M v[36:39],a[156:159],a[124:127],v[36:39]
s_waitcnt lgkmcnt(1)
v_exp_f32 v27,v35
M v[40:43],a[160:163],a[64:67],v[16:19]
buffer_load_dwordx4 v3,s[8:11],s30 offen offset:3072 sc1 lds
M v[40:43],a[164:167],a[68:71],v[40:43]
s_mov_b32 m0,s41
DR a[132:135],v1,17408
v_add_f32 v10,v24,v25
M v[40:43],a[168:171],a[72:75],v[40:43]
DR a[136:139],v1,18432
CV v80,v24,v25
M v[40:43],a[172:175],a[76:79],v[40:43]
DR a[140:143],v1,19456
v_add_f32 v10,v10,v26
M v[40:43],a[176:179],a[80:83],v[40:43]
DR a[144:147],v1,20480
v_add_f32 v10,v10,v27
M v[40:43],a[180:183],a[84:87],v[40:43]
buffer_load_dwordx4 v3,s[8:11],s31 offen offset:0 sc1 lds
M v[40:43],a[184:187],a[88:91],v[40:43]
DR a[148:151],v1,21504
CV v81,v26,v27
M v[40:43],a[188:191],a[92:95],v[40:43]
DR a[152:155],v1,22528
M v[44:47],a[160:163],a[96:99],v[20:23]
DR a[156:159],v1,23552
M v[44:47],a[164:167],a[100:103],v[44:47]
v_exp_f32 v28,v36
M v[44:47],a[168:171],a[104:107],v[44:47]
buffer_load_dwordx4 v3,s[8:11],s31 offen offset:1024 sc1 lds
M v[44:47],a[172:175],a[108:111],v[44:47]
v_exp_f32 v29,v37
M v[44:47],a[176:179],a[112:115],v[44:47]
v_exp_f32 v30,v38
M v[44:47],a[180:183],a[116:119],v[44:47]
v_exp_f32 v31,v39
M v[44:47],a[184:187],a[120:123],v[44:47]
DR a[160:163],v1,24576
v_add_f32 v12,v28,v29
M v[44:47],a[188:191],a[124:127],v[44:47]
s_waitcnt lgkmcnt(1)
DR a[164:167],v1,25600
CV v84,v28,v29
M v[48:51],a[128:131],a[64:67],v[16:19]
buffer_load_dwordx4 v3,s[8:11],s31 offen offset:2048 sc1 lds
M v[48:51],a[132:135],a[68:71],v[48:51]
DR a[168:171],v1,26624
v_add_f32 v12,v12,v30
M v[48:51],a[136:139],a[72:75],v[48:51]
DR a[172:175],v1,27648
v_add_f32 v12,v12,v31
M v[48:51],a[140:143],a[76:79],v[48:51]
DR a[176:179],v1,28672
CV v85,v30,v31
M v[48:51],a[144:147],a[80:83],v[48:51]
buffer_load_dwordx4 v3,s[8:11],s31 offen offset:3072 sc1 lds
M v[48:51],a[148:151],a[84:87],v[48:51]
s_add_u32 s30,s30,32768
DR a[180:183],v1,29696
M v[48:51],a[152:155],a[88:91],v[48:51]
s_cmp_eq_u32 s30,s33
s_cselect_b32 s30,0,s30
DR a[184:187],v1,30720
M v[48:51],a[156:159],a[92:95],v[48:51]
s_add_u32 s31,s30,4096
DR a[188:191],v1,31744
M v[52:55],a[128:131],a[96:99],v[20:23]
v_exp_f32 v112,v40
M v[52:55],a[132:135],a[100:103],v[52:55]
v_exp_f32 v113,v41
M v[52:55],a[136:139],a[104:107],v[52:55]
v_exp_f32 v114,v42
M v[52:55],a[140:143],a[108:111],v[52:55]
v_exp_f32 v115,v43
M v[52:55],a[144:147],a[112:115],v[52:55]
s_mov_b32 m0,s36
v_exp_f32 v116,v44
M v[52:55],a[148:151],a[116:119],v[52:55]
v_exp_f32 v117,v45
M v[52:55],a[152:155],a[120:123],v[52:55]
v_exp_f32 v118,v46
M v[52:55],a[156:159],a[124:127],v[52:55]
s_waitcnt vmcnt(16) lgkmcnt(0)
s_barrier
M v[56:59],a[160:163],a[64:67],v[16:19]
DR a[128:131],v2,0
v_add_f32 v10,v10,v112
M v[56:59],a[164:167],a[68:71],v[56:59]
DR a[132:135],v2,1024
v_add_f32 v10,v10,v113
M v[56:59],a[168:171],a[72:75],v[56:59]
buffer_load_dwordx4 v3,s[4:7],s28 offen offset:0 sc1 lds
M v[56:59],a[172:175],a[76:79],v[56:59]
DR a[136:139],v2,2048
CV v82,v112,v113
M v[56:59],a[176:179],a[80:83],v[56:59]
DR a[140:143],v2,3072
v_add_f32 v10,v10,v114
M v[56:59],a[180:183],a[84:87],v[56:59]
DR a[144:147],v2,4096
v_add_f32 v10,v10,v115
M v[56:59],a[184:187],a[88:91],v[56:59]
DR a[148:151],v2,5120
CV v83,v114,v115
M v[56:59],a[188:191],a[92:95],v[56:59]
DR a[152:155],v2,6144
v_add_f32 v12,v12,v116
M v[60:63],a[160:163],a[96:99],v[20:23]
v_exp_f32 v119,v47
M v[60:63],a[164:167],a[100:103],v[60:63]
DR a[156:159],v2,7168
v_add_f32 v12,v12,v117
M v[60:63],a[168:171],a[104:107],v[60:63]
buffer_load_dwordx4 v3,s[4:7],s28 offen offset:1024 sc1 lds
M v[60:63],a[172:175],a[108:111],v[60:63]
DR a[160:163],v2,8192
CV v86,v116,v117
M v[60:63],a[176:179],a[112:115],v[60:63]
DR a[164:167],v2,9216
v_add_f32 v12,v12,v118
M v[60:63],a[180:183],a[116:119],v[60:63]
DR a[168:171],v2,10240
v_add_f32 v12,v12,v119
M v[60:63],a[184:187],a[120:123],v[60:63]
buffer_load_dwordx4 v3,s[4:7],s28 offen offset:2048 sc1 lds
M v[60:63],a[188:191],a[124:127],v[60:63]
s_waitcnt lgkmcnt(3)
DR a[172:175],v2,11264
CV v87,v118,v119
M v[128:131],a[128:131],v[64:67],v[128:131]
v_exp_f32 v24,v48
M v[128:131],a[132:135],v[72:75],v[128:131]
DR a[176:179],v2,12288
v_add_f32 v10,v10,v24
M v[132:135],a[132:135],v[76:79],v[132:135]
v_exp_f32 v25,v49
M v[132:135],a[128:131],v[68:71],v[132:135]
v_exp_f32 v26,v50
M v[136:139],a[136:139],v[64:67],v[136:139]
buffer_load_dwordx4 v3,s[4:7],s28 offen offset:3072 sc1 lds
M v[136:139],a[140:143],v[72:75],v[136:139]
s_mov_b32 m0,s37
v_exp_f32 v27,v51
M v[140:143],a[140:143],v[76:79],v[140:143]
DR a[180:183],v2,13312
v_add_f32 v10,v10,v25
M v[140:143],a[136:139],v[68:71],v[140:143]
DR a[184:187],v2,14336
CV v88,v24,v25
M v[144:147],a[144:147],v[64:67],v[144:147]
DR a[188:191],v2,15360
v_add_f32 v10,v10,v26
M v[144:147],a[148:151],v[72:75],v[144:147]
DR a[128:131],v2,16384
v_add_f32 v10,v10,v27
M v[148:151],a[148:151],v[76:79],v[148:151]
buffer_load_dwordx4 v3,s[4:7],s29 offen offset:0 sc1 lds
M v[148:151],a[144:147],v[68:71],v[148:151]
v_exp_f32 v28,v52
M v[152:155],a[152:155],v[64:67],v[152:155]
DR a[132:135],v2,17408
CV v89,v26,v27
M v[152:155],a[156:159],v[72:75],v[152:155]
v_exp_f32 v29,v53
M v[156:159],a[156:159],v[76:79],v[156:159]
v_exp_f32 v30,v54
M v[156:159],a[152:155],v[68:71],v[156:159]
s_waitcnt lgkmcnt(2)
v_exp_f32 v31,v55
M v[160:163],a[160:163],v[64:67],v[160:163]
buffer_load_dwordx4 v3,s[4:7],s29 offen offset:1024 sc1 lds
M v[160:163],a[164:167],v[72:75],v[160:163]
DR a[136:139],v2,18432
v_add_f32 v12,v12,v28
M v[164:167],a[164:167],v[76:79],v[164:167]
DR a[140:143],v2,19456
v_add_f32 v12,v12,v29
M v[164:167],a[160:163],v[68:71],v[164:167]
DR a[144:147],v2,20480
CV v92,v28,v29
M v[168:171],a[168:171],v[64:67],v[168:171]
DR a[148:151],v2,21504
v_add_f32 v12,v12,v30
M v[168:171],a[172:175],v[72:75],v[168:171]
DR a[152:155],v2,22528
v_add_f32 v12,v12,v31
M v[172:175],a[172:175],v[76:79],v[172:175]
buffer_load_dwordx4 v3,s[4:7],s29 offen offset:2048 sc1 lds
M v[172:175],a[168:171],v[68:71],v[172:175]
DR a[156:159],v2,23552
CV v93,v30,v31
M v[176:179],a[176:179],v[64:67],v[176:179]
v_exp_f32 v112,v56
M v[176:179],a[180:183],v[72:75],v[176:179]
v_exp_f32 v113,v57
M v[180:183],a[180:183],v[76:79],v[180:183]
v_exp_f32 v114,v58
M v[180:183],a[176:179],v[68:71],v[180:183]
v_exp_f32 v115,v59
M v[184:187],a[184:187],v[64:67],v[184:187]
buffer_load_dwordx4 v3,s[4:7],s29 offen offset:3072 sc1 lds
M v[184:187],a[188:191],v[72:75],v[184:187]
s_add_u32 s28,s28,32768
DR a[160:163],v2,24576
v_add_f32 v10,v10,v112
M v[188:191],a[188:191],v[76:79],v[188:191]
DR a[164:167],v2,25600
v_add_f32 v10,v10,v113
M v[188:191],a[184:187],v[68:71],v[188:191]
s_waitcnt lgkmcnt(2)
DR a[168:171],v2,26624
CV v90,v112,v113
M v[192:195],a[128:131],v[64:67],v[192:195]
DR a[172:175],v2,27648
v_add_f32 v10,v10,v114
M v[192:195],a[132:135],v[72:75],v[192:195]
DR a[176:179],v2,28672
v_add_f32 v10,v10,v115
M v[196:199],a[132:135],v[76:79],v[196:199]
DR a[180:183],v2,29696
CV v91,v114,v115
M v[196:199],a[128:131],v[68:71],v[196:199]
s_cmp_eq_u32 s28,s32
s_cselect_b32 s28,0,s28
DR a[184:187],v2,30720
M v[200:203],a[136:139],v[64:67],v[200:203]
s_add_u32 s29,s28,4096
DR a[188:191],v2,31744
M v[200:203],a[140:143],v[72:75],v[200:203]
v_exp_f32 v116,v60
M v[204:207],a[140:143],v[76:79],v[204:207]
v_exp_f32 v117,v61
M v[204:207],a[136:139],v[68:71],v[204:207]
v_exp_f32 v118,v62
M v[208:211],a[144:147],v[64:67],v[208:211]
v_exp_f32 v119,v63
M v[208:211],a[148:151],v[72:75],v[208:211]
v_add_f32 v12,v12,v116
v_add_f32 v12,v12,v117
M v[212:215],a[148:151],v[76:79],v[212:215]
CV v94,v116,v117
v_add_f32 v12,v12,v118
M v[212:215],a[144:147],v[68:71],v[212:215]
v_add_f32 v12,v12,v119
CV v95,v118,v119
M v[216:219],a[152:155],v[64:67],v[216:219]
v_max_f32 v13,v10,v12
v_cmp_nge_f32 vcc,s51,v13
M v[216:219],a[156:159],v[72:75],v[216:219]
M v[220:223],a[156:159],v[76:79],v[220:223]
M v[220:223],a[152:155],v[68:71],v[220:223]
s_waitcnt vmcnt(16) lgkmcnt(0)
s_barrier
M v[224:227],a[160:163],v[64:67],v[224:227]
DR a[128:131],v1,33152
M v[224:227],a[164:167],v[72:75],v[224:227]
DR a[132:135],v1,34176
M v[228:231],a[164:167],v[76:79],v[228:231]
DR a[136:139],v1,35200
M v[228:231],a[160:163],v[68:71],v[228:231]
DR a[140:143],v1,36224
M v[232:235],a[168:171],v[64:67],v[232:235]
DR a[144:147],v1,37248
M v[232:235],a[172:175],v[72:75],v[232:235]
DR a[148:151],v1,38272
M v[236:239],a[172:175],v[76:79],v[236:239]
DR a[152:155],v1,39296
M v[236:239],a[168:171],v[68:71],v[236:239]
DR a[156:159],v1,40320
M v[240:243],a[176:179],v[64:67],v[240:243]
M v[240:243],a[180:183],v[72:75],v[240:243]
M v[244:247],a[180:183],v[76:79],v[244:247]
M v[244:247],a[176:179],v[68:71],v[244:247]
M v[248:251],a[184:187],v[64:67],v[248:251]
M v[248:251],a[188:191],v[72:75],v[248:251]
M v[252:255],a[188:191],v[76:79],v[252:255]
M v[252:255],a[184:187],v[68:71],v[252:255]
s_waitcnt lgkmcnt(0)
s_cbranch_vccnz L_rare9
L_ret9:
v_add_f32 v8,v8,v10
v_add_f32 v9,v9,v12
s_cmp_lg_u32 s49,0
s_cbranch_scc1 L_loop2
L_fin:
s_waitcnt vmcnt(8) lgkmcnt(0)
s_barrier
DR a[128:131],v2,33152
DR a[132:135],v2,34176
DR a[136:139],v2,35200
DR a[140:143],v2,36224
DR a[144:147],v2,37248
DR a[148:151],v2,38272
DR a[152:155],v2,39296
DR a[156:159],v2,40320
s_waitcnt lgkmcnt(7)
M v[128:131],a[128:131],v[80:83],v[128:131]
s_mov_b32 s54,16384
DR a[160:163],v2,41344
v_mov_b32 v104,v16
s_waitcnt lgkmcnt(7)
M v[128:131],a[132:135],v[88:91],v[128:131]
DR a[164:167],v2,42368
v_mov_b32 v105,v8
M v[132:135],a[132:135],v[92:95],v[132:135]
DR a[168:171],v2,43392
v_mov_b32 v106,v20
M v[132:135],a[128:131],v[84:87],v[132:135]
DR a[172:175],v2,44416
v_mov_b32 v107,v9
s_waitcnt lgkmcnt(9)
M v[136:139],a[136:139],v[80:83],v[136:139]
buffer_store_dwordx4 v[104:107],v4,s[20:23],s54 offen sc1
DR a[176:179],v2,45440
s_waitcnt lgkmcnt(9)
M v[136:139],a[140:143],v[88:91],v[136:139]
s_mov_b32 s54,0
DR a[180:183],v2,46464
M v[140:143],a[140:143],v[92:95],v[140:143]
DR a[184:187],v2,47488
M v[140:143],a[136:139],v[84:87],v[140:143]
DR a[188:191],v2,48512
s_waitcnt lgkmcnt(11)
M v[144:147],a[144:147],v[80:83],v[144:147]
DR a[128:131],v2,49536
s_waitcnt lgkmcnt(11)
M v[144:147],a[148:151],v[88:91],v[144:147]
DR a[132:135],v2,50560
M v[148:151],a[148:151],v[92:95],v[148:151]
DR a[136:139],v2,51584
M v[148:151],a[144:147],v[84:87],v[148:151]
DR a[140:143],v2,52608
CV v128,v128,v129
s_waitcnt lgkmcnt(13)
M v[152:155],a[152:155],v[80:83],v[152:155]
s_waitcnt vmcnt(1)
s_barrier
s_waitcnt lgkmcnt(12)
M v[152:155],a[156:159],v[88:91],v[152:155]
s_add_u32 m0,s67,99456
DR a[144:147],v2,53632
CV v129,v130,v131
M v[156:159],a[156:159],v[92:95],v[156:159]
buffer_load_dwordx4 v120,s[68:71],s84 offen offset:0 lds
M v[156:159],a[152:155],v[84:87],v[156:159]
s_waitcnt lgkmcnt(5)
DR a[148:151],v2,54656
CV v130,v136,v137
M v[160:163],a[160:163],v[80:83],v[160:163]
DR a[152:155],v2,55680
CV v131,v138,v139
M v[160:163],a[164:167],v[88:91],v[160:163]
buffer_store_dwordx4 v[128:131],v4,s[20:23],s54 offen offset:0 sc1
CV v132,v132,v133
M v[164:167],a[164:167],v[92:95],v[164:167]
s_mov_b32 s54,8192
DR a[156:159],v2,56704
CV v133,v134,v135
M v[164:167],a[160:163],v[84:87],v[164:167]
buffer_load_dwordx4 v120,s[68:71],s85 offen offset:1024 lds
M v[168:171],a[168:171],v[80:83],v[168:171]
DR a[160:163],v2,57728
CV v134,v140,v141
M v[168:171],a[172:175],v[88:91],v[168:171]
buffer_load_dwordx4 v120,s[68:71],s86 offen offset:2048 lds
M v[172:175],a[172:175],v[92:95],v[172:175]
DR a[164:167],v2,58752
CV v135,v142,v143
M v[172:175],a[168:171],v[84:87],v[172:175]
buffer_store_dwordx4 v[132:135],v4,s[20:23],s54 offen offset:0 sc1
CV v144,v144,v145
M v[176:179],a[176:179],v[80:83],v[176:179]
s_mov_b32 s54,0
DR a[168:171],v2,59776
CV v145,v146,v147
M v[176:179],a[180:183],v[88:91],v[176:179]
buffer_load_dwordx4 v120,s[68:71],s87 offen offset:3072 lds
M v[180:183],a[180:183],v[92:95],v[180:183]
s_add_u32 m0,s67,103552
DR a[172:175],v2,60800
CV v146,v152,v153
M v[180:183],a[176:179],v[84:87],v[180:183]
buffer_load_dwordx4 v120,s[68:71],s88 offen offset:0 lds
M v[184:187],a[184:187],v[80:83],v[184:187]
DR a[176:179],v2,61824
CV v147,v154,v155
M v[184:187],a[188:191],v[88:91],v[184:187]
buffer_store_dwordx4 v[144:147],v4,s[20:23],s54 offen offset:1024 sc1
CV v148,v148,v149
M v[188:191],a[188:191],v[92:95],v[188:191]
s_mov_b32 s54,8192
DR a[180:183],v2,62848
CV v149,v150,v151
M v[188:191],a[184:187],v[84:87],v[188:191]
s_waitcnt lgkmcnt(6)
DR a[184:187],v2,63872
CV v150,v156,v157
M v[192:195],a[128:131],v[80:83],v[192:195]
buffer_load_dwordx4 v120,s[68:71],s89 offen offset:1024 lds
M v[192:195],a[132:135],v[88:91],v[192:195]
DR a[188:191],v2,64896
CV v151,v158,v159
M v[196:199],a[132:135],v[92:95],v[196:199]
buffer_store_dwordx4 v[148:151],v4,s[20:23],s54 offen offset:1024 sc1
CV v160,v160,v161
M v[196:199],a[128:131],v[84:87],v[196:199]
s_mov_b32 s54,0
CV v161,v162,v163
CV v162,v168,v169
M v[200:203],a[136:139],v[80:83],v[200:203]
buffer_load_dwordx4 v120,s[68:71],s90 offen offset:2048 lds
M v[200:203],a[140:143],v[88:91],v[200:203]
buffer_load_dwordx4 v120,s[68:71],s91 offen offset:3072 lds
M v[204:207],a[140:143],v[92:95],v[204:207]
s_add_u32 s68,s68,128
s_addc_u32 s69,s69,0
s_sub_u32 s70,s70,128
M v[204:207],a[136:139],v[84:87],v[204:207]
CV v163,v170,v171
CV v164,v164,v165
M v[208:211],a[144:147],v[80:83],v[208:211]
buffer_store_dwordx4 v[160:163],v4,s[20:23],s54 offen offset:2048 sc1
CV v165,v166,v167
M v[208:211],a[148:151],v[88:91],v[208:211]
s_mov_b32 s54,8192
CV v166,v172,v173
CV v167,v174,v175
M v[212:215],a[148:151],v[92:95],v[212:215]
buffer_store_dwordx4 v[164:167],v4,s[20:23],s54 offen offset:2048 sc1
CV v176,v176,v177
M v[212:215],a[144:147],v[84:87],v[212:215]
s_mov_b32 s54,0
CV v177,v178,v179
CV v178,v184,v185
M v[216:219],a[152:155],v[80:83],v[216:219]
CV v179,v186,v187
CV v180,v180,v181
M v[216:219],a[156:159],v[88:91],v[216:219]
buffer_store_dwordx4 v[176:179],v4,s[20:23],s54 offen offset:3072 sc1
CV v181,v182,v183
M v[220:223],a[156:159],v[92:95],v[220:223]
s_mov_b32 s54,8192
CV v182,v188,v189
CV v183,v190,v191
M v[220:223],a[152:155],v[84:87],v[220:223]
s_waitcnt lgkmcnt(0)
CV v192,v192,v193
CV v193,v194,v195
M v[224:227],a[160:163],v[80:83],v[224:227]
buffer_store_dwordx4 v[180:183],v4,s[20:23],s54 offen offset:3072 sc1
CV v194,v200,v201
M v[224:227],a[164:167],v[88:91],v[224:227]
s_mov_b32 s54,4096
CV v195,v202,v203
CV v196,v196,v197
M v[228:231],a[164:167],v[92:95],v[228:231]
buffer_store_dwordx4 v[192:195],v4,s[20:23],s54 offen offset:0 sc1
CV v197,v198,v199
M v[228:231],a[160:163],v[84:87],v[228:231]
s_mov_b32 s54,12288
CV v198,v204,v205
CV v199,v206,v207
M v[232:235],a[168:171],v[80:83],v[232:235]
buffer_store_dwordx4 v[196:199],v4,s[20:23],s54 offen offset:0 sc1
CV v208,v208,v209
M v[232:235],a[172:175],v[88:91],v[232:235]
s_mov_b32 s54,4096
CV v209,v210,v211
CV v210,v216,v217
M v[236:239],a[172:175],v[92:95],v[236:239]
CV v211,v218,v219
CV v212,v212,v213
M v[236:239],a[168:171],v[84:87],v[236:239]
buffer_store_dwordx4 v[208:211],v4,s[20:23],s54 offen offset:1024 sc1
CV v213,v214,v215
M v[240:243],a[176:179],v[80:83],v[240:243]
s_mov_b32 s54,12288
CV v214,v220,v221
CV v215,v222,v223
M v[240:243],a[180:183],v[88:91],v[240:243]
buffer_store_dwordx4 v[212:215],v4,s[20:23],s54 offen offset:1024 sc1
M v[244:247],a[180:183],v[92:95],v[244:247]
s_mov_b32 s54,4096
M v[244:247],a[176:179],v[84:87],v[244:247]
CV v224,v224,v225
CV v225,v226,v227
M v[248:251],a[184:187],v[80:83],v[248:251]
CV v226,v232,v233
CV v227,v234,v235
M v[248:251],a[188:191],v[88:91],v[248:251]
buffer_store_dwordx4 v[224:227],v4,s[20:23],s54 offen offset:2048 sc1
CV v228,v228,v229
M v[252:255],a[188:191],v[92:95],v[252:255]
s_mov_b32 s54,12288
CV v229,v230,v231
CV v230,v236,v237
M v[252:255],a[184:187],v[84:87],v[252:255]
CV v231,v238,v239
buffer_store_dwordx4 v[228:231],v4,s[20:23],s54 offen offset:2048 sc1
CV v240,v240,v241
CV v241,v242,v243
CV v242,v248,v249
CV v243,v250,v251
s_mov_b32 s54,4096
buffer_store_dwordx4 v[240:243],v4,s[20:23],s54 offen offset:3072 sc1
CV v244,v244,v245
CV v245,v246,v247
CV v246,v252,v253
CV v247,v254,v255
s_mov_b32 s54,12288
buffer_store_dwordx4 v[244:247],v4,s[20:23],s54 offen offset:3072 sc1
v_accvgpr_read_b32 v128,a192
v_accvgpr_read_b32 v129,a193
v_accvgpr_read_b32 v130,a194
v_accvgpr_read_b32 v131,a195
v_accvgpr_read_b32 v144,a196
v_accvgpr_read_b32 v145,a197
v_accvgpr_read_b32 v146,a198
v_accvgpr_read_b32 v147,a199
v_accvgpr_read_b32 v160,a200
v_accvgpr_read_b32 v161,a201
v_accvgpr_read_b32 v162,a202
v_accvgpr_read_b32 v163,a203
v_accvgpr_read_b32 v176,a204
v_accvgpr_read_b32 v177,a205
v_accvgpr_read_b32 v178,a206
v_accvgpr_read_b32 v179,a207
v_accvgpr_read_b32 v192,a208
v_accvgpr_read_b32 v193,a209
v_accvgpr_read_b32 v194,a210
v_accvgpr_read_b32 v195,a211
v_accvgpr_read_b32 v208,a212
v_accvgpr_read_b32 v209,a213
v_accvgpr_read_b32 v210,a214
v_accvgpr_read_b32 v211,a215
v_accvgpr_read_b32 v224,a216
v_accvgpr_read_b32 v225,a217
v_accvgpr_read_b32 v226,a218
v_accvgpr_read_b32 v227,a219
v_accvgpr_read_b32 v240,a220
v_accvgpr_read_b32 v241,a221
v_accvgpr_read_b32 v242,a222
v_accvgpr_read_b32 v243,a223
v_accvgpr_read_b32 v132,a224
v_accvgpr_read_b32 v133,a225
v_accvgpr_read_b32 v134,a226
v_accvgpr_read_b32 v135,a227
v_accvgpr_read_b32 v148,a228
v_accvgpr_read_b32 v149,a229
v_accvgpr_read_b32 v150,a230
v_accvgpr_read_b32 v151,a231
v_accvgpr_read_b32 v164,a232
v_accvgpr_read_b32 v165,a233
v_accvgpr_read_b32 v166,a234
v_accvgpr_read_b32 v167,a235
v_accvgpr_read_b32 v180,a236
v_accvgpr_read_b32 v181,a237
v_accvgpr_read_b32 v182,a238
v_accvgpr_read_b32 v183,a239
v_accvgpr_read_b32 v196,a240
v_accvgpr_read_b32 v197,a241
v_accvgpr_read_b32 v198,a242
v_accvgpr_read_b32 v199,a243
v_accvgpr_read_b32 v212,a244
v_accvgpr_read_b32 v213,a245
v_accvgpr_read_b32 v214,a246
v_accvgpr_read_b32 v215,a247
v_accvgpr_read_b32 v228,a248
v_accvgpr_read_b32 v229,a249
v_accvgpr_read_b32 v230,a250
v_accvgpr_read_b32 v231,a251
v_accvgpr_read_b32 v244,a252
v_accvgpr_read_b32 v245,a253
v_accvgpr_read_b32 v246,a254
v_accvgpr_read_b32 v247,a255
s_waitcnt vmcnt(0) lgkmcnt(0)
s_barrier
s_bitcmp1_b32 s50,3
s_cbranch_scc0 L_nopub10
s_cmp_eq_u32 s42,0
s_cbranch_scc0 L_nopub10
s_mov_b64 exec,1
v_mov_b32 v14,1
buffer_store_dword v14,off,s[24:27],s55 offset:96 sc1
s_mov_b64 exec,-1
L_nopub10:
s_add_u32 m0,s67,66304
DT a[0:1],v121,33152
buffer_load_dwordx4 v120,s[68:71],s84 offen offset:0 lds
DT a[2:3],v121,33664
buffer_load_dwordx4 v120,s[68:71],s85 offen offset:1024 lds
DT a[4:5],v121,34176
buffer_load_dwordx4 v120,s[68:71],s86 offen offset:2048 lds
DT a[6:7],v121,34688
buffer_load_dwordx4 v120,s[68:71],s87 offen offset:3072 lds
DT a[8:9],v121,35200
s_add_u32 m0,s67,70400
DT a[10:11],v121,35712
buffer_load_dwordx4 v120,s[68:71],s88 offen offset:0 lds
DT a[12:13],v121,36224
buffer_load_dwordx4 v120,s[68:71],s89 offen offset:1024 lds
DT a[14:15],v121,36736
buffer_load_dwordx4 v120,s[68:71],s90 offen offset:2048 lds
DT a[16:17],v121,37248
buffer_load_dwordx4 v120,s[68:71],s91 offen offset:3072 lds
DT a[18:19],v121,37760
s_add_u32 s68,s68,128
s_addc_u32 s69,s69,0
DT a[20:21],v121,38272
s_sub_u32 s70,s70,128
DT a[22:23],v121,38784
s_add_u32 m0,s67,0
DT a[24:25],v121,39296
buffer_load_dwordx4 v120,s[68:71],s84 offen offset:0 lds
DT a[26:27],v121,39808
buffer_load_dwordx4 v120,s[68:71],s85 offen offset:1024 lds
DT a[28:29],v121,40320
buffer_load_dwordx4 v120,s[68:71],s86 offen offset:2048 lds
DT a[30:31],v121,40832
buffer_load_dwordx4 v120,s[68:71],s87 offen offset:3072 lds
DT a[32:33],v121,33184
s_add_u32 m0,s67,4096
DT a[34:35],v121,33696
buffer_load_dwordx4 v120,s[68:71],s88 offen offset:0 lds
DT a[36:37],v121,34208
buffer_load_dwordx4 v120,s[68:71],s89 offen offset:1024 lds
DT a[38:39],v121,34720
buffer_load_dwordx4 v120,s[68:71],s90 offen offset:2048 lds
DT a[40:41],v121,35232
buffer_load_dwordx4 v120,s[68:71],s91 offen offset:3072 lds
DT a[42:43],v121,35744
s_add_u32 s68,s68,128
s_addc_u32 s69,s69,0
DT a[44:45],v121,36256
s_sub_u32 s70,s70,128
DT a[46:47],v121,36768
s_add_u32 m0,s67,33152
DT a[48:49],v121,37280
buffer_load_dwordx4 v120,s[68:71],s84 offen offset:0 lds
DT a[50:51],v121,37792
buffer_load_dwordx4 v120,s[68:71],s85 offen offset:1024 lds
DT a[52:53],v121,38304
buffer_load_dwordx4 v120,s[68:71],s86 offen offset:2048 lds
DT a[54:55],v121,38816
buffer_load_dwordx4 v120,s[68:71],s87 offen offset:3072 lds
DT a[56:57],v121,39328
s_add_u32 m0,s67,37248
DT a[58:59],v121,39840
buffer_load_dwordx4 v120,s[68:71],s88 offen offset:0 lds
DT a[60:61],v121,40352
buffer_load_dwordx4 v120,s[68:71],s89 offen offset:1024 lds
DT a[62:63],v121,40864
buffer_load_dwordx4 v120,s[68:71],s90 offen offset:2048 lds
buffer_load_dwordx4 v120,s[68:71],s91 offen offset:3072 lds
s_add_u32 s68,s68,128
s_addc_u32 s69,s69,0
s_sub_u32 s70,s70,128
s_branch L_l2_done
L_code_end:
L_spin0:
s_mov_b32 s47,0x40000
L_spinl0:
s_sleep 1
buffer_load_dword v13,off,s[92:95],0 sc1
s_waitcnt vmcnt(0)
v_cmp_eq_u32 vcc,1,v13
s_nop 0
s_cmp_eq_u64 vcc,-1
s_cbranch_scc1 L_spun0
s_sub_u32 s47,s47,1
s_cmp_lg_u32 s47,0
s_cbranch_scc1 L_spinl0
s_branch L_spun0
L_spin1:
s_mov_b32 s47,0x40000
L_spinl1:
s_sleep 1
v_lshrrev_b32 v13,2,v4
v_and_b32 v13,4,v13
v_lshl_or_b32 v13,v4,2,v13
v_and_b32 v13,0x84,v13
buffer_load_dword v13,v13,s[24:27],s3 offen offset:16 sc1
s_waitcnt vmcnt(0)
v_and_b32 v14,0x80808080,v13
v_cmp_eq_u32 vcc,0x80808080,v14
s_nop 0
s_cmp_eq_u64 vcc,-1
s_cbranch_scc1 L_spun1
s_sub_u32 s47,s47,1
s_cmp_lg_u32 s47,0
s_cbranch_scc1 L_spinl1
s_branch L_spun1
L_rel2:
buffer_wbl2 sc1
s_waitcnt vmcnt(0)
s_branch L_reld2
L_spin2:
s_mov_b32 s47,0x40000
L_spinl2:
s_sleep 1
buffer_load_dword v14,v13,s[24:27],s51 offen offset:0 sc1
s_waitcnt vmcnt(0)
v_cmp_eq_u32 vcc,1,v14
s_nop 0
s_cmp_eq_u64 vcc,-1
s_cbranch_scc1 L_spun2
s_sub_u32 s47,s47,1
s_cmp_lg_u32 s47,0
s_cbranch_scc1 L_spinl2
s_branch L_spun2
L_acq2:
buffer_inv sc1
s_waitcnt vmcnt(0)
s_branch L_acqd2
L_spin3:
s_mov_b32 s47,0x40000
L_spinl3:
s_sleep 1
buffer_load_dword v15,v0,s[24:27],s3 offen offset:0 sc1
s_waitcnt vmcnt(0)
v_cmp_eq_u32 vcc,0x01010101,v15
s_nop 0
s_cmp_eq_u64 vcc,-1
s_cbranch_scc1 L_spun3
s_sub_u32 s47,s47,1
s_cmp_lg_u32 s47,0
s_cbranch_scc1 L_spinl3
s_branch L_spun3
L_spin4:
s_mov_b32 s47,0x40000
L_spinl4:
s_sleep 1
buffer_load_dword v13,off,s[92:95],0 sc1
s_waitcnt vmcnt(0)
v_cmp_eq_u32 vcc,1,v13
s_nop 0
s_cmp_eq_u64 vcc,-1
s_cbranch_scc1 L_spun4
s_sub_u32 s47,s47,1
s_cmp_lg_u32 s47,0
s_cbranch_scc1 L_spinl4
s_branch L_spun4
L_spin5:
s_mov_b32 s47,0x40000
L_spinl5:
s_sleep 1
v_lshrrev_b32 v13,2,v4
v_and_b32 v13,4,v13
v_lshl_or_b32 v13,v4,2,v13
v_and_b32 v13,0x84,v13
buffer_load_dword v13,v13,s[24:27],s3 offen offset:16 sc1
s_waitcnt vmcnt(0)
v_and_b32 v14,0x80808080,v13
v_cmp_eq_u32 vcc,0x80808080,v14
s_nop 0
s_cmp_eq_u64 vcc,-1
s_cbranch_scc1 L_spun5
s_sub_u32 s47,s47,1
s_cmp_lg_u32 s47,0
s_cbranch_scc1 L_spinl5
s_branch L_spun5
L_spin6:
s_mov_b32 s47,0x40000
L_spinl6:
s_sleep 1
buffer_load_dword v14,v13,s[24:27],s51 offen offset:0 sc1
s_waitcnt vmcnt(0)
v_cmp_eq_u32 vcc,1,v14
s_nop 0
s_cmp_eq_u64 vcc,-1
s_cbranch_scc1 L_spun6
s_sub_u32 s47,s47,1
s_cmp_lg_u32 s47,0
s_cbranch_scc1 L_spinl6
s_branch L_spun6
L_acq6:
buffer_inv sc1
s_waitcnt vmcnt(0)
s_branch L_acqd6
L_rel5:
buffer_wbl2 sc1
s_waitcnt vmcnt(0)
s_branch L_reld5
L_spin7:
s_mov_b32 s47,0x40000
L_spinl7:
s_sleep 1
buffer_load_dword v99,v98,s[24:27],s3 offen offset:32 sc1
s_waitcnt vmcnt(0)
v_cmp_eq_u32 vcc,1,v99
s_nop 0
s_cmp_eq_u64 vcc,-1
s_cbranch_scc1 L_spun7
s_sub_u32 s47,s47,1
s_cmp_lg_u32 s47,0
s_cbranch_scc1 L_spinl7
s_branch L_spun7
L_acq7:
buffer_inv sc1
s_waitcnt vmcnt(0)
s_branch L_acqd7
L_rel7:
buffer_wbl2 sc1
s_waitcnt vmcnt(0)
s_branch L_reld7
L_rare0:
v_max3_f32 v96,v32,v33,v34
v_max_f32 v96,v96,v35
v_max3_f32 v96,v96,v40,v41
v_max3_f32 v96,v96,v42,v43
v_max3_f32 v96,v96,v48,v49
v_max3_f32 v96,v96,v50,v51
v_max3_f32 v96,v96,v56,v57
v_max3_f32 v96,v96,v58,v59
v_mov_b32 v13,v96
s_nop 1
v_permlane16_swap_b32 v96,v13
v_max_f32 v96,v96,v13
v_mov_b32 v13,v96
s_nop 1
v_permlane32_swap_b32 v96,v13
v_max_f32 v96,v96,v13
v_max_f32 v96,0,v96
v_sub_f32 v96,0,v96
v_exp_f32 v13,v96
v_add_f32 v16,v16,v96
v_add_f32 v17,v17,v96
v_add_f32 v18,v18,v96
v_add_f32 v19,v19,v96
v_mul_f32 v8,v8,v13
v_mul_f32 v128,v128,v13
v_mul_f32 v129,v129,v13
v_mul_f32 v130,v130,v13
v_mul_f32 v131,v131,v13
v_mul_f32 v136,v136,v13
v_mul_f32 v137,v137,v13
v_mul_f32 v138,v138,v13
v_mul_f32 v139,v139,v13
v_mul_f32 v144,v144,v13
v_mul_f32 v145,v145,v13
v_mul_f32 v146,v146,v13
v_mul_f32 v147,v147,v13
v_mul_f32 v152,v152,v13
v_mul_f32 v153,v153,v13
v_mul_f32 v154,v154,v13
v_mul_f32 v155,v155,v13
v_mul_f32 v160,v160,v13
v_mul_f32 v161,v161,v13
v_mul_f32 v162,v162,v13
v_mul_f32 v163,v163,v13
v_mul_f32 v168,v168,v13
v_mul_f32 v169,v169,v13
v_mul_f32 v170,v170,v13
v_mul_f32 v171,v171,v13
v_mul_f32 v176,v176,v13
v_mul_f32 v177,v177,v13
v_mul_f32 v178,v178,v13
v_mul_f32 v179,v179,v13
v_mul_f32 v184,v184,v13
v_mul_f32 v185,v185,v13
v_mul_f32 v186,v186,v13
v_mul_f32 v187,v187,v13
v_mul_f32 v192,v192,v13
v_mul_f32 v193,v193,v13
v_mul_f32 v194,v194,v13
v_mul_f32 v195,v195,v13
v_mul_f32 v200,v200,v13
v_mul_f32 v201,v201,v13
v_mul_f32 v202,v202,v13
v_mul_f32 v203,v203,v13
v_mul_f32 v208,v208,v13
v_mul_f32 v209,v209,v13
v_mul_f32 v210,v210,v13
v_mul_f32 v211,v211,v13
v_mul_f32 v216,v216,v13
v_mul_f32 v217,v217,v13
v_mul_f32 v218,v218,v13
v_mul_f32 v219,v219,v13
v_mul_f32 v224,v224,v13
v_mul_f32 v225,v225,v13
v_mul_f32 v226,v226,v13
v_mul_f32 v227,v227,v13
v_mul_f32 v232,v232,v13
v_mul_f32 v233,v233,v13
v_mul_f32 v234,v234,v13
v_mul_f32 v235,v235,v13
v_mul_f32 v240,v240,v13
v_mul_f32 v241,v241,v13
v_mul_f32 v242,v242,v13
v_mul_f32 v243,v243,v13
v_mul_f32 v248,v248,v13
v_mul_f32 v249,v249,v13
v_mul_f32 v250,v250,v13
v_mul_f32 v251,v251,v13
v_add_f32 v24,v32,v96
v_exp_f32 v24,v24
v_add_f32 v25,v33,v96
v_exp_f32 v25,v25
v_add_f32 v26,v34,v96
v_exp_f32 v26,v26
v_add_f32 v27,v35,v96
v_exp_f32 v27,v27
v_add_f32 v10,v24,v25
CV v80,v24,v25
v_add_f32 v10,v10,v26
v_add_f32 v10,v10,v27
CV v81,v26,v27
v_add_f32 v28,v40,v96
v_exp_f32 v28,v28
v_add_f32 v29,v41,v96
v_exp_f32 v29,v29
v_add_f32 v30,v42,v96
v_exp_f32 v30,v30
v_add_f32 v31,v43,v96
v_exp_f32 v31,v31
v_add_f32 v10,v10,v28
v_add_f32 v10,v10,v29
CV v82,v28,v29
v_add_f32 v10,v10,v30
v_add_f32 v10,v10,v31
CV v83,v30,v31
v_add_f32 v24,v48,v96
v_exp_f32 v24,v24
v_add_f32 v25,v49,v96
v_exp_f32 v25,v25
v_add_f32 v26,v50,v96
v_exp_f32 v26,v26
v_add_f32 v27,v51,v96
v_exp_f32 v27,v27
v_add_f32 v10,v10,v24
v_add_f32 v10,v10,v25
CV v88,v24,v25
v_add_f32 v10,v10,v26
v_add_f32 v10,v10,v27
CV v89,v26,v27
v_add_f32 v28,v56,v96
v_exp_f32 v28,v28
v_add_f32 v29,v57,v96
v_exp_f32 v29,v29
v_add_f32 v30,v58,v96
v_exp_f32 v30,v30
v_add_f32 v31,v59,v96
v_exp_f32 v31,v31
v_add_f32 v10,v10,v28
v_add_f32 v10,v10,v29
CV v90,v28,v29
v_add_f32 v10,v10,v30
v_add_f32 v10,v10,v31
CV v91,v30,v31
v_max3_f32 v97,v36,v37,v38
v_max_f32 v97,v97,v39
v_max3_f32 v97,v97,v44,v45
v_max3_f32 v97,v97,v46,v47
v_max3_f32 v97,v97,v52,v53
v_max3_f32 v97,v97,v54,v55
v_max3_f32 v97,v97,v60,v61
v_max3_f32 v97,v97,v62,v63
v_mov_b32 v13,v97
s_nop 1
v_permlane16_swap_b32 v97,v13
v_max_f32 v97,v97,v13
v_mov_b32 v13,v97
s_nop 1
v_permlane32_swap_b32 v97,v13
v_max_f32 v97,v97,v13
v_max_f32 v97,0,v97
v_sub_f32 v97,0,v97
v_exp_f32 v13,v97
v_add_f32 v20,v20,v97
v_add_f32 v21,v21,v97
v_add_f32 v22,v22,v97
v_add_f32 v23,v23,v97
v_mul_f32 v9,v9,v13
v_mul_f32 v132,v132,v13
v_mul_f32 v133,v133,v13
v_mul_f32 v134,v134,v13
v_mul_f32 v135,v135,v13
v_mul_f32 v140,v140,v13
v_mul_f32 v141,v141,v13
v_mul_f32 v142,v142,v13
v_mul_f32 v143,v143,v13
v_mul_f32 v148,v148,v13
v_mul_f32 v149,v149,v13
v_mul_f32 v150,v150,v13
v_mul_f32 v151,v151,v13
v_mul_f32 v156,v156,v13
v_mul_f32 v157,v157,v13
v_mul_f32 v158,v158,v13
v_mul_f32 v159,v159,v13
v_mul_f32 v164,v164,v13
v_mul_f32 v165,v165,v13
v_mul_f32 v166,v166,v13
v_mul_f32 v167,v167,v13
v_mul_f32 v172,v172,v13
v_mul_f32 v173,v173,v13
v_mul_f32 v174,v174,v13
v_mul_f32 v175,v175,v13
v_mul_f32 v180,v180,v13
v_mul_f32 v181,v181,v13
v_mul_f32 v182,v182,v13
v_mul_f32 v183,v183,v13
v_mul_f32 v188,v188,v13
v_mul_f32 v189,v189,v13
v_mul_f32 v190,v190,v13
v_mul_f32 v191,v191,v13
v_mul_f32 v196,v196,v13
v_mul_f32 v197,v197,v13
v_mul_f32 v198,v198,v13
v_mul_f32 v199,v199,v13
v_mul_f32 v204,v204,v13
v_mul_f32 v205,v205,v13
v_mul_f32 v206,v206,v13
v_mul_f32 v207,v207,v13
v_mul_f32 v212,v212,v13
v_mul_f32 v213,v213,v13
v_mul_f32 v214,v214,v13
v_mul_f32 v215,v215,v13
v_mul_f32 v220,v220,v13
v_mul_f32 v221,v221,v13
v_mul_f32 v222,v222,v13
v_mul_f32 v223,v223,v13
v_mul_f32 v228,v228,v13
v_mul_f32 v229,v229,v13
v_mul_f32 v230,v230,v13
v_mul_f32 v231,v231,v13
v_mul_f32 v236,v236,v13
v_mul_f32 v237,v237,v13
v_mul_f32 v238,v238,v13
v_mul_f32 v239,v239,v13
v_mul_f32 v244,v244,v13
v_mul_f32 v245,v245,v13
v_mul_f32 v246,v246,v13
v_mul_f32 v247,v247,v13
v_mul_f32 v252,v252,v13
v_mul_f32 v253,v253,v13
v_mul_f32 v254,v254,v13
v_mul_f32 v255,v255,v13
v_add_f32 v24,v36,v97
v_exp_f32 v24,v24
v_add_f32 v25,v37,v97
v_exp_f32 v25,v25
v_add_f32 v26,v38,v97
v_exp_f32 v26,v26
v_add_f32 v27,v39,v97
v_exp_f32 v27,v27
v_add_f32 v12,v24,v25
CV v84,v24,v25
v_add_f32 v12,v12,v26
v_add_f32 v12,v12,v27
CV v85,v26,v27
v_add_f32 v28,v44,v97
v_exp_f32 v28,v28
v_add_f32 v29,v45,v97
v_exp_f32 v29,v29
v_add_f32 v30,v46,v97
v_exp_f32 v30,v30
v_add_f32 v31,v47,v97
v_exp_f32 v31,v31
v_add_f32 v12,v12,v28
v_add_f32 v12,v12,v29
CV v86,v28,v29
v_add_f32 v12,v12,v30
v_add_f32 v12,v12,v31
CV v87,v30,v31
v_add_f32 v24,v52,v97
v_exp_f32 v24,v24
v_add_f32 v25,v53,v97
v_exp_f32 v25,v25
v_add_f32 v26,v54,v97
v_exp_f32 v26,v26
v_add_f32 v27,v55,v97
v_exp_f32 v27,v27
v_add_f32 v12,v12,v24
v_add_f32 v12,v12,v25
CV v92,v24,v25
v_add_f32 v12,v12,v26
v_add_f32 v12,v12,v27
CV v93,v26,v27
v_add_f32 v28,v60,v97
v_exp_f32 v28,v28
v_add_f32 v29,v61,v97
v_exp_f32 v29,v29
v_add_f32 v30,v62,v97
v_exp_f32 v30,v30
v_add_f32 v31,v63,v97
v_exp_f32 v31,v31
v_add_f32 v12,v12,v28
v_add_f32 v12,v12,v29
CV v94,v28,v29
v_add_f32 v12,v12,v30
v_add_f32 v12,v12,v31
CV v95,v30,v31
s_branch L_ret0
L_rare1:
v_max3_f32 v96,v32,v33,v34
v_max_f32 v96,v96,v35
v_max3_f32 v96,v96,v40,v41
v_max3_f32 v96,v96,v42,v43
v_max3_f32 v96,v96,v48,v49
v_max3_f32 v96,v96,v50,v51
v_max3_f32 v96,v96,v56,v57
v_max3_f32 v96,v96,v58,v59
v_mov_b32 v13,v96
s_nop 1
v_permlane16_swap_b32 v96,v13
v_max_f32 v96,v96,v13
v_mov_b32 v13,v96
s_nop 1
v_permlane32_swap_b32 v96,v13
v_max_f32 v96,v96,v13
v_max_f32 v96,0,v96
v_sub_f32 v96,0,v96
v_exp_f32 v13,v96
v_add_f32 v16,v16,v96
v_add_f32 v17,v17,v96
v_add_f32 v18,v18,v96
v_add_f32 v19,v19,v96
v_mul_f32 v8,v8,v13
v_mul_f32 v128,v128,v13
v_mul_f32 v129,v129,v13
v_mul_f32 v130,v130,v13
v_mul_f32 v131,v131,v13
v_mul_f32 v136,v136,v13
v_mul_f32 v137,v137,v13
v_mul_f32 v138,v138,v13
v_mul_f32 v139,v139,v13
v_mul_f32 v144,v144,v13
v_mul_f32 v145,v145,v13
v_mul_f32 v146,v146,v13
v_mul_f32 v147,v147,v13
v_mul_f32 v152,v152,v13
v_mul_f32 v153,v153,v13
v_mul_f32 v154,v154,v13
v_mul_f32 v155,v155,v13
v_mul_f32 v160,v160,v13
v_mul_f32 v161,v161,v13
v_mul_f32 v162,v162,v13
v_mul_f32 v163,v163,v13
v_mul_f32 v168,v168,v13
v_mul_f32 v169,v169,v13
v_mul_f32 v170,v170,v13
v_mul_f32 v171,v171,v13
v_mul_f32 v176,v176,v13
v_mul_f32 v177,v177,v13
v_mul_f32 v178,v178,v13
v_mul_f32 v179,v179,v13
v_mul_f32 v184,v184,v13
v_mul_f32 v185,v185,v13
v_mul_f32 v186,v186,v13
v_mul_f32 v187,v187,v13
v_mul_f32 v192,v192,v13
v_mul_f32 v193,v193,v13
v_mul_f32 v194,v194,v13
v_mul_f32 v195,v195,v13
v_mul_f32 v200,v200,v13
v_mul_f32 v201,v201,v13
v_mul_f32 v202,v202,v13
v_mul_f32 v203,v203,v13
v_mul_f32 v208,v208,v13
v_mul_f32 v209,v209,v13
v_mul_f32 v210,v210,v13
v_mul_f32 v211,v211,v13
v_mul_f32 v216,v216,v13
v_mul_f32 v217,v217,v13
v_mul_f32 v218,v218,v13
v_mul_f32 v219,v219,v13
v_mul_f32 v224,v224,v13
v_mul_f32 v225,v225,v13
v_mul_f32 v226,v226,v13
v_mul_f32 v227,v227,v13
v_mul_f32 v232,v232,v13
v_mul_f32 v233,v233,v13
v_mul_f32 v234,v234,v13
v_mul_f32 v235,v235,v13
v_mul_f32 v240,v240,v13
v_mul_f32 v241,v241,v13
v_mul_f32 v242,v242,v13
v_mul_f32 v243,v243,v13
v_mul_f32 v248,v248,v13
v_mul_f32 v249,v249,v13
v_mul_f32 v250,v250,v13
v_mul_f32 v251,v251,v13
v_add_f32 v24,v32,v96
v_exp_f32 v24,v24
v_add_f32 v25,v33,v96
v_exp_f32 v25,v25
v_add_f32 v26,v34,v96
v_exp_f32 v26,v26
v_add_f32 v27,v35,v96
v_exp_f32 v27,v27
v_add_f32 v10,v24,v25
CV v64,v24,v25
v_add_f32 v10,v10,v26
v_add_f32 v10,v10,v27
CV v65,v26,v27
v_add_f32 v28,v40,v96
v_exp_f32 v28,v28
v_add_f32 v29,v41,v96
v_exp_f32 v29,v29
v_add_f32 v30,v42,v96
v_exp_f32 v30,v30
v_add_f32 v31,v43,v96
v_exp_f32 v31,v31
v_add_f32 v10,v10,v28
v_add_f32 v10,v10,v29
CV v66,v28,v29
v_add_f32 v10,v10,v30
v_add_f32 v10,v10,v31
CV v67,v30,v31
v_add_f32 v24,v48,v96
v_exp_f32 v24,v24
v_add_f32 v25,v49,v96
v_exp_f32 v25,v25
v_add_f32 v26,v50,v96
v_exp_f32 v26,v26
v_add_f32 v27,v51,v96
v_exp_f32 v27,v27
v_add_f32 v10,v10,v24
v_add_f32 v10,v10,v25
CV v72,v24,v25
v_add_f32 v10,v10,v26
v_add_f32 v10,v10,v27
CV v73,v26,v27
v_add_f32 v28,v56,v96
v_exp_f32 v28,v28
v_add_f32 v29,v57,v96
v_exp_f32 v29,v29
v_add_f32 v30,v58,v96
v_exp_f32 v30,v30
v_add_f32 v31,v59,v96
v_exp_f32 v31,v31
v_add_f32 v10,v10,v28
v_add_f32 v10,v10,v29
CV v74,v28,v29
v_add_f32 v10,v10,v30
v_add_f32 v10,v10,v31
CV v75,v30,v31
v_max3_f32 v97,v36,v37,v38
v_max_f32 v97,v97,v39
v_max3_f32 v97,v97,v44,v45
v_max3_f32 v97,v97,v46,v47
v_max3_f32 v97,v97,v52,v53
v_max3_f32 v97,v97,v54,v55
v_max3_f32 v97,v97,v60,v61
v_max3_f32 v97,v97,v62,v63
v_mov_b32 v13,v97
s_nop 1
v_permlane16_swap_b32 v97,v13
v_max_f32 v97,v97,v13
v_mov_b32 v13,v97
s_nop 1
v_permlane32_swap_b32 v97,v13
v_max_f32 v97,v97,v13
v_max_f32 v97,0,v97
v_sub_f32 v97,0,v97
v_exp_f32 v13,v97
v_add_f32 v20,v20,v97
v_add_f32 v21,v21,v97
v_add_f32 v22,v22,v97
v_add_f32 v23,v23,v97
v_mul_f32 v9,v9,v13
v_mul_f32 v132,v132,v13
v_mul_f32 v133,v133,v13
v_mul_f32 v134,v134,v13
v_mul_f32 v135,v135,v13
v_mul_f32 v140,v140,v13
v_mul_f32 v141,v141,v13
v_mul_f32 v142,v142,v13
v_mul_f32 v143,v143,v13
v_mul_f32 v148,v148,v13
v_mul_f32 v149,v149,v13
v_mul_f32 v150,v150,v13
v_mul_f32 v151,v151,v13
v_mul_f32 v156,v156,v13
v_mul_f32 v157,v157,v13
v_mul_f32 v158,v158,v13
v_mul_f32 v159,v159,v13
v_mul_f32 v164,v164,v13
v_mul_f32 v165,v165,v13
v_mul_f32 v166,v166,v13
v_mul_f32 v167,v167,v13
v_mul_f32 v172,v172,v13
v_mul_f32 v173,v173,v13
v_mul_f32 v174,v174,v13
v_mul_f32 v175,v175,v13
v_mul_f32 v180,v180,v13
v_mul_f32 v181,v181,v13
v_mul_f32 v182,v182,v13
v_mul_f32 v183,v183,v13
v_mul_f32 v188,v188,v13
v_mul_f32 v189,v189,v13
v_mul_f32 v190,v190,v13
v_mul_f32 v191,v191,v13
v_mul_f32 v196,v196,v13
v_mul_f32 v197,v197,v13
v_mul_f32 v198,v198,v13
v_mul_f32 v199,v199,v13
v_mul_f32 v204,v204,v13
v_mul_f32 v205,v205,v13
v_mul_f32 v206,v206,v13
v_mul_f32 v207,v207,v13
v_mul_f32 v212,v212,v13
v_mul_f32 v213,v213,v13
v_mul_f32 v214,v214,v13
v_mul_f32 v215,v215,v13
v_mul_f32 v220,v220,v13
v_mul_f32 v221,v221,v13
v_mul_f32 v222,v222,v13
v_mul_f32 v223,v223,v13
v_mul_f32 v228,v228,v13
v_mul_f32 v229,v229,v13
v_mul_f32 v230,v230,v13
v_mul_f32 v231,v231,v13
v_mul_f32 v236,v236,v13
v_mul_f32 v237,v237,v13
v_mul_f32 v238,v238,v13
v_mul_f32 v239,v239,v13
v_mul_f32 v244,v244,v13
v_mul_f32 v245,v245,v13
v_mul_f32 v246,v246,v13
v_mul_f32 v247,v247,v13
v_mul_f32 v252,v252,v13
v_mul_f32 v253,v253,v13
v_mul_f32 v254,v254,v13
v_mul_f32 v255,v255,v13
v_add_f32 v24,v36,v97
v_exp_f32 v24,v24
v_add_f32 v25,v37,v97
v_exp_f32 v25,v25
v_add_f32 v26,v38,v97
v_exp_f32 v26,v26
v_add_f32 v27,v39,v97
v_exp_f32 v27,v27
v_add_f32 v12,v24,v25
CV v68,v24,v25
v_add_f32 v12,v12,v26
v_add_f32 v12,v12,v27
CV v69,v26,v27
v_add_f32 v28,v44,v97
v_exp_f32 v28,v28
v_add_f32 v29,v45,v97
v_exp_f32 v29,v29
v_add_f32 v30,v46,v97
v_exp_f32 v30,v30
v_add_f32 v31,v47,v97
v_exp_f32 v31,v31
v_add_f32 v12,v12,v28
v_add_f32 v12,v12,v29
CV v70,v28,v29
v_add_f32 v12,v12,v30
v_add_f32 v12,v12,v31
CV v71,v30,v31
v_add_f32 v24,v52,v97
v_exp_f32 v24,v24
v_add_f32 v25,v53,v97
v_exp_f32 v25,v25
v_add_f32 v26,v54,v97
v_exp_f32 v26,v26
v_add_f32 v27,v55,v97
v_exp_f32 v27,v27
v_add_f32 v12,v12,v24
v_add_f32 v12,v12,v25
CV v76,v24,v25
v_add_f32 v12,v12,v26
v_add_f32 v12,v12,v27
CV v77,v26,v27
v_add_f32 v28,v60,v97
v_exp_f32 v28,v28
v_add_f32 v29,v61,v97
v_exp_f32 v29,v29
v_add_f32 v30,v62,v97
v_exp_f32 v30,v30
v_add_f32 v31,v63,v97
v_exp_f32 v31,v31
v_add_f32 v12,v12,v28
v_add_f32 v12,v12,v29
CV v78,v28,v29
v_add_f32 v12,v12,v30
v_add_f32 v12,v12,v31
CV v79,v30,v31
s_branch L_ret1
L_rare2:
v_max3_f32 v96,v32,v33,v34
v_max_f32 v96,v96,v35
v_max3_f32 v96,v96,v40,v41
v_max3_f32 v96,v96,v42,v43
v_max3_f32 v96,v96,v48,v49
v_max3_f32 v96,v96,v50,v51
v_max3_f32 v96,v96,v56,v57
v_max3_f32 v96,v96,v58,v59
v_mov_b32 v13,v96
s_nop 1
v_permlane16_swap_b32 v96,v13
v_max_f32 v96,v96,v13
v_mov_b32 v13,v96
s_nop 1
v_permlane32_swap_b32 v96,v13
v_max_f32 v96,v96,v13
v_max_f32 v96,0,v96
v_sub_f32 v96,0,v96
v_exp_f32 v13,v96
v_add_f32 v16,v16,v96
v_add_f32 v17,v17,v96
v_add_f32 v18,v18,v96
v_add_f32 v19,v19,v96
v_mul_f32 v8,v8,v13
v_mul_f32 v128,v128,v13
v_mul_f32 v129,v129,v13
v_mul_f32 v130,v130,v13
v_mul_f32 v131,v131,v13
v_mul_f32 v136,v136,v13
v_mul_f32 v137,v137,v13
v_mul_f32 v138,v138,v13
v_mul_f32 v139,v139,v13
v_mul_f32 v144,v144,v13
v_mul_f32 v145,v145,v13
v_mul_f32 v146,v146,v13
v_mul_f32 v147,v147,v13
v_mul_f32 v152,v152,v13
v_mul_f32 v153,v153,v13
v_mul_f32 v154,v154,v13
v_mul_f32 v155,v155,v13
v_mul_f32 v160,v160,v13
v_mul_f32 v161,v161,v13
v_mul_f32 v162,v162,v13
v_mul_f32 v163,v163,v13
v_mul_f32 v168,v168,v13
v_mul_f32 v169,v169,v13
v_mul_f32 v170,v170,v13
v_mul_f32 v171,v171,v13
v_mul_f32 v176,v176,v13
v_mul_f32 v177,v177,v13
v_mul_f32 v178,v178,v13
v_mul_f32 v179,v179,v13
v_mul_f32 v184,v184,v13
v_mul_f32 v185,v185,v13
v_mul_f32 v186,v186,v13
v_mul_f32 v187,v187,v13
v_mul_f32 v192,v192,v13
v_mul_f32 v193,v193,v13
v_mul_f32 v194,v194,v13
v_mul_f32 v195,v195,v13
v_mul_f32 v200,v200,v13
v_mul_f32 v201,v201,v13
v_mul_f32 v202,v202,v13
v_mul_f32 v203,v203,v13
v_mul_f32 v208,v208,v13
v_mul_f32 v209,v209,v13
v_mul_f32 v210,v210,v13
v_mul_f32 v211,v211,v13
v_mul_f32 v216,v216,v13
v_mul_f32 v217,v217,v13
v_mul_f32 v218,v218,v13
v_mul_f32 v219,v219,v13
v_mul_f32 v224,v224,v13
v_mul_f32 v225,v225,v13
v_mul_f32 v226,v226,v13
v_mul_f32 v227,v227,v13
v_mul_f32 v232,v232,v13
v_mul_f32 v233,v233,v13
v_mul_f32 v234,v234,v13
v_mul_f32 v235,v235,v13
v_mul_f32 v240,v240,v13
v_mul_f32 v241,v241,v13
v_mul_f32 v242,v242,v13
v_mul_f32 v243,v243,v13
v_mul_f32 v248,v248,v13
v_mul_f32 v249,v249,v13
v_mul_f32 v250,v250,v13
v_mul_f32 v251,v251,v13
v_add_f32 v24,v32,v96
v_exp_f32 v24,v24
v_add_f32 v25,v33,v96
v_exp_f32 v25,v25
v_add_f32 v26,v34,v96
v_exp_f32 v26,v26
v_add_f32 v27,v35,v96
v_exp_f32 v27,v27
v_add_f32 v10,v24,v25
CV v80,v24,v25
v_add_f32 v10,v10,v26
v_add_f32 v10,v10,v27
CV v81,v26,v27
v_add_f32 v28,v40,v96
v_exp_f32 v28,v28
v_add_f32 v29,v41,v96
v_exp_f32 v29,v29
v_add_f32 v30,v42,v96
v_exp_f32 v30,v30
v_add_f32 v31,v43,v96
v_exp_f32 v31,v31
v_add_f32 v10,v10,v28
v_add_f32 v10,v10,v29
CV v82,v28,v29
v_add_f32 v10,v10,v30
v_add_f32 v10,v10,v31
CV v83,v30,v31
v_add_f32 v24,v48,v96
v_exp_f32 v24,v24
v_add_f32 v25,v49,v96
v_exp_f32 v25,v25
v_add_f32 v26,v50,v96
v_exp_f32 v26,v26
v_add_f32 v27,v51,v96
v_exp_f32 v27,v27
v_add_f32 v10,v10,v24
v_add_f32 v10,v10,v25
CV v88,v24,v25
v_add_f32 v10,v10,v26
v_add_f32 v10,v10,v27
CV v89,v26,v27
v_add_f32 v28,v56,v96
v_exp_f32 v28,v28
v_add_f32 v29,v57,v96
v_exp_f32 v29,v29
v_add_f32 v30,v58,v96
v_exp_f32 v30,v30
v_add_f32 v31,v59,v96
v_exp_f32 v31,v31
v_add_f32 v10,v10,v28
v_add_f32 v10,v10,v29
CV v90,v28,v29
v_add_f32 v10,v10,v30
v_add_f32 v10,v10,v31
CV v91,v30,v31
v_max3_f32 v97,v36,v37,v38
v_max_f32 v97,v97,v39
v_max3_f32 v97,v97,v44,v45
v_max3_f32 v97,v97,v46,v47
v_max3_f32 v97,v97,v52,v53
v_max3_f32 v97,v97,v54,v55
v_max3_f32 v97,v97,v60,v61
v_max3_f32 v97,v97,v62,v63
v_mov_b32 v13,v97
s_nop 1
v_permlane16_swap_b32 v97,v13
v_max_f32 v97,v97,v13
v_mov_b32 v13,v97
s_nop 1
v_permlane32_swap_b32 v97,v13
v_max_f32 v97,v97,v13
v_max_f32 v97,0,v97
v_sub_f32 v97,0,v97
v_exp_f32 v13,v97
v_add_f32 v20,v20,v97
v_add_f32 v21,v21,v97
v_add_f32 v22,v22,v97
v_add_f32 v23,v23,v97
v_mul_f32 v9,v9,v13
v_mul_f32 v132,v132,v13
v_mul_f32 v133,v133,v13
v_mul_f32 v134,v134,v13
v_mul_f32 v135,v135,v13
v_mul_f32 v140,v140,v13
v_mul_f32 v141,v141,v13
v_mul_f32 v142,v142,v13
v_mul_f32 v143,v143,v13
v_mul_f32 v148,v148,v13
v_mul_f32 v149,v149,v13
v_mul_f32 v150,v150,v13
v_mul_f32 v151,v151,v13
v_mul_f32 v156,v156,v13
v_mul_f32 v157,v157,v13
v_mul_f32 v158,v158,v13
v_mul_f32 v159,v159,v13
v_mul_f32 v164,v164,v13
v_mul_f32 v165,v165,v13
v_mul_f32 v166,v166,v13
v_mul_f32 v167,v167,v13
v_mul_f32 v172,v172,v13
v_mul_f32 v173,v173,v13
v_mul_f32 v174,v174,v13
v_mul_f32 v175,v175,v13
v_mul_f32 v180,v180,v13
v_mul_f32 v181,v181,v13
v_mul_f32 v182,v182,v13
v_mul_f32 v183,v183,v13
v_mul_f32 v188,v188,v13
v_mul_f32 v189,v189,v13
v_mul_f32 v190,v190,v13
v_mul_f32 v191,v191,v13
v_mul_f32 v196,v196,v13
v_mul_f32 v197,v197,v13
v_mul_f32 v198,v198,v13
v_mul_f32 v199,v199,v13
v_mul_f32 v204,v204,v13
v_mul_f32 v205,v205,v13
v_mul_f32 v206,v206,v13
v_mul_f32 v207,v207,v13
v_mul_f32 v212,v212,v13
v_mul_f32 v213,v213,v13
v_mul_f32 v214,v214,v13
v_mul_f32 v215,v215,v13
v_mul_f32 v220,v220,v13
v_mul_f32 v221,v221,v13
v_mul_f32 v222,v222,v13
v_mul_f32 v223,v223,v13
v_mul_f32 v228,v228,v13
v_mul_f32 v229,v229,v13
v_mul_f32 v230,v230,v13
v_mul_f32 v231,v231,v13
v_mul_f32 v236,v236,v13
v_mul_f32 v237,v237,v13
v_mul_f32 v238,v238,v13
v_mul_f32 v239,v239,v13
v_mul_f32 v244,v244,v13
v_mul_f32 v245,v245,v13
v_mul_f32 v246,v246,v13
v_mul_f32 v247,v247,v13
v_mul_f32 v252,v252,v13
v_mul_f32 v253,v253,v13
v_mul_f32 v254,v254,v13
v_mul_f32 v255,v255,v13
v_add_f32 v24,v36,v97
v_exp_f32 v24,v24
v_add_f32 v25,v37,v97
v_exp_f32 v25,v25
v_add_f32 v26,v38,v97
v_exp_f32 v26,v26
v_add_f32 v27,v39,v97
v_exp_f32 v27,v27
v_add_f32 v12,v24,v25
CV v84,v24,v25
v_add_f32 v12,v12,v26
v_add_f32 v12,v12,v27
CV v85,v26,v27
v_add_f32 v28,v44,v97
v_exp_f32 v28,v28
v_add_f32 v29,v45,v97
v_exp_f32 v29,v29
v_add_f32 v30,v46,v97
v_exp_f32 v30,v30
v_add_f32 v31,v47,v97
v_exp_f32 v31,v31
v_add_f32 v12,v12,v28
v_add_f32 v12,v12,v29
CV v86,v28,v29
v_add_f32 v12,v12,v30
v_add_f32 v12,v12,v31
CV v87,v30,v31
v_add_f32 v24,v52,v97
v_exp_f32 v24,v24
v_add_f32 v25,v53,v97
v_exp_f32 v25,v25
v_add_f32 v26,v54,v97
v_exp_f32 v26,v26
v_add_f32 v27,v55,v97
v_exp_f32 v27,v27
v_add_f32 v12,v12,v24
v_add_f32 v12,v12,v25
CV v92,v24,v25
v_add_f32 v12,v12,v26
v_add_f32 v12,v12,v27
CV v93,v26,v27
v_add_f32 v28,v60,v97
v_exp_f32 v28,v28
v_add_f32 v29,v61,v97
v_exp_f32 v29,v29
v_add_f32 v30,v62,v97
v_exp_f32 v30,v30
v_add_f32 v31,v63,v97
v_exp_f32 v31,v31
v_add_f32 v12,v12,v28
v_add_f32 v12,v12,v29
CV v94,v28,v29
v_add_f32 v12,v12,v30
v_add_f32 v12,v12,v31
CV v95,v30,v31
s_branch L_ret2
L_rare3:
v_max3_f32 v96,v32,v33,v34
v_max_f32 v96,v96,v35
v_max3_f32 v96,v96,v40,v41
v_max3_f32 v96,v96,v42,v43
v_max3_f32 v96,v96,v48,v49
v_max3_f32 v96,v96,v50,v51
v_max3_f32 v96,v96,v56,v57
v_max3_f32 v96,v96,v58,v59
v_mov_b32 v13,v96
s_nop 1
v_permlane16_swap_b32 v96,v13
v_max_f32 v96,v96,v13
v_mov_b32 v13,v96
s_nop 1
v_permlane32_swap_b32 v96,v13
v_max_f32 v96,v96,v13
v_max_f32 v96,0,v96
v_sub_f32 v96,0,v96
v_exp_f32 v13,v96
v_add_f32 v16,v16,v96
v_add_f32 v17,v17,v96
v_add_f32 v18,v18,v96
v_add_f32 v19,v19,v96
v_mul_f32 v8,v8,v13
v_mul_f32 v128,v128,v13
v_mul_f32 v129,v129,v13
v_mul_f32 v130,v130,v13
v_mul_f32 v131,v131,v13
v_mul_f32 v136,v136,v13
v_mul_f32 v137,v137,v13
v_mul_f32 v138,v138,v13
v_mul_f32 v139,v139,v13
v_mul_f32 v144,v144,v13
v_mul_f32 v145,v145,v13
v_mul_f32 v146,v146,v13
v_mul_f32 v147,v147,v13
v_mul_f32 v152,v152,v13
v_mul_f32 v153,v153,v13
v_mul_f32 v154,v154,v13
v_mul_f32 v155,v155,v13
v_mul_f32 v160,v160,v13
v_mul_f32 v161,v161,v13
v_mul_f32 v162,v162,v13
v_mul_f32 v163,v163,v13
v_mul_f32 v168,v168,v13
v_mul_f32 v169,v169,v13
v_mul_f32 v170,v170,v13
v_mul_f32 v171,v171,v13
v_mul_f32 v176,v176,v13
v_mul_f32 v177,v177,v13
v_mul_f32 v178,v178,v13
v_mul_f32 v179,v179,v13
v_mul_f32 v184,v184,v13
v_mul_f32 v185,v185,v13
v_mul_f32 v186,v186,v13
v_mul_f32 v187,v187,v13
v_mul_f32 v192,v192,v13
v_mul_f32 v193,v193,v13
v_mul_f32 v194,v194,v13
v_mul_f32 v195,v195,v13
v_mul_f32 v200,v200,v13
v_mul_f32 v201,v201,v13
v_mul_f32 v202,v202,v13
v_mul_f32 v203,v203,v13
v_mul_f32 v208,v208,v13
v_mul_f32 v209,v209,v13
v_mul_f32 v210,v210,v13
v_mul_f32 v211,v211,v13
v_mul_f32 v216,v216,v13
v_mul_f32 v217,v217,v13
v_mul_f32 v218,v218,v13
v_mul_f32 v219,v219,v13
v_mul_f32 v224,v224,v13
v_mul_f32 v225,v225,v13
v_mul_f32 v226,v226,v13
v_mul_f32 v227,v227,v13
v_mul_f32 v232,v232,v13
v_mul_f32 v233,v233,v13
v_mul_f32 v234,v234,v13
v_mul_f32 v235,v235,v13
v_mul_f32 v240,v240,v13
v_mul_f32 v241,v241,v13
v_mul_f32 v242,v242,v13
v_mul_f32 v243,v243,v13
v_mul_f32 v248,v248,v13
v_mul_f32 v249,v249,v13
v_mul_f32 v250,v250,v13
v_mul_f32 v251,v251,v13
v_add_f32 v24,v32,v96
v_exp_f32 v24,v24
v_add_f32 v25,v33,v96
v_exp_f32 v25,v25
v_add_f32 v26,v34,v96
v_exp_f32 v26,v26
v_add_f32 v27,v35,v96
v_exp_f32 v27,v27
v_add_f32 v10,v24,v25
CV v64,v24,v25
v_add_f32 v10,v10,v26
v_add_f32 v10,v10,v27
CV v65,v26,v27
v_add_f32 v28,v40,v96
v_exp_f32 v28,v28
v_add_f32 v29,v41,v96
v_exp_f32 v29,v29
v_add_f32 v30,v42,v96
v_exp_f32 v30,v30
v_add_f32 v31,v43,v96
v_exp_f32 v31,v31
v_add_f32 v10,v10,v28
v_add_f32 v10,v10,v29
CV v66,v28,v29
v_add_f32 v10,v10,v30
v_add_f32 v10,v10,v31
CV v67,v30,v31
v_add_f32 v24,v48,v96
v_exp_f32 v24,v24
v_add_f32 v25,v49,v96
v_exp_f32 v25,v25
v_add_f32 v26,v50,v96
v_exp_f32 v26,v26
v_add_f32 v27,v51,v96
v_exp_f32 v27,v27
v_add_f32 v10,v10,v24
v_add_f32 v10,v10,v25
CV v72,v24,v25
v_add_f32 v10,v10,v26
v_add_f32 v10,v10,v27
CV v73,v26,v27
v_add_f32 v28,v56,v96
v_exp_f32 v28,v28
v_add_f32 v29,v57,v96
v_exp_f32 v29,v29
v_add_f32 v30,v58,v96
v_exp_f32 v30,v30
v_add_f32 v31,v59,v96
v_exp_f32 v31,v31
v_add_f32 v10,v10,v28
v_add_f32 v10,v10,v29
CV v74,v28,v29
v_add_f32 v10,v10,v30
v_add_f32 v10,v10,v31
CV v75,v30,v31
v_max3_f32 v97,v36,v37,v38
v_max_f32 v97,v97,v39
v_max3_f32 v97,v97,v44,v45
v_max3_f32 v97,v97,v46,v47
v_max3_f32 v97,v97,v52,v53
v_max3_f32 v97,v97,v54,v55
v_max3_f32 v97,v97,v60,v61
v_max3_f32 v97,v97,v62,v63
v_mov_b32 v13,v97
s_nop 1
v_permlane16_swap_b32 v97,v13
v_max_f32 v97,v97,v13
v_mov_b32 v13,v97
s_nop 1
v_permlane32_swap_b32 v97,v13
v_max_f32 v97,v97,v13
v_max_f32 v97,0,v97
v_sub_f32 v97,0,v97
v_exp_f32 v13,v97
v_add_f32 v20,v20,v97
v_add_f32 v21,v21,v97
v_add_f32 v22,v22,v97
v_add_f32 v23,v23,v97
v_mul_f32 v9,v9,v13
v_mul_f32 v132,v132,v13
v_mul_f32 v133,v133,v13
v_mul_f32 v134,v134,v13
v_mul_f32 v135,v135,v13
v_mul_f32 v140,v140,v13
v_mul_f32 v141,v141,v13
v_mul_f32 v142,v142,v13
v_mul_f32 v143,v143,v13
v_mul_f32 v148,v148,v13
v_mul_f32 v149,v149,v13
v_mul_f32 v150,v150,v13
v_mul_f32 v151,v151,v13
v_mul_f32 v156,v156,v13
v_mul_f32 v157,v157,v13
v_mul_f32 v158,v158,v13
v_mul_f32 v159,v159,v13
v_mul_f32 v164,v164,v13
v_mul_f32 v165,v165,v13
v_mul_f32 v166,v166,v13
v_mul_f32 v167,v167,v13
v_mul_f32 v172,v172,v13
v_mul_f32 v173,v173,v13
v_mul_f32 v174,v174,v13
v_mul_f32 v175,v175,v13
v_mul_f32 v180,v180,v13
v_mul_f32 v181,v181,v13
v_mul_f32 v182,v182,v13
v_mul_f32 v183,v183,v13
v_mul_f32 v188,v188,v13
v_mul_f32 v189,v189,v13
v_mul_f32 v190,v190,v13
v_mul_f32 v191,v191,v13
v_mul_f32 v196,v196,v13
v_mul_f32 v197,v197,v13
v_mul_f32 v198,v198,v13
v_mul_f32 v199,v199,v13
v_mul_f32 v204,v204,v13
v_mul_f32 v205,v205,v13
v_mul_f32 v206,v206,v13
v_mul_f32 v207,v207,v13
v_mul_f32 v212,v212,v13
v_mul_f32 v213,v213,v13
v_mul_f32 v214,v214,v13
v_mul_f32 v215,v215,v13
v_mul_f32 v220,v220,v13
v_mul_f32 v221,v221,v13
v_mul_f32 v222,v222,v13
v_mul_f32 v223,v223,v13
v_mul_f32 v228,v228,v13
v_mul_f32 v229,v229,v13
v_mul_f32 v230,v230,v13
v_mul_f32 v231,v231,v13
v_mul_f32 v236,v236,v13
v_mul_f32 v237,v237,v13
v_mul_f32 v238,v238,v13
v_mul_f32 v239,v239,v13
v_mul_f32 v244,v244,v13
v_mul_f32 v245,v245,v13
v_mul_f32 v246,v246,v13
v_mul_f32 v247,v247,v13
v_mul_f32 v252,v252,v13
v_mul_f32 v253,v253,v13
v_mul_f32 v254,v254,v13
v_mul_f32 v255,v255,v13
v_add_f32 v24,v36,v97
v_exp_f32 v24,v24
v_add_f32 v25,v37,v97
v_exp_f32 v25,v25
v_add_f32 v26,v38,v97
v_exp_f32 v26,v26
v_add_f32 v27,v39,v97
v_exp_f32 v27,v27
v_add_f32 v12,v24,v25
CV v68,v24,v25
v_add_f32 v12,v12,v26
v_add_f32 v12,v12,v27
CV v69,v26,v27
v_add_f32 v28,v44,v97
v_exp_f32 v28,v28
v_add_f32 v29,v45,v97
v_exp_f32 v29,v29
v_add_f32 v30,v46,v97
v_exp_f32 v30,v30
v_add_f32 v31,v47,v97
v_exp_f32 v31,v31
v_add_f32 v12,v12,v28
v_add_f32 v12,v12,v29
CV v70,v28,v29
v_add_f32 v12,v12,v30
v_add_f32 v12,v12,v31
CV v71,v30,v31
v_add_f32 v24,v52,v97
v_exp_f32 v24,v24
v_add_f32 v25,v53,v97
v_exp_f32 v25,v25
v_add_f32 v26,v54,v97
v_exp_f32 v26,v26
v_add_f32 v27,v55,v97
v_exp_f32 v27,v27
v_add_f32 v12,v12,v24
v_add_f32 v12,v12,v25
CV v76,v24,v25
v_add_f32 v12,v12,v26
v_add_f32 v12,v12,v27
CV v77,v26,v27
v_add_f32 v28,v60,v97
v_exp_f32 v28,v28
v_add_f32 v29,v61,v97
v_exp_f32 v29,v29
v_add_f32 v30,v62,v97
v_exp_f32 v30,v30
v_add_f32 v31,v63,v97
v_exp_f32 v31,v31
v_add_f32 v12,v12,v28
v_add_f32 v12,v12,v29
CV v78,v28,v29
v_add_f32 v12,v12,v30
v_add_f32 v12,v12,v31
CV v79,v30,v31
s_branch L_ret3
L_spin8:
s_mov_b32 s47,0x40000
L_spinl8:
s_sleep 1
buffer_load_dword v99,v98,s[24:27],s55 offen offset:96 sc1
s_waitcnt vmcnt(0)
v_cmp_eq_u32 vcc,1,v99
s_nop 0
s_cmp_eq_u64 vcc,-1
s_cbranch_scc1 L_spun8
s_sub_u32 s47,s47,1
s_cmp_lg_u32 s47,0
s_cbranch_scc1 L_spinl8
s_branch L_spun8
L_rare4:
v_max3_f32 v97,v36,v37,v38
v_max_f32 v97,v97,v39
v_max3_f32 v97,v97,v44,v45
v_max3_f32 v97,v97,v46,v47
v_max3_f32 v97,v97,v52,v53
v_max3_f32 v97,v97,v54,v55
v_max3_f32 v97,v97,v60,v61
v_max3_f32 v97,v97,v62,v63
v_mov_b32 v13,v97
s_nop 1
v_permlane16_swap_b32 v97,v13
v_max_f32 v97,v97,v13
v_mov_b32 v13,v97
s_nop 1
v_permlane32_swap_b32 v97,v13
v_max_f32 v97,v97,v13
v_max_f32 v97,0,v97
v_sub_f32 v97,0,v97
v_exp_f32 v13,v97
v_add_f32 v20,v20,v97
v_add_f32 v21,v21,v97
v_add_f32 v22,v22,v97
v_add_f32 v23,v23,v97
v_mul_f32 v9,v9,v13
v_mul_f32 v132,v132,v13
v_mul_f32 v133,v133,v13
v_mul_f32 v134,v134,v13
v_mul_f32 v135,v135,v13
v_mul_f32 v140,v140,v13
v_mul_f32 v141,v141,v13
v_mul_f32 v142,v142,v13
v_mul_f32 v143,v143,v13
v_mul_f32 v148,v148,v13
v_mul_f32 v149,v149,v13
v_mul_f32 v150,v150,v13
v_mul_f32 v151,v151,v13
v_mul_f32 v156,v156,v13
v_mul_f32 v157,v157,v13
v_mul_f32 v158,v158,v13
v_mul_f32 v159,v159,v13
v_mul_f32 v164,v164,v13
v_mul_f32 v165,v165,v13
v_mul_f32 v166,v166,v13
v_mul_f32 v167,v167,v13
v_mul_f32 v172,v172,v13
v_mul_f32 v173,v173,v13
v_mul_f32 v174,v174,v13
v_mul_f32 v175,v175,v13
v_mul_f32 v180,v180,v13
v_mul_f32 v181,v181,v13
v_mul_f32 v182,v182,v13
v_mul_f32 v183,v183,v13
v_mul_f32 v188,v188,v13
v_mul_f32 v189,v189,v13
v_mul_f32 v190,v190,v13
v_mul_f32 v191,v191,v13
v_mul_f32 v196,v196,v13
v_mul_f32 v197,v197,v13
v_mul_f32 v198,v198,v13
v_mul_f32 v199,v199,v13
v_mul_f32 v204,v204,v13
v_mul_f32 v205,v205,v13
v_mul_f32 v206,v206,v13
v_mul_f32 v207,v207,v13
v_mul_f32 v212,v212,v13
v_mul_f32 v213,v213,v13
v_mul_f32 v214,v214,v13
v_mul_f32 v215,v215,v13
v_mul_f32 v220,v220,v13
v_mul_f32 v221,v221,v13
v_mul_f32 v222,v222,v13
v_mul_f32 v223,v223,v13
v_mul_f32 v228,v228,v13
v_mul_f32 v229,v229,v13
v_mul_f32 v230,v230,v13
v_mul_f32 v231,v231,v13
v_mul_f32 v236,v236,v13
v_mul_f32 v237,v237,v13
v_mul_f32 v238,v238,v13
v_mul_f32 v239,v239,v13
v_mul_f32 v244,v244,v13
v_mul_f32 v245,v245,v13
v_mul_f32 v246,v246,v13
v_mul_f32 v247,v247,v13
v_mul_f32 v252,v252,v13
v_mul_f32 v253,v253,v13
v_mul_f32 v254,v254,v13
v_mul_f32 v255,v255,v13
v_add_f32 v24,v36,v97
v_exp_f32 v24,v24
v_add_f32 v25,v37,v97
v_exp_f32 v25,v25
v_add_f32 v26,v38,v97
v_exp_f32 v26,v26
v_add_f32 v27,v39,v97
v_exp_f32 v27,v27
v_add_f32 v12,v24,v25
CV v84,v24,v25
v_add_f32 v12,v12,v26
v_add_f32 v12,v12,v27
CV v85,v26,v27
v_add_f32 v28,v44,v97
v_exp_f32 v28,v28
v_add_f32 v29,v45,v97
v_exp_f32 v29,v29
v_add_f32 v30,v46,v97
v_exp_f32 v30,v30
v_add_f32 v31,v47,v97
v_exp_f32 v31,v31
v_add_f32 v12,v12,v28
v_add_f32 v12,v12,v29
CV v86,v28,v29
v_add_f32 v12,v12,v30
v_add_f32 v12,v12,v31
CV v87,v30,v31
v_add_f32 v24,v52,v97
v_exp_f32 v24,v24
v_add_f32 v25,v53,v97
v_exp_f32 v25,v25
v_add_f32 v26,v54,v97
v_exp_f32 v26,v26
v_add_f32 v27,v55,v97
v_exp_f32 v27,v27
v_add_f32 v12,v12,v24
v_add_f32 v12,v12,v25
CV v92,v24,v25
v_add_f32 v12,v12,v26
v_add_f32 v12,v12,v27
CV v93,v26,v27
v_add_f32 v28,v60,v97
v_exp_f32 v28,v28
v_add_f32 v29,v61,v97
v_exp_f32 v29,v29
v_add_f32 v30,v62,v97
v_exp_f32 v30,v30
v_add_f32 v31,v63,v97
v_exp_f32 v31,v31
v_add_f32 v12,v12,v28
v_add_f32 v12,v12,v29
CV v94,v28,v29
v_add_f32 v12,v12,v30
v_add_f32 v12,v12,v31
CV v95,v30,v31
s_branch L_ret4
L_spin9:
s_mov_b32 s47,0x40000
L_spinl9:
s_sleep 1
buffer_load_dword v112,v118,s[24:27],s3 offen offset:8 sc1
s_waitcnt vmcnt(0)
v_cmp_eq_u32 vcc,0x01010101,v112
s_nop 0
s_cmp_eq_u64 vcc,-1
s_cbranch_scc1 L_spun9
s_sub_u32 s47,s47,1
s_cmp_lg_u32 s47,0
s_cbranch_scc1 L_spinl9
s_branch L_spun9
L_spin10:
s_mov_b32 s47,0x40000
L_spinl10:
s_sleep 1
buffer_load_dword v12,v13,s[24:27],s3 offen offset:2048 sc1
s_waitcnt vmcnt(0)
v_cmp_eq_u32 vcc,1,v12
s_nop 0
s_cmp_eq_u64 vcc,-1
s_cbranch_scc1 L_spun10
s_sub_u32 s47,s47,1
s_cmp_lg_u32 s47,0
s_cbranch_scc1 L_spinl10
s_branch L_spun10
L_spin11:
s_mov_b32 s47,0x40000
L_spinl11:
s_sleep 1
buffer_load_dword v12,v13,s[24:27],s3 offen offset:64 sc1
s_waitcnt vmcnt(0)
v_cmp_eq_u32 vcc,1,v12
s_nop 0
s_cmp_eq_u64 vcc,-1
s_cbranch_scc1 L_spun11
s_sub_u32 s47,s47,1
s_cmp_lg_u32 s47,0
s_cbranch_scc1 L_spinl11
s_branch L_spun11
L_spin13:
s_mov_b32 s47,0x40000
L_spinl13:
s_sleep 1
buffer_load_dword v99,v98,s[24:27],s55 offen offset:64 sc1
s_waitcnt vmcnt(0)
v_cmp_eq_u32 vcc,1,v99
s_nop 0
s_cmp_eq_u64 vcc,-1
s_cbranch_scc1 L_spun13
s_sub_u32 s47,s47,1
s_cmp_lg_u32 s47,0
s_cbranch_scc1 L_spinl13
s_branch L_spun13
L_acq13:
buffer_inv sc1
s_waitcnt vmcnt(0)
s_branch L_acqd13
L_rare10:
v_max3_f32 v97,v36,v37,v38
v_max_f32 v97,v97,v39
v_max3_f32 v97,v97,v44,v45
v_max3_f32 v97,v97,v46,v47
v_max3_f32 v97,v97,v52,v53
v_max3_f32 v97,v97,v54,v55
v_max3_f32 v97,v97,v60,v61
v_max3_f32 v97,v97,v62,v63
v_mov_b32 v13,v97
s_nop 1
v_permlane16_swap_b32 v97,v13
v_max_f32 v97,v97,v13
v_mov_b32 v13,v97
s_nop 1
v_permlane32_swap_b32 v97,v13
v_max_f32 v97,v97,v13
v_max_f32 v97,0,v97
v_sub_f32 v97,0,v97
v_exp_f32 v13,v97
v_add_f32 v20,v20,v97
v_add_f32 v21,v21,v97
v_add_f32 v22,v22,v97
v_add_f32 v23,v23,v97
v_mul_f32 v9,v9,v13
v_mul_f32 v132,v132,v13
v_mul_f32 v133,v133,v13
v_mul_f32 v134,v134,v13
v_mul_f32 v135,v135,v13
v_mul_f32 v140,v140,v13
v_mul_f32 v141,v141,v13
v_mul_f32 v142,v142,v13
v_mul_f32 v143,v143,v13
v_mul_f32 v148,v148,v13
v_mul_f32 v149,v149,v13
v_mul_f32 v150,v150,v13
v_mul_f32 v151,v151,v13
v_mul_f32 v156,v156,v13
v_mul_f32 v157,v157,v13
v_mul_f32 v158,v158,v13
v_mul_f32 v159,v159,v13
v_mul_f32 v164,v164,v13
v_mul_f32 v165,v165,v13
v_mul_f32 v166,v166,v13
v_mul_f32 v167,v167,v13
v_mul_f32 v172,v172,v13
v_mul_f32 v173,v173,v13
v_mul_f32 v174,v174,v13
v_mul_f32 v175,v175,v13
v_mul_f32 v180,v180,v13
v_mul_f32 v181,v181,v13
v_mul_f32 v182,v182,v13
v_mul_f32 v183,v183,v13
v_mul_f32 v188,v188,v13
v_mul_f32 v189,v189,v13
v_mul_f32 v190,v190,v13
v_mul_f32 v191,v191,v13
v_mul_f32 v196,v196,v13
v_mul_f32 v197,v197,v13
v_mul_f32 v198,v198,v13
v_mul_f32 v199,v199,v13
v_mul_f32 v204,v204,v13
v_mul_f32 v205,v205,v13
v_mul_f32 v206,v206,v13
v_mul_f32 v207,v207,v13
v_mul_f32 v212,v212,v13
v_mul_f32 v213,v213,v13
v_mul_f32 v214,v214,v13
v_mul_f32 v215,v215,v13
v_mul_f32 v220,v220,v13
v_mul_f32 v221,v221,v13
v_mul_f32 v222,v222,v13
v_mul_f32 v223,v223,v13
v_mul_f32 v228,v228,v13
v_mul_f32 v229,v229,v13
v_mul_f32 v230,v230,v13
v_mul_f32 v231,v231,v13
v_mul_f32 v236,v236,v13
v_mul_f32 v237,v237,v13
v_mul_f32 v238,v238,v13
v_mul_f32 v239,v239,v13
v_mul_f32 v244,v244,v13
v_mul_f32 v245,v245,v13
v_mul_f32 v246,v246,v13
v_mul_f32 v247,v247,v13
v_mul_f32 v252,v252,v13
v_mul_f32 v253,v253,v13
v_mul_f32 v254,v254,v13
v_mul_f32 v255,v255,v13
v_add_f32 v24,v36,v97
v_exp_f32 v24,v24
v_add_f32 v25,v37,v97
v_exp_f32 v25,v25
v_add_f32 v26,v38,v97
v_exp_f32 v26,v26
v_add_f32 v27,v39,v97
v_exp_f32 v27,v27
v_add_f32 v12,v24,v25
CV v84,v24,v25
v_add_f32 v12,v12,v26
v_add_f32 v12,v12,v27
CV v85,v26,v27
v_add_f32 v28,v44,v97
v_exp_f32 v28,v28
v_add_f32 v29,v45,v97
v_exp_f32 v29,v29
v_add_f32 v30,v46,v97
v_exp_f32 v30,v30
v_add_f32 v31,v47,v97
v_exp_f32 v31,v31
v_add_f32 v12,v12,v28
v_add_f32 v12,v12,v29
CV v86,v28,v29
v_add_f32 v12,v12,v30
v_add_f32 v12,v12,v31
CV v87,v30,v31
v_add_f32 v24,v52,v97
v_exp_f32 v24,v24
v_add_f32 v25,v53,v97
v_exp_f32 v25,v25
v_add_f32 v26,v54,v97
v_exp_f32 v26,v26
v_add_f32 v27,v55,v97
v_exp_f32 v27,v27
v_add_f32 v12,v12,v24
v_add_f32 v12,v12,v25
CV v92,v24,v25
v_add_f32 v12,v12,v26
v_add_f32 v12,v12,v27
CV v93,v26,v27
v_add_f32 v28,v60,v97
v_exp_f32 v28,v28
v_add_f32 v29,v61,v97
v_exp_f32 v29,v29
v_add_f32 v30,v62,v97
v_exp_f32 v30,v30
v_add_f32 v31,v63,v97
v_exp_f32 v31,v31
v_add_f32 v12,v12,v28
v_add_f32 v12,v12,v29
CV v94,v28,v29
v_add_f32 v12,v12,v30
v_add_f32 v12,v12,v31
CV v95,v30,v31
s_branch L_ret10
L_spin12:
s_mov_b32 s47,0x40000
L_spinl12:
s_sleep 1
buffer_load_dword v99,v98,s[24:27],s55 offen offset:64 sc1
s_waitcnt vmcnt(0)
v_cmp_eq_u32 vcc,1,v99
s_nop 0
s_cmp_eq_u64 vcc,-1
s_cbranch_scc1 L_spun12
s_sub_u32 s47,s47,1
s_cmp_lg_u32 s47,0
s_cbranch_scc1 L_spinl12
s_branch L_spun12
L_acq12:
buffer_inv sc1
s_waitcnt vmcnt(0)
s_branch L_acqd12
L_rare5:
v_max3_f32 v96,v32,v33,v34
v_max_f32 v96,v96,v35
v_max3_f32 v96,v96,v40,v41
v_max3_f32 v96,v96,v42,v43
v_max3_f32 v96,v96,v48,v49
v_max3_f32 v96,v96,v50,v51
v_max3_f32 v96,v96,v56,v57
v_max3_f32 v96,v96,v58,v59
v_mov_b32 v13,v96
s_nop 1
v_permlane16_swap_b32 v96,v13
v_max_f32 v96,v96,v13
v_mov_b32 v13,v96
s_nop 1
v_permlane32_swap_b32 v96,v13
v_max_f32 v96,v96,v13
v_max_f32 v96,0,v96
v_sub_f32 v96,0,v96
v_exp_f32 v13,v96
v_add_f32 v16,v16,v96
v_add_f32 v17,v17,v96
v_add_f32 v18,v18,v96
v_add_f32 v19,v19,v96
v_mul_f32 v8,v8,v13
v_mul_f32 v128,v128,v13
v_mul_f32 v129,v129,v13
v_mul_f32 v130,v130,v13
v_mul_f32 v131,v131,v13
v_mul_f32 v136,v136,v13
v_mul_f32 v137,v137,v13
v_mul_f32 v138,v138,v13
v_mul_f32 v139,v139,v13
v_mul_f32 v144,v144,v13
v_mul_f32 v145,v145,v13
v_mul_f32 v146,v146,v13
v_mul_f32 v147,v147,v13
v_mul_f32 v152,v152,v13
v_mul_f32 v153,v153,v13
v_mul_f32 v154,v154,v13
v_mul_f32 v155,v155,v13
v_mul_f32 v160,v160,v13
v_mul_f32 v161,v161,v13
v_mul_f32 v162,v162,v13
v_mul_f32 v163,v163,v13
v_mul_f32 v168,v168,v13
v_mul_f32 v169,v169,v13
v_mul_f32 v170,v170,v13
v_mul_f32 v171,v171,v13
v_mul_f32 v176,v176,v13
v_mul_f32 v177,v177,v13
v_mul_f32 v178,v178,v13
v_mul_f32 v179,v179,v13
v_mul_f32 v184,v184,v13
v_mul_f32 v185,v185,v13
v_mul_f32 v186,v186,v13
v_mul_f32 v187,v187,v13
v_mul_f32 v192,v192,v13
v_mul_f32 v193,v193,v13
v_mul_f32 v194,v194,v13
v_mul_f32 v195,v195,v13
v_mul_f32 v200,v200,v13
v_mul_f32 v201,v201,v13
v_mul_f32 v202,v202,v13
v_mul_f32 v203,v203,v13
v_mul_f32 v208,v208,v13
v_mul_f32 v209,v209,v13
v_mul_f32 v210,v210,v13
v_mul_f32 v211,v211,v13
v_mul_f32 v216,v216,v13
v_mul_f32 v217,v217,v13
v_mul_f32 v218,v218,v13
v_mul_f32 v219,v219,v13
v_mul_f32 v224,v224,v13
v_mul_f32 v225,v225,v13
v_mul_f32 v226,v226,v13
v_mul_f32 v227,v227,v13
v_mul_f32 v232,v232,v13
v_mul_f32 v233,v233,v13
v_mul_f32 v234,v234,v13
v_mul_f32 v235,v235,v13
v_mul_f32 v240,v240,v13
v_mul_f32 v241,v241,v13
v_mul_f32 v242,v242,v13
v_mul_f32 v243,v243,v13
v_mul_f32 v248,v248,v13
v_mul_f32 v249,v249,v13
v_mul_f32 v250,v250,v13
v_mul_f32 v251,v251,v13
v_add_f32 v24,v32,v96
v_exp_f32 v24,v24
v_add_f32 v25,v33,v96
v_exp_f32 v25,v25
v_add_f32 v26,v34,v96
v_exp_f32 v26,v26
v_add_f32 v27,v35,v96
v_exp_f32 v27,v27
v_add_f32 v10,v24,v25
CV v64,v24,v25
v_add_f32 v10,v10,v26
v_add_f32 v10,v10,v27
CV v65,v26,v27
v_add_f32 v28,v40,v96
v_exp_f32 v28,v28
v_add_f32 v29,v41,v96
v_exp_f32 v29,v29
v_add_f32 v30,v42,v96
v_exp_f32 v30,v30
v_add_f32 v31,v43,v96
v_exp_f32 v31,v31
v_add_f32 v10,v10,v28
v_add_f32 v10,v10,v29
CV v66,v28,v29
v_add_f32 v10,v10,v30
v_add_f32 v10,v10,v31
CV v67,v30,v31
v_add_f32 v24,v48,v96
v_exp_f32 v24,v24
v_add_f32 v25,v49,v96
v_exp_f32 v25,v25
v_add_f32 v26,v50,v96
v_exp_f32 v26,v26
v_add_f32 v27,v51,v96
v_exp_f32 v27,v27
v_add_f32 v10,v10,v24
v_add_f32 v10,v10,v25
CV v72,v24,v25
v_add_f32 v10,v10,v26
v_add_f32 v10,v10,v27
CV v73,v26,v27
v_add_f32 v28,v56,v96
v_exp_f32 v28,v28
v_add_f32 v29,v57,v96
v_exp_f32 v29,v29
v_add_f32 v30,v58,v96
v_exp_f32 v30,v30
v_add_f32 v31,v59,v96
v_exp_f32 v31,v31
v_add_f32 v10,v10,v28
v_add_f32 v10,v10,v29
CV v74,v28,v29
v_add_f32 v10,v10,v30
v_add_f32 v10,v10,v31
CV v75,v30,v31
v_max3_f32 v97,v36,v37,v38
v_max_f32 v97,v97,v39
v_max3_f32 v97,v97,v44,v45
v_max3_f32 v97,v97,v46,v47
v_max3_f32 v97,v97,v52,v53
v_max3_f32 v97,v97,v54,v55
v_max3_f32 v97,v97,v60,v61
v_max3_f32 v97,v97,v62,v63
v_mov_b32 v13,v97
s_nop 1
v_permlane16_swap_b32 v97,v13
v_max_f32 v97,v97,v13
v_mov_b32 v13,v97
s_nop 1
v_permlane32_swap_b32 v97,v13
v_max_f32 v97,v97,v13
v_max_f32 v97,0,v97
v_sub_f32 v97,0,v97
v_exp_f32 v13,v97
v_add_f32 v20,v20,v97
v_add_f32 v21,v21,v97
v_add_f32 v22,v22,v97
v_add_f32 v23,v23,v97
v_mul_f32 v9,v9,v13
v_mul_f32 v132,v132,v13
v_mul_f32 v133,v133,v13
v_mul_f32 v134,v134,v13
v_mul_f32 v135,v135,v13
v_mul_f32 v140,v140,v13
v_mul_f32 v141,v141,v13
v_mul_f32 v142,v142,v13
v_mul_f32 v143,v143,v13
v_mul_f32 v148,v148,v13
v_mul_f32 v149,v149,v13
v_mul_f32 v150,v150,v13
v_mul_f32 v151,v151,v13
v_mul_f32 v156,v156,v13
v_mul_f32 v157,v157,v13
v_mul_f32 v158,v158,v13
v_mul_f32 v159,v159,v13
v_mul_f32 v164,v164,v13
v_mul_f32 v165,v165,v13
v_mul_f32 v166,v166,v13
v_mul_f32 v167,v167,v13
v_mul_f32 v172,v172,v13
v_mul_f32 v173,v173,v13
v_mul_f32 v174,v174,v13
v_mul_f32 v175,v175,v13
v_mul_f32 v180,v180,v13
v_mul_f32 v181,v181,v13
v_mul_f32 v182,v182,v13
v_mul_f32 v183,v183,v13
v_mul_f32 v188,v188,v13
v_mul_f32 v189,v189,v13
v_mul_f32 v190,v190,v13
v_mul_f32 v191,v191,v13
v_mul_f32 v196,v196,v13
v_mul_f32 v197,v197,v13
v_mul_f32 v198,v198,v13
v_mul_f32 v199,v199,v13
v_mul_f32 v204,v204,v13
v_mul_f32 v205,v205,v13
v_mul_f32 v206,v206,v13
v_mul_f32 v207,v207,v13
v_mul_f32 v212,v212,v13
v_mul_f32 v213,v213,v13
v_mul_f32 v214,v214,v13
v_mul_f32 v215,v215,v13
v_mul_f32 v220,v220,v13
v_mul_f32 v221,v221,v13
v_mul_f32 v222,v222,v13
v_mul_f32 v223,v223,v13
v_mul_f32 v228,v228,v13
v_mul_f32 v229,v229,v13
v_mul_f32 v230,v230,v13
v_mul_f32 v231,v231,v13
v_mul_f32 v236,v236,v13
v_mul_f32 v237,v237,v13
v_mul_f32 v238,v238,v13
v_mul_f32 v239,v239,v13
v_mul_f32 v244,v244,v13
v_mul_f32 v245,v245,v13
v_mul_f32 v246,v246,v13
v_mul_f32 v247,v247,v13
v_mul_f32 v252,v252,v13
v_mul_f32 v253,v253,v13
v_mul_f32 v254,v254,v13
v_mul_f32 v255,v255,v13
v_add_f32 v24,v36,v97
v_exp_f32 v24,v24
v_add_f32 v25,v37,v97
v_exp_f32 v25,v25
v_add_f32 v26,v38,v97
v_exp_f32 v26,v26
v_add_f32 v27,v39,v97
v_exp_f32 v27,v27
v_add_f32 v12,v24,v25
CV v68,v24,v25
v_add_f32 v12,v12,v26
v_add_f32 v12,v12,v27
CV v69,v26,v27
v_add_f32 v28,v44,v97
v_exp_f32 v28,v28
v_add_f32 v29,v45,v97
v_exp_f32 v29,v29
v_add_f32 v30,v46,v97
v_exp_f32 v30,v30
v_add_f32 v31,v47,v97
v_exp_f32 v31,v31
v_add_f32 v12,v12,v28
v_add_f32 v12,v12,v29
CV v70,v28,v29
v_add_f32 v12,v12,v30
v_add_f32 v12,v12,v31
CV v71,v30,v31
v_add_f32 v24,v52,v97
v_exp_f32 v24,v24
v_add_f32 v25,v53,v97
v_exp_f32 v25,v25
v_add_f32 v26,v54,v97
v_exp_f32 v26,v26
v_add_f32 v27,v55,v97
v_exp_f32 v27,v27
v_add_f32 v12,v12,v24
v_add_f32 v12,v12,v25
CV v76,v24,v25
v_add_f32 v12,v12,v26
v_add_f32 v12,v12,v27
CV v77,v26,v27
v_add_f32 v28,v60,v97
v_exp_f32 v28,v28
v_add_f32 v29,v61,v97
v_exp_f32 v29,v29
v_add_f32 v30,v62,v97
v_exp_f32 v30,v30
v_add_f32 v31,v63,v97
v_exp_f32 v31,v31
v_add_f32 v12,v12,v28
v_add_f32 v12,v12,v29
CV v78,v28,v29
v_add_f32 v12,v12,v30
v_add_f32 v12,v12,v31
CV v79,v30,v31
s_branch L_ret5
L_rare6:
v_max3_f32 v97,v36,v37,v38
v_max_f32 v97,v97,v39
v_max3_f32 v97,v97,v44,v45
v_max3_f32 v97,v97,v46,v47
v_max3_f32 v97,v97,v52,v53
v_max3_f32 v97,v97,v54,v55
v_max3_f32 v97,v97,v60,v61
v_max3_f32 v97,v97,v62,v63
v_mov_b32 v13,v97
s_nop 1
v_permlane16_swap_b32 v97,v13
v_max_f32 v97,v97,v13
v_mov_b32 v13,v97
s_nop 1
v_permlane32_swap_b32 v97,v13
v_max_f32 v97,v97,v13
v_max_f32 v97,0,v97
v_sub_f32 v97,0,v97
v_exp_f32 v13,v97
v_add_f32 v20,v20,v97
v_add_f32 v21,v21,v97
v_add_f32 v22,v22,v97
v_add_f32 v23,v23,v97
v_mul_f32 v9,v9,v13
v_mul_f32 v132,v132,v13
v_mul_f32 v133,v133,v13
v_mul_f32 v134,v134,v13
v_mul_f32 v135,v135,v13
v_mul_f32 v140,v140,v13
v_mul_f32 v141,v141,v13
v_mul_f32 v142,v142,v13
v_mul_f32 v143,v143,v13
v_mul_f32 v148,v148,v13
v_mul_f32 v149,v149,v13
v_mul_f32 v150,v150,v13
v_mul_f32 v151,v151,v13
v_mul_f32 v156,v156,v13
v_mul_f32 v157,v157,v13
v_mul_f32 v158,v158,v13
v_mul_f32 v159,v159,v13
v_mul_f32 v164,v164,v13
v_mul_f32 v165,v165,v13
v_mul_f32 v166,v166,v13
v_mul_f32 v167,v167,v13
v_mul_f32 v172,v172,v13
v_mul_f32 v173,v173,v13
v_mul_f32 v174,v174,v13
v_mul_f32 v175,v175,v13
v_mul_f32 v180,v180,v13
v_mul_f32 v181,v181,v13
v_mul_f32 v182,v182,v13
v_mul_f32 v183,v183,v13
v_mul_f32 v188,v188,v13
v_mul_f32 v189,v189,v13
v_mul_f32 v190,v190,v13
v_mul_f32 v191,v191,v13
v_mul_f32 v196,v196,v13
v_mul_f32 v197,v197,v13
v_mul_f32 v198,v198,v13
v_mul_f32 v199,v199,v13
v_mul_f32 v204,v204,v13
v_mul_f32 v205,v205,v13
v_mul_f32 v206,v206,v13
v_mul_f32 v207,v207,v13
v_mul_f32 v212,v212,v13
v_mul_f32 v213,v213,v13
v_mul_f32 v214,v214,v13
v_mul_f32 v215,v215,v13
v_mul_f32 v220,v220,v13
v_mul_f32 v221,v221,v13
v_mul_f32 v222,v222,v13
v_mul_f32 v223,v223,v13
v_mul_f32 v228,v228,v13
v_mul_f32 v229,v229,v13
v_mul_f32 v230,v230,v13
v_mul_f32 v231,v231,v13
v_mul_f32 v236,v236,v13
v_mul_f32 v237,v237,v13
v_mul_f32 v238,v238,v13
v_mul_f32 v239,v239,v13
v_mul_f32 v244,v244,v13
v_mul_f32 v245,v245,v13
v_mul_f32 v246,v246,v13
v_mul_f32 v247,v247,v13
v_mul_f32 v252,v252,v13
v_mul_f32 v253,v253,v13
v_mul_f32 v254,v254,v13
v_mul_f32 v255,v255,v13
v_add_f32 v24,v36,v97
v_exp_f32 v24,v24
v_add_f32 v25,v37,v97
v_exp_f32 v25,v25
v_add_f32 v26,v38,v97
v_exp_f32 v26,v26
v_add_f32 v27,v39,v97
v_exp_f32 v27,v27
v_add_f32 v12,v24,v25
CV v84,v24,v25
v_add_f32 v12,v12,v26
v_add_f32 v12,v12,v27
CV v85,v26,v27
v_add_f32 v28,v44,v97
v_exp_f32 v28,v28
v_add_f32 v29,v45,v97
v_exp_f32 v29,v29
v_add_f32 v30,v46,v97
v_exp_f32 v30,v30
v_add_f32 v31,v47,v97
v_exp_f32 v31,v31
v_add_f32 v12,v12,v28
v_add_f32 v12,v12,v29
CV v86,v28,v29
v_add_f32 v12,v12,v30
v_add_f32 v12,v12,v31
CV v87,v30,v31
v_add_f32 v24,v52,v97
v_exp_f32 v24,v24
v_add_f32 v25,v53,v97
v_exp_f32 v25,v25
v_add_f32 v26,v54,v97
v_exp_f32 v26,v26
v_add_f32 v27,v55,v97
v_exp_f32 v27,v27
v_add_f32 v12,v12,v24
v_add_f32 v12,v12,v25
CV v92,v24,v25
v_add_f32 v12,v12,v26
v_add_f32 v12,v12,v27
CV v93,v26,v27
v_add_f32 v28,v60,v97
v_exp_f32 v28,v28
v_add_f32 v29,v61,v97
v_exp_f32 v29,v29
v_add_f32 v30,v62,v97
v_exp_f32 v30,v30
v_add_f32 v31,v63,v97
v_exp_f32 v31,v31
v_add_f32 v12,v12,v28
v_add_f32 v12,v12,v29
CV v94,v28,v29
v_add_f32 v12,v12,v30
v_add_f32 v12,v12,v31
CV v95,v30,v31
s_branch L_ret6
L_rare7:
v_max3_f32 v96,v32,v33,v34
v_max_f32 v96,v96,v35
v_max3_f32 v96,v96,v40,v41
v_max3_f32 v96,v96,v42,v43
v_max3_f32 v96,v96,v48,v49
v_max3_f32 v96,v96,v50,v51
v_max3_f32 v96,v96,v56,v57
v_max3_f32 v96,v96,v58,v59
v_mov_b32 v13,v96
s_nop 1
v_permlane16_swap_b32 v96,v13
v_max_f32 v96,v96,v13
v_mov_b32 v13,v96
s_nop 1
v_permlane32_swap_b32 v96,v13
v_max_f32 v96,v96,v13
v_max_f32 v96,0,v96
v_sub_f32 v96,0,v96
v_exp_f32 v13,v96
v_add_f32 v16,v16,v96
v_add_f32 v17,v17,v96
v_add_f32 v18,v18,v96
v_add_f32 v19,v19,v96
v_mul_f32 v8,v8,v13
v_mul_f32 v128,v128,v13
v_mul_f32 v129,v129,v13
v_mul_f32 v130,v130,v13
v_mul_f32 v131,v131,v13
v_mul_f32 v136,v136,v13
v_mul_f32 v137,v137,v13
v_mul_f32 v138,v138,v13
v_mul_f32 v139,v139,v13
v_mul_f32 v144,v144,v13
v_mul_f32 v145,v145,v13
v_mul_f32 v146,v146,v13
v_mul_f32 v147,v147,v13
v_mul_f32 v152,v152,v13
v_mul_f32 v153,v153,v13
v_mul_f32 v154,v154,v13
v_mul_f32 v155,v155,v13
v_mul_f32 v160,v160,v13
v_mul_f32 v161,v161,v13
v_mul_f32 v162,v162,v13
v_mul_f32 v163,v163,v13
v_mul_f32 v168,v168,v13
v_mul_f32 v169,v169,v13
v_mul_f32 v170,v170,v13
v_mul_f32 v171,v171,v13
v_mul_f32 v176,v176,v13
v_mul_f32 v177,v177,v13
v_mul_f32 v178,v178,v13
v_mul_f32 v179,v179,v13
v_mul_f32 v184,v184,v13
v_mul_f32 v185,v185,v13
v_mul_f32 v186,v186,v13
v_mul_f32 v187,v187,v13
v_mul_f32 v192,v192,v13
v_mul_f32 v193,v193,v13
v_mul_f32 v194,v194,v13
v_mul_f32 v195,v195,v13
v_mul_f32 v200,v200,v13
v_mul_f32 v201,v201,v13
v_mul_f32 v202,v202,v13
v_mul_f32 v203,v203,v13
v_mul_f32 v208,v208,v13
v_mul_f32 v209,v209,v13
v_mul_f32 v210,v210,v13
v_mul_f32 v211,v211,v13
v_mul_f32 v216,v216,v13
v_mul_f32 v217,v217,v13
v_mul_f32 v218,v218,v13
v_mul_f32 v219,v219,v13
v_mul_f32 v224,v224,v13
v_mul_f32 v225,v225,v13
v_mul_f32 v226,v226,v13
v_mul_f32 v227,v227,v13
v_mul_f32 v232,v232,v13
v_mul_f32 v233,v233,v13
v_mul_f32 v234,v234,v13
v_mul_f32 v235,v235,v13
v_mul_f32 v240,v240,v13
v_mul_f32 v241,v241,v13
v_mul_f32 v242,v242,v13
v_mul_f32 v243,v243,v13
v_mul_f32 v248,v248,v13
v_mul_f32 v249,v249,v13
v_mul_f32 v250,v250,v13
v_mul_f32 v251,v251,v13
v_add_f32 v24,v32,v96
v_exp_f32 v24,v24
v_add_f32 v25,v33,v96
v_exp_f32 v25,v25
v_add_f32 v26,v34,v96
v_exp_f32 v26,v26
v_add_f32 v27,v35,v96
v_exp_f32 v27,v27
v_add_f32 v10,v24,v25
CV v80,v24,v25
v_add_f32 v10,v10,v26
v_add_f32 v10,v10,v27
CV v81,v26,v27
v_add_f32 v28,v40,v96
v_exp_f32 v28,v28
v_add_f32 v29,v41,v96
v_exp_f32 v29,v29
v_add_f32 v30,v42,v96
v_exp_f32 v30,v30
v_add_f32 v31,v43,v96
v_exp_f32 v31,v31
v_add_f32 v10,v10,v28
v_add_f32 v10,v10,v29
CV v82,v28,v29
v_add_f32 v10,v10,v30
v_add_f32 v10,v10,v31
CV v83,v30,v31
v_add_f32 v24,v48,v96
v_exp_f32 v24,v24
v_add_f32 v25,v49,v96
v_exp_f32 v25,v25
v_add_f32 v26,v50,v96
v_exp_f32 v26,v26
v_add_f32 v27,v51,v96
v_exp_f32 v27,v27
v_add_f32 v10,v10,v24
v_add_f32 v10,v10,v25
CV v88,v24,v25
v_add_f32 v10,v10,v26
v_add_f32 v10,v10,v27
CV v89,v26,v27
v_add_f32 v28,v56,v96
v_exp_f32 v28,v28
v_add_f32 v29,v57,v96
v_exp_f32 v29,v29
v_add_f32 v30,v58,v96
v_exp_f32 v30,v30
v_add_f32 v31,v59,v96
v_exp_f32 v31,v31
v_add_f32 v10,v10,v28
v_add_f32 v10,v10,v29
CV v90,v28,v29
v_add_f32 v10,v10,v30
v_add_f32 v10,v10,v31
CV v91,v30,v31
v_max3_f32 v97,v36,v37,v38
v_max_f32 v97,v97,v39
v_max3_f32 v97,v97,v44,v45
v_max3_f32 v97,v97,v46,v47
v_max3_f32 v97,v97,v52,v53
v_max3_f32 v97,v97,v54,v55
v_max3_f32 v97,v97,v60,v61
v_max3_f32 v97,v97,v62,v63
v_mov_b32 v13,v97
s_nop 1
v_permlane16_swap_b32 v97,v13
v_max_f32 v97,v97,v13
v_mov_b32 v13,v97
s_nop 1
v_permlane32_swap_b32 v97,v13
v_max_f32 v97,v97,v13
v_max_f32 v97,0,v97
v_sub_f32 v97,0,v97
v_exp_f32 v13,v97
v_add_f32 v20,v20,v97
v_add_f32 v21,v21,v97
v_add_f32 v22,v22,v97
v_add_f32 v23,v23,v97
v_mul_f32 v9,v9,v13
v_mul_f32 v132,v132,v13
v_mul_f32 v133,v133,v13
v_mul_f32 v134,v134,v13
v_mul_f32 v135,v135,v13
v_mul_f32 v140,v140,v13
v_mul_f32 v141,v141,v13
v_mul_f32 v142,v142,v13
v_mul_f32 v143,v143,v13
v_mul_f32 v148,v148,v13
v_mul_f32 v149,v149,v13
v_mul_f32 v150,v150,v13
v_mul_f32 v151,v151,v13
v_mul_f32 v156,v156,v13
v_mul_f32 v157,v157,v13
v_mul_f32 v158,v158,v13
v_mul_f32 v159,v159,v13
v_mul_f32 v164,v164,v13
v_mul_f32 v165,v165,v13
v_mul_f32 v166,v166,v13
v_mul_f32 v167,v167,v13
v_mul_f32 v172,v172,v13
v_mul_f32 v173,v173,v13
v_mul_f32 v174,v174,v13
v_mul_f32 v175,v175,v13
v_mul_f32 v180,v180,v13
v_mul_f32 v181,v181,v13
v_mul_f32 v182,v182,v13
v_mul_f32 v183,v183,v13
v_mul_f32 v188,v188,v13
v_mul_f32 v189,v189,v13
v_mul_f32 v190,v190,v13
v_mul_f32 v191,v191,v13
v_mul_f32 v196,v196,v13
v_mul_f32 v197,v197,v13
v_mul_f32 v198,v198,v13
v_mul_f32 v199,v199,v13
v_mul_f32 v204,v204,v13
v_mul_f32 v205,v205,v13
v_mul_f32 v206,v206,v13
v_mul_f32 v207,v207,v13
v_mul_f32 v212,v212,v13
v_mul_f32 v213,v213,v13
v_mul_f32 v214,v214,v13
v_mul_f32 v215,v215,v13
v_mul_f32 v220,v220,v13
v_mul_f32 v221,v221,v13
v_mul_f32 v222,v222,v13
v_mul_f32 v223,v223,v13
v_mul_f32 v228,v228,v13
v_mul_f32 v229,v229,v13
v_mul_f32 v230,v230,v13
v_mul_f32 v231,v231,v13
v_mul_f32 v236,v236,v13
v_mul_f32 v237,v237,v13
v_mul_f32 v238,v238,v13
v_mul_f32 v239,v239,v13
v_mul_f32 v244,v244,v13
v_mul_f32 v245,v245,v13
v_mul_f32 v246,v246,v13
v_mul_f32 v247,v247,v13
v_mul_f32 v252,v252,v13
v_mul_f32 v253,v253,v13
v_mul_f32 v254,v254,v13
v_mul_f32 v255,v255,v13
v_add_f32 v24,v36,v97
v_exp_f32 v24,v24
v_add_f32 v25,v37,v97
v_exp_f32 v25,v25
v_add_f32 v26,v38,v97
v_exp_f32 v26,v26
v_add_f32 v27,v39,v97
v_exp_f32 v27,v27
v_add_f32 v12,v24,v25
CV v84,v24,v25
v_add_f32 v12,v12,v26
v_add_f32 v12,v12,v27
CV v85,v26,v27
v_add_f32 v28,v44,v97
v_exp_f32 v28,v28
v_add_f32 v29,v45,v97
v_exp_f32 v29,v29
v_add_f32 v30,v46,v97
v_exp_f32 v30,v30
v_add_f32 v31,v47,v97
v_exp_f32 v31,v31
v_add_f32 v12,v12,v28
v_add_f32 v12,v12,v29
CV v86,v28,v29
v_add_f32 v12,v12,v30
v_add_f32 v12,v12,v31
CV v87,v30,v31
v_add_f32 v24,v52,v97
v_exp_f32 v24,v24
v_add_f32 v25,v53,v97
v_exp_f32 v25,v25
v_add_f32 v26,v54,v97
v_exp_f32 v26,v26
v_add_f32 v27,v55,v97
v_exp_f32 v27,v27
v_add_f32 v12,v12,v24
v_add_f32 v12,v12,v25
CV v92,v24,v25
v_add_f32 v12,v12,v26
v_add_f32 v12,v12,v27
CV v93,v26,v27
v_add_f32 v28,v60,v97
v_exp_f32 v28,v28
v_add_f32 v29,v61,v97
v_exp_f32 v29,v29
v_add_f32 v30,v62,v97
v_exp_f32 v30,v30
v_add_f32 v31,v63,v97
v_exp_f32 v31,v31
v_add_f32 v12,v12,v28
v_add_f32 v12,v12,v29
CV v94,v28,v29
v_add_f32 v12,v12,v30
v_add_f32 v12,v12,v31
CV v95,v30,v31
s_branch L_ret7
L_rare8:
v_max3_f32 v96,v32,v33,v34
v_max_f32 v96,v96,v35
v_max3_f32 v96,v96,v40,v41
v_max3_f32 v96,v96,v42,v43
v_max3_f32 v96,v96,v48,v49
v_max3_f32 v96,v96,v50,v51
v_max3_f32 v96,v96,v56,v57
v_max3_f32 v96,v96,v58,v59
v_mov_b32 v13,v96
s_nop 1
v_permlane16_swap_b32 v96,v13
v_max_f32 v96,v96,v13
v_mov_b32 v13,v96
s_nop 1
v_permlane32_swap_b32 v96,v13
v_max_f32 v96,v96,v13
v_max_f32 v96,0,v96
v_sub_f32 v96,0,v96
v_exp_f32 v13,v96
v_add_f32 v16,v16,v96
v_add_f32 v17,v17,v96
v_add_f32 v18,v18,v96
v_add_f32 v19,v19,v96
v_mul_f32 v8,v8,v13
v_mul_f32 v128,v128,v13
v_mul_f32 v129,v129,v13
v_mul_f32 v130,v130,v13
v_mul_f32 v131,v131,v13
v_mul_f32 v136,v136,v13
v_mul_f32 v137,v137,v13
v_mul_f32 v138,v138,v13
v_mul_f32 v139,v139,v13
v_mul_f32 v144,v144,v13
v_mul_f32 v145,v145,v13
v_mul_f32 v146,v146,v13
v_mul_f32 v147,v147,v13
v_mul_f32 v152,v152,v13
v_mul_f32 v153,v153,v13
v_mul_f32 v154,v154,v13
v_mul_f32 v155,v155,v13
v_mul_f32 v160,v160,v13
v_mul_f32 v161,v161,v13
v_mul_f32 v162,v162,v13
v_mul_f32 v163,v163,v13
v_mul_f32 v168,v168,v13
v_mul_f32 v169,v169,v13
v_mul_f32 v170,v170,v13
v_mul_f32 v171,v171,v13
v_mul_f32 v176,v176,v13
v_mul_f32 v177,v177,v13
v_mul_f32 v178,v178,v13
v_mul_f32 v179,v179,v13
v_mul_f32 v184,v184,v13
v_mul_f32 v185,v185,v13
v_mul_f32 v186,v186,v13
v_mul_f32 v187,v187,v13
v_mul_f32 v192,v192,v13
v_mul_f32 v193,v193,v13
v_mul_f32 v194,v194,v13
v_mul_f32 v195,v195,v13
v_mul_f32 v200,v200,v13
v_mul_f32 v201,v201,v13
v_mul_f32 v202,v202,v13
v_mul_f32 v203,v203,v13
v_mul_f32 v208,v208,v13
v_mul_f32 v209,v209,v13
v_mul_f32 v210,v210,v13
v_mul_f32 v211,v211,v13
v_mul_f32 v216,v216,v13
v_mul_f32 v217,v217,v13
v_mul_f32 v218,v218,v13
v_mul_f32 v219,v219,v13
v_mul_f32 v224,v224,v13
v_mul_f32 v225,v225,v13
v_mul_f32 v226,v226,v13
v_mul_f32 v227,v227,v13
v_mul_f32 v232,v232,v13
v_mul_f32 v233,v233,v13
v_mul_f32 v234,v234,v13
v_mul_f32 v235,v235,v13
v_mul_f32 v240,v240,v13
v_mul_f32 v241,v241,v13
v_mul_f32 v242,v242,v13
v_mul_f32 v243,v243,v13
v_mul_f32 v248,v248,v13
v_mul_f32 v249,v249,v13
v_mul_f32 v250,v250,v13
v_mul_f32 v251,v251,v13
v_add_f32 v24,v32,v96
v_exp_f32 v24,v24
v_add_f32 v25,v33,v96
v_exp_f32 v25,v25
v_add_f32 v26,v34,v96
v_exp_f32 v26,v26
v_add_f32 v27,v35,v96
v_exp_f32 v27,v27
v_add_f32 v10,v24,v25
CV v64,v24,v25
v_add_f32 v10,v10,v26
v_add_f32 v10,v10,v27
CV v65,v26,v27
v_add_f32 v28,v40,v96
v_exp_f32 v28,v28
v_add_f32 v29,v41,v96
v_exp_f32 v29,v29
v_add_f32 v30,v42,v96
v_exp_f32 v30,v30
v_add_f32 v31,v43,v96
v_exp_f32 v31,v31
v_add_f32 v10,v10,v28
v_add_f32 v10,v10,v29
CV v66,v28,v29
v_add_f32 v10,v10,v30
v_add_f32 v10,v10,v31
CV v67,v30,v31
v_add_f32 v24,v48,v96
v_exp_f32 v24,v24
v_add_f32 v25,v49,v96
v_exp_f32 v25,v25
v_add_f32 v26,v50,v96
v_exp_f32 v26,v26
v_add_f32 v27,v51,v96
v_exp_f32 v27,v27
v_add_f32 v10,v10,v24
v_add_f32 v10,v10,v25
CV v72,v24,v25
v_add_f32 v10,v10,v26
v_add_f32 v10,v10,v27
CV v73,v26,v27
v_add_f32 v28,v56,v96
v_exp_f32 v28,v28
v_add_f32 v29,v57,v96
v_exp_f32 v29,v29
v_add_f32 v30,v58,v96
v_exp_f32 v30,v30
v_add_f32 v31,v59,v96
v_exp_f32 v31,v31
v_add_f32 v10,v10,v28
v_add_f32 v10,v10,v29
CV v74,v28,v29
v_add_f32 v10,v10,v30
v_add_f32 v10,v10,v31
CV v75,v30,v31
v_max3_f32 v97,v36,v37,v38
v_max_f32 v97,v97,v39
v_max3_f32 v97,v97,v44,v45
v_max3_f32 v97,v97,v46,v47
v_max3_f32 v97,v97,v52,v53
v_max3_f32 v97,v97,v54,v55
v_max3_f32 v97,v97,v60,v61
v_max3_f32 v97,v97,v62,v63
v_mov_b32 v13,v97
s_nop 1
v_permlane16_swap_b32 v97,v13
v_max_f32 v97,v97,v13
v_mov_b32 v13,v97
s_nop 1
v_permlane32_swap_b32 v97,v13
v_max_f32 v97,v97,v13
v_max_f32 v97,0,v97
v_sub_f32 v97,0,v97
v_exp_f32 v13,v97
v_add_f32 v20,v20,v97
v_add_f32 v21,v21,v97
v_add_f32 v22,v22,v97
v_add_f32 v23,v23,v97
v_mul_f32 v9,v9,v13
v_mul_f32 v132,v132,v13
v_mul_f32 v133,v133,v13
v_mul_f32 v134,v134,v13
v_mul_f32 v135,v135,v13
v_mul_f32 v140,v140,v13
v_mul_f32 v141,v141,v13
v_mul_f32 v142,v142,v13
v_mul_f32 v143,v143,v13
v_mul_f32 v148,v148,v13
v_mul_f32 v149,v149,v13
v_mul_f32 v150,v150,v13
v_mul_f32 v151,v151,v13
v_mul_f32 v156,v156,v13
v_mul_f32 v157,v157,v13
v_mul_f32 v158,v158,v13
v_mul_f32 v159,v159,v13
v_mul_f32 v164,v164,v13
v_mul_f32 v165,v165,v13
v_mul_f32 v166,v166,v13
v_mul_f32 v167,v167,v13
v_mul_f32 v172,v172,v13
v_mul_f32 v173,v173,v13
v_mul_f32 v174,v174,v13
v_mul_f32 v175,v175,v13
v_mul_f32 v180,v180,v13
v_mul_f32 v181,v181,v13
v_mul_f32 v182,v182,v13
v_mul_f32 v183,v183,v13
v_mul_f32 v188,v188,v13
v_mul_f32 v189,v189,v13
v_mul_f32 v190,v190,v13
v_mul_f32 v191,v191,v13
v_mul_f32 v196,v196,v13
v_mul_f32 v197,v197,v13
v_mul_f32 v198,v198,v13
v_mul_f32 v199,v199,v13
v_mul_f32 v204,v204,v13
v_mul_f32 v205,v205,v13
v_mul_f32 v206,v206,v13
v_mul_f32 v207,v207,v13
v_mul_f32 v212,v212,v13
v_mul_f32 v213,v213,v13
v_mul_f32 v214,v214,v13
v_mul_f32 v215,v215,v13
v_mul_f32 v220,v220,v13
v_mul_f32 v221,v221,v13
v_mul_f32 v222,v222,v13
v_mul_f32 v223,v223,v13
v_mul_f32 v228,v228,v13
v_mul_f32 v229,v229,v13
v_mul_f32 v230,v230,v13
v_mul_f32 v231,v231,v13
v_mul_f32 v236,v236,v13
v_mul_f32 v237,v237,v13
v_mul_f32 v238,v238,v13
v_mul_f32 v239,v239,v13
v_mul_f32 v244,v244,v13
v_mul_f32 v245,v245,v13
v_mul_f32 v246,v246,v13
v_mul_f32 v247,v247,v13
v_mul_f32 v252,v252,v13
v_mul_f32 v253,v253,v13
v_mul_f32 v254,v254,v13
v_mul_f32 v255,v255,v13
v_add_f32 v24,v36,v97
v_exp_f32 v24,v24
v_add_f32 v25,v37,v97
v_exp_f32 v25,v25
v_add_f32 v26,v38,v97
v_exp_f32 v26,v26
v_add_f32 v27,v39,v97
v_exp_f32 v27,v27
v_add_f32 v12,v24,v25
CV v68,v24,v25
v_add_f32 v12,v12,v26
v_add_f32 v12,v12,v27
CV v69,v26,v27
v_add_f32 v28,v44,v97
v_exp_f32 v28,v28
v_add_f32 v29,v45,v97
v_exp_f32 v29,v29
v_add_f32 v30,v46,v97
v_exp_f32 v30,v30
v_add_f32 v31,v47,v97
v_exp_f32 v31,v31
v_add_f32 v12,v12,v28
v_add_f32 v12,v12,v29
CV v70,v28,v29
v_add_f32 v12,v12,v30
v_add_f32 v12,v12,v31
CV v71,v30,v31
v_add_f32 v24,v52,v97
v_exp_f32 v24,v24
v_add_f32 v25,v53,v97
v_exp_f32 v25,v25
v_add_f32 v26,v54,v97
v_exp_f32 v26,v26
v_add_f32 v27,v55,v97
v_exp_f32 v27,v27
v_add_f32 v12,v12,v24
v_add_f32 v12,v12,v25
CV v76,v24,v25
v_add_f32 v12,v12,v26
v_add_f32 v12,v12,v27
CV v77,v26,v27
v_add_f32 v28,v60,v97
v_exp_f32 v28,v28
v_add_f32 v29,v61,v97
v_exp_f32 v29,v29
v_add_f32 v30,v62,v97
v_exp_f32 v30,v30
v_add_f32 v31,v63,v97
v_exp_f32 v31,v31
v_add_f32 v12,v12,v28
v_add_f32 v12,v12,v29
CV v78,v28,v29
v_add_f32 v12,v12,v30
v_add_f32 v12,v12,v31
CV v79,v30,v31
s_branch L_ret8
L_rare9:
v_max3_f32 v96,v32,v33,v34
v_max_f32 v96,v96,v35
v_max3_f32 v96,v96,v40,v41
v_max3_f32 v96,v96,v42,v43
v_max3_f32 v96,v96,v48,v49
v_max3_f32 v96,v96,v50,v51
v_max3_f32 v96,v96,v56,v57
v_max3_f32 v96,v96,v58,v59
v_mov_b32 v13,v96
s_nop 1
v_permlane16_swap_b32 v96,v13
v_max_f32 v96,v96,v13
v_mov_b32 v13,v96
s_nop 1
v_permlane32_swap_b32 v96,v13
v_max_f32 v96,v96,v13
v_max_f32 v96,0,v96
v_sub_f32 v96,0,v96
v_exp_f32 v13,v96
v_add_f32 v16,v16,v96
v_add_f32 v17,v17,v96
v_add_f32 v18,v18,v96
v_add_f32 v19,v19,v96
v_mul_f32 v8,v8,v13
v_mul_f32 v128,v128,v13
v_mul_f32 v129,v129,v13
v_mul_f32 v130,v130,v13
v_mul_f32 v131,v131,v13
v_mul_f32 v136,v136,v13
v_mul_f32 v137,v137,v13
v_mul_f32 v138,v138,v13
v_mul_f32 v139,v139,v13
v_mul_f32 v144,v144,v13
v_mul_f32 v145,v145,v13
v_mul_f32 v146,v146,v13
v_mul_f32 v147,v147,v13
v_mul_f32 v152,v152,v13
v_mul_f32 v153,v153,v13
v_mul_f32 v154,v154,v13
v_mul_f32 v155,v155,v13
v_mul_f32 v160,v160,v13
v_mul_f32 v161,v161,v13
v_mul_f32 v162,v162,v13
v_mul_f32 v163,v163,v13
v_mul_f32 v168,v168,v13
v_mul_f32 v169,v169,v13
v_mul_f32 v170,v170,v13
v_mul_f32 v171,v171,v13
v_mul_f32 v176,v176,v13
v_mul_f32 v177,v177,v13
v_mul_f32 v178,v178,v13
v_mul_f32 v179,v179,v13
v_mul_f32 v184,v184,v13
v_mul_f32 v185,v185,v13
v_mul_f32 v186,v186,v13
v_mul_f32 v187,v187,v13
v_mul_f32 v192,v192,v13
v_mul_f32 v193,v193,v13
v_mul_f32 v194,v194,v13
v_mul_f32 v195,v195,v13
v_mul_f32 v200,v200,v13
v_mul_f32 v201,v201,v13
v_mul_f32 v202,v202,v13
v_mul_f32 v203,v203,v13
v_mul_f32 v208,v208,v13
v_mul_f32 v209,v209,v13
v_mul_f32 v210,v210,v13
v_mul_f32 v211,v211,v13
v_mul_f32 v216,v216,v13
v_mul_f32 v217,v217,v13
v_mul_f32 v218,v218,v13
v_mul_f32 v219,v219,v13
v_mul_f32 v224,v224,v13
v_mul_f32 v225,v225,v13
v_mul_f32 v226,v226,v13
v_mul_f32 v227,v227,v13
v_mul_f32 v232,v232,v13
v_mul_f32 v233,v233,v13
v_mul_f32 v234,v234,v13
v_mul_f32 v235,v235,v13
v_mul_f32 v240,v240,v13
v_mul_f32 v241,v241,v13
v_mul_f32 v242,v242,v13
v_mul_f32 v243,v243,v13
v_mul_f32 v248,v248,v13
v_mul_f32 v249,v249,v13
v_mul_f32 v250,v250,v13
v_mul_f32 v251,v251,v13
v_add_f32 v24,v32,v96
v_exp_f32 v24,v24
v_add_f32 v25,v33,v96
v_exp_f32 v25,v25
v_add_f32 v26,v34,v96
v_exp_f32 v26,v26
v_add_f32 v27,v35,v96
v_exp_f32 v27,v27
v_add_f32 v10,v24,v25
CV v80,v24,v25
v_add_f32 v10,v10,v26
v_add_f32 v10,v10,v27
CV v81,v26,v27
v_add_f32 v28,v40,v96
v_exp_f32 v28,v28
v_add_f32 v29,v41,v96
v_exp_f32 v29,v29
v_add_f32 v30,v42,v96
v_exp_f32 v30,v30
v_add_f32 v31,v43,v96
v_exp_f32 v31,v31
v_add_f32 v10,v10,v28
v_add_f32 v10,v10,v29
CV v82,v28,v29
v_add_f32 v10,v10,v30
v_add_f32 v10,v10,v31
CV v83,v30,v31
v_add_f32 v24,v48,v96
v_exp_f32 v24,v24
v_add_f32 v25,v49,v96
v_exp_f32 v25,v25
v_add_f32 v26,v50,v96
v_exp_f32 v26,v26
v_add_f32 v27,v51,v96
v_exp_f32 v27,v27
v_add_f32 v10,v10,v24
v_add_f32 v10,v10,v25
CV v88,v24,v25
v_add_f32 v10,v10,v26
v_add_f32 v10,v10,v27
CV v89,v26,v27
v_add_f32 v28,v56,v96
v_exp_f32 v28,v28
v_add_f32 v29,v57,v96
v_exp_f32 v29,v29
v_add_f32 v30,v58,v96
v_exp_f32 v30,v30
v_add_f32 v31,v59,v96
v_exp_f32 v31,v31
v_add_f32 v10,v10,v28
v_add_f32 v10,v10,v29
CV v90,v28,v29
v_add_f32 v10,v10,v30
v_add_f32 v10,v10,v31
CV v91,v30,v31
v_max3_f32 v97,v36,v37,v38
v_max_f32 v97,v97,v39
v_max3_f32 v97,v97,v44,v45
v_max3_f32 v97,v97,v46,v47
v_max3_f32 v97,v97,v52,v53
v_max3_f32 v97,v97,v54,v55
v_max3_f32 v97,v97,v60,v61
v_max3_f32 v97,v97,v62,v63
v_mov_b32 v13,v97
s_nop 1
v_permlane16_swap_b32 v97,v13
v_max_f32 v97,v97,v13
v_mov_b32 v13,v97
s_nop 1
v_permlane32_swap_b32 v97,v13
v_max_f32 v97,v97,v13
v_max_f32 v97,0,v97
v_sub_f32 v97,0,v97
v_exp_f32 v13,v97
v_add_f32 v20,v20,v97
v_add_f32 v21,v21,v97
v_add_f32 v22,v22,v97
v_add_f32 v23,v23,v97
v_mul_f32 v9,v9,v13
v_mul_f32 v132,v132,v13
v_mul_f32 v133,v133,v13
v_mul_f32 v134,v134,v13
v_mul_f32 v135,v135,v13
v_mul_f32 v140,v140,v13
v_mul_f32 v141,v141,v13
v_mul_f32 v142,v142,v13
v_mul_f32 v143,v143,v13
v_mul_f32 v148,v148,v13
v_mul_f32 v149,v149,v13
v_mul_f32 v150,v150,v13
v_mul_f32 v151,v151,v13
v_mul_f32 v156,v156,v13
v_mul_f32 v157,v157,v13
v_mul_f32 v158,v158,v13
v_mul_f32 v159,v159,v13
v_mul_f32 v164,v164,v13
v_mul_f32 v165,v165,v13
v_mul_f32 v166,v166,v13
v_mul_f32 v167,v167,v13
v_mul_f32 v172,v172,v13
v_mul_f32 v173,v173,v13
v_mul_f32 v174,v174,v13
v_mul_f32 v175,v175,v13
v_mul_f32 v180,v180,v13
v_mul_f32 v181,v181,v13
v_mul_f32 v182,v182,v13
v_mul_f32 v183,v183,v13
v_mul_f32 v188,v188,v13
v_mul_f32 v189,v189,v13
v_mul_f32 v190,v190,v13
v_mul_f32 v191,v191,v13
v_mul_f32 v196,v196,v13
v_mul_f32 v197,v197,v13
v_mul_f32 v198,v198,v13
v_mul_f32 v199,v199,v13
v_mul_f32 v204,v204,v13
v_mul_f32 v205,v205,v13
v_mul_f32 v206,v206,v13
v_mul_f32 v207,v207,v13
v_mul_f32 v212,v212,v13
v_mul_f32 v213,v213,v13
v_mul_f32 v214,v214,v13
v_mul_f32 v215,v215,v13
v_mul_f32 v220,v220,v13
v_mul_f32 v221,v221,v13
v_mul_f32 v222,v222,v13
v_mul_f32 v223,v223,v13
v_mul_f32 v228,v228,v13
v_mul_f32 v229,v229,v13
v_mul_f32 v230,v230,v13
v_mul_f32 v231,v231,v13
v_mul_f32 v236,v236,v13
v_mul_f32 v237,v237,v13
v_mul_f32 v238,v238,v13
v_mul_f32 v239,v239,v13
v_mul_f32 v244,v244,v13
v_mul_f32 v245,v245,v13
v_mul_f32 v246,v246,v13
v_mul_f32 v247,v247,v13
v_mul_f32 v252,v252,v13
v_mul_f32 v253,v253,v13
v_mul_f32 v254,v254,v13
v_mul_f32 v255,v255,v13
v_add_f32 v24,v36,v97
v_exp_f32 v24,v24
v_add_f32 v25,v37,v97
v_exp_f32 v25,v25
v_add_f32 v26,v38,v97
v_exp_f32 v26,v26
v_add_f32 v27,v39,v97
v_exp_f32 v27,v27
v_add_f32 v12,v24,v25
CV v84,v24,v25
v_add_f32 v12,v12,v26
v_add_f32 v12,v12,v27
CV v85,v26,v27
v_add_f32 v28,v44,v97
v_exp_f32 v28,v28
v_add_f32 v29,v45,v97
v_exp_f32 v29,v29
v_add_f32 v30,v46,v97
v_exp_f32 v30,v30
v_add_f32 v31,v47,v97
v_exp_f32 v31,v31
v_add_f32 v12,v12,v28
v_add_f32 v12,v12,v29
CV v86,v28,v29
v_add_f32 v12,v12,v30
v_add_f32 v12,v12,v31
CV v87,v30,v31
v_add_f32 v24,v52,v97
v_exp_f32 v24,v24
v_add_f32 v25,v53,v97
v_exp_f32 v25,v25
v_add_f32 v26,v54,v97
v_exp_f32 v26,v26
v_add_f32 v27,v55,v97
v_exp_f32 v27,v27
v_add_f32 v12,v12,v24
v_add_f32 v12,v12,v25
CV v92,v24,v25
v_add_f32 v12,v12,v26
v_add_f32 v12,v12,v27
CV v93,v26,v27
v_add_f32 v28,v60,v97
v_exp_f32 v28,v28
v_add_f32 v29,v61,v97
v_exp_f32 v29,v29
v_add_f32 v30,v62,v97
v_exp_f32 v30,v30
v_add_f32 v31,v63,v97
v_exp_f32 v31,v31
v_add_f32 v12,v12,v28
v_add_f32 v12,v12,v29
CV v94,v28,v29
v_add_f32 v12,v12,v30
v_add_f32 v12,v12,v31
CV v95,v30,v31
s_branch L_ret9
.section .rodata,"a"
.p2align 6
.amdhsa_kernel concat_heads__spectral_gfnet__compressed_kv_cla__prompt_kernel
  .amdhsa_next_free_vgpr 512
  .amdhsa_next_free_sgpr 102
  .amdhsa_accum_offset 256
  .amdhsa_group_segment_fixed_size 0
  .amdhsa_kernarg_size 96
  .amdhsa_user_sgpr_count 2
  .amdhsa_user_sgpr_kernarg_segment_ptr 1
  .amdhsa_system_sgpr_workgroup_id_x 1
  .amdhsa_float_denorm_mode_32 3
.end_amdhsa_kernel
```
